```python
import torch

def _softmax(x, axis=-1):
    return torch.softmax(x, dim=axis)

def _gelu(x):
    return torch.nn.functional.gelu(x, approximate='tanh')

def _silu(x):
    return torch.nn.functional.silu(x)

def _sigmoid(x):
    return torch.sigmoid(x)

def _layernorm(x, axis=-1, eps=1e-05):
    m = x.mean(dim=axis, keepdim=True)
    v = x.var(dim=axis, keepdim=True, unbiased=False)
    return (x - m) / torch.sqrt(v + eps)

def _scatter_add(tgt, idx, src, axis=0):
    return tgt.clone().index_add_(axis, idx, src)

def _segment_sum(src, seg, n):
    out = torch.zeros((n,) + src.shape[1:], dtype=src.dtype)
    return out.index_add_(0, seg, src)

def _pad(x, pw):
    flat = tuple((v for pair in reversed(pw) for v in pair))
    return torch.nn.functional.pad(x, flat)
kernel_name = 'adaLN_cond__compressed_kv_cla__mixer_token_mlp__prompt'

def setup_inputs():

    _w = lambda a: (lambda t: t.to(torch.bfloat16) if t.is_floating_point() else t)(torch.as_tensor(a))

    def _A_setup():
        B, H, Sq, Sk, D, M = (1, 32, 2048, 2048, 128, 576)
        Dc = 4 * D
        return {'x': _w((lambda *s: torch.randn(*s, dtype=torch.bfloat16) * 0.05)(B, Sq, M)), 'c_kv': _w((lambda *s: torch.randn(*s, dtype=torch.bfloat16) * 0.8)(B, Sk, Dc)), 'w_q': _w((lambda *s: torch.randn(*s, dtype=torch.bfloat16) * 1.6)(M, H, D) * M ** (-0.5)), 'w_uk': _w((lambda *s: torch.randn(*s, dtype=torch.bfloat16) * 1.6)(Dc, H, D) * Dc ** (-0.5)), 'w_uv': _w((lambda *s: torch.randn(*s, dtype=torch.bfloat16) * 0.8)(Dc, H, D) * Dc ** (-0.5)), 'w_o': _w((lambda *s: torch.randn(*s, dtype=torch.bfloat16) * 0.8)(H, D, M) * (H * D) ** (-0.5))}
    _A_in = _A_setup()

    def _B_setup():
        B, S, D, F = (1, 2048, 576, 4608)
        return {'x': _w((lambda *s: torch.randn(*s, dtype=torch.bfloat16) * 0.05)(B, S, D)), 'w1': _w((lambda *s: torch.randn(*s, dtype=torch.bfloat16) * 0.8)(S, F) * S ** (-0.5)), 'b1': _w((lambda *s: torch.randn(*s, dtype=torch.bfloat16) * 12.8)(F) * 0.02), 'w2': _w((lambda *s: torch.randn(*s, dtype=torch.bfloat16) * 0.4)(F, S) * F ** (-0.5)), 'b2': _w((lambda *s: torch.randn(*s, dtype=torch.bfloat16) * 3.2)(S) * 0.02)}
    _B_in = _B_setup()
    return {'A_x': _A_in['x'], 'A_c_kv': _A_in['c_kv'], 'A_w_q': _A_in['w_q'], 'A_w_uk': _A_in['w_uk'], 'A_w_uv': _A_in['w_uv'], 'A_w_o': _A_in['w_o'], 'B_x': _B_in['x'], 'B_w1': _B_in['w1'], 'B_b1': _B_in['b1'], 'B_w2': _B_in['w2'], 'B_b2': _B_in['b2'], 'c': _w((lambda *s: torch.randn(*s, dtype=torch.bfloat16) * 0.1)(1, 576) * 8.0), 'w_mod': _w((lambda *s: torch.randn(*s, dtype=torch.bfloat16) * 0.1)(576, 6 * 576) * 576 ** (-0.5) * 8.0)}

def reference(A_x, A_c_kv, A_w_q, A_w_uk, A_w_uv, A_w_o, B_x, B_w1, B_b1, B_w2, B_b2, c, w_mod):

    def _A_ref(x, c_kv, w_q, w_uk, w_uv, w_o):
        B, Sq, M = (x.shape[0], x.shape[1], x.shape[2])
        Sk = c_kv.shape[1]
        H, D = (w_q.shape[1], w_q.shape[2])
        q = torch.einsum('bqm,mhd->bhqd', x, w_q)
        k = torch.einsum('bkc,chd->bhkd', c_kv, w_uk)
        v = torch.einsum('bkc,chd->bhkd', c_kv, w_uv)
        scores = torch.einsum('bhqd,bhkd->bhqk', q, k) * D ** (-0.5)
        off = Sk - Sq
        qi = torch.arange(Sq)[:, None]
        kj = torch.arange(Sk)[None, :]
        cmask = kj <= qi + off
        scores = torch.where(cmask[None, None], scores, -1000000000.0)
        p = _softmax(scores, axis=-1)
        ctx = torch.einsum('bhqk,bhkd->bhqd', p, v)
        return torch.einsum('bhqd,hdm->bqm', ctx, w_o)

    def _B_ref(x, w1, b1, w2, b2):
        B, S, D = x.shape
        h = _layernorm(x, axis=-1)
        u = torch.einsum('bsd,sf->bdf', h, w1) + b1
        u = _gelu(u)
        y = torch.einsum('bdf,fs->bds', u, w2) + b2
        return (lambda x, *d: x.permute(*d))(y, 0, 2, 1)
    x = A_x
    mod = (_silu(c) @ w_mod).reshape(c.shape[0], 6, 1, -1)
    sa, ca, ga, sb, cb, gb = (mod[:, 0].clone(), mod[:, 1].clone(), mod[:, 2].clone(), mod[:, 3].clone(), mod[:, 4].clone(), mod[:, 5].clone())
    h = _layernorm(x, axis=-1) * (1 + ca) + sa
    x = x + ga * _A_ref(h, A_c_kv, A_w_q, A_w_uk, A_w_uv, A_w_o)
    h = _layernorm(x, axis=-1) * (1 + cb) + sb
    x = x + gb * _B_ref(h, B_w1, B_b1, B_w2, B_b2)
    return x
```

```asm
; @launch grid=(256,1,1) block=(512,1,1) lds=163840
.amdgcn_target "amdgcn-amd-amdhsa--gfx950"
.text
.globl adaLN_cond__compressed_kv_cla__mixer_token_mlp__prompt_kernel
.p2align 8
.type adaLN_cond__compressed_kv_cla__mixer_token_mlp__prompt_kernel,@function
adaLN_cond__compressed_kv_cla__mixer_token_mlp__prompt_kernel:
    s_cmp_ge_u32 s2, 256
    s_cbranch_scc1 Lend
    s_load_dwordx8 s[28:35], s[0:1], 0
    s_load_dwordx2 s[36:37], s[0:1], 32
    s_load_dwordx4 s[40:43], s[0:1], 88
    s_load_dwordx4 s[44:47], s[0:1], 112
    v_and_b32 v1, 63, v0
    v_lshrrev_b32 v2, 6, v0
    s_nop 1
    v_readfirstlane_b32 s3, v2
    s_and_b32 s48, s2, 7
    s_lshr_b32 s49, s2, 3
    s_and_b32 s55, s49, 3
    s_lshl_b32 s48, s48, 2
    s_add_u32 s48, s48, s55
    s_lshr_b32 s49, s49, 2
    v_bfe_u32 v3, v1, 3, 2
    v_lshlrev_b32 v3, 13, v3
    v_lshrrev_b32 v4, 5, v1
    v_lshl_add_u32 v3, v4, 18, v3
    v_and_b32 v4, 7, v1
    v_lshl_add_u32 v3, v4, 4, v3
    s_and_b32 s55, s3, 1
    s_lshl_b32 s55, s55, 12
    s_lshr_b32 s56, s3, 1
    s_lshl_b32 s56, s56, 19
    s_add_u32 s55, s55, s56
    v_add_u32 v3, s55, v3
    v_lshrrev_b32 v4, 4, v1
    v_lshlrev_b32 v4, 15, v4
    v_and_b32 v5, 15, v1
    v_lshl_add_u32 v4, v5, 4, v4
    s_and_b32 s55, s3, 3
    s_lshl_b32 s55, s55, 17
    v_add_u32 v4, s55, v4
    s_lshl_b32 s50, s49, 15
    s_lshl_b32 s51, s48, 8
    s_mul_i32 s52, s3, 4160
    s_mul_i32 s53, s3, 4352
    s_add_u32 s53, s53, 33280
    s_and_b32 s61, s2, 3
    s_mul_i32 s55, s61, 144
    v_lshrrev_b32 v8, 3, v0
    v_add_u32 v8, s55, v8
    v_mul_u32_u24 v245, 6912, v8
    v_and_b32 v2, 7, v0
    v_lshl_add_u32 v245, v2, 4, v245
    s_lshr_b32 s55, s2, 2
    s_lshl_b32 s55, s55, 7
    v_add_u32 v245, s55, v245
    v_lshlrev_b32 v8, 1, v8
    s_lshl_b32 s60, s2, 3
    s_add_u32 s60, s60, s3
    s_mul_i32 s55, s60, 1152
    v_lshlrev_b32 v10, 4, v1
    v_add_u32 v10, s55, v10
    v_cmp_gt_u32 vcc, 8, v1
    v_mov_b32 v15, 0xffffff00
    v_add_u32 v11, 1024, v10
    v_cndmask_b32 v11, v15, v11, vcc
    s_waitcnt lgkmcnt(0)
    s_mov_b32 s4, s46
    s_mov_b32 s5, s47
    s_mov_b32 s8, s30
    s_and_b32 s9, s31, 0xffff
    s_mov_b32 s10, 2097152
    s_mov_b32 s11, 0x20000
    s_cmp_lt_u32 s3, 4
    s_cselect_b32 s34, s34, s36
    s_cselect_b32 s35, s35, s37
    s_mov_b32 s12, s34
    s_and_b32 s13, s35, 0xffff
    s_mov_b32 s14, 4194304
    s_mov_b32 s15, 0x20000
    s_add_u32 m0, s52, 0
    s_nop 0
    buffer_load_dwordx4 v3, s[8:11], s50 offen offset:0 lds
    s_add_u32 m0, s52, 16
    s_nop 0
    buffer_load_dwordx4 v3, s[8:11], s50 offen offset:1024 lds
    s_add_u32 m0, s52, 32
    s_nop 0
    buffer_load_dwordx4 v3, s[8:11], s50 offen offset:2048 lds
    s_add_u32 m0, s52, 48
    s_nop 0
    buffer_load_dwordx4 v3, s[8:11], s50 offen offset:3072 lds
    s_add_u32 m0, s53, 0
    s_add_u32 s55, s51, 0
    buffer_load_dwordx4 v4, s[12:15], s55 offen lds
    s_add_u32 m0, s53, 1088
    s_add_u32 s55, s51, 8192
    buffer_load_dwordx4 v4, s[12:15], s55 offen lds
    s_add_u32 m0, s53, 2176
    s_add_u32 s55, s51, 16384
    buffer_load_dwordx4 v4, s[12:15], s55 offen lds
    s_add_u32 m0, s53, 3264
    s_add_u32 s55, s51, 24576
    buffer_load_dwordx4 v4, s[12:15], s55 offen lds
    s_add_u32 s50, s50, 128
    s_add_u32 s51, s51, 524288
    s_add_u32 m0, s52, 68096
    s_nop 0
    buffer_load_dwordx4 v3, s[8:11], s50 offen offset:0 lds
    s_add_u32 m0, s52, 68112
    s_nop 0
    buffer_load_dwordx4 v3, s[8:11], s50 offen offset:1024 lds
    s_add_u32 m0, s52, 68128
    s_nop 0
    buffer_load_dwordx4 v3, s[8:11], s50 offen offset:2048 lds
    s_add_u32 m0, s52, 68144
    s_nop 0
    buffer_load_dwordx4 v3, s[8:11], s50 offen offset:3072 lds
    s_add_u32 m0, s53, 68096
    s_add_u32 s55, s51, 0
    buffer_load_dwordx4 v4, s[12:15], s55 offen lds
    s_add_u32 m0, s53, 69184
    s_add_u32 s55, s51, 8192
    buffer_load_dwordx4 v4, s[12:15], s55 offen lds
    s_add_u32 m0, s53, 70272
    s_add_u32 s55, s51, 16384
    buffer_load_dwordx4 v4, s[12:15], s55 offen lds
    s_add_u32 m0, s53, 71360
    s_add_u32 s55, s51, 24576
    buffer_load_dwordx4 v4, s[12:15], s55 offen lds
    s_add_u32 s50, s50, 128
    s_add_u32 s51, s51, 524288
    s_getpc_b64 s[16:17]
Lpc:
    s_and_b32 s17, s17, 0xffff
    s_mov_b32 s18, Lend-Lpc
    s_mov_b32 s19, 0x20000
    s_lshr_b32 s55, s2, 3
    s_lshl_b32 s55, s55, 3
    s_add_u32 s55, s55, s3
    s_lshl_b32 s55, s55, 9
    v_lshlrev_b32 v2, 3, v1
    buffer_load_dwordx2 v[220:221], v2, s[16:19], s55 offen
    s_lshl_b32 s63, s49, 15
    s_and_b32 s55, s48, 3
    s_lshl_b32 s55, s55, 10
    s_add_u32 s63, s63, s55
    s_and_b32 s7, s49, 3
    s_lshl_b32 s7, s7, 13
    s_lshl_b32 s55, s48, 8
    s_add_u32 s7, s7, s55
    s_bfe_u32 s55, s3, 0x10001
    s_lshr_b32 s56, s49, 2
    s_cmp_eq_u32 s55, s56
    s_cselect_b32 s7, s7, 0x7f000000
    v_and_b32 v5, 7, v1
    v_mul_u32_u24 v5, 1040, v5
    v_bfe_u32 v6, v1, 3, 2
    v_lshl_add_u32 v5, v6, 7, v5
    v_lshrrev_b32 v6, 5, v1
    v_lshl_add_u32 v5, v6, 4, v5
    s_and_b32 s55, s3, 1
    s_mul_i32 s55, s55, 16640
    v_add_u32 v5, s55, v5
    v_bfe_u32 v6, v1, 2, 2
    v_mul_u32_u24 v6, 1088, v6
    v_lshrrev_b32 v7, 5, v1
    v_lshl_add_u32 v6, v7, 9, v6
    v_bfe_u32 v7, v1, 4, 1
    v_lshl_add_u32 v6, v7, 5, v6
    v_and_b32 v7, 3, v1
    v_lshl_add_u32 v6, v7, 3, v6
    s_lshr_b32 s55, s3, 2
    s_mul_i32 s55, s55, 17408
    s_bfe_u32 s56, s3, 0x10001
    s_lshl_b32 s56, s56, 7
    s_add_u32 s55, s55, s56
    s_add_u32 s55, s55, 33280
    v_add_u32 v6, s55, v6
    v_lshrrev_b32 v9, 3, v0
    v_lshlrev_b32 v13, 9, v9
    v_lshlrev_b32 v9, 5, v9
    v_add_u32 v9, 138240, v9
    v_lshlrev_b32 v12, 4, v0
    v_cmp_gt_u32 vcc, 288, v0
    s_nop 1
    v_cndmask_b32 v12, v15, v12, vcc
    s_lshr_b32 s55, s2, 2
    s_mul_i32 s55, s55, 36864
    s_and_b32 s56, s2, 3
    s_lshl_b32 s56, s56, 7
    s_add_u32 s62, s55, s56
    v_and_b32 v14, 7, v0
    v_lshl_add_u32 v13, v14, 4, v13
    s_lshl_b32 s55, s3, 4
    s_add_u32 s55, s55, 146432
    v_lshlrev_b32 v14, 7, v1
    v_add_u32 v14, s55, v14
    s_lshl_b32 s55, s3, 8
    s_add_u32 s55, s55, 136192
    v_lshlrev_b32 v7, 5, v1
    v_add_u32 v7, s55, v7
    v_mov_b64 v[64:65], 0
    v_mov_b64 v[66:67], 0
    v_mov_b64 v[68:69], 0
    v_mov_b64 v[70:71], 0
    v_mov_b64 v[72:73], 0
    v_mov_b64 v[74:75], 0
    v_mov_b64 v[76:77], 0
    v_mov_b64 v[78:79], 0
    v_mov_b64 v[80:81], 0
    v_mov_b64 v[82:83], 0
    v_mov_b64 v[84:85], 0
    v_mov_b64 v[86:87], 0
    v_mov_b64 v[88:89], 0
    v_mov_b64 v[90:91], 0
    v_mov_b64 v[92:93], 0
    v_mov_b64 v[94:95], 0
    v_mov_b64 v[96:97], 0
    v_mov_b64 v[98:99], 0
    v_mov_b64 v[100:101], 0
    v_mov_b64 v[102:103], 0
    v_mov_b64 v[104:105], 0
    v_mov_b64 v[106:107], 0
    v_mov_b64 v[108:109], 0
    v_mov_b64 v[110:111], 0
    v_mov_b64 v[112:113], 0
    v_mov_b64 v[114:115], 0
    v_mov_b64 v[116:117], 0
    v_mov_b64 v[118:119], 0
    v_mov_b64 v[120:121], 0
    v_mov_b64 v[122:123], 0
    v_mov_b64 v[124:125], 0
    v_mov_b64 v[126:127], 0
    v_mov_b64 v[128:129], 0
    v_mov_b64 v[130:131], 0
    v_mov_b64 v[132:133], 0
    v_mov_b64 v[134:135], 0
    v_mov_b64 v[136:137], 0
    v_mov_b64 v[138:139], 0
    v_mov_b64 v[140:141], 0
    v_mov_b64 v[142:143], 0
    v_mov_b64 v[144:145], 0
    v_mov_b64 v[146:147], 0
    v_mov_b64 v[148:149], 0
    v_mov_b64 v[150:151], 0
    v_mov_b64 v[152:153], 0
    v_mov_b64 v[154:155], 0
    v_mov_b64 v[156:157], 0
    v_mov_b64 v[158:159], 0
    v_mov_b64 v[160:161], 0
    v_mov_b64 v[162:163], 0
    v_mov_b64 v[164:165], 0
    v_mov_b64 v[166:167], 0
    v_mov_b64 v[168:169], 0
    v_mov_b64 v[170:171], 0
    v_mov_b64 v[172:173], 0
    v_mov_b64 v[174:175], 0
    v_mov_b64 v[176:177], 0
    v_mov_b64 v[178:179], 0
    v_mov_b64 v[180:181], 0
    v_mov_b64 v[182:183], 0
    v_mov_b64 v[184:185], 0
    v_mov_b64 v[186:187], 0
    v_mov_b64 v[188:189], 0
    v_mov_b64 v[190:191], 0
    s_waitcnt vmcnt(9)
    s_barrier
    ds_read_b64_tr_b16 v[32:33], v6 offset:0
    ds_read_b64_tr_b16 v[34:35], v6 offset:256
    ds_read_b64_tr_b16 v[36:37], v6 offset:64
    ds_read_b64_tr_b16 v[38:39], v6 offset:320
    ds_read_b128 v[16:19], v5 offset:0
    ds_read_b128 v[20:23], v5 offset:512
    ds_read_b128 v[24:27], v5 offset:8320
    ds_read_b128 v[28:31], v5 offset:8832
    s_cmp_lt_u32 s3, 4
    s_cbranch_scc0 Lkv_r1
Lkv_r0:
    s_setprio 2
    s_waitcnt lgkmcnt(0)
    v_mfma_f32_32x32x16_bf16 v[64:79], v[32:35], v[16:19], v[64:79]
    ds_read_b64_tr_b16 v[56:57], v6 offset:4352
    ds_read_b64_tr_b16 v[58:59], v6 offset:4608
    buffer_load_dwordx4 v[220:223], v3, s[8:11], s63 offen offset:256
    s_add_u32 s56, s7, 1048576
    buffer_load_dwordx4 v[220:223], v4, s[12:15], s56 offen
    buffer_load_dwordx4 v[220:223], v3, s[8:11], s63 offen offset:384
    v_mfma_f32_32x32x16_bf16 v[80:95], v[36:39], v[16:19], v[80:95]
    ds_read_b64_tr_b16 v[60:61], v6 offset:4416
    ds_read_b64_tr_b16 v[62:63], v6 offset:4672
    s_add_u32 s56, s7, 1572864
    buffer_load_dwordx4 v[220:223], v4, s[12:15], s56 offen
    s_mov_b32 s16, s40
    s_and_b32 s17, s41, 0xffff
    v_mfma_f32_32x32x16_bf16 v[96:111], v[32:35], v[20:23], v[96:111]
    ds_read_b128 v[40:43], v5 offset:32
    ds_read_b128 v[44:47], v5 offset:544
    s_mov_b32 s18, 1152
    s_mov_b32 s19, 0x20000
    s_mov_b32 s20, s42
    v_mfma_f32_32x32x16_bf16 v[112:127], v[36:39], v[20:23], v[112:127]
    ds_read_b128 v[48:51], v5 offset:8352
    ds_read_b128 v[52:55], v5 offset:8864
    s_and_b32 s21, s43, 0xffff
    s_mov_b32 s22, 3981312
    s_mov_b32 s23, 0x20000
    v_mfma_f32_32x32x16_bf16 v[128:143], v[32:35], v[24:27], v[128:143]
    s_mov_b32 s24, s28
    s_and_b32 s25, s29, 0xffff
    s_mov_b32 s26, 2359296
    v_mfma_f32_32x32x16_bf16 v[144:159], v[36:39], v[24:27], v[144:159]
    s_mov_b32 s27, 0x20000
    s_cmp_lt_u32 s2, 216
    s_cselect_b32 s22, s22, 0
    v_mfma_f32_32x32x16_bf16 v[160:175], v[32:35], v[28:31], v[160:175]
    s_mov_b32 s59, 0x7f000000
    s_cmp_lt_u32 s3, 2
    s_cselect_b32 s58, 884736, s59
    v_mfma_f32_32x32x16_bf16 v[176:191], v[36:39], v[28:31], v[176:191]
    s_cselect_b32 s59, 256, s59
    s_mov_b32 s55, 442368
    buffer_load_dwordx4 v[192:195], v245, s[20:23], 0 offen
    s_setprio 1
    s_waitcnt lgkmcnt(0)
    v_mfma_f32_32x32x16_bf16 v[64:79], v[56:59], v[40:43], v[64:79]
    ds_read_b64_tr_b16 v[32:33], v6 offset:8704
    ds_read_b64_tr_b16 v[34:35], v6 offset:8960
    buffer_load_ushort v204, v8, s[16:19], 0 offen
    buffer_load_dwordx4 v[196:199], v245, s[20:23], s55 offen
    buffer_load_ushort v205, v8, s[16:19], 0 offen offset:128
    v_mfma_f32_32x32x16_bf16 v[80:95], v[60:63], v[40:43], v[80:95]
    ds_read_b64_tr_b16 v[36:37], v6 offset:8768
    ds_read_b64_tr_b16 v[38:39], v6 offset:9024
    buffer_load_dwordx4 v[200:203], v245, s[20:23], s58 offen
    buffer_load_ushort v206, v8, s[16:19], s59 offen
    buffer_load_dwordx4 v[224:227], v10, s[24:27], 0 offen
    v_mfma_f32_32x32x16_bf16 v[96:111], v[56:59], v[44:47], v[96:111]
    ds_read_b128 v[16:19], v5 offset:64
    ds_read_b128 v[20:23], v5 offset:576
    buffer_load_dwordx4 v[228:231], v11, s[24:27], 0 offen
    s_mov_b32 s96, s4
    s_and_b32 s97, s5, 0xffff
    v_mfma_f32_32x32x16_bf16 v[112:127], v[60:63], v[44:47], v[112:127]
    ds_read_b128 v[24:27], v5 offset:8384
    ds_read_b128 v[28:31], v5 offset:8896
    s_mov_b32 s98, 65536
    s_mov_b32 s99, 0x20000
    v_lshlrev_b32 v2, 2, v1
    v_mfma_f32_32x32x16_bf16 v[128:143], v[56:59], v[48:51], v[128:143]
    s_lshl_b32 s55, s2, 8
    v_add_u32 v2, s55, v2
    v_mov_b32 v243, 0
    v_mfma_f32_32x32x16_bf16 v[144:159], v[60:63], v[48:51], v[144:159]
    s_cmp_lg_u32 s3, 0
    s_cbranch_scc1 Lkv_nz
    buffer_store_dword v243, v2, s[96:99], 0 offen sc1
Lkv_nz:
    s_mov_b32 s36, s44
    s_and_b32 s37, s45, 0xffff
    v_mfma_f32_32x32x16_bf16 v[160:175], v[56:59], v[52:55], v[160:175]
    s_mov_b32 s38, 256
    s_mov_b32 s39, 0x20000
    s_add_u32 s40, s4, 131072
    v_mfma_f32_32x32x16_bf16 v[176:191], v[60:63], v[52:55], v[176:191]
    s_addc_u32 s41, s5, 0
    s_and_b32 s41, s41, 0xffff
    s_mov_b32 s42, 55296
    s_setprio 0
    s_waitcnt lgkmcnt(0)
    v_mfma_f32_32x32x16_bf16 v[64:79], v[32:35], v[16:19], v[64:79]
    ds_read_b64_tr_b16 v[56:57], v6 offset:13056
    ds_read_b64_tr_b16 v[58:59], v6 offset:13312
    s_mov_b32 s43, 0x20000
    s_mov_b32 s16, s32
    s_and_b32 s17, s33, 0xffff
    v_mfma_f32_32x32x16_bf16 v[80:95], v[36:39], v[16:19], v[80:95]
    ds_read_b64_tr_b16 v[60:61], v6 offset:13120
    ds_read_b64_tr_b16 v[62:63], v6 offset:13376
    s_mov_b32 s18, 4718592
    s_mov_b32 s19, 0x20000
    s_add_u32 s24, s4, 196608
    v_mfma_f32_32x32x16_bf16 v[96:111], v[32:35], v[20:23], v[96:111]
    ds_read_b128 v[40:43], v5 offset:96
    ds_read_b128 v[44:47], v5 offset:608
    s_addc_u32 s25, s5, 0
    s_and_b32 s25, s25, 0xffff
    s_mov_b32 s26, 2359296
    v_mfma_f32_32x32x16_bf16 v[112:127], v[36:39], v[20:23], v[112:127]
    ds_read_b128 v[48:51], v5 offset:8416
    ds_read_b128 v[52:55], v5 offset:8928
    s_mov_b32 s27, 0x20000
    s_add_u32 s20, s4, 65536
    s_addc_u32 s21, s5, 0
    v_mfma_f32_32x32x16_bf16 v[128:143], v[32:35], v[24:27], v[128:143]
    s_and_b32 s21, s21, 0xffff
    s_mov_b32 s22, 13824
    s_mov_b32 s23, 0x20000
    v_mfma_f32_32x32x16_bf16 v[144:159], v[36:39], v[24:27], v[144:159]
    v_mfma_f32_32x32x16_bf16 v[160:175], v[32:35], v[28:31], v[160:175]
    v_mfma_f32_32x32x16_bf16 v[176:191], v[36:39], v[28:31], v[176:191]
    v_add_u32 v5, 68096, v5
    v_add_u32 v6, 68096, v6
    s_waitcnt vmcnt(13) lgkmcnt(0)
    s_barrier
    s_setprio 3
    v_mfma_f32_32x32x16_bf16 v[64:79], v[56:59], v[40:43], v[64:79]
    ds_read_b64_tr_b16 v[32:33], v6 offset:0
    ds_read_b64_tr_b16 v[34:35], v6 offset:256
    s_add_u32 m0, s53, 0
    s_add_u32 s55, s51, 0
    buffer_load_dwordx4 v4, s[12:15], s55 offen lds
    v_mfma_f32_32x32x16_bf16 v[80:95], v[60:63], v[40:43], v[80:95]
    ds_read_b64_tr_b16 v[36:37], v6 offset:64
    ds_read_b64_tr_b16 v[38:39], v6 offset:320
    v_mfma_f32_32x32x16_bf16 v[96:111], v[56:59], v[44:47], v[96:111]
    ds_read_b128 v[16:19], v5 offset:0
    ds_read_b128 v[20:23], v5 offset:512
    s_add_u32 m0, s53, 1088
    s_add_u32 s55, s51, 8192
    buffer_load_dwordx4 v4, s[12:15], s55 offen lds
    v_mfma_f32_32x32x16_bf16 v[112:127], v[60:63], v[44:47], v[112:127]
    ds_read_b128 v[24:27], v5 offset:8320
    ds_read_b128 v[28:31], v5 offset:8832
    v_mfma_f32_32x32x16_bf16 v[128:143], v[56:59], v[48:51], v[128:143]
    s_add_u32 m0, s53, 2176
    s_add_u32 s55, s51, 16384
    buffer_load_dwordx4 v4, s[12:15], s55 offen lds
    v_mfma_f32_32x32x16_bf16 v[144:159], v[60:63], v[48:51], v[144:159]
    v_mfma_f32_32x32x16_bf16 v[160:175], v[56:59], v[52:55], v[160:175]
    s_add_u32 m0, s53, 3264
    s_add_u32 s55, s51, 24576
    buffer_load_dwordx4 v4, s[12:15], s55 offen lds
    v_mfma_f32_32x32x16_bf16 v[176:191], v[60:63], v[52:55], v[176:191]
    s_setprio 2
    s_waitcnt lgkmcnt(0)
    v_mfma_f32_32x32x16_bf16 v[64:79], v[32:35], v[16:19], v[64:79]
    ds_read_b64_tr_b16 v[56:57], v6 offset:4352
    ds_read_b64_tr_b16 v[58:59], v6 offset:4608
    s_add_u32 m0, s52, 0
    s_nop 0
    buffer_load_dwordx4 v3, s[8:11], s50 offen offset:0 lds
    v_mfma_f32_32x32x16_bf16 v[80:95], v[36:39], v[16:19], v[80:95]
    ds_read_b64_tr_b16 v[60:61], v6 offset:4416
    ds_read_b64_tr_b16 v[62:63], v6 offset:4672
    v_mfma_f32_32x32x16_bf16 v[96:111], v[32:35], v[20:23], v[96:111]
    ds_read_b128 v[40:43], v5 offset:32
    ds_read_b128 v[44:47], v5 offset:544
    s_add_u32 m0, s52, 16
    s_nop 0
    buffer_load_dwordx4 v3, s[8:11], s50 offen offset:1024 lds
    v_mfma_f32_32x32x16_bf16 v[112:127], v[36:39], v[20:23], v[112:127]
    ds_read_b128 v[48:51], v5 offset:8352
    ds_read_b128 v[52:55], v5 offset:8864
    v_mfma_f32_32x32x16_bf16 v[128:143], v[32:35], v[24:27], v[128:143]
    s_add_u32 m0, s52, 32
    s_nop 0
    buffer_load_dwordx4 v3, s[8:11], s50 offen offset:2048 lds
    v_mfma_f32_32x32x16_bf16 v[144:159], v[36:39], v[24:27], v[144:159]
    v_mfma_f32_32x32x16_bf16 v[160:175], v[32:35], v[28:31], v[160:175]
    s_add_u32 m0, s52, 48
    s_nop 0
    buffer_load_dwordx4 v3, s[8:11], s50 offen offset:3072 lds
    v_mfma_f32_32x32x16_bf16 v[176:191], v[36:39], v[28:31], v[176:191]
    s_add_u32 s50, s50, 128
    s_add_u32 s51, s51, 524288
    s_setprio 1
    s_waitcnt lgkmcnt(0)
    v_mfma_f32_32x32x16_bf16 v[64:79], v[56:59], v[40:43], v[64:79]
    ds_read_b64_tr_b16 v[32:33], v6 offset:8704
    ds_read_b64_tr_b16 v[34:35], v6 offset:8960
    s_waitcnt vmcnt(8)
    v_lshlrev_b32 v204, 16, v204
    v_mul_f32 v216, 0xbfb8aa3b, v204
    v_exp_f32 v216, v216
    s_nop 0
    v_add_f32 v216, 1.0, v216
    v_rcp_f32 v216, v216
    s_nop 0
    v_mul_f32 v204, v204, v216
    v_mfma_f32_32x32x16_bf16 v[80:95], v[60:63], v[40:43], v[80:95]
    ds_read_b64_tr_b16 v[36:37], v6 offset:8768
    ds_read_b64_tr_b16 v[38:39], v6 offset:9024
    v_cvt_pk_bf16_f32 v204, v204, v204
    v_and_b32 v204, 0xffff0000, v204
    v_lshlrev_b32 v216, 16, v192
    v_and_b32 v217, 0xffff0000, v192
    v_mul_f32 v208, v204, v216
    v_mul_f32 v209, v204, v217
    v_lshlrev_b32 v216, 16, v193
    v_and_b32 v217, 0xffff0000, v193
    v_mul_f32 v210, v204, v216
    v_mfma_f32_32x32x16_bf16 v[96:111], v[56:59], v[44:47], v[96:111]
    ds_read_b128 v[16:19], v5 offset:64
    ds_read_b128 v[20:23], v5 offset:576
    v_mul_f32 v211, v204, v217
    v_lshlrev_b32 v216, 16, v194
    v_and_b32 v217, 0xffff0000, v194
    v_mul_f32 v212, v204, v216
    v_mul_f32 v213, v204, v217
    v_lshlrev_b32 v216, 16, v195
    v_and_b32 v217, 0xffff0000, v195
    v_mul_f32 v214, v204, v216
    v_mul_f32 v215, v204, v217
    v_mfma_f32_32x32x16_bf16 v[112:127], v[60:63], v[44:47], v[112:127]
    ds_read_b128 v[24:27], v5 offset:8384
    ds_read_b128 v[28:31], v5 offset:8896
    v_lshlrev_b32 v205, 16, v205
    v_mul_f32 v216, 0xbfb8aa3b, v205
    v_exp_f32 v216, v216
    s_nop 0
    v_add_f32 v216, 1.0, v216
    v_rcp_f32 v216, v216
    s_nop 0
    v_mul_f32 v205, v205, v216
    v_cvt_pk_bf16_f32 v205, v205, v205
    v_mfma_f32_32x32x16_bf16 v[128:143], v[56:59], v[48:51], v[128:143]
    v_and_b32 v205, 0xffff0000, v205
    v_lshlrev_b32 v216, 16, v196
    v_and_b32 v217, 0xffff0000, v196
    v_fmac_f32 v208, v205, v216
    v_fmac_f32 v209, v205, v217
    v_lshlrev_b32 v216, 16, v197
    v_and_b32 v217, 0xffff0000, v197
    v_fmac_f32 v210, v205, v216
    v_fmac_f32 v211, v205, v217
    v_mfma_f32_32x32x16_bf16 v[144:159], v[60:63], v[48:51], v[144:159]
    v_lshlrev_b32 v216, 16, v198
    v_and_b32 v217, 0xffff0000, v198
    v_fmac_f32 v212, v205, v216
    v_fmac_f32 v213, v205, v217
    v_lshlrev_b32 v216, 16, v199
    v_and_b32 v217, 0xffff0000, v199
    v_fmac_f32 v214, v205, v216
    v_fmac_f32 v215, v205, v217
    v_lshlrev_b32 v206, 16, v206
    v_mfma_f32_32x32x16_bf16 v[160:175], v[56:59], v[52:55], v[160:175]
    v_mul_f32 v216, 0xbfb8aa3b, v206
    v_exp_f32 v216, v216
    s_nop 0
    v_add_f32 v216, 1.0, v216
    v_rcp_f32 v216, v216
    s_nop 0
    v_mul_f32 v206, v206, v216
    v_cvt_pk_bf16_f32 v206, v206, v206
    v_and_b32 v206, 0xffff0000, v206
    v_mfma_f32_32x32x16_bf16 v[176:191], v[60:63], v[52:55], v[176:191]
    v_lshlrev_b32 v216, 16, v200
    v_and_b32 v217, 0xffff0000, v200
    v_fmac_f32 v208, v206, v216
    v_fmac_f32 v209, v206, v217
    v_lshlrev_b32 v216, 16, v201
    v_and_b32 v217, 0xffff0000, v201
    v_fmac_f32 v210, v206, v216
    v_fmac_f32 v211, v206, v217
    v_lshlrev_b32 v216, 16, v202
    s_setprio 0
    s_waitcnt lgkmcnt(0)
    v_mfma_f32_32x32x16_bf16 v[64:79], v[32:35], v[16:19], v[64:79]
    ds_read_b64_tr_b16 v[56:57], v6 offset:13056
    ds_read_b64_tr_b16 v[58:59], v6 offset:13312
    v_and_b32 v217, 0xffff0000, v202
    v_fmac_f32 v212, v206, v216
    v_fmac_f32 v213, v206, v217
    v_lshlrev_b32 v216, 16, v203
    v_and_b32 v217, 0xffff0000, v203
    v_fmac_f32 v214, v206, v216
    v_fmac_f32 v215, v206, v217
    s_nop 1
    v_add_f32_dpp v208, v208, v208 row_ror:8 row_mask:0xf bank_mask:0xf
    v_mfma_f32_32x32x16_bf16 v[80:95], v[36:39], v[16:19], v[80:95]
    ds_read_b64_tr_b16 v[60:61], v6 offset:13120
    ds_read_b64_tr_b16 v[62:63], v6 offset:13376
    v_add_f32_dpp v209, v209, v209 row_ror:8 row_mask:0xf bank_mask:0xf
    v_add_f32_dpp v210, v210, v210 row_ror:8 row_mask:0xf bank_mask:0xf
    v_add_f32_dpp v211, v211, v211 row_ror:8 row_mask:0xf bank_mask:0xf
    v_add_f32_dpp v212, v212, v212 row_ror:8 row_mask:0xf bank_mask:0xf
    v_add_f32_dpp v213, v213, v213 row_ror:8 row_mask:0xf bank_mask:0xf
    v_add_f32_dpp v214, v214, v214 row_ror:8 row_mask:0xf bank_mask:0xf
    v_add_f32_dpp v215, v215, v215 row_ror:8 row_mask:0xf bank_mask:0xf
    v_mov_b32 v192, v208
    v_mov_b32 v193, v209
    v_mfma_f32_32x32x16_bf16 v[96:111], v[32:35], v[20:23], v[96:111]
    ds_read_b128 v[40:43], v5 offset:96
    ds_read_b128 v[44:47], v5 offset:608
    v_mov_b32 v194, v210
    v_mov_b32 v195, v211
    v_mov_b32 v196, v212
    v_mov_b32 v197, v213
    v_mov_b32 v198, v214
    v_mov_b32 v199, v215
    s_nop 0
    v_permlane16_swap_b32 v208, v192
    v_permlane16_swap_b32 v209, v193
    v_mfma_f32_32x32x16_bf16 v[112:127], v[36:39], v[20:23], v[112:127]
    ds_read_b128 v[48:51], v5 offset:8416
    ds_read_b128 v[52:55], v5 offset:8928
    v_permlane16_swap_b32 v210, v194
    v_permlane16_swap_b32 v211, v195
    v_permlane16_swap_b32 v212, v196
    v_permlane16_swap_b32 v213, v197
    v_permlane16_swap_b32 v214, v198
    v_permlane16_swap_b32 v215, v199
    v_add_f32 v208, v208, v192
    v_add_f32 v209, v209, v193
    v_add_f32 v210, v210, v194
    v_mfma_f32_32x32x16_bf16 v[128:143], v[32:35], v[24:27], v[128:143]
    v_add_f32 v211, v211, v195
    v_add_f32 v212, v212, v196
    v_add_f32 v213, v213, v197
    v_add_f32 v214, v214, v198
    v_add_f32 v215, v215, v199
    v_mov_b32 v192, v208
    v_mov_b32 v193, v209
    v_mov_b32 v194, v210
    v_mov_b32 v195, v211
    v_mfma_f32_32x32x16_bf16 v[144:159], v[36:39], v[24:27], v[144:159]
    v_mov_b32 v196, v212
    v_mov_b32 v197, v213
    v_mov_b32 v198, v214
    v_mov_b32 v199, v215
    s_nop 0
    v_permlane32_swap_b32 v208, v192
    v_permlane32_swap_b32 v209, v193
    v_permlane32_swap_b32 v210, v194
    v_permlane32_swap_b32 v211, v195
    v_mfma_f32_32x32x16_bf16 v[160:175], v[32:35], v[28:31], v[160:175]
    v_permlane32_swap_b32 v212, v196
    v_permlane32_swap_b32 v213, v197
    v_permlane32_swap_b32 v214, v198
    v_permlane32_swap_b32 v215, v199
    v_add_f32 v208, v208, v192
    v_add_f32 v209, v209, v193
    v_add_f32 v210, v210, v194
    v_add_f32 v211, v211, v195
    v_add_f32 v212, v212, v196
    v_mfma_f32_32x32x16_bf16 v[176:191], v[36:39], v[28:31], v[176:191]
    v_add_f32 v213, v213, v197
    v_add_f32 v214, v214, v198
    v_add_f32 v215, v215, v199
    s_mov_b64 exec, 0xff
    ds_write_b128 v7, v[208:211]
    ds_write_b128 v7, v[212:215] offset:16
    s_mov_b64 exec, -1
    buffer_load_dwordx4 v[220:223], v3, s[8:11], s63 offen offset:512
    s_add_u32 s56, s7, 2097152
    buffer_load_dwordx4 v[220:223], v4, s[12:15], s56 offen
    v_add_u32 v5, 4294899200, v5
    v_add_u32 v6, 4294899200, v6
    s_waitcnt vmcnt(2) lgkmcnt(0)
    s_barrier
    s_setprio 3
    v_mfma_f32_32x32x16_bf16 v[64:79], v[56:59], v[40:43], v[64:79]
    ds_read_b64_tr_b16 v[32:33], v6 offset:0
    ds_read_b64_tr_b16 v[34:35], v6 offset:256
    s_add_u32 m0, s53, 68096
    s_add_u32 s55, s51, 0
    buffer_load_dwordx4 v4, s[12:15], s55 offen lds
    v_mfma_f32_32x32x16_bf16 v[80:95], v[60:63], v[40:43], v[80:95]
    ds_read_b64_tr_b16 v[36:37], v6 offset:64
    ds_read_b64_tr_b16 v[38:39], v6 offset:320
    v_mfma_f32_32x32x16_bf16 v[96:111], v[56:59], v[44:47], v[96:111]
    ds_read_b128 v[16:19], v5 offset:0
    ds_read_b128 v[20:23], v5 offset:512
    s_add_u32 m0, s53, 69184
    s_add_u32 s55, s51, 8192
    buffer_load_dwordx4 v4, s[12:15], s55 offen lds
    v_mfma_f32_32x32x16_bf16 v[112:127], v[60:63], v[44:47], v[112:127]
    ds_read_b128 v[24:27], v5 offset:8320
    ds_read_b128 v[28:31], v5 offset:8832
    v_mfma_f32_32x32x16_bf16 v[128:143], v[56:59], v[48:51], v[128:143]
    s_add_u32 m0, s53, 70272
    s_add_u32 s55, s51, 16384
    buffer_load_dwordx4 v4, s[12:15], s55 offen lds
    v_mfma_f32_32x32x16_bf16 v[144:159], v[60:63], v[48:51], v[144:159]
    v_mfma_f32_32x32x16_bf16 v[160:175], v[56:59], v[52:55], v[160:175]
    s_add_u32 m0, s53, 71360
    s_add_u32 s55, s51, 24576
    buffer_load_dwordx4 v4, s[12:15], s55 offen lds
    v_mfma_f32_32x32x16_bf16 v[176:191], v[60:63], v[52:55], v[176:191]
    s_cmp_lg_u32 s3, 0
    s_cbranch_scc1 Lkv_nofin
    v_lshlrev_b32 v2, 2, v1
    v_add_u32 v15, 136192, v2
    ds_read_b32 v192, v15 offset:0
    ds_read_b32 v193, v15 offset:256
    ds_read_b32 v194, v15 offset:512
    ds_read_b32 v195, v15 offset:768
    ds_read_b32 v196, v15 offset:1024
    ds_read_b32 v197, v15 offset:1280
    ds_read_b32 v198, v15 offset:1536
    ds_read_b32 v199, v15 offset:1792
    s_mul_i32 s55, s61, 13824
    s_lshr_b32 s56, s2, 2
    s_lshl_b32 s56, s56, 8
    s_add_u32 s55, s55, s56
    s_cmp_lt_u32 s2, 216
    s_cselect_b32 s55, s55, 0x7f000000
    s_waitcnt lgkmcnt(0)
    v_add_f32 v192, v192, v193
    v_add_f32 v192, v192, v194
    v_add_f32 v192, v192, v195
    v_add_f32 v192, v192, v196
    v_add_f32 v192, v192, v197
    v_add_f32 v192, v192, v198
    v_add_f32 v192, v192, v199
    buffer_store_dword v192, v2, s[40:43], s55 offen sc1
    v_mov_b32 v2, 1
    s_lshl_b32 s55, s61, 6
    v_and_b32 v11, 3, v1
    v_lshlrev_b32 v11, 6, v11
    s_waitcnt vmcnt(0)
    s_mov_b64 exec, 1
    buffer_atomic_add v2, off, s[36:39], s55 sc1
    s_mov_b64 exec, -1
Lkv_nofin:
    s_setprio 2
    s_waitcnt lgkmcnt(0)
    v_mfma_f32_32x32x16_bf16 v[64:79], v[32:35], v[16:19], v[64:79]
    ds_read_b64_tr_b16 v[56:57], v6 offset:4352
    ds_read_b64_tr_b16 v[58:59], v6 offset:4608
    s_add_u32 m0, s52, 68096
    s_nop 0
    buffer_load_dwordx4 v3, s[8:11], s50 offen offset:0 lds
    v_lshlrev_b32 v232, 16, v224
    v_and_b32 v233, 0xffff0000, v224
    v_lshlrev_b32 v234, 16, v225
    v_mfma_f32_32x32x16_bf16 v[80:95], v[36:39], v[16:19], v[80:95]
    ds_read_b64_tr_b16 v[60:61], v6 offset:4416
    ds_read_b64_tr_b16 v[62:63], v6 offset:4672
    v_and_b32 v235, 0xffff0000, v225
    v_lshlrev_b32 v236, 16, v226
    v_and_b32 v237, 0xffff0000, v226
    v_mfma_f32_32x32x16_bf16 v[96:111], v[32:35], v[20:23], v[96:111]
    ds_read_b128 v[40:43], v5 offset:32
    ds_read_b128 v[44:47], v5 offset:544
    s_add_u32 m0, s52, 68112
    s_nop 0
    buffer_load_dwordx4 v3, s[8:11], s50 offen offset:1024 lds
    v_lshlrev_b32 v238, 16, v227
    v_and_b32 v239, 0xffff0000, v227
    v_lshlrev_b32 v240, 16, v228
    v_mfma_f32_32x32x16_bf16 v[112:127], v[36:39], v[20:23], v[112:127]
    ds_read_b128 v[48:51], v5 offset:8352
    ds_read_b128 v[52:55], v5 offset:8864
    v_and_b32 v241, 0xffff0000, v228
    v_lshlrev_b32 v242, 16, v229
    v_and_b32 v243, 0xffff0000, v229
    v_mfma_f32_32x32x16_bf16 v[128:143], v[32:35], v[24:27], v[128:143]
    s_add_u32 m0, s52, 68128
    s_nop 0
    buffer_load_dwordx4 v3, s[8:11], s50 offen offset:2048 lds
    v_lshlrev_b32 v244, 16, v230
    v_and_b32 v245, 0xffff0000, v230
    v_lshlrev_b32 v246, 16, v231
    v_mfma_f32_32x32x16_bf16 v[144:159], v[36:39], v[24:27], v[144:159]
    v_and_b32 v247, 0xffff0000, v231
    v_add_f32 v216, v232, v233
    v_add_f32 v216, v216, v234
    v_mfma_f32_32x32x16_bf16 v[160:175], v[32:35], v[28:31], v[160:175]
    s_add_u32 m0, s52, 68144
    s_nop 0
    buffer_load_dwordx4 v3, s[8:11], s50 offen offset:3072 lds
    v_add_f32 v216, v216, v235
    v_add_f32 v216, v216, v236
    v_add_f32 v216, v216, v237
    v_mfma_f32_32x32x16_bf16 v[176:191], v[36:39], v[28:31], v[176:191]
    v_add_f32 v216, v216, v238
    v_add_f32 v216, v216, v239
    v_add_f32 v216, v216, v240
    s_add_u32 s50, s50, 128
    s_add_u32 s51, s51, 524288
    s_setprio 1
    s_waitcnt lgkmcnt(0)
    v_mfma_f32_32x32x16_bf16 v[64:79], v[56:59], v[40:43], v[64:79]
    ds_read_b64_tr_b16 v[32:33], v6 offset:8704
    ds_read_b64_tr_b16 v[34:35], v6 offset:8960
    v_add_f32 v216, v216, v241
    v_add_f32 v216, v216, v242
    v_add_f32 v216, v216, v243
    v_mfma_f32_32x32x16_bf16 v[80:95], v[60:63], v[40:43], v[80:95]
    ds_read_b64_tr_b16 v[36:37], v6 offset:8768
    ds_read_b64_tr_b16 v[38:39], v6 offset:9024
    v_add_f32 v216, v216, v244
    v_add_f32 v216, v216, v245
    v_add_f32 v216, v216, v246
    v_mfma_f32_32x32x16_bf16 v[96:111], v[56:59], v[44:47], v[96:111]
    ds_read_b128 v[16:19], v5 offset:64
    ds_read_b128 v[20:23], v5 offset:576
    v_add_f32 v216, v216, v247
    s_nop 1
    v_add_f32_dpp v216, v216, v216 row_ror:8 row_mask:0xf bank_mask:0xf
    v_mfma_f32_32x32x16_bf16 v[112:127], v[60:63], v[44:47], v[112:127]
    ds_read_b128 v[24:27], v5 offset:8384
    ds_read_b128 v[28:31], v5 offset:8896
    s_nop 1
    v_add_f32_dpp v216, v216, v216 row_ror:4 row_mask:0xf bank_mask:0xf
    s_nop 1
    v_mfma_f32_32x32x16_bf16 v[128:143], v[56:59], v[48:51], v[128:143]
    v_add_f32_dpp v216, v216, v216 row_ror:2 row_mask:0xf bank_mask:0xf
    s_nop 1
    v_add_f32_dpp v216, v216, v216 row_ror:1 row_mask:0xf bank_mask:0xf
    v_mfma_f32_32x32x16_bf16 v[144:159], v[60:63], v[48:51], v[144:159]
    v_mov_b32 v217, v216
    s_nop 1
    v_permlane16_swap_b32 v216, v217
    v_mfma_f32_32x32x16_bf16 v[160:175], v[56:59], v[52:55], v[160:175]
    s_nop 1
    v_add_f32 v216, v216, v217
    v_mov_b32 v217, v216
    v_mfma_f32_32x32x16_bf16 v[176:191], v[60:63], v[52:55], v[176:191]
    s_nop 1
    v_permlane32_swap_b32 v216, v217
    s_nop 1
    s_setprio 0
    s_waitcnt lgkmcnt(0)
    v_mfma_f32_32x32x16_bf16 v[64:79], v[32:35], v[16:19], v[64:79]
    ds_read_b64_tr_b16 v[56:57], v6 offset:13056
    ds_read_b64_tr_b16 v[58:59], v6 offset:13312
    v_add_f32 v216, v216, v217
    v_mul_f32 v216, 0x3ae38e39, v216
    v_cmp_gt_u32 vcc, 8, v1
    v_mfma_f32_32x32x16_bf16 v[80:95], v[36:39], v[16:19], v[80:95]
    ds_read_b64_tr_b16 v[60:61], v6 offset:13120
    ds_read_b64_tr_b16 v[62:63], v6 offset:13376
    v_mov_b32 v219, 0
    s_nop 0
    v_cndmask_b32 v218, 0, v216, vcc
    v_mfma_f32_32x32x16_bf16 v[96:111], v[32:35], v[20:23], v[96:111]
    ds_read_b128 v[40:43], v5 offset:96
    ds_read_b128 v[44:47], v5 offset:608
    v_sub_f32 v217, v232, v216
    v_fmac_f32 v219, v217, v217
    v_sub_f32 v217, v233, v216
    v_mfma_f32_32x32x16_bf16 v[112:127], v[36:39], v[20:23], v[112:127]
    ds_read_b128 v[48:51], v5 offset:8416
    ds_read_b128 v[52:55], v5 offset:8928
    v_fmac_f32 v219, v217, v217
    v_sub_f32 v217, v234, v216
    v_fmac_f32 v219, v217, v217
    v_mfma_f32_32x32x16_bf16 v[128:143], v[32:35], v[24:27], v[128:143]
    v_sub_f32 v217, v235, v216
    buffer_load_dwordx4 v[220:223], v3, s[8:11], s63 offen offset:640
    s_add_u32 s56, s7, 2621440
    buffer_load_dwordx4 v[220:223], v4, s[12:15], s56 offen
    v_mfma_f32_32x32x16_bf16 v[144:159], v[36:39], v[24:27], v[144:159]
    v_mfma_f32_32x32x16_bf16 v[160:175], v[32:35], v[28:31], v[160:175]
    v_mfma_f32_32x32x16_bf16 v[176:191], v[36:39], v[28:31], v[176:191]
    v_add_u32 v5, 68096, v5
    v_add_u32 v6, 68096, v6
    s_waitcnt vmcnt(2) lgkmcnt(0)
    s_barrier
    s_setprio 3
    v_mfma_f32_32x32x16_bf16 v[64:79], v[56:59], v[40:43], v[64:79]
    ds_read_b64_tr_b16 v[32:33], v6 offset:0
    ds_read_b64_tr_b16 v[34:35], v6 offset:256
    s_add_u32 m0, s53, 0
    s_add_u32 s55, s51, 0
    buffer_load_dwordx4 v4, s[12:15], s55 offen lds
    v_mfma_f32_32x32x16_bf16 v[80:95], v[60:63], v[40:43], v[80:95]
    ds_read_b64_tr_b16 v[36:37], v6 offset:64
    ds_read_b64_tr_b16 v[38:39], v6 offset:320
    v_mfma_f32_32x32x16_bf16 v[96:111], v[56:59], v[44:47], v[96:111]
    ds_read_b128 v[16:19], v5 offset:0
    ds_read_b128 v[20:23], v5 offset:512
    s_add_u32 m0, s53, 1088
    s_add_u32 s55, s51, 8192
    buffer_load_dwordx4 v4, s[12:15], s55 offen lds
    v_mfma_f32_32x32x16_bf16 v[112:127], v[60:63], v[44:47], v[112:127]
    ds_read_b128 v[24:27], v5 offset:8320
    ds_read_b128 v[28:31], v5 offset:8832
    v_mfma_f32_32x32x16_bf16 v[128:143], v[56:59], v[48:51], v[128:143]
    s_add_u32 m0, s53, 2176
    s_add_u32 s55, s51, 16384
    buffer_load_dwordx4 v4, s[12:15], s55 offen lds
    v_mfma_f32_32x32x16_bf16 v[144:159], v[60:63], v[48:51], v[144:159]
    v_mfma_f32_32x32x16_bf16 v[160:175], v[56:59], v[52:55], v[160:175]
    s_add_u32 m0, s53, 3264
    s_add_u32 s55, s51, 24576
    buffer_load_dwordx4 v4, s[12:15], s55 offen lds
    v_mfma_f32_32x32x16_bf16 v[176:191], v[60:63], v[52:55], v[176:191]
    s_setprio 2
    s_waitcnt lgkmcnt(0)
    v_mfma_f32_32x32x16_bf16 v[64:79], v[32:35], v[16:19], v[64:79]
    ds_read_b64_tr_b16 v[56:57], v6 offset:4352
    ds_read_b64_tr_b16 v[58:59], v6 offset:4608
    s_add_u32 m0, s52, 0
    s_nop 0
    buffer_load_dwordx4 v3, s[8:11], s50 offen offset:0 lds
    v_mfma_f32_32x32x16_bf16 v[80:95], v[36:39], v[16:19], v[80:95]
    ds_read_b64_tr_b16 v[60:61], v6 offset:4416
    ds_read_b64_tr_b16 v[62:63], v6 offset:4672
    v_mfma_f32_32x32x16_bf16 v[96:111], v[32:35], v[20:23], v[96:111]
    ds_read_b128 v[40:43], v5 offset:32
    ds_read_b128 v[44:47], v5 offset:544
    s_add_u32 m0, s52, 16
    s_nop 0
    buffer_load_dwordx4 v3, s[8:11], s50 offen offset:1024 lds
    v_mfma_f32_32x32x16_bf16 v[112:127], v[36:39], v[20:23], v[112:127]
    ds_read_b128 v[48:51], v5 offset:8352
    ds_read_b128 v[52:55], v5 offset:8864
    v_mfma_f32_32x32x16_bf16 v[128:143], v[32:35], v[24:27], v[128:143]
    s_add_u32 m0, s52, 32
    s_nop 0
    buffer_load_dwordx4 v3, s[8:11], s50 offen offset:2048 lds
    v_mfma_f32_32x32x16_bf16 v[144:159], v[36:39], v[24:27], v[144:159]
    v_mfma_f32_32x32x16_bf16 v[160:175], v[32:35], v[28:31], v[160:175]
    s_add_u32 m0, s52, 48
    s_nop 0
    buffer_load_dwordx4 v3, s[8:11], s50 offen offset:3072 lds
    v_mfma_f32_32x32x16_bf16 v[176:191], v[36:39], v[28:31], v[176:191]
    s_add_u32 s50, s50, 128
    s_add_u32 s51, s51, 524288
    s_setprio 1
    s_waitcnt lgkmcnt(0)
    v_mfma_f32_32x32x16_bf16 v[64:79], v[56:59], v[40:43], v[64:79]
    ds_read_b64_tr_b16 v[32:33], v6 offset:8704
    ds_read_b64_tr_b16 v[34:35], v6 offset:8960
    v_fmac_f32 v219, v217, v217
    v_sub_f32 v217, v236, v216
    v_fmac_f32 v219, v217, v217
    v_sub_f32 v217, v237, v216
    v_mfma_f32_32x32x16_bf16 v[80:95], v[60:63], v[40:43], v[80:95]
    ds_read_b64_tr_b16 v[36:37], v6 offset:8768
    ds_read_b64_tr_b16 v[38:39], v6 offset:9024
    v_fmac_f32 v219, v217, v217
    v_sub_f32 v217, v238, v216
    v_fmac_f32 v219, v217, v217
    v_sub_f32 v217, v239, v216
    v_mfma_f32_32x32x16_bf16 v[96:111], v[56:59], v[44:47], v[96:111]
    ds_read_b128 v[16:19], v5 offset:64
    ds_read_b128 v[20:23], v5 offset:576
    v_fmac_f32 v219, v217, v217
    v_sub_f32 v217, v240, v218
    v_fmac_f32 v219, v217, v217
    v_sub_f32 v217, v241, v218
    v_mfma_f32_32x32x16_bf16 v[112:127], v[60:63], v[44:47], v[112:127]
    ds_read_b128 v[24:27], v5 offset:8384
    ds_read_b128 v[28:31], v5 offset:8896
    v_fmac_f32 v219, v217, v217
    v_sub_f32 v217, v242, v218
    v_fmac_f32 v219, v217, v217
    v_sub_f32 v217, v243, v218
    v_mfma_f32_32x32x16_bf16 v[128:143], v[56:59], v[48:51], v[128:143]
    v_fmac_f32 v219, v217, v217
    v_sub_f32 v217, v244, v218
    v_fmac_f32 v219, v217, v217
    v_sub_f32 v217, v245, v218
    v_mfma_f32_32x32x16_bf16 v[144:159], v[60:63], v[48:51], v[144:159]
    v_fmac_f32 v219, v217, v217
    v_sub_f32 v217, v246, v218
    v_fmac_f32 v219, v217, v217
    v_sub_f32 v217, v247, v218
    v_mfma_f32_32x32x16_bf16 v[160:175], v[56:59], v[52:55], v[160:175]
    v_fmac_f32 v219, v217, v217
    s_nop 1
    v_add_f32_dpp v219, v219, v219 row_ror:8 row_mask:0xf bank_mask:0xf
    s_nop 1
    v_mfma_f32_32x32x16_bf16 v[176:191], v[60:63], v[52:55], v[176:191]
    v_add_f32_dpp v219, v219, v219 row_ror:4 row_mask:0xf bank_mask:0xf
    s_nop 1
    v_add_f32_dpp v219, v219, v219 row_ror:2 row_mask:0xf bank_mask:0xf
    s_nop 1
    s_setprio 0
    s_waitcnt lgkmcnt(0)
    v_mfma_f32_32x32x16_bf16 v[64:79], v[32:35], v[16:19], v[64:79]
    ds_read_b64_tr_b16 v[56:57], v6 offset:13056
    ds_read_b64_tr_b16 v[58:59], v6 offset:13312
    v_add_f32_dpp v219, v219, v219 row_ror:1 row_mask:0xf bank_mask:0xf
    v_mov_b32 v217, v219
    s_nop 1
    v_permlane16_swap_b32 v219, v217
    v_mfma_f32_32x32x16_bf16 v[80:95], v[36:39], v[16:19], v[80:95]
    ds_read_b64_tr_b16 v[60:61], v6 offset:13120
    ds_read_b64_tr_b16 v[62:63], v6 offset:13376
    s_nop 1
    v_add_f32 v219, v219, v217
    v_mov_b32 v217, v219
    s_nop 1
    v_mfma_f32_32x32x16_bf16 v[96:111], v[32:35], v[20:23], v[96:111]
    ds_read_b128 v[40:43], v5 offset:96
    ds_read_b128 v[44:47], v5 offset:608
    v_permlane32_swap_b32 v219, v217
    s_nop 1
    v_add_f32 v219, v219, v217
    v_mul_f32 v219, 0x3ae38e39, v219
    v_mfma_f32_32x32x16_bf16 v[112:127], v[36:39], v[20:23], v[112:127]
    ds_read_b128 v[48:51], v5 offset:8416
    ds_read_b128 v[52:55], v5 offset:8928
    v_cvt_pk_bf16_f32 v216, v216, v216
    v_and_b32 v216, 0xffff0000, v216
    v_cvt_pk_bf16_f32 v219, v219, v219
    v_and_b32 v219, 0xffff0000, v219
    v_mfma_f32_32x32x16_bf16 v[128:143], v[32:35], v[24:27], v[128:143]
    v_add_f32 v219, 0x3727c5ac, v219
    v_cvt_pk_bf16_f32 v219, v219, v219
    v_and_b32 v219, 0xffff0000, v219
    v_sqrt_f32 v219, v219
    v_mfma_f32_32x32x16_bf16 v[144:159], v[36:39], v[24:27], v[144:159]
    s_nop 0
    v_cvt_pk_bf16_f32 v219, v219, v219
    v_and_b32 v219, 0xffff0000, v219
    v_rcp_f32 v219, v219
    v_mfma_f32_32x32x16_bf16 v[160:175], v[32:35], v[28:31], v[160:175]
    s_nop 0
    v_sub_f32 v232, v232, v216
    v_sub_f32 v233, v233, v216
    v_sub_f32 v234, v234, v216
    v_mfma_f32_32x32x16_bf16 v[176:191], v[36:39], v[28:31], v[176:191]
    v_sub_f32 v235, v235, v216
    buffer_load_dwordx4 v[220:223], v3, s[8:11], s63 offen offset:768
    s_add_u32 s56, s7, 3145728
    buffer_load_dwordx4 v[220:223], v4, s[12:15], s56 offen
    v_add_u32 v5, 4294899200, v5
    v_add_u32 v6, 4294899200, v6
    s_waitcnt vmcnt(2) lgkmcnt(0)
    s_barrier
    s_setprio 3
    v_mfma_f32_32x32x16_bf16 v[64:79], v[56:59], v[40:43], v[64:79]
    ds_read_b64_tr_b16 v[32:33], v6 offset:0
    ds_read_b64_tr_b16 v[34:35], v6 offset:256
    s_add_u32 m0, s53, 68096
    s_add_u32 s55, s51, 0
    buffer_load_dwordx4 v4, s[12:15], s55 offen lds
    v_mfma_f32_32x32x16_bf16 v[80:95], v[60:63], v[40:43], v[80:95]
    ds_read_b64_tr_b16 v[36:37], v6 offset:64
    ds_read_b64_tr_b16 v[38:39], v6 offset:320
    v_mfma_f32_32x32x16_bf16 v[96:111], v[56:59], v[44:47], v[96:111]
    ds_read_b128 v[16:19], v5 offset:0
    ds_read_b128 v[20:23], v5 offset:512
    s_add_u32 m0, s53, 69184
    s_add_u32 s55, s51, 8192
    buffer_load_dwordx4 v4, s[12:15], s55 offen lds
    v_mfma_f32_32x32x16_bf16 v[112:127], v[60:63], v[44:47], v[112:127]
    ds_read_b128 v[24:27], v5 offset:8320
    ds_read_b128 v[28:31], v5 offset:8832
    v_mfma_f32_32x32x16_bf16 v[128:143], v[56:59], v[48:51], v[128:143]
    s_add_u32 m0, s53, 70272
    s_add_u32 s55, s51, 16384
    buffer_load_dwordx4 v4, s[12:15], s55 offen lds
    v_mfma_f32_32x32x16_bf16 v[144:159], v[60:63], v[48:51], v[144:159]
    v_mfma_f32_32x32x16_bf16 v[160:175], v[56:59], v[52:55], v[160:175]
    s_add_u32 m0, s53, 71360
    s_add_u32 s55, s51, 24576
    buffer_load_dwordx4 v4, s[12:15], s55 offen lds
    v_mfma_f32_32x32x16_bf16 v[176:191], v[60:63], v[52:55], v[176:191]
    s_setprio 2
    s_waitcnt lgkmcnt(0)
    v_mfma_f32_32x32x16_bf16 v[64:79], v[32:35], v[16:19], v[64:79]
    ds_read_b64_tr_b16 v[56:57], v6 offset:4352
    ds_read_b64_tr_b16 v[58:59], v6 offset:4608
    s_add_u32 m0, s52, 68096
    s_nop 0
    buffer_load_dwordx4 v3, s[8:11], s50 offen offset:0 lds
    v_mfma_f32_32x32x16_bf16 v[80:95], v[36:39], v[16:19], v[80:95]
    ds_read_b64_tr_b16 v[60:61], v6 offset:4416
    ds_read_b64_tr_b16 v[62:63], v6 offset:4672
    v_mfma_f32_32x32x16_bf16 v[96:111], v[32:35], v[20:23], v[96:111]
    ds_read_b128 v[40:43], v5 offset:32
    ds_read_b128 v[44:47], v5 offset:544
    s_add_u32 m0, s52, 68112
    s_nop 0
    buffer_load_dwordx4 v3, s[8:11], s50 offen offset:1024 lds
    v_mfma_f32_32x32x16_bf16 v[112:127], v[36:39], v[20:23], v[112:127]
    ds_read_b128 v[48:51], v5 offset:8352
    ds_read_b128 v[52:55], v5 offset:8864
    v_mfma_f32_32x32x16_bf16 v[128:143], v[32:35], v[24:27], v[128:143]
    s_add_u32 m0, s52, 68128
    s_nop 0
    buffer_load_dwordx4 v3, s[8:11], s50 offen offset:2048 lds
    v_mfma_f32_32x32x16_bf16 v[144:159], v[36:39], v[24:27], v[144:159]
    v_mfma_f32_32x32x16_bf16 v[160:175], v[32:35], v[28:31], v[160:175]
    s_add_u32 m0, s52, 68144
    s_nop 0
    buffer_load_dwordx4 v3, s[8:11], s50 offen offset:3072 lds
    v_mfma_f32_32x32x16_bf16 v[176:191], v[36:39], v[28:31], v[176:191]
    s_add_u32 s50, s50, 128
    s_add_u32 s51, s51, 524288
    s_setprio 1
    s_waitcnt lgkmcnt(0)
    v_mfma_f32_32x32x16_bf16 v[64:79], v[56:59], v[40:43], v[64:79]
    ds_read_b64_tr_b16 v[32:33], v6 offset:8704
    ds_read_b64_tr_b16 v[34:35], v6 offset:8960
    v_sub_f32 v236, v236, v216
    v_sub_f32 v237, v237, v216
    v_sub_f32 v238, v238, v216
    v_sub_f32 v239, v239, v216
    v_sub_f32 v240, v240, v216
    v_mfma_f32_32x32x16_bf16 v[80:95], v[60:63], v[40:43], v[80:95]
    ds_read_b64_tr_b16 v[36:37], v6 offset:8768
    ds_read_b64_tr_b16 v[38:39], v6 offset:9024
    v_sub_f32 v241, v241, v216
    v_sub_f32 v242, v242, v216
    v_sub_f32 v243, v243, v216
    v_sub_f32 v244, v244, v216
    v_sub_f32 v245, v245, v216
    v_mfma_f32_32x32x16_bf16 v[96:111], v[56:59], v[44:47], v[96:111]
    ds_read_b128 v[16:19], v5 offset:64
    ds_read_b128 v[20:23], v5 offset:576
    v_sub_f32 v246, v246, v216
    v_sub_f32 v247, v247, v216
    v_cvt_pk_bf16_f32 v217, v232, v233
    v_lshlrev_b32 v232, 16, v217
    v_and_b32 v233, 0xffff0000, v217
    v_mfma_f32_32x32x16_bf16 v[112:127], v[60:63], v[44:47], v[112:127]
    ds_read_b128 v[24:27], v5 offset:8384
    ds_read_b128 v[28:31], v5 offset:8896
    v_cvt_pk_bf16_f32 v217, v234, v235
    v_lshlrev_b32 v234, 16, v217
    v_and_b32 v235, 0xffff0000, v217
    v_cvt_pk_bf16_f32 v217, v236, v237
    v_lshlrev_b32 v236, 16, v217
    v_mfma_f32_32x32x16_bf16 v[128:143], v[56:59], v[48:51], v[128:143]
    s_cmp_lg_u32 s3, 0
    s_cbranch_scc1 Lkv_npl
    buffer_load_dword v15, v11, s[36:39], 0 offen sc1
Lkv_npl:
    s_mul_i32 s55, s60, 2304
    v_lshlrev_b32 v2, 4, v1
    buffer_load_dwordx4 v[220:223], v2, s[16:19], s55 offen offset:0
    buffer_load_dwordx4 v[220:223], v2, s[16:19], s55 offen offset:1024
    buffer_load_dwordx4 v[220:223], v2, s[16:19], s55 offen offset:2048
    v_mfma_f32_32x32x16_bf16 v[144:159], v[60:63], v[48:51], v[144:159]
    v_and_b32 v237, 0xffff0000, v217
    v_cvt_pk_bf16_f32 v217, v238, v239
    v_lshlrev_b32 v238, 16, v217
    v_and_b32 v239, 0xffff0000, v217
    v_cvt_pk_bf16_f32 v217, v240, v241
    v_mfma_f32_32x32x16_bf16 v[160:175], v[56:59], v[52:55], v[160:175]
    v_lshlrev_b32 v240, 16, v217
    v_and_b32 v241, 0xffff0000, v217
    v_cvt_pk_bf16_f32 v217, v242, v243
    v_lshlrev_b32 v242, 16, v217
    v_and_b32 v243, 0xffff0000, v217
    v_mfma_f32_32x32x16_bf16 v[176:191], v[60:63], v[52:55], v[176:191]
    v_cvt_pk_bf16_f32 v217, v244, v245
    v_lshlrev_b32 v244, 16, v217
    v_and_b32 v245, 0xffff0000, v217
    v_cvt_pk_bf16_f32 v217, v246, v247
    v_lshlrev_b32 v246, 16, v217
    s_setprio 0
    s_waitcnt lgkmcnt(0)
    v_mfma_f32_32x32x16_bf16 v[64:79], v[32:35], v[16:19], v[64:79]
    ds_read_b64_tr_b16 v[56:57], v6 offset:13056
    ds_read_b64_tr_b16 v[58:59], v6 offset:13312
    v_and_b32 v247, 0xffff0000, v217
    v_mul_f32 v232, v232, v219
    v_mul_f32 v233, v233, v219
    v_mul_f32 v234, v234, v219
    v_mul_f32 v235, v235, v219
    v_mfma_f32_32x32x16_bf16 v[80:95], v[36:39], v[16:19], v[80:95]
    ds_read_b64_tr_b16 v[60:61], v6 offset:13120
    ds_read_b64_tr_b16 v[62:63], v6 offset:13376
    v_mul_f32 v236, v236, v219
    v_mul_f32 v237, v237, v219
    v_mul_f32 v238, v238, v219
    v_mul_f32 v239, v239, v219
    v_mul_f32 v240, v240, v219
    v_mfma_f32_32x32x16_bf16 v[96:111], v[32:35], v[20:23], v[96:111]
    ds_read_b128 v[40:43], v5 offset:96
    ds_read_b128 v[44:47], v5 offset:608
    v_mul_f32 v241, v241, v219
    v_mul_f32 v242, v242, v219
    v_mul_f32 v243, v243, v219
    v_mul_f32 v244, v244, v219
    v_mul_f32 v245, v245, v219
    v_mfma_f32_32x32x16_bf16 v[112:127], v[36:39], v[20:23], v[112:127]
    ds_read_b128 v[48:51], v5 offset:8416
    ds_read_b128 v[52:55], v5 offset:8928
    v_mul_f32 v246, v246, v219
    v_mul_f32 v247, v247, v219
    v_cvt_pk_bf16_f32 v248, v232, v233
    v_cvt_pk_bf16_f32 v249, v234, v235
    v_cvt_pk_bf16_f32 v250, v236, v237
    v_mfma_f32_32x32x16_bf16 v[128:143], v[32:35], v[24:27], v[128:143]
    v_cvt_pk_bf16_f32 v251, v238, v239
    v_cvt_pk_bf16_f32 v252, v240, v241
    v_cvt_pk_bf16_f32 v253, v242, v243
    v_cvt_pk_bf16_f32 v254, v244, v245
    v_cvt_pk_bf16_f32 v255, v246, v247
    v_mfma_f32_32x32x16_bf16 v[144:159], v[36:39], v[24:27], v[144:159]
    ds_write_b128 v14, v[248:251]
    ds_write_b128 v14, v[252:255] offset:8192
    buffer_load_dwordx4 v[220:223], v3, s[8:11], s63 offen offset:896
    s_add_u32 s56, s7, 3670016
    buffer_load_dwordx4 v[220:223], v4, s[12:15], s56 offen
    v_mfma_f32_32x32x16_bf16 v[160:175], v[32:35], v[28:31], v[160:175]
    v_mfma_f32_32x32x16_bf16 v[176:191], v[36:39], v[28:31], v[176:191]
    v_add_u32 v5, 68096, v5
    v_add_u32 v6, 68096, v6
    s_waitcnt vmcnt(5) lgkmcnt(0)
    s_cmp_lg_u32 s3, 0
    s_cbranch_scc1 Lkv_mpd
    s_mov_b32 s100, 0x8000
Lkv_mp:
    v_cmp_gt_u32 vcc, 64, v15
    s_sub_u32 s100, s100, 1
    s_cbranch_vccz Lkv_mpd
    s_cmp_eq_u32 s100, 0
    s_cbranch_scc1 Lkv_mpd
    buffer_load_dword v15, v11, s[36:39], 0 offen sc1
    s_waitcnt vmcnt(0)
    s_branch Lkv_mp
Lkv_mpd:
    s_barrier
    s_setprio 3
    v_lshlrev_b32 v10, 4, v0
    v_add_u32 v10, 138240, v10
    s_mov_b32 s55, 0
    buffer_load_dwordx4 v[192:195], v12, s[40:43], s55 offen sc1
    s_mov_b32 s55, 13824
    buffer_load_dwordx4 v[196:199], v12, s[40:43], s55 offen sc1
    s_mov_b32 s55, 27648
    buffer_load_dwordx4 v[200:203], v12, s[40:43], s55 offen sc1
    s_mov_b32 s55, 41472
    buffer_load_dwordx4 v[204:207], v12, s[40:43], s55 offen sc1
    v_mfma_f32_32x32x16_bf16 v[64:79], v[56:59], v[40:43], v[64:79]
    ds_read_b64_tr_b16 v[32:33], v6 offset:0
    ds_read_b64_tr_b16 v[34:35], v6 offset:256
    s_add_u32 m0, s53, 0
    s_add_u32 s55, s51, 0
    buffer_load_dwordx4 v4, s[12:15], s55 offen lds
    v_mfma_f32_32x32x16_bf16 v[80:95], v[60:63], v[40:43], v[80:95]
    ds_read_b64_tr_b16 v[36:37], v6 offset:64
    ds_read_b64_tr_b16 v[38:39], v6 offset:320
    v_mfma_f32_32x32x16_bf16 v[96:111], v[56:59], v[44:47], v[96:111]
    ds_read_b128 v[16:19], v5 offset:0
    ds_read_b128 v[20:23], v5 offset:512
    s_add_u32 m0, s53, 1088
    s_add_u32 s55, s51, 8192
    buffer_load_dwordx4 v4, s[12:15], s55 offen lds
    v_mfma_f32_32x32x16_bf16 v[112:127], v[60:63], v[44:47], v[112:127]
    ds_read_b128 v[24:27], v5 offset:8320
    ds_read_b128 v[28:31], v5 offset:8832
    v_mfma_f32_32x32x16_bf16 v[128:143], v[56:59], v[48:51], v[128:143]
    s_add_u32 m0, s53, 2176
    s_add_u32 s55, s51, 16384
    buffer_load_dwordx4 v4, s[12:15], s55 offen lds
    v_mfma_f32_32x32x16_bf16 v[144:159], v[60:63], v[48:51], v[144:159]
    v_mfma_f32_32x32x16_bf16 v[160:175], v[56:59], v[52:55], v[160:175]
    s_add_u32 m0, s53, 3264
    s_add_u32 s55, s51, 24576
    buffer_load_dwordx4 v4, s[12:15], s55 offen lds
    v_mfma_f32_32x32x16_bf16 v[176:191], v[60:63], v[52:55], v[176:191]
    s_setprio 2
    s_waitcnt lgkmcnt(0)
    v_mfma_f32_32x32x16_bf16 v[64:79], v[32:35], v[16:19], v[64:79]
    ds_read_b64_tr_b16 v[56:57], v6 offset:4352
    ds_read_b64_tr_b16 v[58:59], v6 offset:4608
    s_add_u32 m0, s52, 0
    s_nop 0
    buffer_load_dwordx4 v3, s[8:11], s50 offen offset:0 lds
    v_mfma_f32_32x32x16_bf16 v[80:95], v[36:39], v[16:19], v[80:95]
    ds_read_b64_tr_b16 v[60:61], v6 offset:4416
    ds_read_b64_tr_b16 v[62:63], v6 offset:4672
    v_mfma_f32_32x32x16_bf16 v[96:111], v[32:35], v[20:23], v[96:111]
    ds_read_b128 v[40:43], v5 offset:32
    ds_read_b128 v[44:47], v5 offset:544
    s_add_u32 m0, s52, 16
    s_nop 0
    buffer_load_dwordx4 v3, s[8:11], s50 offen offset:1024 lds
    v_mfma_f32_32x32x16_bf16 v[112:127], v[36:39], v[20:23], v[112:127]
    ds_read_b128 v[48:51], v5 offset:8352
    ds_read_b128 v[52:55], v5 offset:8864
    v_mfma_f32_32x32x16_bf16 v[128:143], v[32:35], v[24:27], v[128:143]
    s_add_u32 m0, s52, 32
    s_nop 0
    buffer_load_dwordx4 v3, s[8:11], s50 offen offset:2048 lds
    v_mfma_f32_32x32x16_bf16 v[144:159], v[36:39], v[24:27], v[144:159]
    v_mfma_f32_32x32x16_bf16 v[160:175], v[32:35], v[28:31], v[160:175]
    s_add_u32 m0, s52, 48
    s_nop 0
    buffer_load_dwordx4 v3, s[8:11], s50 offen offset:3072 lds
    v_mfma_f32_32x32x16_bf16 v[176:191], v[36:39], v[28:31], v[176:191]
    s_add_u32 s50, s50, 128
    s_add_u32 s51, s51, 524288
    s_setprio 1
    s_waitcnt lgkmcnt(0)
    v_mfma_f32_32x32x16_bf16 v[64:79], v[56:59], v[40:43], v[64:79]
    ds_read_b64_tr_b16 v[32:33], v6 offset:8704
    ds_read_b64_tr_b16 v[34:35], v6 offset:8960
    v_mfma_f32_32x32x16_bf16 v[80:95], v[60:63], v[40:43], v[80:95]
    ds_read_b64_tr_b16 v[36:37], v6 offset:8768
    ds_read_b64_tr_b16 v[38:39], v6 offset:9024
    v_mfma_f32_32x32x16_bf16 v[96:111], v[56:59], v[44:47], v[96:111]
    ds_read_b128 v[16:19], v5 offset:64
    ds_read_b128 v[20:23], v5 offset:576
    v_mfma_f32_32x32x16_bf16 v[112:127], v[60:63], v[44:47], v[112:127]
    ds_read_b128 v[24:27], v5 offset:8384
    ds_read_b128 v[28:31], v5 offset:8896
    v_mfma_f32_32x32x16_bf16 v[128:143], v[56:59], v[48:51], v[128:143]
    v_mfma_f32_32x32x16_bf16 v[144:159], v[60:63], v[48:51], v[144:159]
    v_mfma_f32_32x32x16_bf16 v[160:175], v[56:59], v[52:55], v[160:175]
    v_mfma_f32_32x32x16_bf16 v[176:191], v[60:63], v[52:55], v[176:191]
    s_waitcnt vmcnt(8)
    v_add_f32 v192, v192, v196
    s_setprio 0
    s_waitcnt lgkmcnt(0)
    v_mfma_f32_32x32x16_bf16 v[64:79], v[32:35], v[16:19], v[64:79]
    ds_read_b64_tr_b16 v[56:57], v6 offset:13056
    ds_read_b64_tr_b16 v[58:59], v6 offset:13312
    v_add_f32 v200, v200, v204
    v_add_f32 v193, v193, v197
    v_add_f32 v201, v201, v205
    v_add_f32 v194, v194, v198
    v_mfma_f32_32x32x16_bf16 v[80:95], v[36:39], v[16:19], v[80:95]
    ds_read_b64_tr_b16 v[60:61], v6 offset:13120
    ds_read_b64_tr_b16 v[62:63], v6 offset:13376
    v_add_f32 v202, v202, v206
    v_add_f32 v195, v195, v199
    v_add_f32 v203, v203, v207
    v_add_f32 v192, v192, v200
    v_mfma_f32_32x32x16_bf16 v[96:111], v[32:35], v[20:23], v[96:111]
    ds_read_b128 v[40:43], v5 offset:96
    ds_read_b128 v[44:47], v5 offset:608
    v_add_f32 v193, v193, v201
    v_add_f32 v194, v194, v202
    v_add_f32 v195, v195, v203
    v_cvt_pk_bf16_f32 v2, v192, v193
    v_mfma_f32_32x32x16_bf16 v[112:127], v[36:39], v[20:23], v[112:127]
    ds_read_b128 v[48:51], v5 offset:8416
    ds_read_b128 v[52:55], v5 offset:8928
    v_lshlrev_b32 v192, 16, v2
    v_and_b32 v193, 0xffff0000, v2
    v_cvt_pk_bf16_f32 v2, v194, v195
    v_lshlrev_b32 v194, 16, v2
    v_mfma_f32_32x32x16_bf16 v[128:143], v[32:35], v[24:27], v[128:143]
    v_and_b32 v195, 0xffff0000, v2
    v_cmp_lt_u32 vcc, 143, v0
    s_nop 1
    v_cndmask_b32 v196, 0, 1.0, vcc
    v_mfma_f32_32x32x16_bf16 v[144:159], v[36:39], v[24:27], v[144:159]
    v_add_f32 v192, v192, v196
    v_add_f32 v193, v193, v196
    v_add_f32 v194, v194, v196
    v_add_f32 v195, v195, v196
    v_mfma_f32_32x32x16_bf16 v[160:175], v[32:35], v[28:31], v[160:175]
    v_cvt_pk_bf16_f32 v2, v192, v193
    v_lshlrev_b32 v192, 16, v2
    v_and_b32 v193, 0xffff0000, v2
    v_cvt_pk_bf16_f32 v2, v194, v195
    v_mfma_f32_32x32x16_bf16 v[176:191], v[36:39], v[28:31], v[176:191]
    v_lshlrev_b32 v194, 16, v2
    v_and_b32 v195, 0xffff0000, v2
    ds_write_b128 v10, v[192:195]
    v_add_u32 v5, 4294899200, v5
    v_add_u32 v6, 4294899200, v6
    s_waitcnt vmcnt(0) lgkmcnt(0)
    s_barrier
    s_setprio 3
    v_mfma_f32_32x32x16_bf16 v[64:79], v[56:59], v[40:43], v[64:79]
    ds_read_b64_tr_b16 v[32:33], v6 offset:0
    ds_read_b64_tr_b16 v[34:35], v6 offset:256
    s_add_u32 m0, s53, 68096
    s_add_u32 s55, s51, 0
    buffer_load_dwordx4 v4, s[12:15], s55 offen lds
    v_mfma_f32_32x32x16_bf16 v[80:95], v[60:63], v[40:43], v[80:95]
    ds_read_b64_tr_b16 v[36:37], v6 offset:64
    ds_read_b64_tr_b16 v[38:39], v6 offset:320
    v_mfma_f32_32x32x16_bf16 v[96:111], v[56:59], v[44:47], v[96:111]
    ds_read_b128 v[16:19], v5 offset:0
    ds_read_b128 v[20:23], v5 offset:512
    s_add_u32 m0, s53, 69184
    s_add_u32 s55, s51, 8192
    buffer_load_dwordx4 v4, s[12:15], s55 offen lds
    v_mfma_f32_32x32x16_bf16 v[112:127], v[60:63], v[44:47], v[112:127]
    ds_read_b128 v[24:27], v5 offset:8320
    ds_read_b128 v[28:31], v5 offset:8832
    v_mfma_f32_32x32x16_bf16 v[128:143], v[56:59], v[48:51], v[128:143]
    s_add_u32 m0, s53, 70272
    s_add_u32 s55, s51, 16384
    buffer_load_dwordx4 v4, s[12:15], s55 offen lds
    v_mfma_f32_32x32x16_bf16 v[144:159], v[60:63], v[48:51], v[144:159]
    v_mfma_f32_32x32x16_bf16 v[160:175], v[56:59], v[52:55], v[160:175]
    s_add_u32 m0, s53, 71360
    s_add_u32 s55, s51, 24576
    buffer_load_dwordx4 v4, s[12:15], s55 offen lds
    v_mfma_f32_32x32x16_bf16 v[176:191], v[60:63], v[52:55], v[176:191]
    s_setprio 2
    s_waitcnt lgkmcnt(0)
    v_mfma_f32_32x32x16_bf16 v[64:79], v[32:35], v[16:19], v[64:79]
    ds_read_b64_tr_b16 v[56:57], v6 offset:4352
    ds_read_b64_tr_b16 v[58:59], v6 offset:4608
    s_add_u32 m0, s52, 68096
    s_nop 0
    buffer_load_dwordx4 v3, s[8:11], s50 offen offset:0 lds
    v_mfma_f32_32x32x16_bf16 v[80:95], v[36:39], v[16:19], v[80:95]
    ds_read_b64_tr_b16 v[60:61], v6 offset:4416
    ds_read_b64_tr_b16 v[62:63], v6 offset:4672
    v_mfma_f32_32x32x16_bf16 v[96:111], v[32:35], v[20:23], v[96:111]
    ds_read_b128 v[40:43], v5 offset:32
    ds_read_b128 v[44:47], v5 offset:544
    s_add_u32 m0, s52, 68112
    s_nop 0
    buffer_load_dwordx4 v3, s[8:11], s50 offen offset:1024 lds
    v_mfma_f32_32x32x16_bf16 v[112:127], v[36:39], v[20:23], v[112:127]
    ds_read_b128 v[48:51], v5 offset:8352
    ds_read_b128 v[52:55], v5 offset:8864
    v_mfma_f32_32x32x16_bf16 v[128:143], v[32:35], v[24:27], v[128:143]
    s_add_u32 m0, s52, 68128
    s_nop 0
    buffer_load_dwordx4 v3, s[8:11], s50 offen offset:2048 lds
    v_mfma_f32_32x32x16_bf16 v[144:159], v[36:39], v[24:27], v[144:159]
    v_mfma_f32_32x32x16_bf16 v[160:175], v[32:35], v[28:31], v[160:175]
    s_add_u32 m0, s52, 68144
    s_nop 0
    buffer_load_dwordx4 v3, s[8:11], s50 offen offset:3072 lds
    v_mfma_f32_32x32x16_bf16 v[176:191], v[36:39], v[28:31], v[176:191]
    s_add_u32 s50, s50, 128
    s_add_u32 s51, s51, 524288
    s_setprio 1
    s_waitcnt lgkmcnt(0)
    v_mfma_f32_32x32x16_bf16 v[64:79], v[56:59], v[40:43], v[64:79]
    ds_read_b64_tr_b16 v[32:33], v6 offset:8704
    ds_read_b64_tr_b16 v[34:35], v6 offset:8960
    ds_read_b128 v[224:227], v10 offset:8192
    ds_read_b128 v[192:195], v9 offset:0
    ds_read_b128 v[196:199], v9 offset:16
    ds_read_b128 v[200:203], v9 offset:2304
    ds_read_b128 v[204:207], v9 offset:2320
    s_waitcnt lgkmcnt(0)
    v_mfma_f32_32x32x16_bf16 v[80:95], v[60:63], v[40:43], v[80:95]
    ds_read_b64_tr_b16 v[36:37], v6 offset:8768
    ds_read_b64_tr_b16 v[38:39], v6 offset:9024
    v_lshlrev_b32 v232, 16, v224
    v_and_b32 v233, 0xffff0000, v224
    v_lshlrev_b32 v234, 16, v225
    v_and_b32 v235, 0xffff0000, v225
    v_lshlrev_b32 v236, 16, v226
    v_and_b32 v237, 0xffff0000, v226
    v_mfma_f32_32x32x16_bf16 v[96:111], v[56:59], v[44:47], v[96:111]
    ds_read_b128 v[16:19], v5 offset:64
    ds_read_b128 v[20:23], v5 offset:576
    v_lshlrev_b32 v238, 16, v227
    v_and_b32 v239, 0xffff0000, v227
    v_mul_f32 v232, v232, v200
    v_mul_f32 v233, v233, v201
    v_mul_f32 v234, v234, v202
    v_mul_f32 v235, v235, v203
    v_mfma_f32_32x32x16_bf16 v[112:127], v[60:63], v[44:47], v[112:127]
    ds_read_b128 v[24:27], v5 offset:8384
    ds_read_b128 v[28:31], v5 offset:8896
    v_mul_f32 v236, v236, v204
    v_mul_f32 v237, v237, v205
    v_mul_f32 v238, v238, v206
    v_mul_f32 v239, v239, v207
    v_cvt_pk_bf16_f32 v2, v232, v233
    v_lshlrev_b32 v232, 16, v2
    v_mfma_f32_32x32x16_bf16 v[128:143], v[56:59], v[48:51], v[128:143]
    v_and_b32 v233, 0xffff0000, v2
    v_cvt_pk_bf16_f32 v2, v234, v235
    v_lshlrev_b32 v234, 16, v2
    v_and_b32 v235, 0xffff0000, v2
    v_cvt_pk_bf16_f32 v2, v236, v237
    v_lshlrev_b32 v236, 16, v2
    v_mfma_f32_32x32x16_bf16 v[144:159], v[60:63], v[48:51], v[144:159]
    v_and_b32 v237, 0xffff0000, v2
    v_cvt_pk_bf16_f32 v2, v238, v239
    v_lshlrev_b32 v238, 16, v2
    v_and_b32 v239, 0xffff0000, v2
    v_add_f32 v232, v232, v192
    v_add_f32 v233, v233, v193
    v_mfma_f32_32x32x16_bf16 v[160:175], v[56:59], v[52:55], v[160:175]
    v_add_f32 v234, v234, v194
    v_add_f32 v235, v235, v195
    v_add_f32 v236, v236, v196
    v_add_f32 v237, v237, v197
    v_add_f32 v238, v238, v198
    v_add_f32 v239, v239, v199
    v_mfma_f32_32x32x16_bf16 v[176:191], v[60:63], v[52:55], v[176:191]
    v_cvt_pk_bf16_f32 v228, v232, v233
    v_cvt_pk_bf16_f32 v229, v234, v235
    v_cvt_pk_bf16_f32 v230, v236, v237
    v_cvt_pk_bf16_f32 v231, v238, v239
    s_add_u32 s55, s62, 0
    buffer_store_dwordx4 v[228:231], v13, s[24:27], s55 offen sc1
    s_cmp_lg_u32 s3, 0
    s_cbranch_scc1 Lkv_noh2
    ds_read_b128 v[224:227], v10 offset:16384
    ds_read_b128 v[192:195], v9 offset:2048
    ds_read_b128 v[196:199], v9 offset:2064
    ds_read_b128 v[200:203], v9 offset:4352
    ds_read_b128 v[204:207], v9 offset:4368
    s_waitcnt lgkmcnt(0)
    v_lshlrev_b32 v232, 16, v224
    v_and_b32 v233, 0xffff0000, v224
    v_lshlrev_b32 v234, 16, v225
    v_and_b32 v235, 0xffff0000, v225
    v_lshlrev_b32 v236, 16, v226
    v_and_b32 v237, 0xffff0000, v226
    v_lshlrev_b32 v238, 16, v227
    v_and_b32 v239, 0xffff0000, v227
    v_mul_f32 v232, v232, v200
    v_mul_f32 v233, v233, v201
    v_mul_f32 v234, v234, v202
    v_mul_f32 v235, v235, v203
    v_mul_f32 v236, v236, v204
    v_mul_f32 v237, v237, v205
    v_mul_f32 v238, v238, v206
    v_mul_f32 v239, v239, v207
    v_cvt_pk_bf16_f32 v2, v232, v233
    v_lshlrev_b32 v232, 16, v2
    v_and_b32 v233, 0xffff0000, v2
    v_cvt_pk_bf16_f32 v2, v234, v235
    v_lshlrev_b32 v234, 16, v2
    v_and_b32 v235, 0xffff0000, v2
    v_cvt_pk_bf16_f32 v2, v236, v237
    v_lshlrev_b32 v236, 16, v2
    v_and_b32 v237, 0xffff0000, v2
    v_cvt_pk_bf16_f32 v2, v238, v239
    v_lshlrev_b32 v238, 16, v2
    v_and_b32 v239, 0xffff0000, v2
    v_add_f32 v232, v232, v192
    v_add_f32 v233, v233, v193
    v_add_f32 v234, v234, v194
    v_add_f32 v235, v235, v195
    v_add_f32 v236, v236, v196
    v_add_f32 v237, v237, v197
    v_add_f32 v238, v238, v198
    v_add_f32 v239, v239, v199
    v_cvt_pk_bf16_f32 v240, v232, v233
    v_cvt_pk_bf16_f32 v241, v234, v235
    v_cvt_pk_bf16_f32 v242, v236, v237
    v_cvt_pk_bf16_f32 v243, v238, v239
    s_add_u32 s55, s62, 32768
    buffer_store_dwordx4 v[240:243], v13, s[24:27], s55 offen sc1
Lkv_noh2:
    s_setprio 0
    s_waitcnt lgkmcnt(0)
    v_mfma_f32_32x32x16_bf16 v[64:79], v[32:35], v[16:19], v[64:79]
    ds_read_b64_tr_b16 v[56:57], v6 offset:13056
    ds_read_b64_tr_b16 v[58:59], v6 offset:13312
    v_mfma_f32_32x32x16_bf16 v[80:95], v[36:39], v[16:19], v[80:95]
    ds_read_b64_tr_b16 v[60:61], v6 offset:13120
    ds_read_b64_tr_b16 v[62:63], v6 offset:13376
    v_mfma_f32_32x32x16_bf16 v[96:111], v[32:35], v[20:23], v[96:111]
    ds_read_b128 v[40:43], v5 offset:96
    ds_read_b128 v[44:47], v5 offset:608
    v_mfma_f32_32x32x16_bf16 v[112:127], v[36:39], v[20:23], v[112:127]
    ds_read_b128 v[48:51], v5 offset:8416
    ds_read_b128 v[52:55], v5 offset:8928
    v_mfma_f32_32x32x16_bf16 v[128:143], v[32:35], v[24:27], v[128:143]
    v_mfma_f32_32x32x16_bf16 v[144:159], v[36:39], v[24:27], v[144:159]
    v_mfma_f32_32x32x16_bf16 v[160:175], v[32:35], v[28:31], v[160:175]
    v_mfma_f32_32x32x16_bf16 v[176:191], v[36:39], v[28:31], v[176:191]
    v_add_u32 v5, 68096, v5
    v_add_u32 v6, 68096, v6
    s_waitcnt vmcnt(0) lgkmcnt(0)
    s_barrier
    s_setprio 3
    v_mfma_f32_32x32x16_bf16 v[64:79], v[56:59], v[40:43], v[64:79]
    ds_read_b64_tr_b16 v[32:33], v6 offset:0
    ds_read_b64_tr_b16 v[34:35], v6 offset:256
    v_mfma_f32_32x32x16_bf16 v[80:95], v[60:63], v[40:43], v[80:95]
    ds_read_b64_tr_b16 v[36:37], v6 offset:64
    ds_read_b64_tr_b16 v[38:39], v6 offset:320
    v_mfma_f32_32x32x16_bf16 v[96:111], v[56:59], v[44:47], v[96:111]
    ds_read_b128 v[16:19], v5 offset:0
    ds_read_b128 v[20:23], v5 offset:512
    v_mfma_f32_32x32x16_bf16 v[112:127], v[60:63], v[44:47], v[112:127]
    ds_read_b128 v[24:27], v5 offset:8320
    ds_read_b128 v[28:31], v5 offset:8832
    v_mfma_f32_32x32x16_bf16 v[128:143], v[56:59], v[48:51], v[128:143]
    v_mfma_f32_32x32x16_bf16 v[144:159], v[60:63], v[48:51], v[144:159]
    v_mfma_f32_32x32x16_bf16 v[160:175], v[56:59], v[52:55], v[160:175]
    v_mfma_f32_32x32x16_bf16 v[176:191], v[60:63], v[52:55], v[176:191]
    s_setprio 2
    s_waitcnt lgkmcnt(0)
    v_mfma_f32_32x32x16_bf16 v[64:79], v[32:35], v[16:19], v[64:79]
    ds_read_b64_tr_b16 v[56:57], v6 offset:4352
    ds_read_b64_tr_b16 v[58:59], v6 offset:4608
    v_mfma_f32_32x32x16_bf16 v[80:95], v[36:39], v[16:19], v[80:95]
    ds_read_b64_tr_b16 v[60:61], v6 offset:4416
    ds_read_b64_tr_b16 v[62:63], v6 offset:4672
    v_mfma_f32_32x32x16_bf16 v[96:111], v[32:35], v[20:23], v[96:111]
    ds_read_b128 v[40:43], v5 offset:32
    ds_read_b128 v[44:47], v5 offset:544
    v_mfma_f32_32x32x16_bf16 v[112:127], v[36:39], v[20:23], v[112:127]
    ds_read_b128 v[48:51], v5 offset:8352
    ds_read_b128 v[52:55], v5 offset:8864
    v_mfma_f32_32x32x16_bf16 v[128:143], v[32:35], v[24:27], v[128:143]
    v_mfma_f32_32x32x16_bf16 v[144:159], v[36:39], v[24:27], v[144:159]
    v_mfma_f32_32x32x16_bf16 v[160:175], v[32:35], v[28:31], v[160:175]
    v_mfma_f32_32x32x16_bf16 v[176:191], v[36:39], v[28:31], v[176:191]
    s_setprio 1
    s_waitcnt lgkmcnt(0)
    v_mfma_f32_32x32x16_bf16 v[64:79], v[56:59], v[40:43], v[64:79]
    ds_read_b64_tr_b16 v[32:33], v6 offset:8704
    ds_read_b64_tr_b16 v[34:35], v6 offset:8960
    v_mfma_f32_32x32x16_bf16 v[80:95], v[60:63], v[40:43], v[80:95]
    ds_read_b64_tr_b16 v[36:37], v6 offset:8768
    ds_read_b64_tr_b16 v[38:39], v6 offset:9024
    v_mfma_f32_32x32x16_bf16 v[96:111], v[56:59], v[44:47], v[96:111]
    ds_read_b128 v[16:19], v5 offset:64
    ds_read_b128 v[20:23], v5 offset:576
    v_mfma_f32_32x32x16_bf16 v[112:127], v[60:63], v[44:47], v[112:127]
    ds_read_b128 v[24:27], v5 offset:8384
    ds_read_b128 v[28:31], v5 offset:8896
    v_mfma_f32_32x32x16_bf16 v[128:143], v[56:59], v[48:51], v[128:143]
    v_mfma_f32_32x32x16_bf16 v[144:159], v[60:63], v[48:51], v[144:159]
    v_mfma_f32_32x32x16_bf16 v[160:175], v[56:59], v[52:55], v[160:175]
    v_mfma_f32_32x32x16_bf16 v[176:191], v[60:63], v[52:55], v[176:191]
    s_setprio 0
    s_waitcnt lgkmcnt(0)
    v_mfma_f32_32x32x16_bf16 v[64:79], v[32:35], v[16:19], v[64:79]
    ds_read_b64_tr_b16 v[56:57], v6 offset:13056
    ds_read_b64_tr_b16 v[58:59], v6 offset:13312
    v_mfma_f32_32x32x16_bf16 v[80:95], v[36:39], v[16:19], v[80:95]
    ds_read_b64_tr_b16 v[60:61], v6 offset:13120
    ds_read_b64_tr_b16 v[62:63], v6 offset:13376
    v_mfma_f32_32x32x16_bf16 v[96:111], v[32:35], v[20:23], v[96:111]
    ds_read_b128 v[40:43], v5 offset:96
    ds_read_b128 v[44:47], v5 offset:608
    v_mfma_f32_32x32x16_bf16 v[112:127], v[36:39], v[20:23], v[112:127]
    ds_read_b128 v[48:51], v5 offset:8416
    ds_read_b128 v[52:55], v5 offset:8928
    v_mfma_f32_32x32x16_bf16 v[128:143], v[32:35], v[24:27], v[128:143]
    v_mfma_f32_32x32x16_bf16 v[144:159], v[36:39], v[24:27], v[144:159]
    v_mfma_f32_32x32x16_bf16 v[160:175], v[32:35], v[28:31], v[160:175]
    v_mfma_f32_32x32x16_bf16 v[176:191], v[36:39], v[28:31], v[176:191]
    v_add_u32 v5, 4294899200, v5
    v_add_u32 v6, 4294899200, v6
    s_waitcnt vmcnt(0) lgkmcnt(0)
    s_barrier
    s_setprio 3
    v_mfma_f32_32x32x16_bf16 v[64:79], v[56:59], v[40:43], v[64:79]
    v_mfma_f32_32x32x16_bf16 v[80:95], v[60:63], v[40:43], v[80:95]
    v_mfma_f32_32x32x16_bf16 v[96:111], v[56:59], v[44:47], v[96:111]
    v_mfma_f32_32x32x16_bf16 v[112:127], v[60:63], v[44:47], v[112:127]
    v_mfma_f32_32x32x16_bf16 v[128:143], v[56:59], v[48:51], v[128:143]
    v_mfma_f32_32x32x16_bf16 v[144:159], v[60:63], v[48:51], v[144:159]
    v_mfma_f32_32x32x16_bf16 v[160:175], v[56:59], v[52:55], v[160:175]
    v_mfma_f32_32x32x16_bf16 v[176:191], v[60:63], v[52:55], v[176:191]
    s_setprio 0
    v_lshlrev_b32 v7, 4, v1
    s_lshl_b32 s55, s48, 19
    s_lshl_b32 s56, s49, 13
    s_add_u32 s55, s55, s56
    s_and_b32 s56, s3, 1
    s_lshl_b32 s56, s56, 18
    s_add_u32 s57, s55, s56
    v_cvt_pk_bf16_f32 v240, v64, v65
    v_cvt_pk_bf16_f32 v241, v66, v67
    v_cvt_pk_bf16_f32 v242, v68, v69
    v_cvt_pk_bf16_f32 v243, v70, v71
    v_cvt_pk_bf16_f32 v244, v72, v73
    v_cvt_pk_bf16_f32 v245, v74, v75
    v_cvt_pk_bf16_f32 v246, v76, v77
    v_cvt_pk_bf16_f32 v247, v78, v79
    v_cvt_pk_bf16_f32 v248, v80, v81
    v_cvt_pk_bf16_f32 v249, v82, v83
    v_cvt_pk_bf16_f32 v250, v84, v85
    v_cvt_pk_bf16_f32 v251, v86, v87
    v_cvt_pk_bf16_f32 v252, v88, v89
    v_cvt_pk_bf16_f32 v253, v90, v91
    v_cvt_pk_bf16_f32 v254, v92, v93
    v_cvt_pk_bf16_f32 v255, v94, v95
    v_cvt_pk_bf16_f32 v128, v128, v129
    v_cvt_pk_bf16_f32 v129, v130, v131
    v_cvt_pk_bf16_f32 v130, v132, v133
    v_cvt_pk_bf16_f32 v131, v134, v135
    v_cvt_pk_bf16_f32 v132, v136, v137
    v_cvt_pk_bf16_f32 v133, v138, v139
    v_cvt_pk_bf16_f32 v134, v140, v141
    v_cvt_pk_bf16_f32 v135, v142, v143
    v_cvt_pk_bf16_f32 v136, v144, v145
    v_cvt_pk_bf16_f32 v137, v146, v147
    v_cvt_pk_bf16_f32 v138, v148, v149
    v_cvt_pk_bf16_f32 v139, v150, v151
    v_cvt_pk_bf16_f32 v140, v152, v153
    v_cvt_pk_bf16_f32 v141, v154, v155
    v_cvt_pk_bf16_f32 v142, v156, v157
    v_cvt_pk_bf16_f32 v143, v158, v159
    v_cvt_pk_bf16_f32 v144, v160, v161
    v_cvt_pk_bf16_f32 v145, v162, v163
    v_cvt_pk_bf16_f32 v146, v164, v165
    v_cvt_pk_bf16_f32 v147, v166, v167
    v_cvt_pk_bf16_f32 v148, v168, v169
    v_cvt_pk_bf16_f32 v149, v170, v171
    v_cvt_pk_bf16_f32 v150, v172, v173
    v_cvt_pk_bf16_f32 v151, v174, v175
    v_cvt_pk_bf16_f32 v152, v176, v177
    v_cvt_pk_bf16_f32 v153, v178, v179
    v_cvt_pk_bf16_f32 v154, v180, v181
    v_cvt_pk_bf16_f32 v155, v182, v183
    v_cvt_pk_bf16_f32 v156, v184, v185
    v_cvt_pk_bf16_f32 v157, v186, v187
    v_cvt_pk_bf16_f32 v158, v188, v189
    v_cvt_pk_bf16_f32 v159, v190, v191
    v_cvt_pk_bf16_f32 v160, v96, v97
    v_cvt_pk_bf16_f32 v161, v98, v99
    v_cvt_pk_bf16_f32 v162, v100, v101
    v_cvt_pk_bf16_f32 v163, v102, v103
    v_cvt_pk_bf16_f32 v164, v104, v105
    v_cvt_pk_bf16_f32 v165, v106, v107
    v_cvt_pk_bf16_f32 v166, v108, v109
    v_cvt_pk_bf16_f32 v167, v110, v111
    v_cvt_pk_bf16_f32 v168, v112, v113
    v_cvt_pk_bf16_f32 v169, v114, v115
    v_cvt_pk_bf16_f32 v170, v116, v117
    v_cvt_pk_bf16_f32 v171, v118, v119
    v_cvt_pk_bf16_f32 v172, v120, v121
    v_cvt_pk_bf16_f32 v173, v122, v123
    v_cvt_pk_bf16_f32 v174, v124, v125
    v_cvt_pk_bf16_f32 v175, v126, v127
    s_add_u32 s16, s4, 2555904
    s_addc_u32 s17, s5, 0
    s_and_b32 s17, s17, 0xffff
    s_mov_b32 s18, 16777216
    s_mov_b32 s19, 0x20000
    s_lshr_b32 s56, s3, 1
    s_lshl_b32 s56, s56, 12
    s_add_u32 s57, s57, s56
    v_mov_b32 v6, v7
    s_bitcmp1_b32 s3, 0
    s_cselect_b64 vcc, -1, 0
    s_cbranch_scc0 Lat_comp
    s_cmp_eq_u32 s3, 3
    s_cbranch_scc1 Lkv_w3
    v_add_u32 v2, 147456, v7
    ds_write_b128 v2, v[240:243] offset:0
    ds_write_b128 v2, v[244:247] offset:1024
    ds_write_b128 v2, v[248:251] offset:2048
    ds_write_b128 v2, v[252:255] offset:3072
    ds_write_b128 v2, v[160:163] offset:4096
    ds_write_b128 v2, v[164:167] offset:5120
    ds_write_b128 v2, v[168:171] offset:6144
    ds_write_b128 v2, v[172:175] offset:7168
    ds_write_b128 v2, v[128:131] offset:8192
    ds_write_b128 v2, v[132:135] offset:9216
    ds_write_b128 v2, v[136:139] offset:10240
    ds_write_b128 v2, v[140:143] offset:11264
    ds_write_b128 v2, v[144:147] offset:12288
    ds_write_b128 v2, v[148:151] offset:13312
    ds_write_b128 v2, v[152:155] offset:14336
    ds_write_b128 v2, v[156:159] offset:15360
    s_waitcnt lgkmcnt(0)
    s_branch Lat_comp
Lkv_w3:
    v_add_u32 v2, 65536, v7
    ds_write_b128 v7, v[240:243] offset:25088
    ds_write_b128 v7, v[244:247] offset:26112
    ds_write_b128 v7, v[248:251] offset:27136
    ds_write_b128 v7, v[252:255] offset:28160
    ds_write_b128 v7, v[160:163] offset:29184
    ds_write_b128 v7, v[164:167] offset:30208
    ds_write_b128 v7, v[168:171] offset:31232
    ds_write_b128 v7, v[172:175] offset:57856
    ds_write_b128 v7, v[128:131] offset:58880
    ds_write_b128 v7, v[132:135] offset:59904
    ds_write_b128 v7, v[136:139] offset:60928
    ds_write_b128 v7, v[140:143] offset:61952
    ds_write_b128 v7, v[144:147] offset:62976
    ds_write_b128 v7, v[148:151] offset:64000
    ds_write_b128 v2, v[152:155] offset:25088
    ds_write_b128 v2, v[156:159] offset:26112
    s_waitcnt lgkmcnt(0)
    s_branch Lat_comp
Lkv_r1:
    s_setprio 2
    s_waitcnt lgkmcnt(0)
    v_mfma_f32_32x32x16_bf16 v[64:79], v[16:19], v[32:35], v[64:79]
    ds_read_b64_tr_b16 v[56:57], v6 offset:4352
    ds_read_b64_tr_b16 v[58:59], v6 offset:4608
    buffer_load_dwordx4 v[220:223], v3, s[8:11], s63 offen offset:256
    s_add_u32 s56, s7, 1048576
    buffer_load_dwordx4 v[220:223], v4, s[12:15], s56 offen
    buffer_load_dwordx4 v[220:223], v3, s[8:11], s63 offen offset:384
    v_mfma_f32_32x32x16_bf16 v[80:95], v[16:19], v[36:39], v[80:95]
    ds_read_b64_tr_b16 v[60:61], v6 offset:4416
    ds_read_b64_tr_b16 v[62:63], v6 offset:4672
    s_add_u32 s56, s7, 1572864
    buffer_load_dwordx4 v[220:223], v4, s[12:15], s56 offen
    s_mov_b32 s16, s40
    s_and_b32 s17, s41, 0xffff
    v_mfma_f32_32x32x16_bf16 v[96:111], v[20:23], v[32:35], v[96:111]
    ds_read_b128 v[40:43], v5 offset:32
    ds_read_b128 v[44:47], v5 offset:544
    s_mov_b32 s18, 1152
    s_mov_b32 s19, 0x20000
    s_mov_b32 s20, s42
    v_mfma_f32_32x32x16_bf16 v[112:127], v[20:23], v[36:39], v[112:127]
    ds_read_b128 v[48:51], v5 offset:8352
    ds_read_b128 v[52:55], v5 offset:8864
    s_and_b32 s21, s43, 0xffff
    s_mov_b32 s22, 3981312
    s_mov_b32 s23, 0x20000
    v_mfma_f32_32x32x16_bf16 v[128:143], v[24:27], v[32:35], v[128:143]
    s_mov_b32 s24, s28
    s_and_b32 s25, s29, 0xffff
    s_mov_b32 s26, 2359296
    v_mfma_f32_32x32x16_bf16 v[144:159], v[24:27], v[36:39], v[144:159]
    s_mov_b32 s27, 0x20000
    s_cmp_lt_u32 s2, 216
    s_cselect_b32 s22, s22, 0
    v_mfma_f32_32x32x16_bf16 v[160:175], v[28:31], v[32:35], v[160:175]
    s_mov_b32 s59, 0x7f000000
    s_cmp_lt_u32 s3, 2
    s_cselect_b32 s58, 884736, s59
    v_mfma_f32_32x32x16_bf16 v[176:191], v[28:31], v[36:39], v[176:191]
    s_cselect_b32 s59, 256, s59
    s_mov_b32 s55, 442368
    buffer_load_dwordx4 v[192:195], v245, s[20:23], 0 offen
    s_setprio 1
    s_waitcnt lgkmcnt(0)
    v_mfma_f32_32x32x16_bf16 v[64:79], v[40:43], v[56:59], v[64:79]
    ds_read_b64_tr_b16 v[32:33], v6 offset:8704
    ds_read_b64_tr_b16 v[34:35], v6 offset:8960
    buffer_load_ushort v204, v8, s[16:19], 0 offen
    buffer_load_dwordx4 v[196:199], v245, s[20:23], s55 offen
    buffer_load_ushort v205, v8, s[16:19], 0 offen offset:128
    v_mfma_f32_32x32x16_bf16 v[80:95], v[40:43], v[60:63], v[80:95]
    ds_read_b64_tr_b16 v[36:37], v6 offset:8768
    ds_read_b64_tr_b16 v[38:39], v6 offset:9024
    buffer_load_dwordx4 v[200:203], v245, s[20:23], s58 offen
    buffer_load_ushort v206, v8, s[16:19], s59 offen
    buffer_load_dwordx4 v[224:227], v10, s[24:27], 0 offen
    v_mfma_f32_32x32x16_bf16 v[96:111], v[44:47], v[56:59], v[96:111]
    ds_read_b128 v[16:19], v5 offset:64
    ds_read_b128 v[20:23], v5 offset:576
    buffer_load_dwordx4 v[228:231], v11, s[24:27], 0 offen
    s_mov_b32 s96, s4
    s_and_b32 s97, s5, 0xffff
    v_mfma_f32_32x32x16_bf16 v[112:127], v[44:47], v[60:63], v[112:127]
    ds_read_b128 v[24:27], v5 offset:8384
    ds_read_b128 v[28:31], v5 offset:8896
    s_mov_b32 s98, 65536
    s_mov_b32 s99, 0x20000
    v_lshlrev_b32 v2, 2, v1
    v_mfma_f32_32x32x16_bf16 v[128:143], v[48:51], v[56:59], v[128:143]
    s_lshl_b32 s55, s2, 8
    v_add_u32 v2, s55, v2
    v_mov_b32 v243, 0
    v_mfma_f32_32x32x16_bf16 v[144:159], v[48:51], v[60:63], v[144:159]
    s_nop 0
    s_mov_b32 s36, s44
    s_and_b32 s37, s45, 0xffff
    v_mfma_f32_32x32x16_bf16 v[160:175], v[52:55], v[56:59], v[160:175]
    s_mov_b32 s38, 256
    s_mov_b32 s39, 0x20000
    s_add_u32 s40, s4, 131072
    v_mfma_f32_32x32x16_bf16 v[176:191], v[52:55], v[60:63], v[176:191]
    s_addc_u32 s41, s5, 0
    s_and_b32 s41, s41, 0xffff
    s_mov_b32 s42, 55296
    s_setprio 0
    s_waitcnt lgkmcnt(0)
    v_mfma_f32_32x32x16_bf16 v[64:79], v[16:19], v[32:35], v[64:79]
    ds_read_b64_tr_b16 v[56:57], v6 offset:13056
    ds_read_b64_tr_b16 v[58:59], v6 offset:13312
    s_mov_b32 s43, 0x20000
    s_mov_b32 s16, s32
    s_and_b32 s17, s33, 0xffff
    v_mfma_f32_32x32x16_bf16 v[80:95], v[16:19], v[36:39], v[80:95]
    ds_read_b64_tr_b16 v[60:61], v6 offset:13120
    ds_read_b64_tr_b16 v[62:63], v6 offset:13376
    s_mov_b32 s18, 4718592
    s_mov_b32 s19, 0x20000
    s_add_u32 s24, s4, 196608
    v_mfma_f32_32x32x16_bf16 v[96:111], v[20:23], v[32:35], v[96:111]
    ds_read_b128 v[40:43], v5 offset:96
    ds_read_b128 v[44:47], v5 offset:608
    s_addc_u32 s25, s5, 0
    s_and_b32 s25, s25, 0xffff
    s_mov_b32 s26, 2359296
    v_mfma_f32_32x32x16_bf16 v[112:127], v[20:23], v[36:39], v[112:127]
    ds_read_b128 v[48:51], v5 offset:8416
    ds_read_b128 v[52:55], v5 offset:8928
    s_mov_b32 s27, 0x20000
    s_add_u32 s20, s4, 65536
    s_addc_u32 s21, s5, 0
    v_mfma_f32_32x32x16_bf16 v[128:143], v[24:27], v[32:35], v[128:143]
    s_and_b32 s21, s21, 0xffff
    s_mov_b32 s22, 13824
    s_mov_b32 s23, 0x20000
    v_mfma_f32_32x32x16_bf16 v[144:159], v[24:27], v[36:39], v[144:159]
    v_mfma_f32_32x32x16_bf16 v[160:175], v[28:31], v[32:35], v[160:175]
    v_mfma_f32_32x32x16_bf16 v[176:191], v[28:31], v[36:39], v[176:191]
    v_add_u32 v5, 68096, v5
    v_add_u32 v6, 68096, v6
    s_waitcnt vmcnt(13) lgkmcnt(0)
    s_barrier
    s_setprio 3
    v_mfma_f32_32x32x16_bf16 v[64:79], v[40:43], v[56:59], v[64:79]
    ds_read_b64_tr_b16 v[32:33], v6 offset:0
    ds_read_b64_tr_b16 v[34:35], v6 offset:256
    v_mfma_f32_32x32x16_bf16 v[80:95], v[40:43], v[60:63], v[80:95]
    ds_read_b64_tr_b16 v[36:37], v6 offset:64
    ds_read_b64_tr_b16 v[38:39], v6 offset:320
    s_add_u32 m0, s53, 0
    s_add_u32 s55, s51, 0
    buffer_load_dwordx4 v4, s[12:15], s55 offen lds
    v_mfma_f32_32x32x16_bf16 v[96:111], v[44:47], v[56:59], v[96:111]
    ds_read_b128 v[16:19], v5 offset:0
    ds_read_b128 v[20:23], v5 offset:512
    v_mfma_f32_32x32x16_bf16 v[112:127], v[44:47], v[60:63], v[112:127]
    ds_read_b128 v[24:27], v5 offset:8320
    ds_read_b128 v[28:31], v5 offset:8832
    s_add_u32 m0, s53, 1088
    s_add_u32 s55, s51, 8192
    buffer_load_dwordx4 v4, s[12:15], s55 offen lds
    v_mfma_f32_32x32x16_bf16 v[128:143], v[48:51], v[56:59], v[128:143]
    v_mfma_f32_32x32x16_bf16 v[144:159], v[48:51], v[60:63], v[144:159]
    s_add_u32 m0, s53, 2176
    s_add_u32 s55, s51, 16384
    buffer_load_dwordx4 v4, s[12:15], s55 offen lds
    v_mfma_f32_32x32x16_bf16 v[160:175], v[52:55], v[56:59], v[160:175]
    v_mfma_f32_32x32x16_bf16 v[176:191], v[52:55], v[60:63], v[176:191]
    s_add_u32 m0, s53, 3264
    s_add_u32 s55, s51, 24576
    buffer_load_dwordx4 v4, s[12:15], s55 offen lds
    s_setprio 2
    s_waitcnt lgkmcnt(0)
    v_mfma_f32_32x32x16_bf16 v[64:79], v[16:19], v[32:35], v[64:79]
    ds_read_b64_tr_b16 v[56:57], v6 offset:4352
    ds_read_b64_tr_b16 v[58:59], v6 offset:4608
    v_mfma_f32_32x32x16_bf16 v[80:95], v[16:19], v[36:39], v[80:95]
    ds_read_b64_tr_b16 v[60:61], v6 offset:4416
    ds_read_b64_tr_b16 v[62:63], v6 offset:4672
    s_add_u32 m0, s52, 0
    s_nop 0
    buffer_load_dwordx4 v3, s[8:11], s50 offen offset:0 lds
    v_mfma_f32_32x32x16_bf16 v[96:111], v[20:23], v[32:35], v[96:111]
    ds_read_b128 v[40:43], v5 offset:32
    ds_read_b128 v[44:47], v5 offset:544
    v_mfma_f32_32x32x16_bf16 v[112:127], v[20:23], v[36:39], v[112:127]
    ds_read_b128 v[48:51], v5 offset:8352
    ds_read_b128 v[52:55], v5 offset:8864
    s_add_u32 m0, s52, 16
    s_nop 0
    buffer_load_dwordx4 v3, s[8:11], s50 offen offset:1024 lds
    v_mfma_f32_32x32x16_bf16 v[128:143], v[24:27], v[32:35], v[128:143]
    v_mfma_f32_32x32x16_bf16 v[144:159], v[24:27], v[36:39], v[144:159]
    s_add_u32 m0, s52, 32
    s_nop 0
    buffer_load_dwordx4 v3, s[8:11], s50 offen offset:2048 lds
    v_mfma_f32_32x32x16_bf16 v[160:175], v[28:31], v[32:35], v[160:175]
    v_mfma_f32_32x32x16_bf16 v[176:191], v[28:31], v[36:39], v[176:191]
    s_add_u32 m0, s52, 48
    s_nop 0
    buffer_load_dwordx4 v3, s[8:11], s50 offen offset:3072 lds
    s_add_u32 s50, s50, 128
    s_add_u32 s51, s51, 524288
    s_setprio 1
    s_waitcnt lgkmcnt(0)
    v_mfma_f32_32x32x16_bf16 v[64:79], v[40:43], v[56:59], v[64:79]
    ds_read_b64_tr_b16 v[32:33], v6 offset:8704
    ds_read_b64_tr_b16 v[34:35], v6 offset:8960
    s_waitcnt vmcnt(8)
    v_lshlrev_b32 v204, 16, v204
    v_mul_f32 v216, 0xbfb8aa3b, v204
    v_exp_f32 v216, v216
    s_nop 0
    v_add_f32 v216, 1.0, v216
    v_rcp_f32 v216, v216
    s_nop 0
    v_mul_f32 v204, v204, v216
    v_mfma_f32_32x32x16_bf16 v[80:95], v[40:43], v[60:63], v[80:95]
    ds_read_b64_tr_b16 v[36:37], v6 offset:8768
    ds_read_b64_tr_b16 v[38:39], v6 offset:9024
    v_cvt_pk_bf16_f32 v204, v204, v204
    v_and_b32 v204, 0xffff0000, v204
    v_lshlrev_b32 v216, 16, v192
    v_and_b32 v217, 0xffff0000, v192
    v_mul_f32 v208, v204, v216
    v_mul_f32 v209, v204, v217
    v_lshlrev_b32 v216, 16, v193
    v_and_b32 v217, 0xffff0000, v193
    v_mul_f32 v210, v204, v216
    v_mfma_f32_32x32x16_bf16 v[96:111], v[44:47], v[56:59], v[96:111]
    ds_read_b128 v[16:19], v5 offset:64
    ds_read_b128 v[20:23], v5 offset:576
    v_mul_f32 v211, v204, v217
    v_lshlrev_b32 v216, 16, v194
    v_and_b32 v217, 0xffff0000, v194
    v_mul_f32 v212, v204, v216
    v_mul_f32 v213, v204, v217
    v_lshlrev_b32 v216, 16, v195
    v_and_b32 v217, 0xffff0000, v195
    v_mul_f32 v214, v204, v216
    v_mul_f32 v215, v204, v217
    v_mfma_f32_32x32x16_bf16 v[112:127], v[44:47], v[60:63], v[112:127]
    ds_read_b128 v[24:27], v5 offset:8384
    ds_read_b128 v[28:31], v5 offset:8896
    v_lshlrev_b32 v205, 16, v205
    v_mul_f32 v216, 0xbfb8aa3b, v205
    v_exp_f32 v216, v216
    s_nop 0
    v_add_f32 v216, 1.0, v216
    v_rcp_f32 v216, v216
    s_nop 0
    v_mul_f32 v205, v205, v216
    v_cvt_pk_bf16_f32 v205, v205, v205
    v_mfma_f32_32x32x16_bf16 v[128:143], v[48:51], v[56:59], v[128:143]
    v_and_b32 v205, 0xffff0000, v205
    v_lshlrev_b32 v216, 16, v196
    v_and_b32 v217, 0xffff0000, v196
    v_fmac_f32 v208, v205, v216
    v_fmac_f32 v209, v205, v217
    v_lshlrev_b32 v216, 16, v197
    v_and_b32 v217, 0xffff0000, v197
    v_fmac_f32 v210, v205, v216
    v_fmac_f32 v211, v205, v217
    v_mfma_f32_32x32x16_bf16 v[144:159], v[48:51], v[60:63], v[144:159]
    v_lshlrev_b32 v216, 16, v198
    v_and_b32 v217, 0xffff0000, v198
    v_fmac_f32 v212, v205, v216
    v_fmac_f32 v213, v205, v217
    v_lshlrev_b32 v216, 16, v199
    v_and_b32 v217, 0xffff0000, v199
    v_fmac_f32 v214, v205, v216
    v_fmac_f32 v215, v205, v217
    v_lshlrev_b32 v206, 16, v206
    v_mfma_f32_32x32x16_bf16 v[160:175], v[52:55], v[56:59], v[160:175]
    v_mul_f32 v216, 0xbfb8aa3b, v206
    v_exp_f32 v216, v216
    s_nop 0
    v_add_f32 v216, 1.0, v216
    v_rcp_f32 v216, v216
    s_nop 0
    v_mul_f32 v206, v206, v216
    v_cvt_pk_bf16_f32 v206, v206, v206
    v_and_b32 v206, 0xffff0000, v206
    v_mfma_f32_32x32x16_bf16 v[176:191], v[52:55], v[60:63], v[176:191]
    v_lshlrev_b32 v216, 16, v200
    v_and_b32 v217, 0xffff0000, v200
    v_fmac_f32 v208, v206, v216
    v_fmac_f32 v209, v206, v217
    v_lshlrev_b32 v216, 16, v201
    v_and_b32 v217, 0xffff0000, v201
    v_fmac_f32 v210, v206, v216
    v_fmac_f32 v211, v206, v217
    v_lshlrev_b32 v216, 16, v202
    s_setprio 0
    s_waitcnt lgkmcnt(0)
    v_mfma_f32_32x32x16_bf16 v[64:79], v[16:19], v[32:35], v[64:79]
    ds_read_b64_tr_b16 v[56:57], v6 offset:13056
    ds_read_b64_tr_b16 v[58:59], v6 offset:13312
    v_and_b32 v217, 0xffff0000, v202
    v_fmac_f32 v212, v206, v216
    v_fmac_f32 v213, v206, v217
    v_lshlrev_b32 v216, 16, v203
    v_and_b32 v217, 0xffff0000, v203
    v_fmac_f32 v214, v206, v216
    v_fmac_f32 v215, v206, v217
    s_nop 1
    v_add_f32_dpp v208, v208, v208 row_ror:8 row_mask:0xf bank_mask:0xf
    v_mfma_f32_32x32x16_bf16 v[80:95], v[16:19], v[36:39], v[80:95]
    ds_read_b64_tr_b16 v[60:61], v6 offset:13120
    ds_read_b64_tr_b16 v[62:63], v6 offset:13376
    v_add_f32_dpp v209, v209, v209 row_ror:8 row_mask:0xf bank_mask:0xf
    v_add_f32_dpp v210, v210, v210 row_ror:8 row_mask:0xf bank_mask:0xf
    v_add_f32_dpp v211, v211, v211 row_ror:8 row_mask:0xf bank_mask:0xf
    v_add_f32_dpp v212, v212, v212 row_ror:8 row_mask:0xf bank_mask:0xf
    v_add_f32_dpp v213, v213, v213 row_ror:8 row_mask:0xf bank_mask:0xf
    v_add_f32_dpp v214, v214, v214 row_ror:8 row_mask:0xf bank_mask:0xf
    v_add_f32_dpp v215, v215, v215 row_ror:8 row_mask:0xf bank_mask:0xf
    v_mov_b32 v192, v208
    v_mov_b32 v193, v209
    v_mfma_f32_32x32x16_bf16 v[96:111], v[20:23], v[32:35], v[96:111]
    ds_read_b128 v[40:43], v5 offset:96
    ds_read_b128 v[44:47], v5 offset:608
    v_mov_b32 v194, v210
    v_mov_b32 v195, v211
    v_mov_b32 v196, v212
    v_mov_b32 v197, v213
    v_mov_b32 v198, v214
    v_mov_b32 v199, v215
    s_nop 0
    v_permlane16_swap_b32 v208, v192
    v_permlane16_swap_b32 v209, v193
    v_mfma_f32_32x32x16_bf16 v[112:127], v[20:23], v[36:39], v[112:127]
    ds_read_b128 v[48:51], v5 offset:8416
    ds_read_b128 v[52:55], v5 offset:8928
    v_permlane16_swap_b32 v210, v194
    v_permlane16_swap_b32 v211, v195
    v_permlane16_swap_b32 v212, v196
    v_permlane16_swap_b32 v213, v197
    v_permlane16_swap_b32 v214, v198
    v_permlane16_swap_b32 v215, v199
    v_add_f32 v208, v208, v192
    v_add_f32 v209, v209, v193
    v_add_f32 v210, v210, v194
    v_mfma_f32_32x32x16_bf16 v[128:143], v[24:27], v[32:35], v[128:143]
    v_add_f32 v211, v211, v195
    v_add_f32 v212, v212, v196
    v_add_f32 v213, v213, v197
    v_add_f32 v214, v214, v198
    v_add_f32 v215, v215, v199
    v_mov_b32 v192, v208
    v_mov_b32 v193, v209
    v_mov_b32 v194, v210
    v_mov_b32 v195, v211
    v_mfma_f32_32x32x16_bf16 v[144:159], v[24:27], v[36:39], v[144:159]
    v_mov_b32 v196, v212
    v_mov_b32 v197, v213
    v_mov_b32 v198, v214
    v_mov_b32 v199, v215
    s_nop 0
    v_permlane32_swap_b32 v208, v192
    v_permlane32_swap_b32 v209, v193
    v_permlane32_swap_b32 v210, v194
    v_permlane32_swap_b32 v211, v195
    v_mfma_f32_32x32x16_bf16 v[160:175], v[28:31], v[32:35], v[160:175]
    v_permlane32_swap_b32 v212, v196
    v_permlane32_swap_b32 v213, v197
    v_permlane32_swap_b32 v214, v198
    v_permlane32_swap_b32 v215, v199
    v_add_f32 v208, v208, v192
    v_add_f32 v209, v209, v193
    v_add_f32 v210, v210, v194
    v_add_f32 v211, v211, v195
    v_add_f32 v212, v212, v196
    v_mfma_f32_32x32x16_bf16 v[176:191], v[28:31], v[36:39], v[176:191]
    v_add_f32 v213, v213, v197
    v_add_f32 v214, v214, v198
    v_add_f32 v215, v215, v199
    s_mov_b64 exec, 0xff
    ds_write_b128 v7, v[208:211]
    ds_write_b128 v7, v[212:215] offset:16
    s_mov_b64 exec, -1
    buffer_load_dwordx4 v[220:223], v3, s[8:11], s63 offen offset:512
    s_add_u32 s56, s7, 2097152
    buffer_load_dwordx4 v[220:223], v4, s[12:15], s56 offen
    v_add_u32 v5, 4294899200, v5
    v_add_u32 v6, 4294899200, v6
    s_waitcnt vmcnt(2) lgkmcnt(0)
    s_barrier
    s_setprio 3
    v_mfma_f32_32x32x16_bf16 v[64:79], v[40:43], v[56:59], v[64:79]
    ds_read_b64_tr_b16 v[32:33], v6 offset:0
    ds_read_b64_tr_b16 v[34:35], v6 offset:256
    v_mfma_f32_32x32x16_bf16 v[80:95], v[40:43], v[60:63], v[80:95]
    ds_read_b64_tr_b16 v[36:37], v6 offset:64
    ds_read_b64_tr_b16 v[38:39], v6 offset:320
    s_add_u32 m0, s53, 68096
    s_add_u32 s55, s51, 0
    buffer_load_dwordx4 v4, s[12:15], s55 offen lds
    v_mfma_f32_32x32x16_bf16 v[96:111], v[44:47], v[56:59], v[96:111]
    ds_read_b128 v[16:19], v5 offset:0
    ds_read_b128 v[20:23], v5 offset:512
    v_mfma_f32_32x32x16_bf16 v[112:127], v[44:47], v[60:63], v[112:127]
    ds_read_b128 v[24:27], v5 offset:8320
    ds_read_b128 v[28:31], v5 offset:8832
    s_add_u32 m0, s53, 69184
    s_add_u32 s55, s51, 8192
    buffer_load_dwordx4 v4, s[12:15], s55 offen lds
    v_mfma_f32_32x32x16_bf16 v[128:143], v[48:51], v[56:59], v[128:143]
    v_mfma_f32_32x32x16_bf16 v[144:159], v[48:51], v[60:63], v[144:159]
    s_add_u32 m0, s53, 70272
    s_add_u32 s55, s51, 16384
    buffer_load_dwordx4 v4, s[12:15], s55 offen lds
    v_mfma_f32_32x32x16_bf16 v[160:175], v[52:55], v[56:59], v[160:175]
    v_mfma_f32_32x32x16_bf16 v[176:191], v[52:55], v[60:63], v[176:191]
    s_add_u32 m0, s53, 71360
    s_add_u32 s55, s51, 24576
    buffer_load_dwordx4 v4, s[12:15], s55 offen lds
    s_setprio 2
    s_waitcnt lgkmcnt(0)
    v_mfma_f32_32x32x16_bf16 v[64:79], v[16:19], v[32:35], v[64:79]
    ds_read_b64_tr_b16 v[56:57], v6 offset:4352
    ds_read_b64_tr_b16 v[58:59], v6 offset:4608
    v_lshlrev_b32 v232, 16, v224
    v_and_b32 v233, 0xffff0000, v224
    v_lshlrev_b32 v234, 16, v225
    v_mfma_f32_32x32x16_bf16 v[80:95], v[16:19], v[36:39], v[80:95]
    ds_read_b64_tr_b16 v[60:61], v6 offset:4416
    ds_read_b64_tr_b16 v[62:63], v6 offset:4672
    s_add_u32 m0, s52, 68096
    s_nop 0
    buffer_load_dwordx4 v3, s[8:11], s50 offen offset:0 lds
    v_and_b32 v235, 0xffff0000, v225
    v_lshlrev_b32 v236, 16, v226
    v_and_b32 v237, 0xffff0000, v226
    v_mfma_f32_32x32x16_bf16 v[96:111], v[20:23], v[32:35], v[96:111]
    ds_read_b128 v[40:43], v5 offset:32
    ds_read_b128 v[44:47], v5 offset:544
    v_lshlrev_b32 v238, 16, v227
    v_and_b32 v239, 0xffff0000, v227
    v_lshlrev_b32 v240, 16, v228
    v_mfma_f32_32x32x16_bf16 v[112:127], v[20:23], v[36:39], v[112:127]
    ds_read_b128 v[48:51], v5 offset:8352
    ds_read_b128 v[52:55], v5 offset:8864
    s_add_u32 m0, s52, 68112
    s_nop 0
    buffer_load_dwordx4 v3, s[8:11], s50 offen offset:1024 lds
    v_and_b32 v241, 0xffff0000, v228
    v_lshlrev_b32 v242, 16, v229
    v_and_b32 v243, 0xffff0000, v229
    v_mfma_f32_32x32x16_bf16 v[128:143], v[24:27], v[32:35], v[128:143]
    v_lshlrev_b32 v244, 16, v230
    v_and_b32 v245, 0xffff0000, v230
    v_lshlrev_b32 v246, 16, v231
    v_mfma_f32_32x32x16_bf16 v[144:159], v[24:27], v[36:39], v[144:159]
    s_add_u32 m0, s52, 68128
    s_nop 0
    buffer_load_dwordx4 v3, s[8:11], s50 offen offset:2048 lds
    v_and_b32 v247, 0xffff0000, v231
    v_add_f32 v216, v232, v233
    v_add_f32 v216, v216, v234
    v_mfma_f32_32x32x16_bf16 v[160:175], v[28:31], v[32:35], v[160:175]
    v_add_f32 v216, v216, v235
    v_add_f32 v216, v216, v236
    v_add_f32 v216, v216, v237
    v_mfma_f32_32x32x16_bf16 v[176:191], v[28:31], v[36:39], v[176:191]
    s_add_u32 m0, s52, 68144
    s_nop 0
    buffer_load_dwordx4 v3, s[8:11], s50 offen offset:3072 lds
    v_add_f32 v216, v216, v238
    v_add_f32 v216, v216, v239
    v_add_f32 v216, v216, v240
    s_add_u32 s50, s50, 128
    s_add_u32 s51, s51, 524288
    s_setprio 1
    s_waitcnt lgkmcnt(0)
    v_mfma_f32_32x32x16_bf16 v[64:79], v[40:43], v[56:59], v[64:79]
    ds_read_b64_tr_b16 v[32:33], v6 offset:8704
    ds_read_b64_tr_b16 v[34:35], v6 offset:8960
    v_add_f32 v216, v216, v241
    v_add_f32 v216, v216, v242
    v_add_f32 v216, v216, v243
    v_mfma_f32_32x32x16_bf16 v[80:95], v[40:43], v[60:63], v[80:95]
    ds_read_b64_tr_b16 v[36:37], v6 offset:8768
    ds_read_b64_tr_b16 v[38:39], v6 offset:9024
    v_add_f32 v216, v216, v244
    v_add_f32 v216, v216, v245
    v_add_f32 v216, v216, v246
    v_mfma_f32_32x32x16_bf16 v[96:111], v[44:47], v[56:59], v[96:111]
    ds_read_b128 v[16:19], v5 offset:64
    ds_read_b128 v[20:23], v5 offset:576
    v_add_f32 v216, v216, v247
    s_nop 1
    v_add_f32_dpp v216, v216, v216 row_ror:8 row_mask:0xf bank_mask:0xf
    v_mfma_f32_32x32x16_bf16 v[112:127], v[44:47], v[60:63], v[112:127]
    ds_read_b128 v[24:27], v5 offset:8384
    ds_read_b128 v[28:31], v5 offset:8896
    s_nop 1
    v_add_f32_dpp v216, v216, v216 row_ror:4 row_mask:0xf bank_mask:0xf
    s_nop 1
    v_mfma_f32_32x32x16_bf16 v[128:143], v[48:51], v[56:59], v[128:143]
    v_add_f32_dpp v216, v216, v216 row_ror:2 row_mask:0xf bank_mask:0xf
    s_nop 1
    v_add_f32_dpp v216, v216, v216 row_ror:1 row_mask:0xf bank_mask:0xf
    v_mfma_f32_32x32x16_bf16 v[144:159], v[48:51], v[60:63], v[144:159]
    v_mov_b32 v217, v216
    s_nop 1
    v_permlane16_swap_b32 v216, v217
    v_mfma_f32_32x32x16_bf16 v[160:175], v[52:55], v[56:59], v[160:175]
    s_nop 1
    v_add_f32 v216, v216, v217
    v_mov_b32 v217, v216
    v_mfma_f32_32x32x16_bf16 v[176:191], v[52:55], v[60:63], v[176:191]
    s_nop 1
    v_permlane32_swap_b32 v216, v217
    s_nop 1
    s_setprio 0
    s_waitcnt lgkmcnt(0)
    v_mfma_f32_32x32x16_bf16 v[64:79], v[16:19], v[32:35], v[64:79]
    ds_read_b64_tr_b16 v[56:57], v6 offset:13056
    ds_read_b64_tr_b16 v[58:59], v6 offset:13312
    v_add_f32 v216, v216, v217
    v_mul_f32 v216, 0x3ae38e39, v216
    v_cmp_gt_u32 vcc, 8, v1
    v_mfma_f32_32x32x16_bf16 v[80:95], v[16:19], v[36:39], v[80:95]
    ds_read_b64_tr_b16 v[60:61], v6 offset:13120
    ds_read_b64_tr_b16 v[62:63], v6 offset:13376
    v_mov_b32 v219, 0
    s_nop 0
    v_cndmask_b32 v218, 0, v216, vcc
    v_mfma_f32_32x32x16_bf16 v[96:111], v[20:23], v[32:35], v[96:111]
    ds_read_b128 v[40:43], v5 offset:96
    ds_read_b128 v[44:47], v5 offset:608
    v_sub_f32 v217, v232, v216
    v_fmac_f32 v219, v217, v217
    v_sub_f32 v217, v233, v216
    v_mfma_f32_32x32x16_bf16 v[112:127], v[20:23], v[36:39], v[112:127]
    ds_read_b128 v[48:51], v5 offset:8416
    ds_read_b128 v[52:55], v5 offset:8928
    v_fmac_f32 v219, v217, v217
    v_sub_f32 v217, v234, v216
    v_fmac_f32 v219, v217, v217
    v_mfma_f32_32x32x16_bf16 v[128:143], v[24:27], v[32:35], v[128:143]
    v_sub_f32 v217, v235, v216
    buffer_load_dwordx4 v[220:223], v3, s[8:11], s63 offen offset:640
    s_add_u32 s56, s7, 2621440
    buffer_load_dwordx4 v[220:223], v4, s[12:15], s56 offen
    v_mfma_f32_32x32x16_bf16 v[144:159], v[24:27], v[36:39], v[144:159]
    v_mfma_f32_32x32x16_bf16 v[160:175], v[28:31], v[32:35], v[160:175]
    v_mfma_f32_32x32x16_bf16 v[176:191], v[28:31], v[36:39], v[176:191]
    v_add_u32 v5, 68096, v5
    v_add_u32 v6, 68096, v6
    s_waitcnt vmcnt(2) lgkmcnt(0)
    s_barrier
    s_setprio 3
    v_mfma_f32_32x32x16_bf16 v[64:79], v[40:43], v[56:59], v[64:79]
    ds_read_b64_tr_b16 v[32:33], v6 offset:0
    ds_read_b64_tr_b16 v[34:35], v6 offset:256
    v_mfma_f32_32x32x16_bf16 v[80:95], v[40:43], v[60:63], v[80:95]
    ds_read_b64_tr_b16 v[36:37], v6 offset:64
    ds_read_b64_tr_b16 v[38:39], v6 offset:320
    s_add_u32 m0, s53, 0
    s_add_u32 s55, s51, 0
    buffer_load_dwordx4 v4, s[12:15], s55 offen lds
    v_mfma_f32_32x32x16_bf16 v[96:111], v[44:47], v[56:59], v[96:111]
    ds_read_b128 v[16:19], v5 offset:0
    ds_read_b128 v[20:23], v5 offset:512
    v_mfma_f32_32x32x16_bf16 v[112:127], v[44:47], v[60:63], v[112:127]
    ds_read_b128 v[24:27], v5 offset:8320
    ds_read_b128 v[28:31], v5 offset:8832
    s_add_u32 m0, s53, 1088
    s_add_u32 s55, s51, 8192
    buffer_load_dwordx4 v4, s[12:15], s55 offen lds
    v_mfma_f32_32x32x16_bf16 v[128:143], v[48:51], v[56:59], v[128:143]
    v_mfma_f32_32x32x16_bf16 v[144:159], v[48:51], v[60:63], v[144:159]
    s_add_u32 m0, s53, 2176
    s_add_u32 s55, s51, 16384
    buffer_load_dwordx4 v4, s[12:15], s55 offen lds
    v_mfma_f32_32x32x16_bf16 v[160:175], v[52:55], v[56:59], v[160:175]
    v_mfma_f32_32x32x16_bf16 v[176:191], v[52:55], v[60:63], v[176:191]
    s_add_u32 m0, s53, 3264
    s_add_u32 s55, s51, 24576
    buffer_load_dwordx4 v4, s[12:15], s55 offen lds
    s_setprio 2
    s_waitcnt lgkmcnt(0)
    v_mfma_f32_32x32x16_bf16 v[64:79], v[16:19], v[32:35], v[64:79]
    ds_read_b64_tr_b16 v[56:57], v6 offset:4352
    ds_read_b64_tr_b16 v[58:59], v6 offset:4608
    v_mfma_f32_32x32x16_bf16 v[80:95], v[16:19], v[36:39], v[80:95]
    ds_read_b64_tr_b16 v[60:61], v6 offset:4416
    ds_read_b64_tr_b16 v[62:63], v6 offset:4672
    s_add_u32 m0, s52, 0
    s_nop 0
    buffer_load_dwordx4 v3, s[8:11], s50 offen offset:0 lds
    v_mfma_f32_32x32x16_bf16 v[96:111], v[20:23], v[32:35], v[96:111]
    ds_read_b128 v[40:43], v5 offset:32
    ds_read_b128 v[44:47], v5 offset:544
    v_mfma_f32_32x32x16_bf16 v[112:127], v[20:23], v[36:39], v[112:127]
    ds_read_b128 v[48:51], v5 offset:8352
    ds_read_b128 v[52:55], v5 offset:8864
    s_add_u32 m0, s52, 16
    s_nop 0
    buffer_load_dwordx4 v3, s[8:11], s50 offen offset:1024 lds
    v_mfma_f32_32x32x16_bf16 v[128:143], v[24:27], v[32:35], v[128:143]
    v_mfma_f32_32x32x16_bf16 v[144:159], v[24:27], v[36:39], v[144:159]
    s_add_u32 m0, s52, 32
    s_nop 0
    buffer_load_dwordx4 v3, s[8:11], s50 offen offset:2048 lds
    v_mfma_f32_32x32x16_bf16 v[160:175], v[28:31], v[32:35], v[160:175]
    v_mfma_f32_32x32x16_bf16 v[176:191], v[28:31], v[36:39], v[176:191]
    s_add_u32 m0, s52, 48
    s_nop 0
    buffer_load_dwordx4 v3, s[8:11], s50 offen offset:3072 lds
    s_add_u32 s50, s50, 128
    s_add_u32 s51, s51, 524288
    s_setprio 1
    s_waitcnt lgkmcnt(0)
    v_mfma_f32_32x32x16_bf16 v[64:79], v[40:43], v[56:59], v[64:79]
    ds_read_b64_tr_b16 v[32:33], v6 offset:8704
    ds_read_b64_tr_b16 v[34:35], v6 offset:8960
    v_fmac_f32 v219, v217, v217
    v_sub_f32 v217, v236, v216
    v_fmac_f32 v219, v217, v217
    v_sub_f32 v217, v237, v216
    v_mfma_f32_32x32x16_bf16 v[80:95], v[40:43], v[60:63], v[80:95]
    ds_read_b64_tr_b16 v[36:37], v6 offset:8768
    ds_read_b64_tr_b16 v[38:39], v6 offset:9024
    v_fmac_f32 v219, v217, v217
    v_sub_f32 v217, v238, v216
    v_fmac_f32 v219, v217, v217
    v_sub_f32 v217, v239, v216
    v_mfma_f32_32x32x16_bf16 v[96:111], v[44:47], v[56:59], v[96:111]
    ds_read_b128 v[16:19], v5 offset:64
    ds_read_b128 v[20:23], v5 offset:576
    v_fmac_f32 v219, v217, v217
    v_sub_f32 v217, v240, v218
    v_fmac_f32 v219, v217, v217
    v_sub_f32 v217, v241, v218
    v_mfma_f32_32x32x16_bf16 v[112:127], v[44:47], v[60:63], v[112:127]
    ds_read_b128 v[24:27], v5 offset:8384
    ds_read_b128 v[28:31], v5 offset:8896
    v_fmac_f32 v219, v217, v217
    v_sub_f32 v217, v242, v218
    v_fmac_f32 v219, v217, v217
    v_sub_f32 v217, v243, v218
    v_mfma_f32_32x32x16_bf16 v[128:143], v[48:51], v[56:59], v[128:143]
    v_fmac_f32 v219, v217, v217
    v_sub_f32 v217, v244, v218
    v_fmac_f32 v219, v217, v217
    v_sub_f32 v217, v245, v218
    v_mfma_f32_32x32x16_bf16 v[144:159], v[48:51], v[60:63], v[144:159]
    v_fmac_f32 v219, v217, v217
    v_sub_f32 v217, v246, v218
    v_fmac_f32 v219, v217, v217
    v_sub_f32 v217, v247, v218
    v_mfma_f32_32x32x16_bf16 v[160:175], v[52:55], v[56:59], v[160:175]
    v_fmac_f32 v219, v217, v217
    s_nop 1
    v_add_f32_dpp v219, v219, v219 row_ror:8 row_mask:0xf bank_mask:0xf
    s_nop 1
    v_mfma_f32_32x32x16_bf16 v[176:191], v[52:55], v[60:63], v[176:191]
    v_add_f32_dpp v219, v219, v219 row_ror:4 row_mask:0xf bank_mask:0xf
    s_nop 1
    v_add_f32_dpp v219, v219, v219 row_ror:2 row_mask:0xf bank_mask:0xf
    s_nop 1
    s_setprio 0
    s_waitcnt lgkmcnt(0)
    v_mfma_f32_32x32x16_bf16 v[64:79], v[16:19], v[32:35], v[64:79]
    ds_read_b64_tr_b16 v[56:57], v6 offset:13056
    ds_read_b64_tr_b16 v[58:59], v6 offset:13312
    v_add_f32_dpp v219, v219, v219 row_ror:1 row_mask:0xf bank_mask:0xf
    v_mov_b32 v217, v219
    s_nop 1
    v_permlane16_swap_b32 v219, v217
    v_mfma_f32_32x32x16_bf16 v[80:95], v[16:19], v[36:39], v[80:95]
    ds_read_b64_tr_b16 v[60:61], v6 offset:13120
    ds_read_b64_tr_b16 v[62:63], v6 offset:13376
    s_nop 1
    v_add_f32 v219, v219, v217
    v_mov_b32 v217, v219
    s_nop 1
    v_mfma_f32_32x32x16_bf16 v[96:111], v[20:23], v[32:35], v[96:111]
    ds_read_b128 v[40:43], v5 offset:96
    ds_read_b128 v[44:47], v5 offset:608
    v_permlane32_swap_b32 v219, v217
    s_nop 1
    v_add_f32 v219, v219, v217
    v_mul_f32 v219, 0x3ae38e39, v219
    v_mfma_f32_32x32x16_bf16 v[112:127], v[20:23], v[36:39], v[112:127]
    ds_read_b128 v[48:51], v5 offset:8416
    ds_read_b128 v[52:55], v5 offset:8928
    v_cvt_pk_bf16_f32 v216, v216, v216
    v_and_b32 v216, 0xffff0000, v216
    v_cvt_pk_bf16_f32 v219, v219, v219
    v_and_b32 v219, 0xffff0000, v219
    v_mfma_f32_32x32x16_bf16 v[128:143], v[24:27], v[32:35], v[128:143]
    v_add_f32 v219, 0x3727c5ac, v219
    v_cvt_pk_bf16_f32 v219, v219, v219
    v_and_b32 v219, 0xffff0000, v219
    v_sqrt_f32 v219, v219
    v_mfma_f32_32x32x16_bf16 v[144:159], v[24:27], v[36:39], v[144:159]
    s_nop 0
    v_cvt_pk_bf16_f32 v219, v219, v219
    v_and_b32 v219, 0xffff0000, v219
    v_rcp_f32 v219, v219
    v_mfma_f32_32x32x16_bf16 v[160:175], v[28:31], v[32:35], v[160:175]
    s_nop 0
    v_sub_f32 v232, v232, v216
    v_sub_f32 v233, v233, v216
    v_sub_f32 v234, v234, v216
    v_mfma_f32_32x32x16_bf16 v[176:191], v[28:31], v[36:39], v[176:191]
    v_sub_f32 v235, v235, v216
    buffer_load_dwordx4 v[220:223], v3, s[8:11], s63 offen offset:768
    s_add_u32 s56, s7, 3145728
    buffer_load_dwordx4 v[220:223], v4, s[12:15], s56 offen
    v_add_u32 v5, 4294899200, v5
    v_add_u32 v6, 4294899200, v6
    s_waitcnt vmcnt(2) lgkmcnt(0)
    s_barrier
    s_setprio 3
    v_mfma_f32_32x32x16_bf16 v[64:79], v[40:43], v[56:59], v[64:79]
    ds_read_b64_tr_b16 v[32:33], v6 offset:0
    ds_read_b64_tr_b16 v[34:35], v6 offset:256
    v_mfma_f32_32x32x16_bf16 v[80:95], v[40:43], v[60:63], v[80:95]
    ds_read_b64_tr_b16 v[36:37], v6 offset:64
    ds_read_b64_tr_b16 v[38:39], v6 offset:320
    s_add_u32 m0, s53, 68096
    s_add_u32 s55, s51, 0
    buffer_load_dwordx4 v4, s[12:15], s55 offen lds
    v_mfma_f32_32x32x16_bf16 v[96:111], v[44:47], v[56:59], v[96:111]
    ds_read_b128 v[16:19], v5 offset:0
    ds_read_b128 v[20:23], v5 offset:512
    v_mfma_f32_32x32x16_bf16 v[112:127], v[44:47], v[60:63], v[112:127]
    ds_read_b128 v[24:27], v5 offset:8320
    ds_read_b128 v[28:31], v5 offset:8832
    s_add_u32 m0, s53, 69184
    s_add_u32 s55, s51, 8192
    buffer_load_dwordx4 v4, s[12:15], s55 offen lds
    v_mfma_f32_32x32x16_bf16 v[128:143], v[48:51], v[56:59], v[128:143]
    v_mfma_f32_32x32x16_bf16 v[144:159], v[48:51], v[60:63], v[144:159]
    s_add_u32 m0, s53, 70272
    s_add_u32 s55, s51, 16384
    buffer_load_dwordx4 v4, s[12:15], s55 offen lds
    v_mfma_f32_32x32x16_bf16 v[160:175], v[52:55], v[56:59], v[160:175]
    v_mfma_f32_32x32x16_bf16 v[176:191], v[52:55], v[60:63], v[176:191]
    s_add_u32 m0, s53, 71360
    s_add_u32 s55, s51, 24576
    buffer_load_dwordx4 v4, s[12:15], s55 offen lds
    s_setprio 2
    s_waitcnt lgkmcnt(0)
    v_mfma_f32_32x32x16_bf16 v[64:79], v[16:19], v[32:35], v[64:79]
    ds_read_b64_tr_b16 v[56:57], v6 offset:4352
    ds_read_b64_tr_b16 v[58:59], v6 offset:4608
    v_mfma_f32_32x32x16_bf16 v[80:95], v[16:19], v[36:39], v[80:95]
    ds_read_b64_tr_b16 v[60:61], v6 offset:4416
    ds_read_b64_tr_b16 v[62:63], v6 offset:4672
    s_add_u32 m0, s52, 68096
    s_nop 0
    buffer_load_dwordx4 v3, s[8:11], s50 offen offset:0 lds
    v_mfma_f32_32x32x16_bf16 v[96:111], v[20:23], v[32:35], v[96:111]
    ds_read_b128 v[40:43], v5 offset:32
    ds_read_b128 v[44:47], v5 offset:544
    v_mfma_f32_32x32x16_bf16 v[112:127], v[20:23], v[36:39], v[112:127]
    ds_read_b128 v[48:51], v5 offset:8352
    ds_read_b128 v[52:55], v5 offset:8864
    s_add_u32 m0, s52, 68112
    s_nop 0
    buffer_load_dwordx4 v3, s[8:11], s50 offen offset:1024 lds
    v_mfma_f32_32x32x16_bf16 v[128:143], v[24:27], v[32:35], v[128:143]
    v_mfma_f32_32x32x16_bf16 v[144:159], v[24:27], v[36:39], v[144:159]
    s_add_u32 m0, s52, 68128
    s_nop 0
    buffer_load_dwordx4 v3, s[8:11], s50 offen offset:2048 lds
    v_mfma_f32_32x32x16_bf16 v[160:175], v[28:31], v[32:35], v[160:175]
    v_mfma_f32_32x32x16_bf16 v[176:191], v[28:31], v[36:39], v[176:191]
    s_add_u32 m0, s52, 68144
    s_nop 0
    buffer_load_dwordx4 v3, s[8:11], s50 offen offset:3072 lds
    s_add_u32 s50, s50, 128
    s_add_u32 s51, s51, 524288
    s_setprio 1
    s_waitcnt lgkmcnt(0)
    v_mfma_f32_32x32x16_bf16 v[64:79], v[40:43], v[56:59], v[64:79]
    ds_read_b64_tr_b16 v[32:33], v6 offset:8704
    ds_read_b64_tr_b16 v[34:35], v6 offset:8960
    v_sub_f32 v236, v236, v216
    v_sub_f32 v237, v237, v216
    v_sub_f32 v238, v238, v216
    v_sub_f32 v239, v239, v216
    v_sub_f32 v240, v240, v216
    v_mfma_f32_32x32x16_bf16 v[80:95], v[40:43], v[60:63], v[80:95]
    ds_read_b64_tr_b16 v[36:37], v6 offset:8768
    ds_read_b64_tr_b16 v[38:39], v6 offset:9024
    v_sub_f32 v241, v241, v216
    v_sub_f32 v242, v242, v216
    v_sub_f32 v243, v243, v216
    v_sub_f32 v244, v244, v216
    v_sub_f32 v245, v245, v216
    v_mfma_f32_32x32x16_bf16 v[96:111], v[44:47], v[56:59], v[96:111]
    ds_read_b128 v[16:19], v5 offset:64
    ds_read_b128 v[20:23], v5 offset:576
    v_sub_f32 v246, v246, v216
    v_sub_f32 v247, v247, v216
    v_cvt_pk_bf16_f32 v217, v232, v233
    v_lshlrev_b32 v232, 16, v217
    v_and_b32 v233, 0xffff0000, v217
    v_mfma_f32_32x32x16_bf16 v[112:127], v[44:47], v[60:63], v[112:127]
    ds_read_b128 v[24:27], v5 offset:8384
    ds_read_b128 v[28:31], v5 offset:8896
    v_cvt_pk_bf16_f32 v217, v234, v235
    v_lshlrev_b32 v234, 16, v217
    v_and_b32 v235, 0xffff0000, v217
    v_cvt_pk_bf16_f32 v217, v236, v237
    v_lshlrev_b32 v236, 16, v217
    v_mfma_f32_32x32x16_bf16 v[128:143], v[48:51], v[56:59], v[128:143]
    s_mul_i32 s55, s60, 2304
    v_lshlrev_b32 v2, 4, v1
    buffer_load_dwordx4 v[220:223], v2, s[16:19], s55 offen offset:0
    buffer_load_dwordx4 v[220:223], v2, s[16:19], s55 offen offset:1024
    buffer_load_dwordx4 v[220:223], v2, s[16:19], s55 offen offset:2048
    v_and_b32 v237, 0xffff0000, v217
    v_mfma_f32_32x32x16_bf16 v[144:159], v[48:51], v[60:63], v[144:159]
    v_cvt_pk_bf16_f32 v217, v238, v239
    v_lshlrev_b32 v238, 16, v217
    v_and_b32 v239, 0xffff0000, v217
    v_cvt_pk_bf16_f32 v217, v240, v241
    v_lshlrev_b32 v240, 16, v217
    v_mfma_f32_32x32x16_bf16 v[160:175], v[52:55], v[56:59], v[160:175]
    v_and_b32 v241, 0xffff0000, v217
    v_cvt_pk_bf16_f32 v217, v242, v243
    v_lshlrev_b32 v242, 16, v217
    v_and_b32 v243, 0xffff0000, v217
    v_cvt_pk_bf16_f32 v217, v244, v245
    v_mfma_f32_32x32x16_bf16 v[176:191], v[52:55], v[60:63], v[176:191]
    v_lshlrev_b32 v244, 16, v217
    v_and_b32 v245, 0xffff0000, v217
    v_cvt_pk_bf16_f32 v217, v246, v247
    v_lshlrev_b32 v246, 16, v217
    v_and_b32 v247, 0xffff0000, v217
    s_setprio 0
    s_waitcnt lgkmcnt(0)
    v_mfma_f32_32x32x16_bf16 v[64:79], v[16:19], v[32:35], v[64:79]
    ds_read_b64_tr_b16 v[56:57], v6 offset:13056
    ds_read_b64_tr_b16 v[58:59], v6 offset:13312
    v_mul_f32 v232, v232, v219
    v_mul_f32 v233, v233, v219
    v_mul_f32 v234, v234, v219
    v_mul_f32 v235, v235, v219
    v_mul_f32 v236, v236, v219
    v_mfma_f32_32x32x16_bf16 v[80:95], v[16:19], v[36:39], v[80:95]
    ds_read_b64_tr_b16 v[60:61], v6 offset:13120
    ds_read_b64_tr_b16 v[62:63], v6 offset:13376
    v_mul_f32 v237, v237, v219
    v_mul_f32 v238, v238, v219
    v_mul_f32 v239, v239, v219
    v_mul_f32 v240, v240, v219
    v_mul_f32 v241, v241, v219
    v_mfma_f32_32x32x16_bf16 v[96:111], v[20:23], v[32:35], v[96:111]
    ds_read_b128 v[40:43], v5 offset:96
    ds_read_b128 v[44:47], v5 offset:608
    v_mul_f32 v242, v242, v219
    v_mul_f32 v243, v243, v219
    v_mul_f32 v244, v244, v219
    v_mul_f32 v245, v245, v219
    v_mul_f32 v246, v246, v219
    v_mfma_f32_32x32x16_bf16 v[112:127], v[20:23], v[36:39], v[112:127]
    ds_read_b128 v[48:51], v5 offset:8416
    ds_read_b128 v[52:55], v5 offset:8928
    v_mul_f32 v247, v247, v219
    v_cvt_pk_bf16_f32 v248, v232, v233
    v_cvt_pk_bf16_f32 v249, v234, v235
    v_cvt_pk_bf16_f32 v250, v236, v237
    v_cvt_pk_bf16_f32 v251, v238, v239
    v_mfma_f32_32x32x16_bf16 v[128:143], v[24:27], v[32:35], v[128:143]
    v_cvt_pk_bf16_f32 v252, v240, v241
    v_cvt_pk_bf16_f32 v253, v242, v243
    v_cvt_pk_bf16_f32 v254, v244, v245
    v_cvt_pk_bf16_f32 v255, v246, v247
    ds_write_b128 v14, v[248:251]
    v_mfma_f32_32x32x16_bf16 v[144:159], v[24:27], v[36:39], v[144:159]
    ds_write_b128 v14, v[252:255] offset:8192
    buffer_load_dwordx4 v[220:223], v3, s[8:11], s63 offen offset:896
    s_add_u32 s56, s7, 3670016
    buffer_load_dwordx4 v[220:223], v4, s[12:15], s56 offen
    v_mfma_f32_32x32x16_bf16 v[160:175], v[28:31], v[32:35], v[160:175]
    v_mfma_f32_32x32x16_bf16 v[176:191], v[28:31], v[36:39], v[176:191]
    v_add_u32 v5, 68096, v5
    v_add_u32 v6, 68096, v6
    s_waitcnt vmcnt(5) lgkmcnt(0)
    s_barrier
    s_setprio 3
    v_lshlrev_b32 v10, 4, v0
    v_add_u32 v10, 138240, v10
    s_mov_b32 s55, 0
    buffer_load_dwordx4 v[192:195], v12, s[40:43], s55 offen sc1
    s_mov_b32 s55, 13824
    buffer_load_dwordx4 v[196:199], v12, s[40:43], s55 offen sc1
    s_mov_b32 s55, 27648
    buffer_load_dwordx4 v[200:203], v12, s[40:43], s55 offen sc1
    s_mov_b32 s55, 41472
    buffer_load_dwordx4 v[204:207], v12, s[40:43], s55 offen sc1
    v_mfma_f32_32x32x16_bf16 v[64:79], v[40:43], v[56:59], v[64:79]
    ds_read_b64_tr_b16 v[32:33], v6 offset:0
    ds_read_b64_tr_b16 v[34:35], v6 offset:256
    v_mfma_f32_32x32x16_bf16 v[80:95], v[40:43], v[60:63], v[80:95]
    ds_read_b64_tr_b16 v[36:37], v6 offset:64
    ds_read_b64_tr_b16 v[38:39], v6 offset:320
    s_add_u32 m0, s53, 0
    s_add_u32 s55, s51, 0
    buffer_load_dwordx4 v4, s[12:15], s55 offen lds
    v_mfma_f32_32x32x16_bf16 v[96:111], v[44:47], v[56:59], v[96:111]
    ds_read_b128 v[16:19], v5 offset:0
    ds_read_b128 v[20:23], v5 offset:512
    v_mfma_f32_32x32x16_bf16 v[112:127], v[44:47], v[60:63], v[112:127]
    ds_read_b128 v[24:27], v5 offset:8320
    ds_read_b128 v[28:31], v5 offset:8832
    s_add_u32 m0, s53, 1088
    s_add_u32 s55, s51, 8192
    buffer_load_dwordx4 v4, s[12:15], s55 offen lds
    v_mfma_f32_32x32x16_bf16 v[128:143], v[48:51], v[56:59], v[128:143]
    v_mfma_f32_32x32x16_bf16 v[144:159], v[48:51], v[60:63], v[144:159]
    s_add_u32 m0, s53, 2176
    s_add_u32 s55, s51, 16384
    buffer_load_dwordx4 v4, s[12:15], s55 offen lds
    v_mfma_f32_32x32x16_bf16 v[160:175], v[52:55], v[56:59], v[160:175]
    v_mfma_f32_32x32x16_bf16 v[176:191], v[52:55], v[60:63], v[176:191]
    s_add_u32 m0, s53, 3264
    s_add_u32 s55, s51, 24576
    buffer_load_dwordx4 v4, s[12:15], s55 offen lds
    s_cmp_lg_u32 s3, 7
    s_cbranch_scc1 Lkv_nofm5
    s_lshl_b32 s55, s2, 6
    v_lshlrev_b32 v15, 2, v1
    v_add_u32 v15, s55, v15
    v_cmp_gt_u32 vcc, 16, v1
    v_mov_b32 v2, 0xffffff00
    s_cmp_lt_u32 s2, 216
    s_cselect_b64 vcc, vcc, 0
    s_nop 1
    v_cndmask_b32 v15, v2, v15, vcc
    s_mov_b32 s55, 0
    buffer_load_dword v208, v15, s[40:43], s55 offen sc1
    s_mov_b32 s55, 13824
    buffer_load_dword v209, v15, s[40:43], s55 offen sc1
    s_mov_b32 s55, 27648
    buffer_load_dword v210, v15, s[40:43], s55 offen sc1
    s_mov_b32 s55, 41472
    buffer_load_dword v211, v15, s[40:43], s55 offen sc1
Lkv_nofm5:
    s_setprio 2
    s_waitcnt lgkmcnt(0)
    v_mfma_f32_32x32x16_bf16 v[64:79], v[16:19], v[32:35], v[64:79]
    ds_read_b64_tr_b16 v[56:57], v6 offset:4352
    ds_read_b64_tr_b16 v[58:59], v6 offset:4608
    v_mfma_f32_32x32x16_bf16 v[80:95], v[16:19], v[36:39], v[80:95]
    ds_read_b64_tr_b16 v[60:61], v6 offset:4416
    ds_read_b64_tr_b16 v[62:63], v6 offset:4672
    s_add_u32 m0, s52, 0
    s_nop 0
    buffer_load_dwordx4 v3, s[8:11], s50 offen offset:0 lds
    v_mfma_f32_32x32x16_bf16 v[96:111], v[20:23], v[32:35], v[96:111]
    ds_read_b128 v[40:43], v5 offset:32
    ds_read_b128 v[44:47], v5 offset:544
    v_mfma_f32_32x32x16_bf16 v[112:127], v[20:23], v[36:39], v[112:127]
    ds_read_b128 v[48:51], v5 offset:8352
    ds_read_b128 v[52:55], v5 offset:8864
    s_add_u32 m0, s52, 16
    s_nop 0
    buffer_load_dwordx4 v3, s[8:11], s50 offen offset:1024 lds
    v_mfma_f32_32x32x16_bf16 v[128:143], v[24:27], v[32:35], v[128:143]
    v_mfma_f32_32x32x16_bf16 v[144:159], v[24:27], v[36:39], v[144:159]
    s_add_u32 m0, s52, 32
    s_nop 0
    buffer_load_dwordx4 v3, s[8:11], s50 offen offset:2048 lds
    v_mfma_f32_32x32x16_bf16 v[160:175], v[28:31], v[32:35], v[160:175]
    v_mfma_f32_32x32x16_bf16 v[176:191], v[28:31], v[36:39], v[176:191]
    s_add_u32 m0, s52, 48
    s_nop 0
    buffer_load_dwordx4 v3, s[8:11], s50 offen offset:3072 lds
    s_add_u32 s50, s50, 128
    s_add_u32 s51, s51, 524288
    s_setprio 1
    s_waitcnt lgkmcnt(0)
    v_mfma_f32_32x32x16_bf16 v[64:79], v[40:43], v[56:59], v[64:79]
    ds_read_b64_tr_b16 v[32:33], v6 offset:8704
    ds_read_b64_tr_b16 v[34:35], v6 offset:8960
    v_mfma_f32_32x32x16_bf16 v[80:95], v[40:43], v[60:63], v[80:95]
    ds_read_b64_tr_b16 v[36:37], v6 offset:8768
    ds_read_b64_tr_b16 v[38:39], v6 offset:9024
    v_mfma_f32_32x32x16_bf16 v[96:111], v[44:47], v[56:59], v[96:111]
    ds_read_b128 v[16:19], v5 offset:64
    ds_read_b128 v[20:23], v5 offset:576
    v_mfma_f32_32x32x16_bf16 v[112:127], v[44:47], v[60:63], v[112:127]
    ds_read_b128 v[24:27], v5 offset:8384
    ds_read_b128 v[28:31], v5 offset:8896
    v_mfma_f32_32x32x16_bf16 v[128:143], v[48:51], v[56:59], v[128:143]
    v_mfma_f32_32x32x16_bf16 v[144:159], v[48:51], v[60:63], v[144:159]
    v_mfma_f32_32x32x16_bf16 v[160:175], v[52:55], v[56:59], v[160:175]
    v_mfma_f32_32x32x16_bf16 v[176:191], v[52:55], v[60:63], v[176:191]
    s_waitcnt vmcnt(8)
    v_add_f32 v192, v192, v196
    s_setprio 0
    s_waitcnt lgkmcnt(0)
    v_mfma_f32_32x32x16_bf16 v[64:79], v[16:19], v[32:35], v[64:79]
    ds_read_b64_tr_b16 v[56:57], v6 offset:13056
    ds_read_b64_tr_b16 v[58:59], v6 offset:13312
    v_add_f32 v200, v200, v204
    v_add_f32 v193, v193, v197
    v_add_f32 v201, v201, v205
    v_add_f32 v194, v194, v198
    v_mfma_f32_32x32x16_bf16 v[80:95], v[16:19], v[36:39], v[80:95]
    ds_read_b64_tr_b16 v[60:61], v6 offset:13120
    ds_read_b64_tr_b16 v[62:63], v6 offset:13376
    v_add_f32 v202, v202, v206
    v_add_f32 v195, v195, v199
    v_add_f32 v203, v203, v207
    v_add_f32 v192, v192, v200
    v_mfma_f32_32x32x16_bf16 v[96:111], v[20:23], v[32:35], v[96:111]
    ds_read_b128 v[40:43], v5 offset:96
    ds_read_b128 v[44:47], v5 offset:608
    v_add_f32 v193, v193, v201
    v_add_f32 v194, v194, v202
    v_add_f32 v195, v195, v203
    v_cvt_pk_bf16_f32 v2, v192, v193
    v_mfma_f32_32x32x16_bf16 v[112:127], v[20:23], v[36:39], v[112:127]
    ds_read_b128 v[48:51], v5 offset:8416
    ds_read_b128 v[52:55], v5 offset:8928
    v_lshlrev_b32 v192, 16, v2
    v_and_b32 v193, 0xffff0000, v2
    v_cvt_pk_bf16_f32 v2, v194, v195
    v_lshlrev_b32 v194, 16, v2
    v_mfma_f32_32x32x16_bf16 v[128:143], v[24:27], v[32:35], v[128:143]
    v_and_b32 v195, 0xffff0000, v2
    v_cmp_lt_u32 vcc, 143, v0
    s_nop 1
    v_cndmask_b32 v196, 0, 1.0, vcc
    v_mfma_f32_32x32x16_bf16 v[144:159], v[24:27], v[36:39], v[144:159]
    v_add_f32 v192, v192, v196
    v_add_f32 v193, v193, v196
    v_add_f32 v194, v194, v196
    v_add_f32 v195, v195, v196
    v_mfma_f32_32x32x16_bf16 v[160:175], v[28:31], v[32:35], v[160:175]
    v_cvt_pk_bf16_f32 v2, v192, v193
    v_lshlrev_b32 v192, 16, v2
    v_and_b32 v193, 0xffff0000, v2
    v_cvt_pk_bf16_f32 v2, v194, v195
    v_mfma_f32_32x32x16_bf16 v[176:191], v[28:31], v[36:39], v[176:191]
    v_lshlrev_b32 v194, 16, v2
    v_and_b32 v195, 0xffff0000, v2
    ds_write_b128 v10, v[192:195]
    v_add_u32 v5, 4294899200, v5
    v_add_u32 v6, 4294899200, v6
    s_waitcnt vmcnt(0) lgkmcnt(0)
    s_barrier
    s_setprio 3
    v_mfma_f32_32x32x16_bf16 v[64:79], v[40:43], v[56:59], v[64:79]
    ds_read_b64_tr_b16 v[32:33], v6 offset:0
    ds_read_b64_tr_b16 v[34:35], v6 offset:256
    v_mfma_f32_32x32x16_bf16 v[80:95], v[40:43], v[60:63], v[80:95]
    ds_read_b64_tr_b16 v[36:37], v6 offset:64
    ds_read_b64_tr_b16 v[38:39], v6 offset:320
    s_add_u32 m0, s53, 68096
    s_add_u32 s55, s51, 0
    buffer_load_dwordx4 v4, s[12:15], s55 offen lds
    v_mfma_f32_32x32x16_bf16 v[96:111], v[44:47], v[56:59], v[96:111]
    ds_read_b128 v[16:19], v5 offset:0
    ds_read_b128 v[20:23], v5 offset:512
    v_mfma_f32_32x32x16_bf16 v[112:127], v[44:47], v[60:63], v[112:127]
    ds_read_b128 v[24:27], v5 offset:8320
    ds_read_b128 v[28:31], v5 offset:8832
    s_add_u32 m0, s53, 69184
    s_add_u32 s55, s51, 8192
    buffer_load_dwordx4 v4, s[12:15], s55 offen lds
    v_mfma_f32_32x32x16_bf16 v[128:143], v[48:51], v[56:59], v[128:143]
    v_mfma_f32_32x32x16_bf16 v[144:159], v[48:51], v[60:63], v[144:159]
    s_add_u32 m0, s53, 70272
    s_add_u32 s55, s51, 16384
    buffer_load_dwordx4 v4, s[12:15], s55 offen lds
    v_mfma_f32_32x32x16_bf16 v[160:175], v[52:55], v[56:59], v[160:175]
    v_mfma_f32_32x32x16_bf16 v[176:191], v[52:55], v[60:63], v[176:191]
    s_add_u32 m0, s53, 71360
    s_add_u32 s55, s51, 24576
    buffer_load_dwordx4 v4, s[12:15], s55 offen lds
    s_cmp_lg_u32 s3, 7
    s_cbranch_scc1 Lkv_nofm6
    v_add_f32 v208, v208, v209
    v_add_f32 v210, v210, v211
    v_add_f32 v208, v208, v210
    v_cvt_pk_bf16_f32 v208, v208, v208
    v_and_b32 v208, 0xffff0000, v208
    buffer_store_dword v208, v15, s[20:23], 0 offen sc1
Lkv_nofm6:
    s_setprio 2
    s_waitcnt lgkmcnt(0)
    v_mfma_f32_32x32x16_bf16 v[64:79], v[16:19], v[32:35], v[64:79]
    ds_read_b64_tr_b16 v[56:57], v6 offset:4352
    ds_read_b64_tr_b16 v[58:59], v6 offset:4608
    v_mfma_f32_32x32x16_bf16 v[80:95], v[16:19], v[36:39], v[80:95]
    ds_read_b64_tr_b16 v[60:61], v6 offset:4416
    ds_read_b64_tr_b16 v[62:63], v6 offset:4672
    s_add_u32 m0, s52, 68096
    s_nop 0
    buffer_load_dwordx4 v3, s[8:11], s50 offen offset:0 lds
    v_mfma_f32_32x32x16_bf16 v[96:111], v[20:23], v[32:35], v[96:111]
    ds_read_b128 v[40:43], v5 offset:32
    ds_read_b128 v[44:47], v5 offset:544
    v_mfma_f32_32x32x16_bf16 v[112:127], v[20:23], v[36:39], v[112:127]
    ds_read_b128 v[48:51], v5 offset:8352
    ds_read_b128 v[52:55], v5 offset:8864
    s_add_u32 m0, s52, 68112
    s_nop 0
    buffer_load_dwordx4 v3, s[8:11], s50 offen offset:1024 lds
    v_mfma_f32_32x32x16_bf16 v[128:143], v[24:27], v[32:35], v[128:143]
    v_mfma_f32_32x32x16_bf16 v[144:159], v[24:27], v[36:39], v[144:159]
    s_add_u32 m0, s52, 68128
    s_nop 0
    buffer_load_dwordx4 v3, s[8:11], s50 offen offset:2048 lds
    v_mfma_f32_32x32x16_bf16 v[160:175], v[28:31], v[32:35], v[160:175]
    v_mfma_f32_32x32x16_bf16 v[176:191], v[28:31], v[36:39], v[176:191]
    s_add_u32 m0, s52, 68144
    s_nop 0
    buffer_load_dwordx4 v3, s[8:11], s50 offen offset:3072 lds
    s_add_u32 s50, s50, 128
    s_add_u32 s51, s51, 524288
    s_setprio 1
    s_waitcnt lgkmcnt(0)
    v_mfma_f32_32x32x16_bf16 v[64:79], v[40:43], v[56:59], v[64:79]
    ds_read_b64_tr_b16 v[32:33], v6 offset:8704
    ds_read_b64_tr_b16 v[34:35], v6 offset:8960
    ds_read_b128 v[224:227], v10 offset:8192
    ds_read_b128 v[192:195], v9 offset:0
    ds_read_b128 v[196:199], v9 offset:16
    ds_read_b128 v[200:203], v9 offset:2304
    ds_read_b128 v[204:207], v9 offset:2320
    s_waitcnt lgkmcnt(0)
    v_mfma_f32_32x32x16_bf16 v[80:95], v[40:43], v[60:63], v[80:95]
    ds_read_b64_tr_b16 v[36:37], v6 offset:8768
    ds_read_b64_tr_b16 v[38:39], v6 offset:9024
    v_lshlrev_b32 v232, 16, v224
    v_and_b32 v233, 0xffff0000, v224
    v_lshlrev_b32 v234, 16, v225
    v_and_b32 v235, 0xffff0000, v225
    v_lshlrev_b32 v236, 16, v226
    v_and_b32 v237, 0xffff0000, v226
    v_mfma_f32_32x32x16_bf16 v[96:111], v[44:47], v[56:59], v[96:111]
    ds_read_b128 v[16:19], v5 offset:64
    ds_read_b128 v[20:23], v5 offset:576
    v_lshlrev_b32 v238, 16, v227
    v_and_b32 v239, 0xffff0000, v227
    v_mul_f32 v232, v232, v200
    v_mul_f32 v233, v233, v201
    v_mul_f32 v234, v234, v202
    v_mul_f32 v235, v235, v203
    v_mfma_f32_32x32x16_bf16 v[112:127], v[44:47], v[60:63], v[112:127]
    ds_read_b128 v[24:27], v5 offset:8384
    ds_read_b128 v[28:31], v5 offset:8896
    v_mul_f32 v236, v236, v204
    v_mul_f32 v237, v237, v205
    v_mul_f32 v238, v238, v206
    v_mul_f32 v239, v239, v207
    v_cvt_pk_bf16_f32 v2, v232, v233
    v_lshlrev_b32 v232, 16, v2
    v_mfma_f32_32x32x16_bf16 v[128:143], v[48:51], v[56:59], v[128:143]
    v_and_b32 v233, 0xffff0000, v2
    v_cvt_pk_bf16_f32 v2, v234, v235
    v_lshlrev_b32 v234, 16, v2
    v_and_b32 v235, 0xffff0000, v2
    v_cvt_pk_bf16_f32 v2, v236, v237
    v_lshlrev_b32 v236, 16, v2
    v_mfma_f32_32x32x16_bf16 v[144:159], v[48:51], v[60:63], v[144:159]
    v_and_b32 v237, 0xffff0000, v2
    v_cvt_pk_bf16_f32 v2, v238, v239
    v_lshlrev_b32 v238, 16, v2
    v_and_b32 v239, 0xffff0000, v2
    v_add_f32 v232, v232, v192
    v_add_f32 v233, v233, v193
    v_mfma_f32_32x32x16_bf16 v[160:175], v[52:55], v[56:59], v[160:175]
    v_add_f32 v234, v234, v194
    v_add_f32 v235, v235, v195
    v_add_f32 v236, v236, v196
    v_add_f32 v237, v237, v197
    v_add_f32 v238, v238, v198
    v_add_f32 v239, v239, v199
    v_mfma_f32_32x32x16_bf16 v[176:191], v[52:55], v[60:63], v[176:191]
    v_cvt_pk_bf16_f32 v228, v232, v233
    v_cvt_pk_bf16_f32 v229, v234, v235
    v_cvt_pk_bf16_f32 v230, v236, v237
    v_cvt_pk_bf16_f32 v231, v238, v239
    s_add_u32 s55, s62, 0
    buffer_store_dwordx4 v[228:231], v13, s[24:27], s55 offen sc1
    s_setprio 0
    s_waitcnt lgkmcnt(0)
    v_mfma_f32_32x32x16_bf16 v[64:79], v[16:19], v[32:35], v[64:79]
    ds_read_b64_tr_b16 v[56:57], v6 offset:13056
    ds_read_b64_tr_b16 v[58:59], v6 offset:13312
    v_mfma_f32_32x32x16_bf16 v[80:95], v[16:19], v[36:39], v[80:95]
    ds_read_b64_tr_b16 v[60:61], v6 offset:13120
    ds_read_b64_tr_b16 v[62:63], v6 offset:13376
    v_mfma_f32_32x32x16_bf16 v[96:111], v[20:23], v[32:35], v[96:111]
    ds_read_b128 v[40:43], v5 offset:96
    ds_read_b128 v[44:47], v5 offset:608
    v_mfma_f32_32x32x16_bf16 v[112:127], v[20:23], v[36:39], v[112:127]
    ds_read_b128 v[48:51], v5 offset:8416
    ds_read_b128 v[52:55], v5 offset:8928
    v_mfma_f32_32x32x16_bf16 v[128:143], v[24:27], v[32:35], v[128:143]
    v_mfma_f32_32x32x16_bf16 v[144:159], v[24:27], v[36:39], v[144:159]
    v_mfma_f32_32x32x16_bf16 v[160:175], v[28:31], v[32:35], v[160:175]
    v_mfma_f32_32x32x16_bf16 v[176:191], v[28:31], v[36:39], v[176:191]
    v_add_u32 v5, 68096, v5
    v_add_u32 v6, 68096, v6
    s_waitcnt vmcnt(0) lgkmcnt(0)
    s_barrier
    s_cmp_lg_u32 s3, 7
    s_cbranch_scc1 Lkv_ns1
    s_lshr_b32 s55, s2, 4
    s_lshl_b32 s55, s55, 7
    v_mov_b32 v2, 1
    s_mov_b64 exec, 1
    buffer_atomic_add v2, off, s[96:99], s55 sc1
    s_mov_b64 exec, -1
Lkv_ns1:
    s_setprio 3
    v_mfma_f32_32x32x16_bf16 v[64:79], v[40:43], v[56:59], v[64:79]
    ds_read_b64_tr_b16 v[32:33], v6 offset:0
    ds_read_b64_tr_b16 v[34:35], v6 offset:256
    v_mfma_f32_32x32x16_bf16 v[80:95], v[40:43], v[60:63], v[80:95]
    ds_read_b64_tr_b16 v[36:37], v6 offset:64
    ds_read_b64_tr_b16 v[38:39], v6 offset:320
    v_mfma_f32_32x32x16_bf16 v[96:111], v[44:47], v[56:59], v[96:111]
    ds_read_b128 v[16:19], v5 offset:0
    ds_read_b128 v[20:23], v5 offset:512
    v_mfma_f32_32x32x16_bf16 v[112:127], v[44:47], v[60:63], v[112:127]
    ds_read_b128 v[24:27], v5 offset:8320
    ds_read_b128 v[28:31], v5 offset:8832
    v_mfma_f32_32x32x16_bf16 v[128:143], v[48:51], v[56:59], v[128:143]
    v_mfma_f32_32x32x16_bf16 v[144:159], v[48:51], v[60:63], v[144:159]
    v_mfma_f32_32x32x16_bf16 v[160:175], v[52:55], v[56:59], v[160:175]
    v_mfma_f32_32x32x16_bf16 v[176:191], v[52:55], v[60:63], v[176:191]
    s_sub_u32 s6, s3, 4
    s_cmp_ge_u32 s3, 6
    s_cbranch_scc1 Lkv_nls
    s_lshl_b32 s62, s49, 13
    s_add_u32 s62, s62, 0x40000
    s_cmp_eq_u32 s6, 0
    s_cselect_b32 s55, 4096, 0
    s_add_u32 s62, s62, s55
    s_cmp_eq_u32 s6, 0
    s_cselect_b32 s63, 1, 4
    s_cselect_b32 s7, 2, 1
    s_cselect_b32 s101, 3, 5
    s_lshl_b32 s63, s63, 10
    s_lshl_b32 s7, s7, 10
    s_lshl_b32 s101, s101, 10
    s_load_dwordx2 s[56:57], s[0:1], 40
    s_load_dwordx2 s[58:59], s[0:1], 56
    s_load_dwordx2 s[60:61], s[0:1], 72
    s_and_b32 s28, s2, 7
    s_lshr_b32 s29, s2, 3
    s_and_b32 s30, s29, 3
    s_lshl_b32 s28, s28, 2
    s_add_u32 s28, s28, s30
    s_lshr_b32 s30, s29, 2
    s_sub_u32 s31, 15, s30
    v_and_b32 v8, 63, v0
    v_lshlrev_b32 v1, 4, v8
    s_add_u32 s12, s4, 196608
    s_addc_u32 s13, s5, 0
    s_and_b32 s13, s13, 0xffff
    s_mov_b32 s14, 2359296
    s_mov_b32 s15, 0x20000
    s_lshl_b32 s32, s28, 19
    s_add_u32 s18, s32, 2555904
    s_add_u32 s16, s4, s18
    s_addc_u32 s17, s5, 0
    s_and_b32 s17, s17, 0xffff
    s_mov_b32 s18, 524288
    s_mov_b32 s19, 0x20000
    s_add_u32 s22, s32, 19333120
    s_add_u32 s20, s4, s22
    s_addc_u32 s21, s5, 0
    s_and_b32 s21, s21, 0xffff
    s_mov_b32 s22, 524288
    s_mov_b32 s23, 0x20000
    s_lshl_b32 s35, s30, 1
    s_add_u32 s35, s35, s6
    s_mul_i32 s35, s35, 73728
    s_lshl_b32 s36, s31, 1
    s_add_u32 s36, s36, s6
    s_mul_i32 s36, s36, 73728
    s_lshl_b32 s38, s6, 12
    s_add_u32 s38, s38, 8704
    s_lshl_b32 s39, s6, 13
    s_mov_b32 s40, 0
    s_sub_u32 s44, s39, 8192
    s_sub_u32 s45, s39, 24576
    s_mov_b32 s46, s44
    s_mov_b32 s47, s45
    s_mov_b32 s48, 0
    s_lshl_b32 s49, s30, 1
    s_add_u32 s49, s49, 3
Lkv_nls:
    s_cmp_lg_u32 s3, 7
    s_cbranch_scc1 Lkv_nl7
    s_lshr_b32 s31, s2, 5
    s_sub_u32 s30, 15, s31
    v_and_b32 v3, 1, v1
    v_mov_b32 v4, s30
    v_mov_b32 v2, s31
    v_cmp_eq_u32 vcc, 0, v3
    s_nop 1
    v_cndmask_b32 v3, v2, v4, vcc
    v_lshlrev_b32 v3, 7, v3
    s_mov_b32 s8, s32
    s_and_b32 s9, s33, 0xffff
    s_mov_b32 s10, 4718592
    s_mov_b32 s11, 0x20000
    v_lshrrev_b32 v13, 4, v1
    v_lshlrev_b32 v13, 15, v13
    v_and_b32 v2, 15, v1
    v_lshl_add_u32 v13, v2, 4, v13
    s_lshl_b32 s34, s48, 8
    s_mov_b32 s40, 0
Lkv_nl7:
    s_setprio 2
    s_waitcnt lgkmcnt(0)
    v_mfma_f32_32x32x16_bf16 v[64:79], v[16:19], v[32:35], v[64:79]
    ds_read_b64_tr_b16 v[56:57], v6 offset:4352
    ds_read_b64_tr_b16 v[58:59], v6 offset:4608
    v_mfma_f32_32x32x16_bf16 v[80:95], v[16:19], v[36:39], v[80:95]
    ds_read_b64_tr_b16 v[60:61], v6 offset:4416
    ds_read_b64_tr_b16 v[62:63], v6 offset:4672
    v_mfma_f32_32x32x16_bf16 v[96:111], v[20:23], v[32:35], v[96:111]
    ds_read_b128 v[40:43], v5 offset:32
    ds_read_b128 v[44:47], v5 offset:544
    v_mfma_f32_32x32x16_bf16 v[112:127], v[20:23], v[36:39], v[112:127]
    ds_read_b128 v[48:51], v5 offset:8352
    ds_read_b128 v[52:55], v5 offset:8864
    v_mfma_f32_32x32x16_bf16 v[128:143], v[24:27], v[32:35], v[128:143]
    v_mfma_f32_32x32x16_bf16 v[144:159], v[24:27], v[36:39], v[144:159]
    v_mfma_f32_32x32x16_bf16 v[160:175], v[28:31], v[32:35], v[160:175]
    v_mfma_f32_32x32x16_bf16 v[176:191], v[28:31], v[36:39], v[176:191]
    s_cmp_lg_u32 s3, 7
    s_cbranch_scc1 Lkv_nl8
    buffer_load_dword v244, v3, s[96:99], 0 offen sc1
Lkv_nl8:
    s_setprio 1
    s_waitcnt lgkmcnt(0)
    v_mfma_f32_32x32x16_bf16 v[64:79], v[40:43], v[56:59], v[64:79]
    ds_read_b64_tr_b16 v[32:33], v6 offset:8704
    ds_read_b64_tr_b16 v[34:35], v6 offset:8960
    v_mfma_f32_32x32x16_bf16 v[80:95], v[40:43], v[60:63], v[80:95]
    ds_read_b64_tr_b16 v[36:37], v6 offset:8768
    ds_read_b64_tr_b16 v[38:39], v6 offset:9024
    v_mfma_f32_32x32x16_bf16 v[96:111], v[44:47], v[56:59], v[96:111]
    ds_read_b128 v[16:19], v5 offset:64
    ds_read_b128 v[20:23], v5 offset:576
    v_mfma_f32_32x32x16_bf16 v[112:127], v[44:47], v[60:63], v[112:127]
    ds_read_b128 v[24:27], v5 offset:8384
    ds_read_b128 v[28:31], v5 offset:8896
    v_mfma_f32_32x32x16_bf16 v[128:143], v[48:51], v[56:59], v[128:143]
    v_mfma_f32_32x32x16_bf16 v[144:159], v[48:51], v[60:63], v[144:159]
    v_mfma_f32_32x32x16_bf16 v[160:175], v[52:55], v[56:59], v[160:175]
    v_mfma_f32_32x32x16_bf16 v[176:191], v[52:55], v[60:63], v[176:191]
    s_setprio 0
    s_waitcnt lgkmcnt(0)
    v_mfma_f32_32x32x16_bf16 v[64:79], v[16:19], v[32:35], v[64:79]
    ds_read_b64_tr_b16 v[56:57], v6 offset:13056
    ds_read_b64_tr_b16 v[58:59], v6 offset:13312
    v_mfma_f32_32x32x16_bf16 v[80:95], v[16:19], v[36:39], v[80:95]
    ds_read_b64_tr_b16 v[60:61], v6 offset:13120
    ds_read_b64_tr_b16 v[62:63], v6 offset:13376
    v_mfma_f32_32x32x16_bf16 v[96:111], v[20:23], v[32:35], v[96:111]
    ds_read_b128 v[40:43], v5 offset:96
    ds_read_b128 v[44:47], v5 offset:608
    v_mfma_f32_32x32x16_bf16 v[112:127], v[20:23], v[36:39], v[112:127]
    ds_read_b128 v[48:51], v5 offset:8416
    ds_read_b128 v[52:55], v5 offset:8928
    v_mfma_f32_32x32x16_bf16 v[128:143], v[24:27], v[32:35], v[128:143]
    v_mfma_f32_32x32x16_bf16 v[144:159], v[24:27], v[36:39], v[144:159]
    v_mfma_f32_32x32x16_bf16 v[160:175], v[28:31], v[32:35], v[160:175]
    v_mfma_f32_32x32x16_bf16 v[176:191], v[28:31], v[36:39], v[176:191]
    v_add_u32 v5, 4294899200, v5
    v_add_u32 v6, 4294899200, v6
    s_waitcnt vmcnt(0) lgkmcnt(0)
    s_cmp_lg_u32 s3, 7
    s_cbranch_scc1 Lkv_np1
    v_cmp_gt_u32 vcc, 16, v244
    v_mov_b32 v247, 136192
    s_nop 1
    s_cmp_eq_u64 vcc, 0
    s_cselect_b32 s59, 1, 0
    v_mov_b32 v248, s59
    ds_write_b32 v247, v248
    s_waitcnt lgkmcnt(0)
Lkv_np1:
    s_barrier
    s_cmp_ge_u32 s3, 6
    s_cbranch_scc1 Lkv_nq0
    v_mov_b32 v247, 136192
    ds_read_b32 v248, v247
    s_waitcnt lgkmcnt(0)
    v_readfirstlane_b32 s51, v248
    s_cmp_eq_u32 s51, 0
    s_cbranch_scc1 Lkv_nq0
    s_add_u32 s32, s40, s38
    s_add_u32 m0, s32, 0
    s_add_u32 s33, s35, 0
    buffer_load_dwordx4 v1, s[12:15], s33 offen sc1 lds
    buffer_load_dwordx4 v1, s[12:15], s33 offen offset:1024 sc1 lds
    s_add_u32 m0, s32, 2048
    s_add_u32 s33, s35, 36864
    buffer_load_dwordx4 v1, s[12:15], s33 offen sc1 lds
    buffer_load_dwordx4 v1, s[12:15], s33 offen offset:1024 sc1 lds
    s_add_u32 m0, s32, 8192
    s_add_u32 s33, s36, 0
    buffer_load_dwordx4 v1, s[12:15], s33 offen sc1 lds
    buffer_load_dwordx4 v1, s[12:15], s33 offen offset:1024 sc1 lds
    s_add_u32 m0, s32, 10240
    s_add_u32 s33, s36, 36864
    buffer_load_dwordx4 v1, s[12:15], s33 offen sc1 lds
    buffer_load_dwordx4 v1, s[12:15], s33 offen offset:1024 sc1 lds
    s_add_u32 s35, s35, 2048
    s_add_u32 s36, s36, 2048
    s_add_u32 s40, s40, 32768
    s_cmp_eq_u32 s40, 163840
    s_cselect_b32 s40, 0, s40
    s_add_u32 s32, s40, s38
    s_add_u32 m0, s32, 0
    s_add_u32 s33, s35, 0
    buffer_load_dwordx4 v1, s[12:15], s33 offen sc1 lds
    buffer_load_dwordx4 v1, s[12:15], s33 offen offset:1024 sc1 lds
    s_add_u32 m0, s32, 2048
    s_add_u32 s33, s35, 36864
    buffer_load_dwordx4 v1, s[12:15], s33 offen sc1 lds
    buffer_load_dwordx4 v1, s[12:15], s33 offen offset:1024 sc1 lds
    s_add_u32 m0, s32, 8192
    s_add_u32 s33, s36, 0
    buffer_load_dwordx4 v1, s[12:15], s33 offen sc1 lds
    buffer_load_dwordx4 v1, s[12:15], s33 offen offset:1024 sc1 lds
    s_add_u32 m0, s32, 10240
    s_add_u32 s33, s36, 36864
    buffer_load_dwordx4 v1, s[12:15], s33 offen sc1 lds
    buffer_load_dwordx4 v1, s[12:15], s33 offen offset:1024 sc1 lds
    s_add_u32 s35, s35, 2048
    s_add_u32 s36, s36, 2048
    s_add_u32 s40, s40, 32768
    s_cmp_eq_u32 s40, 163840
    s_cselect_b32 s40, 0, s40
Lkv_nq0:
    s_cmp_lg_u32 s3, 7
    s_cbranch_scc1 Lkv_nq1
    s_add_u32 m0, s40, 0
    s_add_u32 s36, s34, 0
    buffer_load_dwordx4 v13, s[8:11], s36 offen lds
    s_add_u32 m0, s40, 1088
    s_add_u32 s36, s34, 8192
    buffer_load_dwordx4 v13, s[8:11], s36 offen lds
    s_add_u32 m0, s40, 2176
    s_add_u32 s36, s34, 16384
    buffer_load_dwordx4 v13, s[8:11], s36 offen lds
    s_add_u32 m0, s40, 3264
    s_add_u32 s36, s34, 24576
    buffer_load_dwordx4 v13, s[8:11], s36 offen lds
    s_add_u32 m0, s40, 4352
    s_add_u32 s36, s34, 131072
    buffer_load_dwordx4 v13, s[8:11], s36 offen lds
    s_add_u32 m0, s40, 5440
    s_add_u32 s36, s34, 139264
    buffer_load_dwordx4 v13, s[8:11], s36 offen lds
    s_add_u32 m0, s40, 6528
    s_add_u32 s36, s34, 147456
    buffer_load_dwordx4 v13, s[8:11], s36 offen lds
    s_add_u32 m0, s40, 7616
    s_add_u32 s36, s34, 155648
    buffer_load_dwordx4 v13, s[8:11], s36 offen lds
    s_add_u32 s34, s34, 262144
    s_add_u32 s40, s40, 32768
    s_cmp_eq_u32 s40, 163840
    s_cselect_b32 s40, 0, s40
    s_add_u32 m0, s40, 0
    s_add_u32 s36, s34, 0
    buffer_load_dwordx4 v13, s[8:11], s36 offen lds
    s_add_u32 m0, s40, 1088
    s_add_u32 s36, s34, 8192
    buffer_load_dwordx4 v13, s[8:11], s36 offen lds
    s_add_u32 m0, s40, 2176
    s_add_u32 s36, s34, 16384
    buffer_load_dwordx4 v13, s[8:11], s36 offen lds
    s_add_u32 m0, s40, 3264
    s_add_u32 s36, s34, 24576
    buffer_load_dwordx4 v13, s[8:11], s36 offen lds
    s_add_u32 m0, s40, 4352
    s_add_u32 s36, s34, 131072
    buffer_load_dwordx4 v13, s[8:11], s36 offen lds
    s_add_u32 m0, s40, 5440
    s_add_u32 s36, s34, 139264
    buffer_load_dwordx4 v13, s[8:11], s36 offen lds
    s_add_u32 m0, s40, 6528
    s_add_u32 s36, s34, 147456
    buffer_load_dwordx4 v13, s[8:11], s36 offen lds
    s_add_u32 m0, s40, 7616
    s_add_u32 s36, s34, 155648
    buffer_load_dwordx4 v13, s[8:11], s36 offen lds
    s_add_u32 s34, s34, 262144
    s_add_u32 s40, s40, 32768
    s_cmp_eq_u32 s40, 163840
    s_cselect_b32 s40, 0, s40
Lkv_nq1:
    s_setprio 3
    v_mfma_f32_32x32x16_bf16 v[64:79], v[40:43], v[56:59], v[64:79]
    v_mfma_f32_32x32x16_bf16 v[80:95], v[40:43], v[60:63], v[80:95]
    v_mfma_f32_32x32x16_bf16 v[96:111], v[44:47], v[56:59], v[96:111]
    v_mfma_f32_32x32x16_bf16 v[112:127], v[44:47], v[60:63], v[112:127]
    v_mfma_f32_32x32x16_bf16 v[128:143], v[48:51], v[56:59], v[128:143]
    v_mfma_f32_32x32x16_bf16 v[144:159], v[48:51], v[60:63], v[144:159]
    v_mfma_f32_32x32x16_bf16 v[160:175], v[52:55], v[56:59], v[160:175]
    v_mfma_f32_32x32x16_bf16 v[176:191], v[52:55], v[60:63], v[176:191]
    s_setprio 0
    s_cmp_ge_u32 s3, 6
    s_cbranch_scc1 Lkv_sw
    s_nop 7
    s_cmp_eq_u32 s3, 5
    s_cbranch_scc1 Lkv_w5
    v_add_u32 v12, 131072, v1
    v_add_u32 v14, 65536, v1
    v_cvt_pk_bf16_f32 v16, v64, v65
    v_cvt_pk_bf16_f32 v17, v66, v67
    v_cvt_pk_bf16_f32 v18, v68, v69
    v_cvt_pk_bf16_f32 v19, v70, v71
    ds_write_b128 v12, v[16:19] offset:0
    v_cvt_pk_bf16_f32 v20, v72, v73
    v_cvt_pk_bf16_f32 v21, v74, v75
    v_cvt_pk_bf16_f32 v22, v76, v77
    v_cvt_pk_bf16_f32 v23, v78, v79
    ds_write_b128 v12, v[20:23] offset:1024
    v_cvt_pk_bf16_f32 v24, v80, v81
    v_cvt_pk_bf16_f32 v25, v82, v83
    v_cvt_pk_bf16_f32 v26, v84, v85
    v_cvt_pk_bf16_f32 v27, v86, v87
    ds_write_b128 v12, v[24:27] offset:2048
    v_cvt_pk_bf16_f32 v28, v88, v89
    v_cvt_pk_bf16_f32 v29, v90, v91
    v_cvt_pk_bf16_f32 v30, v92, v93
    v_cvt_pk_bf16_f32 v31, v94, v95
    ds_write_b128 v12, v[28:31] offset:3072
    v_cvt_pk_bf16_f32 v32, v96, v97
    v_cvt_pk_bf16_f32 v33, v98, v99
    v_cvt_pk_bf16_f32 v34, v100, v101
    v_cvt_pk_bf16_f32 v35, v102, v103
    ds_write_b128 v12, v[32:35] offset:4096
    v_cvt_pk_bf16_f32 v36, v104, v105
    v_cvt_pk_bf16_f32 v37, v106, v107
    v_cvt_pk_bf16_f32 v38, v108, v109
    v_cvt_pk_bf16_f32 v39, v110, v111
    ds_write_b128 v12, v[36:39] offset:5120
    v_cvt_pk_bf16_f32 v40, v112, v113
    v_cvt_pk_bf16_f32 v41, v114, v115
    v_cvt_pk_bf16_f32 v42, v116, v117
    v_cvt_pk_bf16_f32 v43, v118, v119
    ds_write_b128 v12, v[40:43] offset:6144
    v_cvt_pk_bf16_f32 v44, v120, v121
    v_cvt_pk_bf16_f32 v45, v122, v123
    v_cvt_pk_bf16_f32 v46, v124, v125
    v_cvt_pk_bf16_f32 v47, v126, v127
    ds_write_b128 v12, v[44:47] offset:7168
    v_cvt_pk_bf16_f32 v16, v128, v129
    v_cvt_pk_bf16_f32 v17, v130, v131
    v_cvt_pk_bf16_f32 v18, v132, v133
    v_cvt_pk_bf16_f32 v19, v134, v135
    ds_write_b128 v12, v[16:19] offset:8192
    v_cvt_pk_bf16_f32 v20, v136, v137
    v_cvt_pk_bf16_f32 v21, v138, v139
    v_cvt_pk_bf16_f32 v22, v140, v141
    v_cvt_pk_bf16_f32 v23, v142, v143
    ds_write_b128 v12, v[20:23] offset:9216
    v_cvt_pk_bf16_f32 v24, v144, v145
    v_cvt_pk_bf16_f32 v25, v146, v147
    v_cvt_pk_bf16_f32 v26, v148, v149
    v_cvt_pk_bf16_f32 v27, v150, v151
    ds_write_b128 v12, v[24:27] offset:10240
    v_cvt_pk_bf16_f32 v28, v152, v153
    v_cvt_pk_bf16_f32 v29, v154, v155
    v_cvt_pk_bf16_f32 v30, v156, v157
    v_cvt_pk_bf16_f32 v31, v158, v159
    ds_write_b128 v12, v[28:31] offset:11264
    v_cvt_pk_bf16_f32 v32, v160, v161
    v_cvt_pk_bf16_f32 v33, v162, v163
    v_cvt_pk_bf16_f32 v34, v164, v165
    v_cvt_pk_bf16_f32 v35, v166, v167
    ds_write_b128 v12, v[32:35] offset:12288
    v_cvt_pk_bf16_f32 v36, v168, v169
    v_cvt_pk_bf16_f32 v37, v170, v171
    v_cvt_pk_bf16_f32 v38, v172, v173
    v_cvt_pk_bf16_f32 v39, v174, v175
    ds_write_b128 v12, v[36:39] offset:13312
    v_cvt_pk_bf16_f32 v40, v176, v177
    v_cvt_pk_bf16_f32 v41, v178, v179
    v_cvt_pk_bf16_f32 v42, v180, v181
    v_cvt_pk_bf16_f32 v43, v182, v183
    ds_write_b128 v12, v[40:43] offset:14336
    v_cvt_pk_bf16_f32 v44, v184, v185
    v_cvt_pk_bf16_f32 v45, v186, v187
    v_cvt_pk_bf16_f32 v46, v188, v189
    v_cvt_pk_bf16_f32 v47, v190, v191
    ds_write_b128 v12, v[44:47] offset:15360
    s_waitcnt lgkmcnt(0)
    s_barrier
    ds_read_b128 v[192:195], v1 offset:25088
    ds_read_b128 v[196:199], v1 offset:26112
    ds_read_b128 v[200:203], v1 offset:27136
    ds_read_b128 v[204:207], v1 offset:28160
    ds_read_b128 v[208:211], v1 offset:29184
    ds_read_b128 v[212:215], v1 offset:30208
    ds_read_b128 v[216:219], v1 offset:31232
    ds_read_b128 v[220:223], v1 offset:57856
    ds_read_b128 v[224:227], v1 offset:58880
    ds_read_b128 v[228:231], v1 offset:59904
    ds_read_b128 v[232:235], v1 offset:60928
    ds_read_b128 v[236:239], v1 offset:61952
    ds_read_b128 v[240:243], v1 offset:62976
    ds_read_b128 v[244:247], v1 offset:64000
    ds_read_b128 v[248:251], v14 offset:25088
    ds_read_b128 v[252:255], v14 offset:26112
    s_branch Lat_load
Lkv_w5:
    v_cvt_pk_bf16_f32 v192, v64, v65
    v_cvt_pk_bf16_f32 v193, v66, v67
    v_cvt_pk_bf16_f32 v194, v68, v69
    v_cvt_pk_bf16_f32 v195, v70, v71
    v_cvt_pk_bf16_f32 v196, v72, v73
    v_cvt_pk_bf16_f32 v197, v74, v75
    v_cvt_pk_bf16_f32 v198, v76, v77
    v_cvt_pk_bf16_f32 v199, v78, v79
    v_cvt_pk_bf16_f32 v200, v80, v81
    v_cvt_pk_bf16_f32 v201, v82, v83
    v_cvt_pk_bf16_f32 v202, v84, v85
    v_cvt_pk_bf16_f32 v203, v86, v87
    v_cvt_pk_bf16_f32 v204, v88, v89
    v_cvt_pk_bf16_f32 v205, v90, v91
    v_cvt_pk_bf16_f32 v206, v92, v93
    v_cvt_pk_bf16_f32 v207, v94, v95
    v_cvt_pk_bf16_f32 v208, v96, v97
    v_cvt_pk_bf16_f32 v209, v98, v99
    v_cvt_pk_bf16_f32 v210, v100, v101
    v_cvt_pk_bf16_f32 v211, v102, v103
    v_cvt_pk_bf16_f32 v212, v104, v105
    v_cvt_pk_bf16_f32 v213, v106, v107
    v_cvt_pk_bf16_f32 v214, v108, v109
    v_cvt_pk_bf16_f32 v215, v110, v111
    v_cvt_pk_bf16_f32 v216, v112, v113
    v_cvt_pk_bf16_f32 v217, v114, v115
    v_cvt_pk_bf16_f32 v218, v116, v117
    v_cvt_pk_bf16_f32 v219, v118, v119
    v_cvt_pk_bf16_f32 v220, v120, v121
    v_cvt_pk_bf16_f32 v221, v122, v123
    v_cvt_pk_bf16_f32 v222, v124, v125
    v_cvt_pk_bf16_f32 v223, v126, v127
    v_cvt_pk_bf16_f32 v224, v128, v129
    v_cvt_pk_bf16_f32 v225, v130, v131
    v_cvt_pk_bf16_f32 v226, v132, v133
    v_cvt_pk_bf16_f32 v227, v134, v135
    v_cvt_pk_bf16_f32 v228, v136, v137
    v_cvt_pk_bf16_f32 v229, v138, v139
    v_cvt_pk_bf16_f32 v230, v140, v141
    v_cvt_pk_bf16_f32 v231, v142, v143
    v_cvt_pk_bf16_f32 v232, v144, v145
    v_cvt_pk_bf16_f32 v233, v146, v147
    v_cvt_pk_bf16_f32 v234, v148, v149
    v_cvt_pk_bf16_f32 v235, v150, v151
    v_cvt_pk_bf16_f32 v236, v152, v153
    v_cvt_pk_bf16_f32 v237, v154, v155
    v_cvt_pk_bf16_f32 v238, v156, v157
    v_cvt_pk_bf16_f32 v239, v158, v159
    v_cvt_pk_bf16_f32 v240, v160, v161
    v_cvt_pk_bf16_f32 v241, v162, v163
    v_cvt_pk_bf16_f32 v242, v164, v165
    v_cvt_pk_bf16_f32 v243, v166, v167
    v_cvt_pk_bf16_f32 v244, v168, v169
    v_cvt_pk_bf16_f32 v245, v170, v171
    v_cvt_pk_bf16_f32 v246, v172, v173
    v_cvt_pk_bf16_f32 v247, v174, v175
    v_cvt_pk_bf16_f32 v248, v176, v177
    v_cvt_pk_bf16_f32 v249, v178, v179
    v_cvt_pk_bf16_f32 v250, v180, v181
    v_cvt_pk_bf16_f32 v251, v182, v183
    v_cvt_pk_bf16_f32 v252, v184, v185
    v_cvt_pk_bf16_f32 v253, v186, v187
    v_cvt_pk_bf16_f32 v254, v188, v189
    v_cvt_pk_bf16_f32 v255, v190, v191
    s_barrier
    s_branch Lat_load
Lkv_sw:
    v_lshlrev_b32 v7, 4, v1
    s_lshl_b32 s55, s48, 19
    s_lshl_b32 s56, s49, 13
    s_add_u32 s55, s55, s56
    s_and_b32 s56, s3, 1
    s_lshl_b32 s56, s56, 18
    s_add_u32 s57, s55, s56
    s_and_b32 s55, s3, 1
    s_lshl_b32 s55, s55, 14
    s_add_u32 s55, s55, 131072
    v_add_u32 v2, s55, v7
    v_cvt_pk_bf16_f32 v64, v64, v65
    v_cvt_pk_bf16_f32 v65, v66, v67
    v_cvt_pk_bf16_f32 v66, v68, v69
    v_cvt_pk_bf16_f32 v67, v70, v71
    v_cvt_pk_bf16_f32 v68, v72, v73
    v_cvt_pk_bf16_f32 v69, v74, v75
    v_cvt_pk_bf16_f32 v70, v76, v77
    v_cvt_pk_bf16_f32 v71, v78, v79
    v_cvt_pk_bf16_f32 v72, v80, v81
    v_cvt_pk_bf16_f32 v73, v82, v83
    v_cvt_pk_bf16_f32 v74, v84, v85
    v_cvt_pk_bf16_f32 v75, v86, v87
    v_cvt_pk_bf16_f32 v76, v88, v89
    v_cvt_pk_bf16_f32 v77, v90, v91
    v_cvt_pk_bf16_f32 v78, v92, v93
    v_cvt_pk_bf16_f32 v79, v94, v95
    v_cvt_pk_bf16_f32 v80, v96, v97
    v_cvt_pk_bf16_f32 v81, v98, v99
    v_cvt_pk_bf16_f32 v82, v100, v101
    v_cvt_pk_bf16_f32 v83, v102, v103
    v_cvt_pk_bf16_f32 v84, v104, v105
    v_cvt_pk_bf16_f32 v85, v106, v107
    v_cvt_pk_bf16_f32 v86, v108, v109
    v_cvt_pk_bf16_f32 v87, v110, v111
    v_cvt_pk_bf16_f32 v88, v112, v113
    v_cvt_pk_bf16_f32 v89, v114, v115
    v_cvt_pk_bf16_f32 v90, v116, v117
    v_cvt_pk_bf16_f32 v91, v118, v119
    v_cvt_pk_bf16_f32 v92, v120, v121
    v_cvt_pk_bf16_f32 v93, v122, v123
    v_cvt_pk_bf16_f32 v94, v124, v125
    v_cvt_pk_bf16_f32 v95, v126, v127
    v_cvt_pk_bf16_f32 v96, v128, v129
    v_cvt_pk_bf16_f32 v97, v130, v131
    v_cvt_pk_bf16_f32 v98, v132, v133
    v_cvt_pk_bf16_f32 v99, v134, v135
    v_cvt_pk_bf16_f32 v100, v136, v137
    v_cvt_pk_bf16_f32 v101, v138, v139
    v_cvt_pk_bf16_f32 v102, v140, v141
    v_cvt_pk_bf16_f32 v103, v142, v143
    v_cvt_pk_bf16_f32 v104, v144, v145
    v_cvt_pk_bf16_f32 v105, v146, v147
    v_cvt_pk_bf16_f32 v106, v148, v149
    v_cvt_pk_bf16_f32 v107, v150, v151
    v_cvt_pk_bf16_f32 v108, v152, v153
    v_cvt_pk_bf16_f32 v109, v154, v155
    v_cvt_pk_bf16_f32 v110, v156, v157
    v_cvt_pk_bf16_f32 v111, v158, v159
    v_cvt_pk_bf16_f32 v112, v160, v161
    v_cvt_pk_bf16_f32 v113, v162, v163
    v_cvt_pk_bf16_f32 v114, v164, v165
    v_cvt_pk_bf16_f32 v115, v166, v167
    v_cvt_pk_bf16_f32 v116, v168, v169
    v_cvt_pk_bf16_f32 v117, v170, v171
    v_cvt_pk_bf16_f32 v118, v172, v173
    v_cvt_pk_bf16_f32 v119, v174, v175
    v_cvt_pk_bf16_f32 v120, v176, v177
    v_cvt_pk_bf16_f32 v121, v178, v179
    v_cvt_pk_bf16_f32 v122, v180, v181
    v_cvt_pk_bf16_f32 v123, v182, v183
    v_cvt_pk_bf16_f32 v124, v184, v185
    v_cvt_pk_bf16_f32 v125, v186, v187
    v_cvt_pk_bf16_f32 v126, v188, v189
    v_cvt_pk_bf16_f32 v127, v190, v191
    s_add_u32 s20, s4, 19333120
    s_addc_u32 s21, s5, 0
    s_and_b32 s21, s21, 0xffff
    s_mov_b32 s22, 16777216
    s_mov_b32 s23, 0x20000
    s_add_u32 s16, s4, 2555904
    s_addc_u32 s17, s5, 0
    s_and_b32 s17, s17, 0xffff
    s_mov_b32 s18, 16777216
    s_mov_b32 s19, 0x20000
    s_cmp_lg_u32 s3, 7
    s_cbranch_scc1 Lkv_np2
    s_cmp_lg_u32 s59, 0
    s_cbranch_scc1 Lkv_np2
    s_mov_b32 s100, 0x8000
Lpoll0:
    buffer_load_dword v244, v3, s[96:99], 0 offen sc1
    s_waitcnt vmcnt(0)
    v_cmp_gt_u32 vcc, 16, v244
    s_sub_u32 s100, s100, 1
    s_cbranch_vccz Lpolld0
    s_cmp_eq_u32 s100, 0
    s_cbranch_scc1 Lpolld0
    s_sleep 1
    s_branch Lpoll0
Lpolld0:
Lkv_np2:
    s_barrier
    ds_read_b128 v[128:131], v2 offset:0
    ds_read_b128 v[132:135], v2 offset:1024
    ds_read_b128 v[136:139], v2 offset:2048
    ds_read_b128 v[140:143], v2 offset:3072
    ds_read_b128 v[144:147], v2 offset:4096
    ds_read_b128 v[148:151], v2 offset:5120
    ds_read_b128 v[152:155], v2 offset:6144
    ds_read_b128 v[156:159], v2 offset:7168
    ds_read_b128 v[160:163], v2 offset:8192
    ds_read_b128 v[164:167], v2 offset:9216
    ds_read_b128 v[168:171], v2 offset:10240
    ds_read_b128 v[172:175], v2 offset:11264
    ds_read_b128 v[176:179], v2 offset:12288
    ds_read_b128 v[180:183], v2 offset:13312
    ds_read_b128 v[184:187], v2 offset:14336
    ds_read_b128 v[188:191], v2 offset:15360
    s_branch Lat_sw
Lat_comp:
    s_and_b32 s28, s2, 7
    s_lshr_b32 s29, s2, 3
    s_and_b32 s30, s29, 3
    s_lshl_b32 s28, s28, 2
    s_add_u32 s28, s28, s30
    s_lshr_b32 s30, s29, 2
    s_sub_u32 s31, 15, s30
    v_and_b32 v8, 63, v0
    v_lshlrev_b32 v1, 4, v8
    v_bfe_u32 v2, v8, 2, 2
    v_mul_u32_u24 v2, 1088, v2
    v_lshrrev_b32 v9, 5, v8
    v_lshl_add_u32 v2, v9, 9, v2
    v_bfe_u32 v9, v8, 4, 1
    v_lshl_add_u32 v2, v9, 5, v2
    v_and_b32 v9, 3, v8
    v_lshl_add_u32 v2, v9, 3, v2
    s_lshl_b32 s32, s3, 11
    s_add_u32 s32, s32, 8704
    v_add_u32 v3, s32, v1
    v_and_b32 v9, 31, v8
    s_lshl_b32 s32, s3, 5
    v_add_u32 v9, s32, v9
    v_lshrrev_b32 v10, 5, v8
    v_lshlrev_b32 v10, 2, v10
    v_sub_u32 v9, v9, v10
    v_cvt_f32_i32 v9, v9
    v_add_f32 v9, 0.5, v9
    v_mul_f32 v7, 0x71800000, v9
    v_mov_b64 v[16:17], 0
    v_mov_b64 v[176:177], 0
    v_mov_b64 v[18:19], 0
    v_mov_b64 v[178:179], 0
    v_mov_b64 v[20:21], 0
    v_mov_b64 v[180:181], 0
    v_mov_b64 v[22:23], 0
    v_mov_b64 v[182:183], 0
    v_mov_b64 v[24:25], 0
    v_mov_b64 v[184:185], 0
    v_mov_b64 v[26:27], 0
    v_mov_b64 v[186:187], 0
    v_mov_b64 v[28:29], 0
    v_mov_b64 v[188:189], 0
    v_mov_b64 v[30:31], 0
    v_mov_b64 v[190:191], 0
    v_mov_b64 v[32:33], 0
    v_mov_b64 v[192:193], 0
    v_mov_b64 v[34:35], 0
    v_mov_b64 v[194:195], 0
    v_mov_b64 v[36:37], 0
    v_mov_b64 v[196:197], 0
    v_mov_b64 v[38:39], 0
    v_mov_b64 v[198:199], 0
    v_mov_b64 v[40:41], 0
    v_mov_b64 v[200:201], 0
    v_mov_b64 v[42:43], 0
    v_mov_b64 v[202:203], 0
    v_mov_b64 v[44:45], 0
    v_mov_b64 v[204:205], 0
    v_mov_b64 v[46:47], 0
    v_mov_b64 v[206:207], 0
    v_mov_b64 v[48:49], 0
    v_mov_b64 v[208:209], 0
    v_mov_b64 v[50:51], 0
    v_mov_b64 v[210:211], 0
    v_mov_b64 v[52:53], 0
    v_mov_b64 v[212:213], 0
    v_mov_b64 v[54:55], 0
    v_mov_b64 v[214:215], 0
    v_mov_b64 v[56:57], 0
    v_mov_b64 v[216:217], 0
    v_mov_b64 v[58:59], 0
    v_mov_b64 v[218:219], 0
    v_mov_b64 v[60:61], 0
    v_mov_b64 v[220:221], 0
    v_mov_b64 v[62:63], 0
    v_mov_b64 v[222:223], 0
    v_mov_b64 v[64:65], 0
    v_mov_b64 v[224:225], 0
    v_mov_b64 v[66:67], 0
    v_mov_b64 v[226:227], 0
    v_mov_b64 v[68:69], 0
    v_mov_b64 v[228:229], 0
    v_mov_b64 v[70:71], 0
    v_mov_b64 v[230:231], 0
    v_mov_b64 v[72:73], 0
    v_mov_b64 v[232:233], 0
    v_mov_b64 v[74:75], 0
    v_mov_b64 v[234:235], 0
    v_mov_b64 v[76:77], 0
    v_mov_b64 v[236:237], 0
    v_mov_b64 v[78:79], 0
    v_mov_b64 v[238:239], 0
    s_add_u32 s20, s4, 36110336
    s_addc_u32 s21, s5, 0
    s_and_b32 s21, s21, 0xffff
    s_mov_b32 s22, 16777216
    s_mov_b32 s23, 0x20000
    s_mov_b32 s46, 0x3e0293ee
    s_mov_b32 s47, 0x3e0293ee
    s_mov_b32 s40, 0
    s_barrier
    s_barrier
    ds_read_b128 v[96:99], v3 offset:0
    ds_read_b128 v[100:103], v3 offset:8192
    ds_read_b64_tr_b16 v[80:81], v2 offset:0
    ds_read_b64_tr_b16 v[82:83], v2 offset:256
    ds_read_b64_tr_b16 v[84:85], v2 offset:64
    ds_read_b64_tr_b16 v[86:87], v2 offset:320
    ds_read_b64_tr_b16 v[88:89], v2 offset:128
    ds_read_b64_tr_b16 v[90:91], v2 offset:384
    ds_read_b64_tr_b16 v[92:93], v2 offset:192
    ds_read_b64_tr_b16 v[94:95], v2 offset:448
    s_waitcnt lgkmcnt(0)
    v_mfma_f32_32x32x16_bf16 v[16:31], v[80:83], v[96:99], v[16:31]
    ds_read_b128 v[120:123], v3 offset:1024
    ds_read_b128 v[124:127], v3 offset:9216
    v_mfma_f32_32x32x16_bf16 v[176:191], v[80:83], v[100:103], v[176:191]
    ds_read_b64_tr_b16 v[104:105], v2 offset:4352
    ds_read_b64_tr_b16 v[106:107], v2 offset:4608
    v_mfma_f32_32x32x16_bf16 v[32:47], v[84:87], v[96:99], v[32:47]
    ds_read_b64_tr_b16 v[108:109], v2 offset:4416
    ds_read_b64_tr_b16 v[110:111], v2 offset:4672
    v_mfma_f32_32x32x16_bf16 v[192:207], v[84:87], v[100:103], v[192:207]
    ds_read_b64_tr_b16 v[112:113], v2 offset:4480
    ds_read_b64_tr_b16 v[114:115], v2 offset:4736
    v_mfma_f32_32x32x16_bf16 v[48:63], v[88:91], v[96:99], v[48:63]
    ds_read_b64_tr_b16 v[116:117], v2 offset:4544
    ds_read_b64_tr_b16 v[118:119], v2 offset:4800
    v_mfma_f32_32x32x16_bf16 v[208:223], v[88:91], v[100:103], v[208:223]
    v_mfma_f32_32x32x16_bf16 v[64:79], v[92:95], v[96:99], v[64:79]
    v_mfma_f32_32x32x16_bf16 v[224:239], v[92:95], v[100:103], v[224:239]
    s_cbranch_vccnz Lat_nk0
    s_add_u32 s55, s57, 0
    buffer_store_dwordx4 v[240:243], v6, s[16:19], s55 offen offset:0 sc1
Lat_nk0:
    v_add_u32 v2, 32768, v2
    v_add_u32 v3, 32768, v3
    s_waitcnt lgkmcnt(0)
    v_mfma_f32_32x32x16_bf16 v[16:31], v[104:107], v[120:123], v[16:31]
    ds_read_b128 v[96:99], v3 offset:0
    ds_read_b128 v[100:103], v3 offset:8192
    v_mfma_f32_32x32x16_bf16 v[176:191], v[104:107], v[124:127], v[176:191]
    ds_read_b64_tr_b16 v[80:81], v2 offset:0
    ds_read_b64_tr_b16 v[82:83], v2 offset:256
    v_mfma_f32_32x32x16_bf16 v[32:47], v[108:111], v[120:123], v[32:47]
    ds_read_b64_tr_b16 v[84:85], v2 offset:64
    ds_read_b64_tr_b16 v[86:87], v2 offset:320
    v_mfma_f32_32x32x16_bf16 v[192:207], v[108:111], v[124:127], v[192:207]
    ds_read_b64_tr_b16 v[88:89], v2 offset:128
    ds_read_b64_tr_b16 v[90:91], v2 offset:384
    v_mfma_f32_32x32x16_bf16 v[48:63], v[112:115], v[120:123], v[48:63]
    ds_read_b64_tr_b16 v[92:93], v2 offset:192
    ds_read_b64_tr_b16 v[94:95], v2 offset:448
    v_mfma_f32_32x32x16_bf16 v[208:223], v[112:115], v[124:127], v[208:223]
    v_mfma_f32_32x32x16_bf16 v[64:79], v[116:119], v[120:123], v[64:79]
    v_mfma_f32_32x32x16_bf16 v[224:239], v[116:119], v[124:127], v[224:239]
    s_barrier
    s_waitcnt lgkmcnt(0)
    v_mfma_f32_32x32x16_bf16 v[16:31], v[80:83], v[96:99], v[16:31]
    ds_read_b128 v[120:123], v3 offset:1024
    ds_read_b128 v[124:127], v3 offset:9216
    v_mfma_f32_32x32x16_bf16 v[176:191], v[80:83], v[100:103], v[176:191]
    ds_read_b64_tr_b16 v[104:105], v2 offset:4352
    ds_read_b64_tr_b16 v[106:107], v2 offset:4608
    v_mfma_f32_32x32x16_bf16 v[32:47], v[84:87], v[96:99], v[32:47]
    ds_read_b64_tr_b16 v[108:109], v2 offset:4416
    ds_read_b64_tr_b16 v[110:111], v2 offset:4672
    v_mfma_f32_32x32x16_bf16 v[192:207], v[84:87], v[100:103], v[192:207]
    ds_read_b64_tr_b16 v[112:113], v2 offset:4480
    ds_read_b64_tr_b16 v[114:115], v2 offset:4736
    v_mfma_f32_32x32x16_bf16 v[48:63], v[88:91], v[96:99], v[48:63]
    ds_read_b64_tr_b16 v[116:117], v2 offset:4544
    ds_read_b64_tr_b16 v[118:119], v2 offset:4800
    v_mfma_f32_32x32x16_bf16 v[208:223], v[88:91], v[100:103], v[208:223]
    v_mfma_f32_32x32x16_bf16 v[64:79], v[92:95], v[96:99], v[64:79]
    v_mfma_f32_32x32x16_bf16 v[224:239], v[92:95], v[100:103], v[224:239]
    s_cbranch_vccnz Lat_nk1
    s_add_u32 s55, s57, 0
    buffer_store_dwordx4 v[244:247], v6, s[16:19], s55 offen offset:1024 sc1
Lat_nk1:
    v_add_u32 v2, 32768, v2
    v_add_u32 v3, 32768, v3
    s_waitcnt lgkmcnt(0)
    v_mfma_f32_32x32x16_bf16 v[16:31], v[104:107], v[120:123], v[16:31]
    ds_read_b128 v[96:99], v3 offset:0
    ds_read_b128 v[100:103], v3 offset:8192
    v_mfma_f32_32x32x16_bf16 v[176:191], v[104:107], v[124:127], v[176:191]
    ds_read_b64_tr_b16 v[80:81], v2 offset:0
    ds_read_b64_tr_b16 v[82:83], v2 offset:256
    v_mfma_f32_32x32x16_bf16 v[32:47], v[108:111], v[120:123], v[32:47]
    ds_read_b64_tr_b16 v[84:85], v2 offset:64
    ds_read_b64_tr_b16 v[86:87], v2 offset:320
    v_mfma_f32_32x32x16_bf16 v[192:207], v[108:111], v[124:127], v[192:207]
    ds_read_b64_tr_b16 v[88:89], v2 offset:128
    ds_read_b64_tr_b16 v[90:91], v2 offset:384
    v_mfma_f32_32x32x16_bf16 v[48:63], v[112:115], v[120:123], v[48:63]
    ds_read_b64_tr_b16 v[92:93], v2 offset:192
    ds_read_b64_tr_b16 v[94:95], v2 offset:448
    v_mfma_f32_32x32x16_bf16 v[208:223], v[112:115], v[124:127], v[208:223]
    v_mfma_f32_32x32x16_bf16 v[64:79], v[116:119], v[120:123], v[64:79]
    v_mfma_f32_32x32x16_bf16 v[224:239], v[116:119], v[124:127], v[224:239]
    s_barrier
    s_waitcnt lgkmcnt(0)
    v_mfma_f32_32x32x16_bf16 v[16:31], v[80:83], v[96:99], v[16:31]
    ds_read_b128 v[120:123], v3 offset:1024
    ds_read_b128 v[124:127], v3 offset:9216
    v_mfma_f32_32x32x16_bf16 v[176:191], v[80:83], v[100:103], v[176:191]
    ds_read_b64_tr_b16 v[104:105], v2 offset:4352
    ds_read_b64_tr_b16 v[106:107], v2 offset:4608
    v_mfma_f32_32x32x16_bf16 v[32:47], v[84:87], v[96:99], v[32:47]
    ds_read_b64_tr_b16 v[108:109], v2 offset:4416
    ds_read_b64_tr_b16 v[110:111], v2 offset:4672
    v_mfma_f32_32x32x16_bf16 v[192:207], v[84:87], v[100:103], v[192:207]
    ds_read_b64_tr_b16 v[112:113], v2 offset:4480
    ds_read_b64_tr_b16 v[114:115], v2 offset:4736
    v_mfma_f32_32x32x16_bf16 v[48:63], v[88:91], v[96:99], v[48:63]
    ds_read_b64_tr_b16 v[116:117], v2 offset:4544
    ds_read_b64_tr_b16 v[118:119], v2 offset:4800
    v_mfma_f32_32x32x16_bf16 v[208:223], v[88:91], v[100:103], v[208:223]
    v_mfma_f32_32x32x16_bf16 v[64:79], v[92:95], v[96:99], v[64:79]
    v_mfma_f32_32x32x16_bf16 v[224:239], v[92:95], v[100:103], v[224:239]
    s_cbranch_vccnz Lat_nk2
    s_add_u32 s55, s57, 0
    buffer_store_dwordx4 v[248:251], v6, s[16:19], s55 offen offset:2048 sc1
Lat_nk2:
    v_add_u32 v2, 32768, v2
    v_add_u32 v3, 32768, v3
    s_waitcnt lgkmcnt(0)
    v_mfma_f32_32x32x16_bf16 v[16:31], v[104:107], v[120:123], v[16:31]
    ds_read_b128 v[96:99], v3 offset:0
    ds_read_b128 v[100:103], v3 offset:8192
    v_mfma_f32_32x32x16_bf16 v[176:191], v[104:107], v[124:127], v[176:191]
    ds_read_b64_tr_b16 v[80:81], v2 offset:0
    ds_read_b64_tr_b16 v[82:83], v2 offset:256
    v_mfma_f32_32x32x16_bf16 v[32:47], v[108:111], v[120:123], v[32:47]
    ds_read_b64_tr_b16 v[84:85], v2 offset:64
    ds_read_b64_tr_b16 v[86:87], v2 offset:320
    v_mfma_f32_32x32x16_bf16 v[192:207], v[108:111], v[124:127], v[192:207]
    ds_read_b64_tr_b16 v[88:89], v2 offset:128
    ds_read_b64_tr_b16 v[90:91], v2 offset:384
    v_mfma_f32_32x32x16_bf16 v[48:63], v[112:115], v[120:123], v[48:63]
    ds_read_b64_tr_b16 v[92:93], v2 offset:192
    ds_read_b64_tr_b16 v[94:95], v2 offset:448
    v_mfma_f32_32x32x16_bf16 v[208:223], v[112:115], v[124:127], v[208:223]
    v_mfma_f32_32x32x16_bf16 v[64:79], v[116:119], v[120:123], v[64:79]
    v_mfma_f32_32x32x16_bf16 v[224:239], v[116:119], v[124:127], v[224:239]
    s_barrier
    s_waitcnt lgkmcnt(0)
    v_mfma_f32_32x32x16_bf16 v[16:31], v[80:83], v[96:99], v[16:31]
    ds_read_b128 v[120:123], v3 offset:1024
    ds_read_b128 v[124:127], v3 offset:9216
    v_mfma_f32_32x32x16_bf16 v[176:191], v[80:83], v[100:103], v[176:191]
    ds_read_b64_tr_b16 v[104:105], v2 offset:4352
    ds_read_b64_tr_b16 v[106:107], v2 offset:4608
    v_mfma_f32_32x32x16_bf16 v[32:47], v[84:87], v[96:99], v[32:47]
    ds_read_b64_tr_b16 v[108:109], v2 offset:4416
    ds_read_b64_tr_b16 v[110:111], v2 offset:4672
    v_mfma_f32_32x32x16_bf16 v[192:207], v[84:87], v[100:103], v[192:207]
    ds_read_b64_tr_b16 v[112:113], v2 offset:4480
    ds_read_b64_tr_b16 v[114:115], v2 offset:4736
    v_mfma_f32_32x32x16_bf16 v[48:63], v[88:91], v[96:99], v[48:63]
    ds_read_b64_tr_b16 v[116:117], v2 offset:4544
    ds_read_b64_tr_b16 v[118:119], v2 offset:4800
    v_mfma_f32_32x32x16_bf16 v[208:223], v[88:91], v[100:103], v[208:223]
    v_mfma_f32_32x32x16_bf16 v[64:79], v[92:95], v[96:99], v[64:79]
    v_mfma_f32_32x32x16_bf16 v[224:239], v[92:95], v[100:103], v[224:239]
    s_cbranch_vccnz Lat_nk3
    s_add_u32 s55, s57, 0
    buffer_store_dwordx4 v[252:255], v6, s[16:19], s55 offen offset:3072 sc1
Lat_nk3:
    v_add_u32 v2, 32768, v2
    v_add_u32 v3, 32768, v3
    s_waitcnt lgkmcnt(0)
    v_mfma_f32_32x32x16_bf16 v[16:31], v[104:107], v[120:123], v[16:31]
    ds_read_b128 v[96:99], v3 offset:0
    ds_read_b128 v[100:103], v3 offset:8192
    v_mfma_f32_32x32x16_bf16 v[176:191], v[104:107], v[124:127], v[176:191]
    ds_read_b64_tr_b16 v[80:81], v2 offset:0
    ds_read_b64_tr_b16 v[82:83], v2 offset:256
    v_mfma_f32_32x32x16_bf16 v[32:47], v[108:111], v[120:123], v[32:47]
    ds_read_b64_tr_b16 v[84:85], v2 offset:64
    ds_read_b64_tr_b16 v[86:87], v2 offset:320
    v_mfma_f32_32x32x16_bf16 v[192:207], v[108:111], v[124:127], v[192:207]
    ds_read_b64_tr_b16 v[88:89], v2 offset:128
    ds_read_b64_tr_b16 v[90:91], v2 offset:384
    v_mfma_f32_32x32x16_bf16 v[48:63], v[112:115], v[120:123], v[48:63]
    ds_read_b64_tr_b16 v[92:93], v2 offset:192
    ds_read_b64_tr_b16 v[94:95], v2 offset:448
    v_mfma_f32_32x32x16_bf16 v[208:223], v[112:115], v[124:127], v[208:223]
    v_mfma_f32_32x32x16_bf16 v[64:79], v[116:119], v[120:123], v[64:79]
    v_mfma_f32_32x32x16_bf16 v[224:239], v[116:119], v[124:127], v[224:239]
    s_barrier
    s_waitcnt lgkmcnt(0)
    v_mfma_f32_32x32x16_bf16 v[16:31], v[80:83], v[96:99], v[16:31]
    ds_read_b128 v[120:123], v3 offset:1024
    ds_read_b128 v[124:127], v3 offset:9216
    v_mfma_f32_32x32x16_bf16 v[176:191], v[80:83], v[100:103], v[176:191]
    ds_read_b64_tr_b16 v[104:105], v2 offset:4352
    ds_read_b64_tr_b16 v[106:107], v2 offset:4608
    v_mfma_f32_32x32x16_bf16 v[32:47], v[84:87], v[96:99], v[32:47]
    ds_read_b64_tr_b16 v[108:109], v2 offset:4416
    ds_read_b64_tr_b16 v[110:111], v2 offset:4672
    v_mfma_f32_32x32x16_bf16 v[192:207], v[84:87], v[100:103], v[192:207]
    ds_read_b64_tr_b16 v[112:113], v2 offset:4480
    ds_read_b64_tr_b16 v[114:115], v2 offset:4736
    v_mfma_f32_32x32x16_bf16 v[48:63], v[88:91], v[96:99], v[48:63]
    ds_read_b64_tr_b16 v[116:117], v2 offset:4544
    ds_read_b64_tr_b16 v[118:119], v2 offset:4800
    v_mfma_f32_32x32x16_bf16 v[208:223], v[88:91], v[100:103], v[208:223]
    v_mfma_f32_32x32x16_bf16 v[64:79], v[92:95], v[96:99], v[64:79]
    v_mfma_f32_32x32x16_bf16 v[224:239], v[92:95], v[100:103], v[224:239]
    s_cbranch_vccnz Lat_nk4
    s_add_u32 s55, s57, 65536
    buffer_store_dwordx4 v[160:163], v6, s[16:19], s55 offen offset:0 sc1
Lat_nk4:
    v_add_u32 v2, 4294836224, v2
    v_add_u32 v3, 4294836224, v3
    s_waitcnt lgkmcnt(0)
    v_mfma_f32_32x32x16_bf16 v[16:31], v[104:107], v[120:123], v[16:31]
    ds_read_b128 v[96:99], v3 offset:0
    ds_read_b128 v[100:103], v3 offset:8192
    v_mfma_f32_32x32x16_bf16 v[176:191], v[104:107], v[124:127], v[176:191]
    ds_read_b64_tr_b16 v[80:81], v2 offset:0
    ds_read_b64_tr_b16 v[82:83], v2 offset:256
    v_mfma_f32_32x32x16_bf16 v[32:47], v[108:111], v[120:123], v[32:47]
    ds_read_b64_tr_b16 v[84:85], v2 offset:64
    ds_read_b64_tr_b16 v[86:87], v2 offset:320
    v_mfma_f32_32x32x16_bf16 v[192:207], v[108:111], v[124:127], v[192:207]
    ds_read_b64_tr_b16 v[88:89], v2 offset:128
    ds_read_b64_tr_b16 v[90:91], v2 offset:384
    v_mfma_f32_32x32x16_bf16 v[48:63], v[112:115], v[120:123], v[48:63]
    ds_read_b64_tr_b16 v[92:93], v2 offset:192
    ds_read_b64_tr_b16 v[94:95], v2 offset:448
    v_mfma_f32_32x32x16_bf16 v[208:223], v[112:115], v[124:127], v[208:223]
    v_mfma_f32_32x32x16_bf16 v[64:79], v[116:119], v[120:123], v[64:79]
    v_mfma_f32_32x32x16_bf16 v[224:239], v[116:119], v[124:127], v[224:239]
    s_barrier
    s_waitcnt lgkmcnt(0)
    v_mfma_f32_32x32x16_bf16 v[16:31], v[80:83], v[96:99], v[16:31]
    ds_read_b128 v[120:123], v3 offset:1024
    ds_read_b128 v[124:127], v3 offset:9216
    v_mfma_f32_32x32x16_bf16 v[176:191], v[80:83], v[100:103], v[176:191]
    ds_read_b64_tr_b16 v[104:105], v2 offset:4352
    ds_read_b64_tr_b16 v[106:107], v2 offset:4608
    v_mfma_f32_32x32x16_bf16 v[32:47], v[84:87], v[96:99], v[32:47]
    ds_read_b64_tr_b16 v[108:109], v2 offset:4416
    ds_read_b64_tr_b16 v[110:111], v2 offset:4672
    v_mfma_f32_32x32x16_bf16 v[192:207], v[84:87], v[100:103], v[192:207]
    ds_read_b64_tr_b16 v[112:113], v2 offset:4480
    ds_read_b64_tr_b16 v[114:115], v2 offset:4736
    v_mfma_f32_32x32x16_bf16 v[48:63], v[88:91], v[96:99], v[48:63]
    ds_read_b64_tr_b16 v[116:117], v2 offset:4544
    ds_read_b64_tr_b16 v[118:119], v2 offset:4800
    v_mfma_f32_32x32x16_bf16 v[208:223], v[88:91], v[100:103], v[208:223]
    v_mfma_f32_32x32x16_bf16 v[64:79], v[92:95], v[96:99], v[64:79]
    v_mfma_f32_32x32x16_bf16 v[224:239], v[92:95], v[100:103], v[224:239]
    s_cbranch_vccnz Lat_nk5
    s_add_u32 s55, s57, 65536
    buffer_store_dwordx4 v[164:167], v6, s[16:19], s55 offen offset:1024 sc1
Lat_nk5:
    v_add_u32 v2, 32768, v2
    v_add_u32 v3, 32768, v3
    s_waitcnt lgkmcnt(0)
    v_mfma_f32_32x32x16_bf16 v[16:31], v[104:107], v[120:123], v[16:31]
    ds_read_b128 v[96:99], v3 offset:0
    ds_read_b128 v[100:103], v3 offset:8192
    v_mfma_f32_32x32x16_bf16 v[176:191], v[104:107], v[124:127], v[176:191]
    ds_read_b64_tr_b16 v[80:81], v2 offset:0
    ds_read_b64_tr_b16 v[82:83], v2 offset:256
    v_mfma_f32_32x32x16_bf16 v[32:47], v[108:111], v[120:123], v[32:47]
    ds_read_b64_tr_b16 v[84:85], v2 offset:64
    ds_read_b64_tr_b16 v[86:87], v2 offset:320
    v_mfma_f32_32x32x16_bf16 v[192:207], v[108:111], v[124:127], v[192:207]
    ds_read_b64_tr_b16 v[88:89], v2 offset:128
    ds_read_b64_tr_b16 v[90:91], v2 offset:384
    v_mfma_f32_32x32x16_bf16 v[48:63], v[112:115], v[120:123], v[48:63]
    ds_read_b64_tr_b16 v[92:93], v2 offset:192
    ds_read_b64_tr_b16 v[94:95], v2 offset:448
    v_mfma_f32_32x32x16_bf16 v[208:223], v[112:115], v[124:127], v[208:223]
    v_mfma_f32_32x32x16_bf16 v[64:79], v[116:119], v[120:123], v[64:79]
    v_mfma_f32_32x32x16_bf16 v[224:239], v[116:119], v[124:127], v[224:239]
    s_barrier
    s_waitcnt lgkmcnt(0)
    v_mfma_f32_32x32x16_bf16 v[16:31], v[80:83], v[96:99], v[16:31]
    ds_read_b128 v[120:123], v3 offset:1024
    ds_read_b128 v[124:127], v3 offset:9216
    v_mfma_f32_32x32x16_bf16 v[176:191], v[80:83], v[100:103], v[176:191]
    ds_read_b64_tr_b16 v[104:105], v2 offset:4352
    ds_read_b64_tr_b16 v[106:107], v2 offset:4608
    v_mfma_f32_32x32x16_bf16 v[32:47], v[84:87], v[96:99], v[32:47]
    ds_read_b64_tr_b16 v[108:109], v2 offset:4416
    ds_read_b64_tr_b16 v[110:111], v2 offset:4672
    v_mfma_f32_32x32x16_bf16 v[192:207], v[84:87], v[100:103], v[192:207]
    ds_read_b64_tr_b16 v[112:113], v2 offset:4480
    ds_read_b64_tr_b16 v[114:115], v2 offset:4736
    v_mfma_f32_32x32x16_bf16 v[48:63], v[88:91], v[96:99], v[48:63]
    ds_read_b64_tr_b16 v[116:117], v2 offset:4544
    ds_read_b64_tr_b16 v[118:119], v2 offset:4800
    v_mfma_f32_32x32x16_bf16 v[208:223], v[88:91], v[100:103], v[208:223]
    v_mfma_f32_32x32x16_bf16 v[64:79], v[92:95], v[96:99], v[64:79]
    v_mfma_f32_32x32x16_bf16 v[224:239], v[92:95], v[100:103], v[224:239]
    s_cbranch_vccnz Lat_nk6
    s_add_u32 s55, s57, 65536
    buffer_store_dwordx4 v[168:171], v6, s[16:19], s55 offen offset:2048 sc1
Lat_nk6:
    v_add_u32 v2, 32768, v2
    v_add_u32 v3, 32768, v3
    s_waitcnt lgkmcnt(0)
    v_mfma_f32_32x32x16_bf16 v[16:31], v[104:107], v[120:123], v[16:31]
    ds_read_b128 v[96:99], v3 offset:0
    ds_read_b128 v[100:103], v3 offset:8192
    v_mfma_f32_32x32x16_bf16 v[176:191], v[104:107], v[124:127], v[176:191]
    ds_read_b64_tr_b16 v[80:81], v2 offset:0
    ds_read_b64_tr_b16 v[82:83], v2 offset:256
    v_mfma_f32_32x32x16_bf16 v[32:47], v[108:111], v[120:123], v[32:47]
    ds_read_b64_tr_b16 v[84:85], v2 offset:64
    ds_read_b64_tr_b16 v[86:87], v2 offset:320
    v_mfma_f32_32x32x16_bf16 v[192:207], v[108:111], v[124:127], v[192:207]
    ds_read_b64_tr_b16 v[88:89], v2 offset:128
    ds_read_b64_tr_b16 v[90:91], v2 offset:384
    v_mfma_f32_32x32x16_bf16 v[48:63], v[112:115], v[120:123], v[48:63]
    ds_read_b64_tr_b16 v[92:93], v2 offset:192
    ds_read_b64_tr_b16 v[94:95], v2 offset:448
    v_mfma_f32_32x32x16_bf16 v[208:223], v[112:115], v[124:127], v[208:223]
    v_mfma_f32_32x32x16_bf16 v[64:79], v[116:119], v[120:123], v[64:79]
    v_mfma_f32_32x32x16_bf16 v[224:239], v[116:119], v[124:127], v[224:239]
    s_barrier
    s_waitcnt lgkmcnt(0)
    v_mfma_f32_32x32x16_bf16 v[16:31], v[80:83], v[96:99], v[16:31]
    ds_read_b128 v[120:123], v3 offset:1024
    ds_read_b128 v[124:127], v3 offset:9216
    v_mfma_f32_32x32x16_bf16 v[176:191], v[80:83], v[100:103], v[176:191]
    ds_read_b64_tr_b16 v[104:105], v2 offset:4352
    ds_read_b64_tr_b16 v[106:107], v2 offset:4608
    v_mfma_f32_32x32x16_bf16 v[32:47], v[84:87], v[96:99], v[32:47]
    ds_read_b64_tr_b16 v[108:109], v2 offset:4416
    ds_read_b64_tr_b16 v[110:111], v2 offset:4672
    v_mfma_f32_32x32x16_bf16 v[192:207], v[84:87], v[100:103], v[192:207]
    ds_read_b64_tr_b16 v[112:113], v2 offset:4480
    ds_read_b64_tr_b16 v[114:115], v2 offset:4736
    v_mfma_f32_32x32x16_bf16 v[48:63], v[88:91], v[96:99], v[48:63]
    ds_read_b64_tr_b16 v[116:117], v2 offset:4544
    ds_read_b64_tr_b16 v[118:119], v2 offset:4800
    v_mfma_f32_32x32x16_bf16 v[208:223], v[88:91], v[100:103], v[208:223]
    v_mfma_f32_32x32x16_bf16 v[64:79], v[92:95], v[96:99], v[64:79]
    v_mfma_f32_32x32x16_bf16 v[224:239], v[92:95], v[100:103], v[224:239]
    s_cbranch_vccnz Lat_nk7
    s_add_u32 s55, s57, 65536
    buffer_store_dwordx4 v[172:175], v6, s[16:19], s55 offen offset:3072 sc1
Lat_nk7:
    v_add_u32 v2, 32768, v2
    v_add_u32 v3, 32768, v3
    s_waitcnt lgkmcnt(0)
    v_mfma_f32_32x32x16_bf16 v[16:31], v[104:107], v[120:123], v[16:31]
    ds_read_b128 v[96:99], v3 offset:0
    ds_read_b128 v[100:103], v3 offset:8192
    v_mfma_f32_32x32x16_bf16 v[176:191], v[104:107], v[124:127], v[176:191]
    ds_read_b64_tr_b16 v[80:81], v2 offset:0
    ds_read_b64_tr_b16 v[82:83], v2 offset:256
    v_mfma_f32_32x32x16_bf16 v[32:47], v[108:111], v[120:123], v[32:47]
    ds_read_b64_tr_b16 v[84:85], v2 offset:64
    ds_read_b64_tr_b16 v[86:87], v2 offset:320
    v_mfma_f32_32x32x16_bf16 v[192:207], v[108:111], v[124:127], v[192:207]
    ds_read_b64_tr_b16 v[88:89], v2 offset:128
    ds_read_b64_tr_b16 v[90:91], v2 offset:384
    v_mfma_f32_32x32x16_bf16 v[48:63], v[112:115], v[120:123], v[48:63]
    ds_read_b64_tr_b16 v[92:93], v2 offset:192
    ds_read_b64_tr_b16 v[94:95], v2 offset:448
    v_mfma_f32_32x32x16_bf16 v[208:223], v[112:115], v[124:127], v[208:223]
    v_mfma_f32_32x32x16_bf16 v[64:79], v[116:119], v[120:123], v[64:79]
    v_mfma_f32_32x32x16_bf16 v[224:239], v[116:119], v[124:127], v[224:239]
    s_barrier
    s_waitcnt lgkmcnt(0)
    v_mfma_f32_32x32x16_bf16 v[16:31], v[80:83], v[96:99], v[16:31]
    ds_read_b128 v[120:123], v3 offset:1024
    ds_read_b128 v[124:127], v3 offset:9216
    v_mfma_f32_32x32x16_bf16 v[176:191], v[80:83], v[100:103], v[176:191]
    ds_read_b64_tr_b16 v[104:105], v2 offset:4352
    ds_read_b64_tr_b16 v[106:107], v2 offset:4608
    v_mfma_f32_32x32x16_bf16 v[32:47], v[84:87], v[96:99], v[32:47]
    ds_read_b64_tr_b16 v[108:109], v2 offset:4416
    ds_read_b64_tr_b16 v[110:111], v2 offset:4672
    v_mfma_f32_32x32x16_bf16 v[192:207], v[84:87], v[100:103], v[192:207]
    ds_read_b64_tr_b16 v[112:113], v2 offset:4480
    ds_read_b64_tr_b16 v[114:115], v2 offset:4736
    v_mfma_f32_32x32x16_bf16 v[48:63], v[88:91], v[96:99], v[48:63]
    ds_read_b64_tr_b16 v[116:117], v2 offset:4544
    ds_read_b64_tr_b16 v[118:119], v2 offset:4800
    v_mfma_f32_32x32x16_bf16 v[208:223], v[88:91], v[100:103], v[208:223]
    v_mfma_f32_32x32x16_bf16 v[64:79], v[92:95], v[96:99], v[64:79]
    v_mfma_f32_32x32x16_bf16 v[224:239], v[92:95], v[100:103], v[224:239]
    s_cbranch_vccnz Lat_nk8
    s_add_u32 s55, s57, 131072
    buffer_store_dwordx4 v[128:131], v6, s[16:19], s55 offen offset:0 sc1
Lat_nk8:
    v_add_u32 v2, 32768, v2
    v_add_u32 v3, 32768, v3
    s_waitcnt lgkmcnt(0)
    v_mfma_f32_32x32x16_bf16 v[16:31], v[104:107], v[120:123], v[16:31]
    ds_read_b128 v[96:99], v3 offset:0
    ds_read_b128 v[100:103], v3 offset:8192
    v_mfma_f32_32x32x16_bf16 v[176:191], v[104:107], v[124:127], v[176:191]
    ds_read_b64_tr_b16 v[80:81], v2 offset:0
    ds_read_b64_tr_b16 v[82:83], v2 offset:256
    v_mfma_f32_32x32x16_bf16 v[32:47], v[108:111], v[120:123], v[32:47]
    ds_read_b64_tr_b16 v[84:85], v2 offset:64
    ds_read_b64_tr_b16 v[86:87], v2 offset:320
    v_mfma_f32_32x32x16_bf16 v[192:207], v[108:111], v[124:127], v[192:207]
    ds_read_b64_tr_b16 v[88:89], v2 offset:128
    ds_read_b64_tr_b16 v[90:91], v2 offset:384
    v_mfma_f32_32x32x16_bf16 v[48:63], v[112:115], v[120:123], v[48:63]
    ds_read_b64_tr_b16 v[92:93], v2 offset:192
    ds_read_b64_tr_b16 v[94:95], v2 offset:448
    v_mfma_f32_32x32x16_bf16 v[208:223], v[112:115], v[124:127], v[208:223]
    v_mfma_f32_32x32x16_bf16 v[64:79], v[116:119], v[120:123], v[64:79]
    v_mfma_f32_32x32x16_bf16 v[224:239], v[116:119], v[124:127], v[224:239]
    s_barrier
    s_waitcnt lgkmcnt(0)
    v_mfma_f32_32x32x16_bf16 v[16:31], v[80:83], v[96:99], v[16:31]
    ds_read_b128 v[120:123], v3 offset:1024
    ds_read_b128 v[124:127], v3 offset:9216
    v_mfma_f32_32x32x16_bf16 v[176:191], v[80:83], v[100:103], v[176:191]
    ds_read_b64_tr_b16 v[104:105], v2 offset:4352
    ds_read_b64_tr_b16 v[106:107], v2 offset:4608
    v_mfma_f32_32x32x16_bf16 v[32:47], v[84:87], v[96:99], v[32:47]
    ds_read_b64_tr_b16 v[108:109], v2 offset:4416
    ds_read_b64_tr_b16 v[110:111], v2 offset:4672
    v_mfma_f32_32x32x16_bf16 v[192:207], v[84:87], v[100:103], v[192:207]
    ds_read_b64_tr_b16 v[112:113], v2 offset:4480
    ds_read_b64_tr_b16 v[114:115], v2 offset:4736
    v_mfma_f32_32x32x16_bf16 v[48:63], v[88:91], v[96:99], v[48:63]
    ds_read_b64_tr_b16 v[116:117], v2 offset:4544
    ds_read_b64_tr_b16 v[118:119], v2 offset:4800
    v_mfma_f32_32x32x16_bf16 v[208:223], v[88:91], v[100:103], v[208:223]
    v_mfma_f32_32x32x16_bf16 v[64:79], v[92:95], v[96:99], v[64:79]
    v_mfma_f32_32x32x16_bf16 v[224:239], v[92:95], v[100:103], v[224:239]
    s_cbranch_vccnz Lat_nk9
    s_add_u32 s55, s57, 131072
    buffer_store_dwordx4 v[132:135], v6, s[16:19], s55 offen offset:1024 sc1
Lat_nk9:
    v_add_u32 v2, 4294836224, v2
    v_add_u32 v3, 4294836224, v3
    s_waitcnt vmcnt(2)
    s_waitcnt lgkmcnt(0)
    v_mfma_f32_32x32x16_bf16 v[16:31], v[104:107], v[120:123], v[16:31]
    ds_read_b128 v[96:99], v3 offset:0
    ds_read_b128 v[100:103], v3 offset:8192
    v_mfma_f32_32x32x16_bf16 v[176:191], v[104:107], v[124:127], v[176:191]
    ds_read_b64_tr_b16 v[80:81], v2 offset:0
    ds_read_b64_tr_b16 v[82:83], v2 offset:256
    v_mfma_f32_32x32x16_bf16 v[32:47], v[108:111], v[120:123], v[32:47]
    ds_read_b64_tr_b16 v[84:85], v2 offset:64
    ds_read_b64_tr_b16 v[86:87], v2 offset:320
    v_mfma_f32_32x32x16_bf16 v[192:207], v[108:111], v[124:127], v[192:207]
    ds_read_b64_tr_b16 v[88:89], v2 offset:128
    ds_read_b64_tr_b16 v[90:91], v2 offset:384
    v_mfma_f32_32x32x16_bf16 v[48:63], v[112:115], v[120:123], v[48:63]
    ds_read_b64_tr_b16 v[92:93], v2 offset:192
    ds_read_b64_tr_b16 v[94:95], v2 offset:448
    v_mfma_f32_32x32x16_bf16 v[208:223], v[112:115], v[124:127], v[208:223]
    v_mfma_f32_32x32x16_bf16 v[64:79], v[116:119], v[120:123], v[64:79]
    v_mfma_f32_32x32x16_bf16 v[224:239], v[116:119], v[124:127], v[224:239]
    s_barrier
    s_waitcnt lgkmcnt(0)
    v_mfma_f32_32x32x16_bf16 v[16:31], v[80:83], v[96:99], v[16:31]
    ds_read_b128 v[120:123], v3 offset:1024
    ds_read_b128 v[124:127], v3 offset:9216
    v_mfma_f32_32x32x16_bf16 v[176:191], v[80:83], v[100:103], v[176:191]
    ds_read_b64_tr_b16 v[104:105], v2 offset:4352
    ds_read_b64_tr_b16 v[106:107], v2 offset:4608
    v_mfma_f32_32x32x16_bf16 v[32:47], v[84:87], v[96:99], v[32:47]
    ds_read_b64_tr_b16 v[108:109], v2 offset:4416
    ds_read_b64_tr_b16 v[110:111], v2 offset:4672
    v_mfma_f32_32x32x16_bf16 v[192:207], v[84:87], v[100:103], v[192:207]
    ds_read_b64_tr_b16 v[112:113], v2 offset:4480
    ds_read_b64_tr_b16 v[114:115], v2 offset:4736
    v_mfma_f32_32x32x16_bf16 v[48:63], v[88:91], v[96:99], v[48:63]
    ds_read_b64_tr_b16 v[116:117], v2 offset:4544
    ds_read_b64_tr_b16 v[118:119], v2 offset:4800
    v_mfma_f32_32x32x16_bf16 v[208:223], v[88:91], v[100:103], v[208:223]
    v_mfma_f32_32x32x16_bf16 v[64:79], v[92:95], v[96:99], v[64:79]
    v_mfma_f32_32x32x16_bf16 v[224:239], v[92:95], v[100:103], v[224:239]
    s_cbranch_vccnz Lat_nk10
    s_add_u32 s55, s57, 131072
    buffer_store_dwordx4 v[136:139], v6, s[16:19], s55 offen offset:2048 sc1
Lat_nk10:
    v_add_u32 v2, 32768, v2
    v_add_u32 v3, 32768, v3
    s_waitcnt lgkmcnt(0)
    v_mfma_f32_32x32x16_bf16 v[16:31], v[104:107], v[120:123], v[16:31]
    ds_read_b128 v[96:99], v3 offset:0
    ds_read_b128 v[100:103], v3 offset:8192
    v_mfma_f32_32x32x16_bf16 v[176:191], v[104:107], v[124:127], v[176:191]
    ds_read_b64_tr_b16 v[80:81], v2 offset:0
    ds_read_b64_tr_b16 v[82:83], v2 offset:256
    v_mfma_f32_32x32x16_bf16 v[32:47], v[108:111], v[120:123], v[32:47]
    ds_read_b64_tr_b16 v[84:85], v2 offset:64
    ds_read_b64_tr_b16 v[86:87], v2 offset:320
    v_mfma_f32_32x32x16_bf16 v[192:207], v[108:111], v[124:127], v[192:207]
    ds_read_b64_tr_b16 v[88:89], v2 offset:128
    ds_read_b64_tr_b16 v[90:91], v2 offset:384
    v_mfma_f32_32x32x16_bf16 v[48:63], v[112:115], v[120:123], v[48:63]
    ds_read_b64_tr_b16 v[92:93], v2 offset:192
    ds_read_b64_tr_b16 v[94:95], v2 offset:448
    v_mfma_f32_32x32x16_bf16 v[208:223], v[112:115], v[124:127], v[208:223]
    v_mfma_f32_32x32x16_bf16 v[64:79], v[116:119], v[120:123], v[64:79]
    v_mfma_f32_32x32x16_bf16 v[224:239], v[116:119], v[124:127], v[224:239]
    s_barrier
    s_waitcnt lgkmcnt(0)
    v_mfma_f32_32x32x16_bf16 v[16:31], v[80:83], v[96:99], v[16:31]
    ds_read_b128 v[120:123], v3 offset:1024
    ds_read_b128 v[124:127], v3 offset:9216
    v_mfma_f32_32x32x16_bf16 v[176:191], v[80:83], v[100:103], v[176:191]
    ds_read_b64_tr_b16 v[104:105], v2 offset:4352
    ds_read_b64_tr_b16 v[106:107], v2 offset:4608
    v_mfma_f32_32x32x16_bf16 v[32:47], v[84:87], v[96:99], v[32:47]
    ds_read_b64_tr_b16 v[108:109], v2 offset:4416
    ds_read_b64_tr_b16 v[110:111], v2 offset:4672
    v_mfma_f32_32x32x16_bf16 v[192:207], v[84:87], v[100:103], v[192:207]
    ds_read_b64_tr_b16 v[112:113], v2 offset:4480
    ds_read_b64_tr_b16 v[114:115], v2 offset:4736
    v_mfma_f32_32x32x16_bf16 v[48:63], v[88:91], v[96:99], v[48:63]
    ds_read_b64_tr_b16 v[116:117], v2 offset:4544
    ds_read_b64_tr_b16 v[118:119], v2 offset:4800
    v_mfma_f32_32x32x16_bf16 v[208:223], v[88:91], v[100:103], v[208:223]
    v_mfma_f32_32x32x16_bf16 v[64:79], v[92:95], v[96:99], v[64:79]
    v_mfma_f32_32x32x16_bf16 v[224:239], v[92:95], v[100:103], v[224:239]
    s_cbranch_vccnz Lat_nk11
    s_add_u32 s55, s57, 131072
    buffer_store_dwordx4 v[140:143], v6, s[16:19], s55 offen offset:3072 sc1
Lat_nk11:
    v_add_u32 v2, 32768, v2
    v_add_u32 v3, 32768, v3
    s_waitcnt lgkmcnt(0)
    v_mfma_f32_32x32x16_bf16 v[16:31], v[104:107], v[120:123], v[16:31]
    ds_read_b128 v[96:99], v3 offset:0
    ds_read_b128 v[100:103], v3 offset:8192
    v_mfma_f32_32x32x16_bf16 v[176:191], v[104:107], v[124:127], v[176:191]
    ds_read_b64_tr_b16 v[80:81], v2 offset:0
    ds_read_b64_tr_b16 v[82:83], v2 offset:256
    v_mfma_f32_32x32x16_bf16 v[32:47], v[108:111], v[120:123], v[32:47]
    ds_read_b64_tr_b16 v[84:85], v2 offset:64
    ds_read_b64_tr_b16 v[86:87], v2 offset:320
    v_mfma_f32_32x32x16_bf16 v[192:207], v[108:111], v[124:127], v[192:207]
    ds_read_b64_tr_b16 v[88:89], v2 offset:128
    ds_read_b64_tr_b16 v[90:91], v2 offset:384
    v_mfma_f32_32x32x16_bf16 v[48:63], v[112:115], v[120:123], v[48:63]
    ds_read_b64_tr_b16 v[92:93], v2 offset:192
    ds_read_b64_tr_b16 v[94:95], v2 offset:448
    v_mfma_f32_32x32x16_bf16 v[208:223], v[112:115], v[124:127], v[208:223]
    v_mfma_f32_32x32x16_bf16 v[64:79], v[116:119], v[120:123], v[64:79]
    v_mfma_f32_32x32x16_bf16 v[224:239], v[116:119], v[124:127], v[224:239]
    s_barrier
    s_waitcnt lgkmcnt(0)
    v_mfma_f32_32x32x16_bf16 v[16:31], v[80:83], v[96:99], v[16:31]
    ds_read_b128 v[120:123], v3 offset:1024
    ds_read_b128 v[124:127], v3 offset:9216
    v_mfma_f32_32x32x16_bf16 v[176:191], v[80:83], v[100:103], v[176:191]
    ds_read_b64_tr_b16 v[104:105], v2 offset:4352
    ds_read_b64_tr_b16 v[106:107], v2 offset:4608
    v_mfma_f32_32x32x16_bf16 v[32:47], v[84:87], v[96:99], v[32:47]
    ds_read_b64_tr_b16 v[108:109], v2 offset:4416
    ds_read_b64_tr_b16 v[110:111], v2 offset:4672
    v_mfma_f32_32x32x16_bf16 v[192:207], v[84:87], v[100:103], v[192:207]
    ds_read_b64_tr_b16 v[112:113], v2 offset:4480
    ds_read_b64_tr_b16 v[114:115], v2 offset:4736
    v_mfma_f32_32x32x16_bf16 v[48:63], v[88:91], v[96:99], v[48:63]
    ds_read_b64_tr_b16 v[116:117], v2 offset:4544
    ds_read_b64_tr_b16 v[118:119], v2 offset:4800
    v_mfma_f32_32x32x16_bf16 v[208:223], v[88:91], v[100:103], v[208:223]
    v_mfma_f32_32x32x16_bf16 v[64:79], v[92:95], v[96:99], v[64:79]
    v_mfma_f32_32x32x16_bf16 v[224:239], v[92:95], v[100:103], v[224:239]
    s_cbranch_vccnz Lat_nk12
    s_add_u32 s55, s57, 196608
    buffer_store_dwordx4 v[144:147], v6, s[16:19], s55 offen offset:0 sc1
Lat_nk12:
    v_add_u32 v2, 32768, v2
    v_add_u32 v3, 32768, v3
    s_waitcnt lgkmcnt(0)
    v_mfma_f32_32x32x16_bf16 v[16:31], v[104:107], v[120:123], v[16:31]
    ds_read_b128 v[96:99], v3 offset:0
    ds_read_b128 v[100:103], v3 offset:8192
    v_mfma_f32_32x32x16_bf16 v[176:191], v[104:107], v[124:127], v[176:191]
    ds_read_b64_tr_b16 v[80:81], v2 offset:0
    ds_read_b64_tr_b16 v[82:83], v2 offset:256
    v_mfma_f32_32x32x16_bf16 v[32:47], v[108:111], v[120:123], v[32:47]
    ds_read_b64_tr_b16 v[84:85], v2 offset:64
    ds_read_b64_tr_b16 v[86:87], v2 offset:320
    v_mfma_f32_32x32x16_bf16 v[192:207], v[108:111], v[124:127], v[192:207]
    ds_read_b64_tr_b16 v[88:89], v2 offset:128
    ds_read_b64_tr_b16 v[90:91], v2 offset:384
    v_mfma_f32_32x32x16_bf16 v[48:63], v[112:115], v[120:123], v[48:63]
    ds_read_b64_tr_b16 v[92:93], v2 offset:192
    ds_read_b64_tr_b16 v[94:95], v2 offset:448
    v_mfma_f32_32x32x16_bf16 v[208:223], v[112:115], v[124:127], v[208:223]
    v_mfma_f32_32x32x16_bf16 v[64:79], v[116:119], v[120:123], v[64:79]
    v_mfma_f32_32x32x16_bf16 v[224:239], v[116:119], v[124:127], v[224:239]
    s_barrier
    s_waitcnt lgkmcnt(0)
    v_mfma_f32_32x32x16_bf16 v[16:31], v[80:83], v[96:99], v[16:31]
    ds_read_b128 v[120:123], v3 offset:1024
    ds_read_b128 v[124:127], v3 offset:9216
    v_mfma_f32_32x32x16_bf16 v[176:191], v[80:83], v[100:103], v[176:191]
    ds_read_b64_tr_b16 v[104:105], v2 offset:4352
    ds_read_b64_tr_b16 v[106:107], v2 offset:4608
    v_mfma_f32_32x32x16_bf16 v[32:47], v[84:87], v[96:99], v[32:47]
    ds_read_b64_tr_b16 v[108:109], v2 offset:4416
    ds_read_b64_tr_b16 v[110:111], v2 offset:4672
    v_mfma_f32_32x32x16_bf16 v[192:207], v[84:87], v[100:103], v[192:207]
    ds_read_b64_tr_b16 v[112:113], v2 offset:4480
    ds_read_b64_tr_b16 v[114:115], v2 offset:4736
    v_mfma_f32_32x32x16_bf16 v[48:63], v[88:91], v[96:99], v[48:63]
    ds_read_b64_tr_b16 v[116:117], v2 offset:4544
    ds_read_b64_tr_b16 v[118:119], v2 offset:4800
    v_mfma_f32_32x32x16_bf16 v[208:223], v[88:91], v[100:103], v[208:223]
    v_mfma_f32_32x32x16_bf16 v[64:79], v[92:95], v[96:99], v[64:79]
    v_mfma_f32_32x32x16_bf16 v[224:239], v[92:95], v[100:103], v[224:239]
    s_cbranch_vccnz Lat_nk13
    s_add_u32 s55, s57, 196608
    buffer_store_dwordx4 v[148:151], v6, s[16:19], s55 offen offset:1024 sc1
Lat_nk13:
    v_add_u32 v2, 32768, v2
    v_add_u32 v3, 32768, v3
    s_waitcnt lgkmcnt(0)
    v_mfma_f32_32x32x16_bf16 v[16:31], v[104:107], v[120:123], v[16:31]
    ds_read_b128 v[96:99], v3 offset:0
    ds_read_b128 v[100:103], v3 offset:8192
    v_mfma_f32_32x32x16_bf16 v[176:191], v[104:107], v[124:127], v[176:191]
    ds_read_b64_tr_b16 v[80:81], v2 offset:0
    ds_read_b64_tr_b16 v[82:83], v2 offset:256
    v_mfma_f32_32x32x16_bf16 v[32:47], v[108:111], v[120:123], v[32:47]
    ds_read_b64_tr_b16 v[84:85], v2 offset:64
    ds_read_b64_tr_b16 v[86:87], v2 offset:320
    v_mfma_f32_32x32x16_bf16 v[192:207], v[108:111], v[124:127], v[192:207]
    ds_read_b64_tr_b16 v[88:89], v2 offset:128
    ds_read_b64_tr_b16 v[90:91], v2 offset:384
    v_mfma_f32_32x32x16_bf16 v[48:63], v[112:115], v[120:123], v[48:63]
    ds_read_b64_tr_b16 v[92:93], v2 offset:192
    ds_read_b64_tr_b16 v[94:95], v2 offset:448
    v_mfma_f32_32x32x16_bf16 v[208:223], v[112:115], v[124:127], v[208:223]
    v_mfma_f32_32x32x16_bf16 v[64:79], v[116:119], v[120:123], v[64:79]
    v_mfma_f32_32x32x16_bf16 v[224:239], v[116:119], v[124:127], v[224:239]
    s_barrier
    s_waitcnt lgkmcnt(0)
    v_mfma_f32_32x32x16_bf16 v[16:31], v[80:83], v[96:99], v[16:31]
    ds_read_b128 v[120:123], v3 offset:1024
    ds_read_b128 v[124:127], v3 offset:9216
    v_mfma_f32_32x32x16_bf16 v[176:191], v[80:83], v[100:103], v[176:191]
    ds_read_b64_tr_b16 v[104:105], v2 offset:4352
    ds_read_b64_tr_b16 v[106:107], v2 offset:4608
    v_mfma_f32_32x32x16_bf16 v[32:47], v[84:87], v[96:99], v[32:47]
    ds_read_b64_tr_b16 v[108:109], v2 offset:4416
    ds_read_b64_tr_b16 v[110:111], v2 offset:4672
    v_mfma_f32_32x32x16_bf16 v[192:207], v[84:87], v[100:103], v[192:207]
    ds_read_b64_tr_b16 v[112:113], v2 offset:4480
    ds_read_b64_tr_b16 v[114:115], v2 offset:4736
    v_mfma_f32_32x32x16_bf16 v[48:63], v[88:91], v[96:99], v[48:63]
    ds_read_b64_tr_b16 v[116:117], v2 offset:4544
    ds_read_b64_tr_b16 v[118:119], v2 offset:4800
    v_mfma_f32_32x32x16_bf16 v[208:223], v[88:91], v[100:103], v[208:223]
    v_mfma_f32_32x32x16_bf16 v[64:79], v[92:95], v[96:99], v[64:79]
    v_mfma_f32_32x32x16_bf16 v[224:239], v[92:95], v[100:103], v[224:239]
    s_cbranch_vccnz Lat_nk14
    s_add_u32 s55, s57, 196608
    buffer_store_dwordx4 v[152:155], v6, s[16:19], s55 offen offset:2048 sc1
Lat_nk14:
    v_add_u32 v2, 4294836224, v2
    v_add_u32 v3, 4294836224, v3
    s_waitcnt lgkmcnt(0)
    v_mfma_f32_32x32x16_bf16 v[16:31], v[104:107], v[120:123], v[16:31]
    ds_read_b128 v[96:99], v3 offset:0
    ds_read_b128 v[100:103], v3 offset:8192
    v_mfma_f32_32x32x16_bf16 v[176:191], v[104:107], v[124:127], v[176:191]
    ds_read_b64_tr_b16 v[80:81], v2 offset:0
    ds_read_b64_tr_b16 v[82:83], v2 offset:256
    v_mfma_f32_32x32x16_bf16 v[32:47], v[108:111], v[120:123], v[32:47]
    ds_read_b64_tr_b16 v[84:85], v2 offset:64
    ds_read_b64_tr_b16 v[86:87], v2 offset:320
    v_mfma_f32_32x32x16_bf16 v[192:207], v[108:111], v[124:127], v[192:207]
    ds_read_b64_tr_b16 v[88:89], v2 offset:128
    ds_read_b64_tr_b16 v[90:91], v2 offset:384
    v_mfma_f32_32x32x16_bf16 v[48:63], v[112:115], v[120:123], v[48:63]
    ds_read_b64_tr_b16 v[92:93], v2 offset:192
    ds_read_b64_tr_b16 v[94:95], v2 offset:448
    v_mfma_f32_32x32x16_bf16 v[208:223], v[112:115], v[124:127], v[208:223]
    v_mfma_f32_32x32x16_bf16 v[64:79], v[116:119], v[120:123], v[64:79]
    v_mfma_f32_32x32x16_bf16 v[224:239], v[116:119], v[124:127], v[224:239]
    s_barrier
    s_waitcnt lgkmcnt(0)
    v_mfma_f32_32x32x16_bf16 v[16:31], v[80:83], v[96:99], v[16:31]
    ds_read_b128 v[120:123], v3 offset:1024
    ds_read_b128 v[124:127], v3 offset:9216
    v_mfma_f32_32x32x16_bf16 v[176:191], v[80:83], v[100:103], v[176:191]
    ds_read_b64_tr_b16 v[104:105], v2 offset:4352
    ds_read_b64_tr_b16 v[106:107], v2 offset:4608
    v_mfma_f32_32x32x16_bf16 v[32:47], v[84:87], v[96:99], v[32:47]
    ds_read_b64_tr_b16 v[108:109], v2 offset:4416
    ds_read_b64_tr_b16 v[110:111], v2 offset:4672
    v_mfma_f32_32x32x16_bf16 v[192:207], v[84:87], v[100:103], v[192:207]
    ds_read_b64_tr_b16 v[112:113], v2 offset:4480
    ds_read_b64_tr_b16 v[114:115], v2 offset:4736
    v_mfma_f32_32x32x16_bf16 v[48:63], v[88:91], v[96:99], v[48:63]
    ds_read_b64_tr_b16 v[116:117], v2 offset:4544
    ds_read_b64_tr_b16 v[118:119], v2 offset:4800
    v_mfma_f32_32x32x16_bf16 v[208:223], v[88:91], v[100:103], v[208:223]
    v_mfma_f32_32x32x16_bf16 v[64:79], v[92:95], v[96:99], v[64:79]
    v_mfma_f32_32x32x16_bf16 v[224:239], v[92:95], v[100:103], v[224:239]
    s_cbranch_vccnz Lat_nk15
    s_add_u32 s55, s57, 196608
    buffer_store_dwordx4 v[156:159], v6, s[16:19], s55 offen offset:3072 sc1
Lat_nk15:
    v_add_u32 v2, 32768, v2
    v_add_u32 v3, 32768, v3
    s_waitcnt lgkmcnt(0)
    v_mfma_f32_32x32x16_bf16 v[16:31], v[104:107], v[120:123], v[16:31]
    ds_read_b128 v[96:99], v3 offset:0
    ds_read_b128 v[100:103], v3 offset:8192
    v_mfma_f32_32x32x16_bf16 v[176:191], v[104:107], v[124:127], v[176:191]
    ds_read_b64_tr_b16 v[80:81], v2 offset:0
    ds_read_b64_tr_b16 v[82:83], v2 offset:256
    v_mfma_f32_32x32x16_bf16 v[32:47], v[108:111], v[120:123], v[32:47]
    ds_read_b64_tr_b16 v[84:85], v2 offset:64
    ds_read_b64_tr_b16 v[86:87], v2 offset:320
    v_mfma_f32_32x32x16_bf16 v[192:207], v[108:111], v[124:127], v[192:207]
    ds_read_b64_tr_b16 v[88:89], v2 offset:128
    ds_read_b64_tr_b16 v[90:91], v2 offset:384
    v_mfma_f32_32x32x16_bf16 v[48:63], v[112:115], v[120:123], v[48:63]
    ds_read_b64_tr_b16 v[92:93], v2 offset:192
    ds_read_b64_tr_b16 v[94:95], v2 offset:448
    v_mfma_f32_32x32x16_bf16 v[208:223], v[112:115], v[124:127], v[208:223]
    v_mfma_f32_32x32x16_bf16 v[64:79], v[116:119], v[120:123], v[64:79]
    v_mfma_f32_32x32x16_bf16 v[224:239], v[116:119], v[124:127], v[224:239]
    s_barrier
    s_waitcnt lgkmcnt(0)
    v_mfma_f32_32x32x16_bf16 v[16:31], v[80:83], v[96:99], v[16:31]
    ds_read_b128 v[120:123], v3 offset:1024
    ds_read_b128 v[124:127], v3 offset:9216
    v_mfma_f32_32x32x16_bf16 v[176:191], v[80:83], v[100:103], v[176:191]
    ds_read_b64_tr_b16 v[104:105], v2 offset:4352
    ds_read_b64_tr_b16 v[106:107], v2 offset:4608
    v_mfma_f32_32x32x16_bf16 v[32:47], v[84:87], v[96:99], v[32:47]
    ds_read_b64_tr_b16 v[108:109], v2 offset:4416
    ds_read_b64_tr_b16 v[110:111], v2 offset:4672
    v_mfma_f32_32x32x16_bf16 v[192:207], v[84:87], v[100:103], v[192:207]
    ds_read_b64_tr_b16 v[112:113], v2 offset:4480
    ds_read_b64_tr_b16 v[114:115], v2 offset:4736
    v_mfma_f32_32x32x16_bf16 v[48:63], v[88:91], v[96:99], v[48:63]
    ds_read_b64_tr_b16 v[116:117], v2 offset:4544
    ds_read_b64_tr_b16 v[118:119], v2 offset:4800
    v_mfma_f32_32x32x16_bf16 v[208:223], v[88:91], v[100:103], v[208:223]
    v_mfma_f32_32x32x16_bf16 v[64:79], v[92:95], v[96:99], v[64:79]
    v_mfma_f32_32x32x16_bf16 v[224:239], v[92:95], v[100:103], v[224:239]
    v_add_u32 v2, 32768, v2
    v_add_u32 v3, 32768, v3
    s_waitcnt lgkmcnt(0)
    v_mfma_f32_32x32x16_bf16 v[16:31], v[104:107], v[120:123], v[16:31]
    ds_read_b128 v[96:99], v3 offset:0
    ds_read_b128 v[100:103], v3 offset:8192
    v_mfma_f32_32x32x16_bf16 v[176:191], v[104:107], v[124:127], v[176:191]
    ds_read_b64_tr_b16 v[80:81], v2 offset:0
    ds_read_b64_tr_b16 v[82:83], v2 offset:256
    v_mfma_f32_32x32x16_bf16 v[32:47], v[108:111], v[120:123], v[32:47]
    ds_read_b64_tr_b16 v[84:85], v2 offset:64
    ds_read_b64_tr_b16 v[86:87], v2 offset:320
    v_mfma_f32_32x32x16_bf16 v[192:207], v[108:111], v[124:127], v[192:207]
    ds_read_b64_tr_b16 v[88:89], v2 offset:128
    ds_read_b64_tr_b16 v[90:91], v2 offset:384
    v_mfma_f32_32x32x16_bf16 v[48:63], v[112:115], v[120:123], v[48:63]
    ds_read_b64_tr_b16 v[92:93], v2 offset:192
    ds_read_b64_tr_b16 v[94:95], v2 offset:448
    v_mfma_f32_32x32x16_bf16 v[208:223], v[112:115], v[124:127], v[208:223]
    v_mfma_f32_32x32x16_bf16 v[64:79], v[116:119], v[120:123], v[64:79]
    v_mfma_f32_32x32x16_bf16 v[224:239], v[116:119], v[124:127], v[224:239]
    s_barrier
    s_waitcnt lgkmcnt(0)
    v_mfma_f32_32x32x16_bf16 v[16:31], v[80:83], v[96:99], v[16:31]
    ds_read_b128 v[120:123], v3 offset:1024
    ds_read_b128 v[124:127], v3 offset:9216
    v_mfma_f32_32x32x16_bf16 v[176:191], v[80:83], v[100:103], v[176:191]
    ds_read_b64_tr_b16 v[104:105], v2 offset:4352
    ds_read_b64_tr_b16 v[106:107], v2 offset:4608
    v_mfma_f32_32x32x16_bf16 v[32:47], v[84:87], v[96:99], v[32:47]
    ds_read_b64_tr_b16 v[108:109], v2 offset:4416
    ds_read_b64_tr_b16 v[110:111], v2 offset:4672
    v_mfma_f32_32x32x16_bf16 v[192:207], v[84:87], v[100:103], v[192:207]
    ds_read_b64_tr_b16 v[112:113], v2 offset:4480
    ds_read_b64_tr_b16 v[114:115], v2 offset:4736
    v_mfma_f32_32x32x16_bf16 v[48:63], v[88:91], v[96:99], v[48:63]
    ds_read_b64_tr_b16 v[116:117], v2 offset:4544
    ds_read_b64_tr_b16 v[118:119], v2 offset:4800
    v_mfma_f32_32x32x16_bf16 v[208:223], v[88:91], v[100:103], v[208:223]
    v_mfma_f32_32x32x16_bf16 v[64:79], v[92:95], v[96:99], v[64:79]
    v_mfma_f32_32x32x16_bf16 v[224:239], v[92:95], v[100:103], v[224:239]
    v_add_u32 v2, 32768, v2
    v_add_u32 v3, 32768, v3
    s_waitcnt vmcnt(0)
    s_waitcnt lgkmcnt(0)
    v_mfma_f32_32x32x16_bf16 v[16:31], v[104:107], v[120:123], v[16:31]
    v_mfma_f32_32x32x16_bf16 v[176:191], v[104:107], v[124:127], v[176:191]
    v_mfma_f32_32x32x16_bf16 v[32:47], v[108:111], v[120:123], v[32:47]
    v_mfma_f32_32x32x16_bf16 v[192:207], v[108:111], v[124:127], v[192:207]
    v_mfma_f32_32x32x16_bf16 v[48:63], v[112:115], v[120:123], v[48:63]
    v_mfma_f32_32x32x16_bf16 v[208:223], v[112:115], v[124:127], v[208:223]
    v_mfma_f32_32x32x16_bf16 v[64:79], v[116:119], v[120:123], v[64:79]
    v_mfma_f32_32x32x16_bf16 v[224:239], v[116:119], v[124:127], v[224:239]
    s_barrier
    s_mov_b32 s40, 98304
    v_and_b32 v8, 63, v0
    v_bfe_u32 v9, v8, 4, 1
    v_lshlrev_b32 v9, 17, v9
    v_lshrrev_b32 v10, 5, v8
    v_lshl_add_u32 v9, v10, 8, v9
    v_and_b32 v10, 15, v8
    v_lshl_add_u32 v240, v10, 4, v9
    v_mov_b32 v241, 0x4e800000
    v_add_u32 v2, s40, v1
    s_nop 7
    v_pk_mul_f32 v[176:177], v[176:177], s[46:47]
    v_pk_mul_f32 v[178:179], v[178:179], s[46:47]
    v_pk_mul_f32 v[180:181], v[180:181], s[46:47]
    v_pk_mul_f32 v[182:183], v[182:183], s[46:47]
    v_cvt_pk_bf16_f32 v144, v176, v177
    v_cvt_pk_bf16_f32 v145, v178, v179
    v_cvt_pk_bf16_f32 v146, v180, v181
    v_cvt_pk_bf16_f32 v147, v182, v183
    v_pk_mul_f32 v[184:185], v[184:185], s[46:47]
    v_pk_mul_f32 v[186:187], v[186:187], s[46:47]
    v_pk_mul_f32 v[188:189], v[188:189], s[46:47]
    v_pk_mul_f32 v[190:191], v[190:191], s[46:47]
    v_cvt_pk_bf16_f32 v148, v184, v185
    v_cvt_pk_bf16_f32 v149, v186, v187
    v_cvt_pk_bf16_f32 v150, v188, v189
    v_cvt_pk_bf16_f32 v151, v190, v191
    v_pk_mul_f32 v[192:193], v[192:193], s[46:47]
    v_pk_mul_f32 v[194:195], v[194:195], s[46:47]
    v_pk_mul_f32 v[196:197], v[196:197], s[46:47]
    v_pk_mul_f32 v[198:199], v[198:199], s[46:47]
    v_cvt_pk_bf16_f32 v152, v192, v193
    v_cvt_pk_bf16_f32 v153, v194, v195
    v_cvt_pk_bf16_f32 v154, v196, v197
    v_cvt_pk_bf16_f32 v155, v198, v199
    v_pk_mul_f32 v[200:201], v[200:201], s[46:47]
    v_pk_mul_f32 v[202:203], v[202:203], s[46:47]
    v_pk_mul_f32 v[204:205], v[204:205], s[46:47]
    v_pk_mul_f32 v[206:207], v[206:207], s[46:47]
    v_cvt_pk_bf16_f32 v156, v200, v201
    v_cvt_pk_bf16_f32 v157, v202, v203
    v_cvt_pk_bf16_f32 v158, v204, v205
    v_cvt_pk_bf16_f32 v159, v206, v207
    v_pk_mul_f32 v[208:209], v[208:209], s[46:47]
    v_pk_mul_f32 v[210:211], v[210:211], s[46:47]
    v_pk_mul_f32 v[212:213], v[212:213], s[46:47]
    v_pk_mul_f32 v[214:215], v[214:215], s[46:47]
    v_cvt_pk_bf16_f32 v160, v208, v209
    v_cvt_pk_bf16_f32 v161, v210, v211
    v_cvt_pk_bf16_f32 v162, v212, v213
    v_cvt_pk_bf16_f32 v163, v214, v215
    v_pk_mul_f32 v[216:217], v[216:217], s[46:47]
    v_pk_mul_f32 v[218:219], v[218:219], s[46:47]
    v_pk_mul_f32 v[220:221], v[220:221], s[46:47]
    v_pk_mul_f32 v[222:223], v[222:223], s[46:47]
    v_cvt_pk_bf16_f32 v164, v216, v217
    v_cvt_pk_bf16_f32 v165, v218, v219
    v_cvt_pk_bf16_f32 v166, v220, v221
    v_cvt_pk_bf16_f32 v167, v222, v223
    v_pk_mul_f32 v[224:225], v[224:225], s[46:47]
    v_pk_mul_f32 v[226:227], v[226:227], s[46:47]
    v_pk_mul_f32 v[228:229], v[228:229], s[46:47]
    v_pk_mul_f32 v[230:231], v[230:231], s[46:47]
    v_cvt_pk_bf16_f32 v168, v224, v225
    v_cvt_pk_bf16_f32 v169, v226, v227
    v_cvt_pk_bf16_f32 v170, v228, v229
    v_cvt_pk_bf16_f32 v171, v230, v231
    v_pk_mul_f32 v[232:233], v[232:233], s[46:47]
    v_pk_mul_f32 v[234:235], v[234:235], s[46:47]
    v_pk_mul_f32 v[236:237], v[236:237], s[46:47]
    v_pk_mul_f32 v[238:239], v[238:239], s[46:47]
    v_cvt_pk_bf16_f32 v172, v232, v233
    v_cvt_pk_bf16_f32 v173, v234, v235
    v_cvt_pk_bf16_f32 v174, v236, v237
    v_cvt_pk_bf16_f32 v175, v238, v239
    ds_read_b128 v[80:83], v2 offset:8192
    ds_read_b128 v[84:87], v2 offset:9216
    ds_read_b128 v[88:91], v2 offset:10240
    ds_read_b128 v[92:95], v2 offset:11264
    ds_read_b128 v[96:99], v2 offset:12288
    ds_read_b128 v[100:103], v2 offset:13312
    ds_read_b128 v[104:107], v2 offset:14336
    ds_read_b128 v[108:111], v2 offset:15360
    v_pk_mul_f32 v[16:17], v[16:17], s[46:47]
    v_pk_mul_f32 v[18:19], v[18:19], s[46:47]
    v_pk_mul_f32 v[20:21], v[20:21], s[46:47]
    v_pk_mul_f32 v[22:23], v[22:23], s[46:47]
    v_cvt_pk_bf16_f32 v112, v16, v17
    v_cvt_pk_bf16_f32 v113, v18, v19
    v_cvt_pk_bf16_f32 v114, v20, v21
    v_cvt_pk_bf16_f32 v115, v22, v23
    v_pk_mul_f32 v[24:25], v[24:25], s[46:47]
    v_pk_mul_f32 v[26:27], v[26:27], s[46:47]
    v_pk_mul_f32 v[28:29], v[28:29], s[46:47]
    v_pk_mul_f32 v[30:31], v[30:31], s[46:47]
    v_cvt_pk_bf16_f32 v116, v24, v25
    v_cvt_pk_bf16_f32 v117, v26, v27
    v_cvt_pk_bf16_f32 v118, v28, v29
    v_cvt_pk_bf16_f32 v119, v30, v31
    v_pk_mul_f32 v[32:33], v[32:33], s[46:47]
    v_pk_mul_f32 v[34:35], v[34:35], s[46:47]
    v_pk_mul_f32 v[36:37], v[36:37], s[46:47]
    v_pk_mul_f32 v[38:39], v[38:39], s[46:47]
    v_cvt_pk_bf16_f32 v120, v32, v33
    v_cvt_pk_bf16_f32 v121, v34, v35
    v_cvt_pk_bf16_f32 v122, v36, v37
    v_cvt_pk_bf16_f32 v123, v38, v39
    v_pk_mul_f32 v[40:41], v[40:41], s[46:47]
    v_pk_mul_f32 v[42:43], v[42:43], s[46:47]
    v_pk_mul_f32 v[44:45], v[44:45], s[46:47]
    v_pk_mul_f32 v[46:47], v[46:47], s[46:47]
    v_cvt_pk_bf16_f32 v124, v40, v41
    v_cvt_pk_bf16_f32 v125, v42, v43
    v_cvt_pk_bf16_f32 v126, v44, v45
    v_cvt_pk_bf16_f32 v127, v46, v47
    v_pk_mul_f32 v[48:49], v[48:49], s[46:47]
    v_pk_mul_f32 v[50:51], v[50:51], s[46:47]
    v_pk_mul_f32 v[52:53], v[52:53], s[46:47]
    v_pk_mul_f32 v[54:55], v[54:55], s[46:47]
    v_cvt_pk_bf16_f32 v128, v48, v49
    v_cvt_pk_bf16_f32 v129, v50, v51
    v_cvt_pk_bf16_f32 v130, v52, v53
    v_cvt_pk_bf16_f32 v131, v54, v55
    v_pk_mul_f32 v[56:57], v[56:57], s[46:47]
    v_pk_mul_f32 v[58:59], v[58:59], s[46:47]
    v_pk_mul_f32 v[60:61], v[60:61], s[46:47]
    v_pk_mul_f32 v[62:63], v[62:63], s[46:47]
    v_cvt_pk_bf16_f32 v132, v56, v57
    v_cvt_pk_bf16_f32 v133, v58, v59
    v_cvt_pk_bf16_f32 v134, v60, v61
    v_cvt_pk_bf16_f32 v135, v62, v63
    v_pk_mul_f32 v[64:65], v[64:65], s[46:47]
    v_pk_mul_f32 v[66:67], v[66:67], s[46:47]
    v_pk_mul_f32 v[68:69], v[68:69], s[46:47]
    v_pk_mul_f32 v[70:71], v[70:71], s[46:47]
    v_cvt_pk_bf16_f32 v136, v64, v65
    v_cvt_pk_bf16_f32 v137, v66, v67
    v_cvt_pk_bf16_f32 v138, v68, v69
    v_cvt_pk_bf16_f32 v139, v70, v71
    v_pk_mul_f32 v[72:73], v[72:73], s[46:47]
    v_pk_mul_f32 v[74:75], v[74:75], s[46:47]
    v_pk_mul_f32 v[76:77], v[76:77], s[46:47]
    v_pk_mul_f32 v[78:79], v[78:79], s[46:47]
    v_cvt_pk_bf16_f32 v140, v72, v73
    v_cvt_pk_bf16_f32 v141, v74, v75
    v_cvt_pk_bf16_f32 v142, v76, v77
    v_cvt_pk_bf16_f32 v143, v78, v79
    s_mov_b32 s42, s30
    s_mov_b32 s43, 0
Lat_qk0:
    s_lshl_b32 s32, s42, 7
    v_cvt_f32_u32 v6, s32
    v_mul_f32 v6, 0x71800000, v6
    v_add_f32 v6, v6, v7
    v_mov_b32 v5, 0
    v_min_f32 v16, v6, v5
    v_add_f32 v17, 0xf1800000, v6
    v_min_f32 v17, v17, v5
    v_add_f32 v18, 0xf2000000, v6
    v_min_f32 v18, v18, v5
    v_add_f32 v19, 0xf2400000, v6
    v_min_f32 v19, v19, v5
    v_add_f32 v20, 0xf3000000, v6
    v_min_f32 v20, v20, v5
    v_add_f32 v21, 0xf3100000, v6
    v_min_f32 v21, v21, v5
    v_add_f32 v22, 0xf3200000, v6
    v_min_f32 v22, v22, v5
    v_add_f32 v23, 0xf3300000, v6
    v_min_f32 v23, v23, v5
    v_add_f32 v24, 0xf3800000, v6
    v_min_f32 v24, v24, v5
    v_add_f32 v25, 0xf3880000, v6
    v_min_f32 v25, v25, v5
    v_add_f32 v26, 0xf3900000, v6
    v_min_f32 v26, v26, v5
    v_add_f32 v27, 0xf3980000, v6
    v_min_f32 v27, v27, v5
    v_add_f32 v28, 0xf3c00000, v6
    v_min_f32 v28, v28, v5
    v_add_f32 v29, 0xf3c80000, v6
    v_min_f32 v29, v29, v5
    v_add_f32 v30, 0xf3d00000, v6
    v_min_f32 v30, v30, v5
    v_add_f32 v31, 0xf3d80000, v6
    v_min_f32 v31, v31, v5
    v_add_f32 v6, 0xf4000000, v6
    s_add_u32 s40, s40, 32768
    s_cmp_eq_u32 s40, 163840
    s_cselect_b32 s40, 0, s40
    v_add_u32 v2, s40, v1
    s_waitcnt lgkmcnt(5)
    v_mfma_f32_32x32x16_bf16 v[32:47], v[80:83], v[112:115], v[16:31]
    ds_read_b128 v[80:83], v2 offset:0
    v_mov_b64 v[176:177], 0
    v_mov_b64 v[178:179], 0
    v_mov_b64 v[180:181], 0
    v_mov_b64 v[182:183], 0
    v_mov_b64 v[184:185], 0
    v_mfma_f32_32x32x16_bf16 v[32:47], v[84:87], v[116:119], v[32:47]
    ds_read_b128 v[84:87], v2 offset:1024
    v_mov_b64 v[186:187], 0
    v_mov_b64 v[188:189], 0
    v_mov_b64 v[190:191], 0
    v_mov_b64 v[192:193], 0
    v_mov_b64 v[194:195], 0
    v_mfma_f32_32x32x16_bf16 v[32:47], v[88:91], v[120:123], v[32:47]
    ds_read_b128 v[88:91], v2 offset:2048
    v_mov_b64 v[196:197], 0
    v_mov_b64 v[198:199], 0
    v_mov_b64 v[200:201], 0
    v_mov_b64 v[202:203], 0
    v_mov_b64 v[204:205], 0
    s_waitcnt lgkmcnt(4)
    v_mfma_f32_32x32x16_bf16 v[32:47], v[92:95], v[124:127], v[32:47]
    ds_read_b128 v[92:95], v2 offset:3072
    v_mov_b64 v[206:207], 0
    v_mov_b64 v[208:209], 0
    v_mov_b64 v[210:211], 0
    v_mov_b64 v[212:213], 0
    v_mov_b64 v[214:215], 0
    v_mfma_f32_32x32x16_bf16 v[32:47], v[96:99], v[128:131], v[32:47]
    ds_read_b128 v[96:99], v2 offset:4096
    v_mov_b64 v[216:217], 0
    v_mov_b64 v[218:219], 0
    v_mov_b64 v[220:221], 0
    v_mov_b64 v[222:223], 0
    v_mov_b64 v[224:225], 0
    v_mfma_f32_32x32x16_bf16 v[32:47], v[100:103], v[132:135], v[32:47]
    ds_read_b128 v[100:103], v2 offset:5120
    v_mov_b64 v[226:227], 0
    v_mov_b64 v[228:229], 0
    v_mov_b64 v[230:231], 0
    v_mov_b64 v[232:233], 0
    v_mov_b64 v[234:235], 0
    v_mfma_f32_32x32x16_bf16 v[32:47], v[104:107], v[136:139], v[32:47]
    ds_read_b128 v[104:107], v2 offset:6144
    v_mov_b64 v[236:237], 0
    v_mov_b64 v[238:239], 0
    v_mov_b64 v[72:73], 0
    v_mov_b64 v[74:75], 0
    v_mov_b64 v[76:77], 0
    s_waitcnt lgkmcnt(4)
    v_mfma_f32_32x32x16_bf16 v[32:47], v[108:111], v[140:143], v[32:47]
    ds_read_b128 v[108:111], v2 offset:7168
    v_mov_b64 v[78:79], 0
    v_mov_b32 v3, 0
    v_mov_b32 v245, 0
    s_nop 7
    s_nop 1
    v_max3_f32 v243, v32, v33, v34
    v_max3_f32 v243, v243, v35, v36
    v_max3_f32 v243, v243, v37, v38
    v_max3_f32 v243, v243, v39, v40
    v_max3_f32 v243, v243, v41, v42
    v_max3_f32 v243, v243, v43, v44
    v_max3_f32 v243, v243, v45, v46
    v_max_f32 v243, v243, v47
    v_mov_b32 v242, v243
    s_nop 1
    v_permlane32_swap_b32 v243, v242
    s_nop 1
    v_max_f32 v243, v243, v242
    v_sub_f32 v5, 0, v243
    v_sub_f32 v32, v32, v243
    v_sub_f32 v33, v33, v243
    v_sub_f32 v34, v34, v243
    v_sub_f32 v35, v35, v243
    v_sub_f32 v36, v36, v243
    v_sub_f32 v37, v37, v243
    v_sub_f32 v38, v38, v243
    v_sub_f32 v39, v39, v243
    v_sub_f32 v40, v40, v243
    v_sub_f32 v41, v41, v243
    v_sub_f32 v42, v42, v243
    v_sub_f32 v43, v43, v243
    v_sub_f32 v44, v44, v243
    v_sub_f32 v45, v45, v243
    v_sub_f32 v46, v46, v243
    v_sub_f32 v47, v47, v243
    v_min_f32 v16, v6, v5
    v_add_f32 v17, 0xf1800000, v6
    v_min_f32 v17, v17, v5
    v_add_f32 v18, 0xf2000000, v6
    v_min_f32 v18, v18, v5
    v_add_f32 v19, 0xf2400000, v6
    v_min_f32 v19, v19, v5
    v_add_f32 v20, 0xf3000000, v6
    v_min_f32 v20, v20, v5
    v_add_f32 v21, 0xf3100000, v6
    v_min_f32 v21, v21, v5
    v_add_f32 v22, 0xf3200000, v6
    v_min_f32 v22, v22, v5
    v_add_f32 v23, 0xf3300000, v6
    v_min_f32 v23, v23, v5
    v_add_f32 v24, 0xf3800000, v6
    v_min_f32 v24, v24, v5
    v_add_f32 v25, 0xf3880000, v6
    v_min_f32 v25, v25, v5
    v_add_f32 v26, 0xf3900000, v6
    v_min_f32 v26, v26, v5
    v_add_f32 v27, 0xf3980000, v6
    v_min_f32 v27, v27, v5
    v_add_f32 v28, 0xf3c00000, v6
    v_min_f32 v28, v28, v5
    v_add_f32 v29, 0xf3c80000, v6
    v_min_f32 v29, v29, v5
    v_add_f32 v30, 0xf3d00000, v6
    v_min_f32 v30, v30, v5
    v_add_f32 v31, 0xf3d80000, v6
    v_min_f32 v31, v31, v5
    v_add_f32 v6, 0xf4000000, v6
    s_cmp_eq_u32 s43, 0
    s_cbranch_scc1 Lat_ns0
    s_lshr_b32 s32, s28, 2
    s_add_u32 s32, s32, 48
    s_lshl_b32 s33, s30, 3
    s_add_u32 s33, s33, s32
    s_lshl_b32 s33, s33, 7
    s_waitcnt vmcnt(0)
    v_mov_b32 v6, 1
    s_mov_b64 exec, 1
    buffer_atomic_add v6, off, s[96:99], s33 sc1
    s_mov_b64 exec, -1
Lat_ns0:
    s_lshl_b32 s32, s3, 5
    v_cvt_f32_u32 v6, s32
    v_mul_f32 v6, 0xf1800000, v6
    v_add_f32 v6, v6, v7
    s_cmp_eq_u32 s42, 0
    s_cbranch_scc0 Lat_plain_pre
    s_cmp_eq_u32 s3, 0
    s_cbranch_scc1 Lat_t0b
    s_cmp_eq_u32 s3, 1
    s_cbranch_scc1 Lat_t1b
    s_cmp_eq_u32 s3, 2
    s_cbranch_scc1 Lat_t2b
    s_branch Lat_t3b
Lat_plain_pre:
    s_lshl_b32 s41, s42, 1
    s_sub_u32 s41, s41, 1
Lat_plain:
    v_mfma_f32_32x32x16_bf16 v[48:63], v[80:83], v[112:115], v[16:31]
    ds_read_b128 v[80:83], v2 offset:16384
    v_exp_f32 v8, v32
    v_exp_f32 v9, v33
    v_mfma_f32_32x32x16_bf16 v[48:63], v[84:87], v[116:119], v[48:63]
    ds_read_b128 v[84:87], v2 offset:17408
    v_exp_f32 v10, v34
    v_add_f32 v244, v8, v9
    v_cvt_pk_bf16_f32 v64, v8, v9
    v_mfma_f32_32x32x16_bf16 v[48:63], v[88:91], v[120:123], v[48:63]
    ds_read_b128 v[88:91], v2 offset:18432
    v_exp_f32 v11, v35
    v_exp_f32 v12, v36
    s_waitcnt lgkmcnt(4)
    v_mfma_f32_32x32x16_bf16 v[48:63], v[92:95], v[124:127], v[48:63]
    ds_read_b128 v[92:95], v2 offset:19456
    v_exp_f32 v13, v37
    v_add_f32 v244, v244, v10
    v_cvt_pk_bf16_f32 v65, v10, v11
    v_mfma_f32_32x32x16_bf16 v[48:63], v[96:99], v[128:131], v[48:63]
    ds_read_b128 v[96:99], v2 offset:20480
    v_exp_f32 v14, v38
    v_add_f32 v244, v244, v11
    v_add_f32 v244, v244, v12
    v_mfma_f32_32x32x16_bf16 v[48:63], v[100:103], v[132:135], v[48:63]
    ds_read_b128 v[100:103], v2 offset:21504
    v_exp_f32 v15, v39
    v_add_f32 v244, v244, v13
    v_cvt_pk_bf16_f32 v66, v12, v13
    v_mfma_f32_32x32x16_bf16 v[48:63], v[104:107], v[136:139], v[48:63]
    ds_read_b128 v[104:107], v2 offset:22528
    v_exp_f32 v8, v40
    v_add_f32 v244, v244, v14
    v_add_f32 v3, v3, v245
    s_waitcnt lgkmcnt(4)
    v_mfma_f32_32x32x16_bf16 v[48:63], v[108:111], v[140:143], v[48:63]
    ds_read_b128 v[108:111], v2 offset:23552
    v_exp_f32 v9, v41
    v_add_f32 v244, v244, v15
    v_cvt_pk_bf16_f32 v67, v14, v15
    v_mfma_f32_32x32x16_bf16 v[176:191], v[80:83], v[72:75], v[176:191]
    ds_read_b128 v[80:83], v2 offset:8192
    s_barrier
    v_exp_f32 v10, v42
    v_add_f32 v244, v244, v8
    v_mfma_f32_32x32x16_bf16 v[192:207], v[84:87], v[72:75], v[192:207]
    ds_read_b128 v[84:87], v2 offset:9216
    v_exp_f32 v11, v43
    v_add_f32 v244, v244, v9
    v_cvt_pk_bf16_f32 v68, v8, v9
    v_mfma_f32_32x32x16_bf16 v[208:223], v[88:91], v[72:75], v[208:223]
    ds_read_b128 v[88:91], v2 offset:10240
    v_exp_f32 v12, v44
    v_add_f32 v244, v244, v10
    s_waitcnt lgkmcnt(4)
    v_mfma_f32_32x32x16_bf16 v[224:239], v[92:95], v[72:75], v[224:239]
    ds_read_b128 v[92:95], v2 offset:11264
    v_exp_f32 v13, v45
    v_add_f32 v244, v244, v11
    v_cvt_pk_bf16_f32 v69, v10, v11
    v_mfma_f32_32x32x16_bf16 v[176:191], v[96:99], v[76:79], v[176:191]
    ds_read_b128 v[96:99], v2 offset:12288
    v_exp_f32 v14, v46
    v_add_f32 v244, v244, v12
    v_mfma_f32_32x32x16_bf16 v[192:207], v[100:103], v[76:79], v[192:207]
    ds_read_b128 v[100:103], v2 offset:13312
    v_exp_f32 v15, v47
    v_add_f32 v244, v244, v13
    v_cvt_pk_bf16_f32 v70, v12, v13
    v_mfma_f32_32x32x16_bf16 v[208:223], v[104:107], v[76:79], v[208:223]
    ds_read_b128 v[104:107], v2 offset:14336
    v_add_f32 v244, v244, v14
    v_add_f32 v244, v244, v15
    v_cmp_nle_f32 vcc, v244, v241
    v_cvt_pk_bf16_f32 v71, v14, v15
    s_waitcnt lgkmcnt(4)
    v_mfma_f32_32x32x16_bf16 v[224:239], v[108:111], v[76:79], v[224:239]
    ds_read_b128 v[108:111], v2 offset:15360
    s_cbranch_vccnz Lat_rs0
Lat_rb0:
    v_mfma_f32_32x32x16_bf16 v[32:47], v[80:83], v[112:115], v[16:31]
    ds_read_b128 v[80:83], v2 offset:24576
    v_exp_f32 v8, v48
    v_exp_f32 v9, v49
    v_mfma_f32_32x32x16_bf16 v[32:47], v[84:87], v[116:119], v[32:47]
    ds_read_b128 v[84:87], v2 offset:25600
    v_exp_f32 v10, v50
    v_add_f32 v245, v8, v9
    v_cvt_pk_bf16_f32 v72, v8, v9
    v_mfma_f32_32x32x16_bf16 v[32:47], v[88:91], v[120:123], v[32:47]
    ds_read_b128 v[88:91], v2 offset:26624
    v_exp_f32 v11, v51
    v_exp_f32 v12, v52
    s_waitcnt lgkmcnt(4)
    v_mfma_f32_32x32x16_bf16 v[32:47], v[92:95], v[124:127], v[32:47]
    ds_read_b128 v[92:95], v2 offset:27648
    v_exp_f32 v13, v53
    v_add_f32 v245, v245, v10
    v_cvt_pk_bf16_f32 v73, v10, v11
    v_mfma_f32_32x32x16_bf16 v[32:47], v[96:99], v[128:131], v[32:47]
    ds_read_b128 v[96:99], v2 offset:28672
    v_exp_f32 v14, v54
    v_add_f32 v245, v245, v11
    v_add_f32 v245, v245, v12
    v_mfma_f32_32x32x16_bf16 v[32:47], v[100:103], v[132:135], v[32:47]
    ds_read_b128 v[100:103], v2 offset:29696
    v_exp_f32 v15, v55
    v_add_f32 v245, v245, v13
    v_cvt_pk_bf16_f32 v74, v12, v13
    v_mfma_f32_32x32x16_bf16 v[32:47], v[104:107], v[136:139], v[32:47]
    ds_read_b128 v[104:107], v2 offset:30720
    s_add_u32 s40, s40, 32768
    s_cmp_eq_u32 s40, 163840
    s_cselect_b32 s40, 0, s40
    v_exp_f32 v8, v56
    v_add_f32 v245, v245, v14
    v_add_f32 v3, v3, v244
    s_waitcnt lgkmcnt(4)
    v_mfma_f32_32x32x16_bf16 v[32:47], v[108:111], v[140:143], v[32:47]
    ds_read_b128 v[108:111], v2 offset:31744
    v_exp_f32 v9, v57
    v_add_f32 v245, v245, v15
    v_cvt_pk_bf16_f32 v75, v14, v15
    v_mfma_f32_32x32x16_bf16 v[176:191], v[80:83], v[64:67], v[176:191]
    v_add_u32 v2, s40, v1
    ds_read_b128 v[80:83], v2 offset:0
    v_exp_f32 v10, v58
    v_add_f32 v245, v245, v8
    v_mfma_f32_32x32x16_bf16 v[192:207], v[84:87], v[64:67], v[192:207]
    ds_read_b128 v[84:87], v2 offset:1024
    v_exp_f32 v11, v59
    v_add_f32 v245, v245, v9
    v_cvt_pk_bf16_f32 v76, v8, v9
    v_mfma_f32_32x32x16_bf16 v[208:223], v[88:91], v[64:67], v[208:223]
    ds_read_b128 v[88:91], v2 offset:2048
    v_exp_f32 v12, v60
    v_add_f32 v245, v245, v10
    s_waitcnt lgkmcnt(4)
    v_mfma_f32_32x32x16_bf16 v[224:239], v[92:95], v[64:67], v[224:239]
    ds_read_b128 v[92:95], v2 offset:3072
    v_exp_f32 v13, v61
    v_add_f32 v245, v245, v11
    v_cvt_pk_bf16_f32 v77, v10, v11
    v_mfma_f32_32x32x16_bf16 v[176:191], v[96:99], v[68:71], v[176:191]
    ds_read_b128 v[96:99], v2 offset:4096
    v_exp_f32 v14, v62
    v_add_f32 v245, v245, v12
    v_mfma_f32_32x32x16_bf16 v[192:207], v[100:103], v[68:71], v[192:207]
    ds_read_b128 v[100:103], v2 offset:5120
    v_exp_f32 v15, v63
    v_add_f32 v245, v245, v13
    v_cvt_pk_bf16_f32 v78, v12, v13
    v_mfma_f32_32x32x16_bf16 v[208:223], v[104:107], v[68:71], v[208:223]
    ds_read_b128 v[104:107], v2 offset:6144
    v_add_f32 v245, v245, v14
    v_add_f32 v245, v245, v15
    v_cmp_nle_f32 vcc, v245, v241
    v_cvt_pk_bf16_f32 v79, v14, v15
    s_waitcnt lgkmcnt(4)
    v_mfma_f32_32x32x16_bf16 v[224:239], v[108:111], v[68:71], v[224:239]
    ds_read_b128 v[108:111], v2 offset:7168
    s_sub_u32 s41, s41, 1
    s_cmp_lg_u32 s41, 0
    s_cbranch_vccnz Lat_rs1
Lat_rb1:
    s_cbranch_scc1 Lat_plain
    s_cmp_eq_u32 s3, 0
    s_cbranch_scc1 Lat_t0
    s_cmp_eq_u32 s3, 1
    s_cbranch_scc1 Lat_t1
    s_cmp_eq_u32 s3, 2
    s_cbranch_scc1 Lat_t2
Lat_t3:
    v_mfma_f32_32x32x16_bf16 v[48:63], v[80:83], v[112:115], v[16:31]
    ds_read_b128 v[80:83], v2 offset:16384
    v_exp_f32 v8, v32
    v_exp_f32 v9, v33
    v_mfma_f32_32x32x16_bf16 v[48:63], v[84:87], v[116:119], v[48:63]
    ds_read_b128 v[84:87], v2 offset:17408
    v_exp_f32 v10, v34
    v_add_f32 v244, v8, v9
    v_cvt_pk_bf16_f32 v64, v8, v9
    v_mfma_f32_32x32x16_bf16 v[48:63], v[88:91], v[120:123], v[48:63]
    ds_read_b128 v[88:91], v2 offset:18432
    v_exp_f32 v11, v35
    v_exp_f32 v12, v36
    s_waitcnt lgkmcnt(4)
    v_mfma_f32_32x32x16_bf16 v[48:63], v[92:95], v[124:127], v[48:63]
    ds_read_b128 v[92:95], v2 offset:19456
    v_exp_f32 v13, v37
    v_add_f32 v244, v244, v10
    v_cvt_pk_bf16_f32 v65, v10, v11
    v_mfma_f32_32x32x16_bf16 v[48:63], v[96:99], v[128:131], v[48:63]
    ds_read_b128 v[96:99], v2 offset:20480
    v_exp_f32 v14, v38
    v_add_f32 v244, v244, v11
    v_add_f32 v244, v244, v12
    v_mfma_f32_32x32x16_bf16 v[48:63], v[100:103], v[132:135], v[48:63]
    ds_read_b128 v[100:103], v2 offset:21504
    v_exp_f32 v15, v39
    v_add_f32 v244, v244, v13
    v_cvt_pk_bf16_f32 v66, v12, v13
    v_mfma_f32_32x32x16_bf16 v[48:63], v[104:107], v[136:139], v[48:63]
    ds_read_b128 v[104:107], v2 offset:22528
    v_exp_f32 v8, v40
    v_add_f32 v244, v244, v14
    v_add_f32 v3, v3, v245
    s_waitcnt lgkmcnt(4)
    v_mfma_f32_32x32x16_bf16 v[48:63], v[108:111], v[140:143], v[48:63]
    ds_read_b128 v[108:111], v2 offset:23552
    v_exp_f32 v9, v41
    v_add_f32 v244, v244, v15
    v_cvt_pk_bf16_f32 v67, v14, v15
    v_mfma_f32_32x32x16_bf16 v[176:191], v[80:83], v[72:75], v[176:191]
    ds_read_b128 v[80:83], v2 offset:8192
    s_barrier
    v_exp_f32 v10, v42
    v_add_f32 v244, v244, v8
    v_mfma_f32_32x32x16_bf16 v[192:207], v[84:87], v[72:75], v[192:207]
    ds_read_b128 v[84:87], v2 offset:9216
    v_exp_f32 v11, v43
    v_add_f32 v244, v244, v9
    v_cvt_pk_bf16_f32 v68, v8, v9
    v_mfma_f32_32x32x16_bf16 v[208:223], v[88:91], v[72:75], v[208:223]
    ds_read_b128 v[88:91], v2 offset:10240
    v_exp_f32 v12, v44
    v_add_f32 v244, v244, v10
    s_waitcnt lgkmcnt(4)
    v_mfma_f32_32x32x16_bf16 v[224:239], v[92:95], v[72:75], v[224:239]
    ds_read_b128 v[92:95], v2 offset:11264
    v_exp_f32 v13, v45
    v_add_f32 v244, v244, v11
    v_cvt_pk_bf16_f32 v69, v10, v11
    v_mfma_f32_32x32x16_bf16 v[176:191], v[96:99], v[76:79], v[176:191]
    ds_read_b128 v[96:99], v2 offset:12288
    v_exp_f32 v14, v46
    v_add_f32 v244, v244, v12
    v_mfma_f32_32x32x16_bf16 v[192:207], v[100:103], v[76:79], v[192:207]
    ds_read_b128 v[100:103], v2 offset:13312
    v_exp_f32 v15, v47
    v_add_f32 v244, v244, v13
    v_cvt_pk_bf16_f32 v70, v12, v13
    v_mfma_f32_32x32x16_bf16 v[208:223], v[104:107], v[76:79], v[208:223]
    ds_read_b128 v[104:107], v2 offset:14336
    v_add_f32 v244, v244, v14
    v_add_f32 v244, v244, v15
    v_cmp_nle_f32 vcc, v244, v241
    v_cvt_pk_bf16_f32 v71, v14, v15
    s_waitcnt lgkmcnt(4)
    v_mfma_f32_32x32x16_bf16 v[224:239], v[108:111], v[76:79], v[224:239]
    ds_read_b128 v[108:111], v2 offset:15360
    s_cbranch_vccnz Lat_rs3_0
Lat_rb3_0:
    v_mfma_f32_32x32x16_bf16 v[32:47], v[80:83], v[112:115], v[16:31]
    ds_read_b128 v[80:83], v2 offset:24576
    v_exp_f32 v8, v48
    v_exp_f32 v9, v49
    v_mfma_f32_32x32x16_bf16 v[32:47], v[84:87], v[116:119], v[32:47]
    ds_read_b128 v[84:87], v2 offset:25600
    v_exp_f32 v10, v50
    v_add_f32 v245, v8, v9
    v_cvt_pk_bf16_f32 v72, v8, v9
    v_mfma_f32_32x32x16_bf16 v[32:47], v[88:91], v[120:123], v[32:47]
    ds_read_b128 v[88:91], v2 offset:26624
    v_exp_f32 v11, v51
    v_exp_f32 v12, v52
    s_waitcnt lgkmcnt(4)
    v_mfma_f32_32x32x16_bf16 v[32:47], v[92:95], v[124:127], v[32:47]
    ds_read_b128 v[92:95], v2 offset:27648
    v_exp_f32 v13, v53
    v_add_f32 v245, v245, v10
    v_cvt_pk_bf16_f32 v73, v10, v11
    v_mfma_f32_32x32x16_bf16 v[32:47], v[96:99], v[128:131], v[32:47]
    ds_read_b128 v[96:99], v2 offset:28672
    v_exp_f32 v14, v54
    v_add_f32 v245, v245, v11
    v_add_f32 v245, v245, v12
    v_mfma_f32_32x32x16_bf16 v[32:47], v[100:103], v[132:135], v[32:47]
    ds_read_b128 v[100:103], v2 offset:29696
    v_exp_f32 v15, v55
    v_add_f32 v245, v245, v13
    v_cvt_pk_bf16_f32 v74, v12, v13
    v_mfma_f32_32x32x16_bf16 v[32:47], v[104:107], v[136:139], v[32:47]
    ds_read_b128 v[104:107], v2 offset:30720
    s_add_u32 s40, s40, 32768
    s_cmp_eq_u32 s40, 163840
    s_cselect_b32 s40, 0, s40
    v_exp_f32 v8, v56
    v_add_f32 v245, v245, v14
    v_add_f32 v3, v3, v244
    s_waitcnt lgkmcnt(4)
    v_mfma_f32_32x32x16_bf16 v[32:47], v[108:111], v[140:143], v[32:47]
    ds_read_b128 v[108:111], v2 offset:31744
    v_exp_f32 v9, v57
    v_add_f32 v245, v245, v15
    v_cvt_pk_bf16_f32 v75, v14, v15
    v_mfma_f32_32x32x16_bf16 v[176:191], v[80:83], v[64:67], v[176:191]
    v_add_u32 v2, s40, v1
    ds_read_b128 v[80:83], v2 offset:0
    v_exp_f32 v10, v58
    v_add_f32 v245, v245, v8
    v_mfma_f32_32x32x16_bf16 v[192:207], v[84:87], v[64:67], v[192:207]
    ds_read_b128 v[84:87], v2 offset:1024
    v_exp_f32 v11, v59
    v_add_f32 v245, v245, v9
    v_cvt_pk_bf16_f32 v76, v8, v9
    v_mfma_f32_32x32x16_bf16 v[208:223], v[88:91], v[64:67], v[208:223]
    ds_read_b128 v[88:91], v2 offset:2048
    v_exp_f32 v12, v60
    v_add_f32 v245, v245, v10
    s_waitcnt lgkmcnt(4)
    v_mfma_f32_32x32x16_bf16 v[224:239], v[92:95], v[64:67], v[224:239]
    ds_read_b128 v[92:95], v2 offset:3072
    v_exp_f32 v13, v61
    v_add_f32 v245, v245, v11
    v_cvt_pk_bf16_f32 v77, v10, v11
    v_mfma_f32_32x32x16_bf16 v[176:191], v[96:99], v[68:71], v[176:191]
    ds_read_b128 v[96:99], v2 offset:4096
    v_exp_f32 v14, v62
    v_add_f32 v245, v245, v12
    v_mfma_f32_32x32x16_bf16 v[192:207], v[100:103], v[68:71], v[192:207]
    ds_read_b128 v[100:103], v2 offset:5120
    v_exp_f32 v15, v63
    v_add_f32 v245, v245, v13
    v_cvt_pk_bf16_f32 v78, v12, v13
    v_mfma_f32_32x32x16_bf16 v[208:223], v[104:107], v[68:71], v[208:223]
    ds_read_b128 v[104:107], v2 offset:6144
    v_add_f32 v245, v245, v14
    v_add_f32 v245, v245, v15
    v_cmp_nle_f32 vcc, v245, v241
    v_cvt_pk_bf16_f32 v79, v14, v15
    s_waitcnt lgkmcnt(4)
    v_mfma_f32_32x32x16_bf16 v[224:239], v[108:111], v[68:71], v[224:239]
    ds_read_b128 v[108:111], v2 offset:7168
    s_cbranch_vccnz Lat_rs3_1
Lat_rb3_1:
Lat_t3b:
    v_mfma_f32_32x32x16_bf16 v[48:63], v[80:83], v[112:115], v[16:31]
    ds_read_b128 v[80:83], v2 offset:16384
    v_exp_f32 v8, v32
    v_exp_f32 v9, v33
    v_mfma_f32_32x32x16_bf16 v[48:63], v[84:87], v[116:119], v[48:63]
    ds_read_b128 v[84:87], v2 offset:17408
    v_exp_f32 v10, v34
    v_add_f32 v244, v8, v9
    v_cvt_pk_bf16_f32 v64, v8, v9
    v_mfma_f32_32x32x16_bf16 v[48:63], v[88:91], v[120:123], v[48:63]
    ds_read_b128 v[88:91], v2 offset:18432
    v_exp_f32 v11, v35
    v_exp_f32 v12, v36
    s_waitcnt lgkmcnt(4)
    v_mfma_f32_32x32x16_bf16 v[48:63], v[92:95], v[124:127], v[48:63]
    ds_read_b128 v[92:95], v2 offset:19456
    v_exp_f32 v13, v37
    v_add_f32 v244, v244, v10
    v_cvt_pk_bf16_f32 v65, v10, v11
    v_mfma_f32_32x32x16_bf16 v[48:63], v[96:99], v[128:131], v[48:63]
    ds_read_b128 v[96:99], v2 offset:20480
    v_exp_f32 v14, v38
    v_add_f32 v244, v244, v11
    v_add_f32 v244, v244, v12
    v_mfma_f32_32x32x16_bf16 v[48:63], v[100:103], v[132:135], v[48:63]
    ds_read_b128 v[100:103], v2 offset:21504
    v_exp_f32 v15, v39
    v_add_f32 v244, v244, v13
    v_cvt_pk_bf16_f32 v66, v12, v13
    v_mfma_f32_32x32x16_bf16 v[48:63], v[104:107], v[136:139], v[48:63]
    ds_read_b128 v[104:107], v2 offset:22528
    v_exp_f32 v8, v40
    v_add_f32 v244, v244, v14
    v_add_f32 v3, v3, v245
    s_waitcnt lgkmcnt(4)
    v_mfma_f32_32x32x16_bf16 v[48:63], v[108:111], v[140:143], v[48:63]
    ds_read_b128 v[108:111], v2 offset:23552
    v_exp_f32 v9, v41
    v_add_f32 v244, v244, v15
    v_cvt_pk_bf16_f32 v67, v14, v15
    v_mfma_f32_32x32x16_bf16 v[176:191], v[80:83], v[72:75], v[176:191]
    ds_read_b128 v[80:83], v2 offset:8192
    s_barrier
    v_exp_f32 v10, v42
    v_add_f32 v244, v244, v8
    v_mfma_f32_32x32x16_bf16 v[192:207], v[84:87], v[72:75], v[192:207]
    ds_read_b128 v[84:87], v2 offset:9216
    v_exp_f32 v11, v43
    v_add_f32 v244, v244, v9
    v_cvt_pk_bf16_f32 v68, v8, v9
    v_mfma_f32_32x32x16_bf16 v[208:223], v[88:91], v[72:75], v[208:223]
    ds_read_b128 v[88:91], v2 offset:10240
    v_exp_f32 v12, v44
    v_add_f32 v244, v244, v10
    s_waitcnt lgkmcnt(4)
    v_mfma_f32_32x32x16_bf16 v[224:239], v[92:95], v[72:75], v[224:239]
    ds_read_b128 v[92:95], v2 offset:11264
    v_exp_f32 v13, v45
    v_add_f32 v244, v244, v11
    v_cvt_pk_bf16_f32 v69, v10, v11
    v_mfma_f32_32x32x16_bf16 v[176:191], v[96:99], v[76:79], v[176:191]
    ds_read_b128 v[96:99], v2 offset:12288
    v_exp_f32 v14, v46
    v_add_f32 v244, v244, v12
    v_mfma_f32_32x32x16_bf16 v[192:207], v[100:103], v[76:79], v[192:207]
    ds_read_b128 v[100:103], v2 offset:13312
    v_exp_f32 v15, v47
    v_add_f32 v244, v244, v13
    v_cvt_pk_bf16_f32 v70, v12, v13
    v_mfma_f32_32x32x16_bf16 v[208:223], v[104:107], v[76:79], v[208:223]
    ds_read_b128 v[104:107], v2 offset:14336
    v_add_f32 v244, v244, v14
    v_add_f32 v244, v244, v15
    v_cmp_nle_f32 vcc, v244, v241
    v_cvt_pk_bf16_f32 v71, v14, v15
    s_waitcnt lgkmcnt(4)
    v_mfma_f32_32x32x16_bf16 v[224:239], v[108:111], v[76:79], v[224:239]
    ds_read_b128 v[108:111], v2 offset:15360
    s_cbranch_vccnz Lat_rs3_2
Lat_rb3_2:
    v_mfma_f32_32x32x16_bf16 v[32:47], v[80:83], v[112:115], v[16:31]
    ds_read_b128 v[80:83], v2 offset:24576
    v_exp_f32 v8, v48
    v_exp_f32 v9, v49
    v_mfma_f32_32x32x16_bf16 v[32:47], v[84:87], v[116:119], v[32:47]
    ds_read_b128 v[84:87], v2 offset:25600
    v_exp_f32 v10, v50
    v_add_f32 v245, v8, v9
    v_cvt_pk_bf16_f32 v72, v8, v9
    v_mfma_f32_32x32x16_bf16 v[32:47], v[88:91], v[120:123], v[32:47]
    ds_read_b128 v[88:91], v2 offset:26624
    v_exp_f32 v11, v51
    v_exp_f32 v12, v52
    s_waitcnt lgkmcnt(4)
    v_mfma_f32_32x32x16_bf16 v[32:47], v[92:95], v[124:127], v[32:47]
    ds_read_b128 v[92:95], v2 offset:27648
    v_exp_f32 v13, v53
    v_add_f32 v245, v245, v10
    v_cvt_pk_bf16_f32 v73, v10, v11
    v_mfma_f32_32x32x16_bf16 v[32:47], v[96:99], v[128:131], v[32:47]
    ds_read_b128 v[96:99], v2 offset:28672
    v_exp_f32 v14, v54
    v_add_f32 v245, v245, v11
    v_add_f32 v245, v245, v12
    v_mfma_f32_32x32x16_bf16 v[32:47], v[100:103], v[132:135], v[32:47]
    ds_read_b128 v[100:103], v2 offset:29696
    v_exp_f32 v15, v55
    v_add_f32 v245, v245, v13
    v_cvt_pk_bf16_f32 v74, v12, v13
    v_mfma_f32_32x32x16_bf16 v[32:47], v[104:107], v[136:139], v[32:47]
    ds_read_b128 v[104:107], v2 offset:30720
    s_add_u32 s40, s40, 32768
    s_cmp_eq_u32 s40, 163840
    s_cselect_b32 s40, 0, s40
    v_exp_f32 v8, v56
    v_add_f32 v245, v245, v14
    v_add_f32 v3, v3, v244
    s_waitcnt lgkmcnt(4)
    v_mfma_f32_32x32x16_bf16 v[32:47], v[108:111], v[140:143], v[32:47]
    ds_read_b128 v[108:111], v2 offset:31744
    v_exp_f32 v9, v57
    v_add_f32 v245, v245, v15
    v_cvt_pk_bf16_f32 v75, v14, v15
    v_mfma_f32_32x32x16_bf16 v[176:191], v[80:83], v[64:67], v[176:191]
    v_add_u32 v2, s40, v1
    ds_read_b128 v[80:83], v2 offset:0
    v_exp_f32 v10, v58
    v_add_f32 v245, v245, v8
    v_min_f32 v16, v6, v5
    v_add_f32 v17, 0xf1800000, v6
    v_min_f32 v17, v17, v5
    v_add_f32 v18, 0xf2000000, v6
    v_mfma_f32_32x32x16_bf16 v[192:207], v[84:87], v[64:67], v[192:207]
    ds_read_b128 v[84:87], v2 offset:1024
    v_exp_f32 v11, v59
    v_add_f32 v245, v245, v9
    v_cvt_pk_bf16_f32 v76, v8, v9
    v_min_f32 v18, v18, v5
    v_add_f32 v19, 0xf2400000, v6
    v_min_f32 v19, v19, v5
    v_add_f32 v20, 0xf3000000, v6
    v_mfma_f32_32x32x16_bf16 v[208:223], v[88:91], v[64:67], v[208:223]
    ds_read_b128 v[88:91], v2 offset:2048
    v_exp_f32 v12, v60
    v_add_f32 v245, v245, v10
    v_min_f32 v20, v20, v5
    v_add_f32 v21, 0xf3100000, v6
    v_min_f32 v21, v21, v5
    v_add_f32 v22, 0xf3200000, v6
    s_waitcnt lgkmcnt(4)
    v_mfma_f32_32x32x16_bf16 v[224:239], v[92:95], v[64:67], v[224:239]
    ds_read_b128 v[92:95], v2 offset:3072
    v_exp_f32 v13, v61
    v_add_f32 v245, v245, v11
    v_cvt_pk_bf16_f32 v77, v10, v11
    v_min_f32 v22, v22, v5
    v_add_f32 v23, 0xf3300000, v6
    v_min_f32 v23, v23, v5
    v_add_f32 v24, 0xf3800000, v6
    v_mfma_f32_32x32x16_bf16 v[176:191], v[96:99], v[68:71], v[176:191]
    ds_read_b128 v[96:99], v2 offset:4096
    v_exp_f32 v14, v62
    v_add_f32 v245, v245, v12
    v_min_f32 v24, v24, v5
    v_add_f32 v25, 0xf3880000, v6
    v_min_f32 v25, v25, v5
    v_add_f32 v26, 0xf3900000, v6
    v_mfma_f32_32x32x16_bf16 v[192:207], v[100:103], v[68:71], v[192:207]
    ds_read_b128 v[100:103], v2 offset:5120
    v_exp_f32 v15, v63
    v_add_f32 v245, v245, v13
    v_cvt_pk_bf16_f32 v78, v12, v13
    v_min_f32 v26, v26, v5
    v_add_f32 v27, 0xf3980000, v6
    v_min_f32 v27, v27, v5
    v_add_f32 v28, 0xf3c00000, v6
    v_mfma_f32_32x32x16_bf16 v[208:223], v[104:107], v[68:71], v[208:223]
    ds_read_b128 v[104:107], v2 offset:6144
    v_add_f32 v245, v245, v14
    v_add_f32 v245, v245, v15
    v_cmp_nle_f32 vcc, v245, v241
    v_cvt_pk_bf16_f32 v79, v14, v15
    v_min_f32 v28, v28, v5
    v_add_f32 v29, 0xf3c80000, v6
    v_min_f32 v29, v29, v5
    v_add_f32 v30, 0xf3d00000, v6
    s_waitcnt lgkmcnt(4)
    v_mfma_f32_32x32x16_bf16 v[224:239], v[108:111], v[68:71], v[224:239]
    ds_read_b128 v[108:111], v2 offset:7168
    v_min_f32 v30, v30, v5
    v_add_f32 v31, 0xf3d80000, v6
    v_min_f32 v31, v31, v5
    v_add_f32 v6, 0xf4000000, v6
    s_cbranch_vccnz Lat_rs3_3
Lat_rb3_3:
    v_mfma_f32_32x32x16_bf16 v[48:63], v[80:83], v[112:115], v[16:31]
    ds_read_b128 v[80:83], v2 offset:16384
    v_exp_f32 v8, v32
    v_exp_f32 v9, v33
    v_mfma_f32_32x32x16_bf16 v[48:63], v[84:87], v[116:119], v[48:63]
    ds_read_b128 v[84:87], v2 offset:17408
    v_exp_f32 v10, v34
    v_add_f32 v244, v8, v9
    v_cvt_pk_bf16_f32 v64, v8, v9
    v_mfma_f32_32x32x16_bf16 v[48:63], v[88:91], v[120:123], v[48:63]
    ds_read_b128 v[88:91], v2 offset:18432
    v_exp_f32 v11, v35
    v_exp_f32 v12, v36
    s_waitcnt lgkmcnt(4)
    v_mfma_f32_32x32x16_bf16 v[48:63], v[92:95], v[124:127], v[48:63]
    ds_read_b128 v[92:95], v2 offset:19456
    v_exp_f32 v13, v37
    v_add_f32 v244, v244, v10
    v_cvt_pk_bf16_f32 v65, v10, v11
    v_mfma_f32_32x32x16_bf16 v[48:63], v[96:99], v[128:131], v[48:63]
    ds_read_b128 v[96:99], v2 offset:20480
    v_exp_f32 v14, v38
    v_add_f32 v244, v244, v11
    v_add_f32 v244, v244, v12
    v_mfma_f32_32x32x16_bf16 v[48:63], v[100:103], v[132:135], v[48:63]
    ds_read_b128 v[100:103], v2 offset:21504
    v_exp_f32 v15, v39
    v_add_f32 v244, v244, v13
    v_cvt_pk_bf16_f32 v66, v12, v13
    v_mfma_f32_32x32x16_bf16 v[48:63], v[104:107], v[136:139], v[48:63]
    ds_read_b128 v[104:107], v2 offset:22528
    v_exp_f32 v8, v40
    v_add_f32 v244, v244, v14
    v_add_f32 v3, v3, v245
    s_waitcnt lgkmcnt(4)
    v_mfma_f32_32x32x16_bf16 v[48:63], v[108:111], v[140:143], v[48:63]
    ds_read_b128 v[108:111], v2 offset:23552
    v_exp_f32 v9, v41
    v_add_f32 v244, v244, v15
    v_cvt_pk_bf16_f32 v67, v14, v15
    v_mfma_f32_32x32x16_bf16 v[176:191], v[80:83], v[72:75], v[176:191]
    ds_read_b128 v[80:83], v2 offset:24576
    s_barrier
    v_exp_f32 v10, v42
    v_add_f32 v244, v244, v8
    v_mfma_f32_32x32x16_bf16 v[192:207], v[84:87], v[72:75], v[192:207]
    ds_read_b128 v[84:87], v2 offset:25600
    v_exp_f32 v11, v43
    v_add_f32 v244, v244, v9
    v_cvt_pk_bf16_f32 v68, v8, v9
    v_mfma_f32_32x32x16_bf16 v[208:223], v[88:91], v[72:75], v[208:223]
    ds_read_b128 v[88:91], v2 offset:26624
    v_exp_f32 v12, v44
    v_add_f32 v244, v244, v10
    s_waitcnt lgkmcnt(4)
    v_mfma_f32_32x32x16_bf16 v[224:239], v[92:95], v[72:75], v[224:239]
    ds_read_b128 v[92:95], v2 offset:27648
    v_exp_f32 v13, v45
    v_add_f32 v244, v244, v11
    v_cvt_pk_bf16_f32 v69, v10, v11
    v_mfma_f32_32x32x16_bf16 v[176:191], v[96:99], v[76:79], v[176:191]
    ds_read_b128 v[96:99], v2 offset:28672
    v_exp_f32 v14, v46
    v_add_f32 v244, v244, v12
    v_mfma_f32_32x32x16_bf16 v[192:207], v[100:103], v[76:79], v[192:207]
    ds_read_b128 v[100:103], v2 offset:29696
    v_exp_f32 v15, v47
    v_add_f32 v244, v244, v13
    v_cvt_pk_bf16_f32 v70, v12, v13
    v_mfma_f32_32x32x16_bf16 v[208:223], v[104:107], v[76:79], v[208:223]
    ds_read_b128 v[104:107], v2 offset:30720
    v_add_f32 v244, v244, v14
    v_add_f32 v244, v244, v15
    v_cmp_nle_f32 vcc, v244, v241
    v_cvt_pk_bf16_f32 v71, v14, v15
    s_waitcnt lgkmcnt(4)
    v_mfma_f32_32x32x16_bf16 v[224:239], v[108:111], v[76:79], v[224:239]
    ds_read_b128 v[108:111], v2 offset:31744
    s_cbranch_vccnz Lat_rs3_4
Lat_rb3_4:
    v_mfma_f32_32x32x16_bf16 v[176:191], v[80:83], v[64:67], v[176:191]
    s_add_u32 s40, s40, 32768
    s_cmp_eq_u32 s40, 163840
    s_cselect_b32 s40, 0, s40
    v_add_u32 v2, s40, v1
    ds_read_b128 v[80:83], v2 offset:16384
    v_exp_f32 v8, v48
    v_exp_f32 v9, v49
    v_exp_f32 v10, v50
    v_add_f32 v3, v3, v244
    v_mfma_f32_32x32x16_bf16 v[192:207], v[84:87], v[64:67], v[192:207]
    ds_read_b128 v[84:87], v2 offset:17408
    v_exp_f32 v11, v51
    v_add_f32 v245, v8, v9
    v_cvt_pk_bf16_f32 v72, v8, v9
    v_add_f32 v245, v245, v10
    v_exp_f32 v12, v52
    v_mfma_f32_32x32x16_bf16 v[208:223], v[88:91], v[64:67], v[208:223]
    ds_read_b128 v[88:91], v2 offset:18432
    v_exp_f32 v13, v53
    v_add_f32 v245, v245, v11
    v_cvt_pk_bf16_f32 v73, v10, v11
    v_add_f32 v245, v245, v12
    v_exp_f32 v14, v54
    s_waitcnt lgkmcnt(4)
    v_mfma_f32_32x32x16_bf16 v[224:239], v[92:95], v[64:67], v[224:239]
    ds_read_b128 v[92:95], v2 offset:19456
    v_exp_f32 v15, v55
    v_add_f32 v245, v245, v13
    v_cvt_pk_bf16_f32 v74, v12, v13
    v_add_f32 v245, v245, v14
    v_exp_f32 v8, v56
    v_mfma_f32_32x32x16_bf16 v[176:191], v[96:99], v[68:71], v[176:191]
    ds_read_b128 v[96:99], v2 offset:20480
    v_exp_f32 v9, v57
    v_add_f32 v245, v245, v15
    v_cvt_pk_bf16_f32 v75, v14, v15
    v_add_f32 v245, v245, v8
    v_exp_f32 v10, v58
    v_mfma_f32_32x32x16_bf16 v[192:207], v[100:103], v[68:71], v[192:207]
    ds_read_b128 v[100:103], v2 offset:21504
    v_exp_f32 v11, v59
    v_add_f32 v245, v245, v9
    v_cvt_pk_bf16_f32 v76, v8, v9
    v_add_f32 v245, v245, v10
    v_exp_f32 v12, v60
    v_mfma_f32_32x32x16_bf16 v[208:223], v[104:107], v[68:71], v[208:223]
    ds_read_b128 v[104:107], v2 offset:22528
    v_exp_f32 v13, v61
    v_add_f32 v245, v245, v11
    v_cvt_pk_bf16_f32 v77, v10, v11
    v_add_f32 v245, v245, v12
    v_exp_f32 v14, v62
    s_waitcnt lgkmcnt(4)
    v_mfma_f32_32x32x16_bf16 v[224:239], v[108:111], v[68:71], v[224:239]
    ds_read_b128 v[108:111], v2 offset:23552
    v_exp_f32 v15, v63
    v_add_f32 v245, v245, v13
    v_add_f32 v245, v245, v14
    v_cvt_pk_bf16_f32 v78, v12, v13
    v_add_f32 v245, v245, v15
    v_cmp_nle_f32 vcc, v245, v241
    v_cvt_pk_bf16_f32 v79, v14, v15
    s_cbranch_vccnz Lat_rs3_5
Lat_rb3_5:
    s_barrier
    v_mfma_f32_32x32x16_bf16 v[176:191], v[80:83], v[72:75], v[176:191]
    ds_read_b128 v[80:83], v2 offset:8192
    v_mov_b64 v[112:113], v[144:145]
    v_mov_b64 v[114:115], v[146:147]
    v_mfma_f32_32x32x16_bf16 v[192:207], v[84:87], v[72:75], v[192:207]
    ds_read_b128 v[84:87], v2 offset:9216
    v_mov_b64 v[116:117], v[148:149]
    v_mov_b64 v[118:119], v[150:151]
    v_mfma_f32_32x32x16_bf16 v[208:223], v[88:91], v[72:75], v[208:223]
    ds_read_b128 v[88:91], v2 offset:10240
    v_mov_b64 v[120:121], v[152:153]
    v_mov_b64 v[122:123], v[154:155]
    s_waitcnt lgkmcnt(4)
    v_mfma_f32_32x32x16_bf16 v[224:239], v[92:95], v[72:75], v[224:239]
    ds_read_b128 v[92:95], v2 offset:11264
    v_mov_b64 v[124:125], v[156:157]
    v_mov_b64 v[126:127], v[158:159]
    v_mfma_f32_32x32x16_bf16 v[176:191], v[96:99], v[76:79], v[176:191]
    ds_read_b128 v[96:99], v2 offset:12288
    v_mov_b64 v[128:129], v[160:161]
    v_mov_b64 v[130:131], v[162:163]
    v_mfma_f32_32x32x16_bf16 v[192:207], v[100:103], v[76:79], v[192:207]
    ds_read_b128 v[100:103], v2 offset:13312
    v_mov_b64 v[132:133], v[164:165]
    v_mov_b64 v[134:135], v[166:167]
    v_mfma_f32_32x32x16_bf16 v[208:223], v[104:107], v[76:79], v[208:223]
    ds_read_b128 v[104:107], v2 offset:14336
    v_mov_b64 v[136:137], v[168:169]
    v_mov_b64 v[138:139], v[170:171]
    s_waitcnt lgkmcnt(4)
    v_mfma_f32_32x32x16_bf16 v[224:239], v[108:111], v[76:79], v[224:239]
    ds_read_b128 v[108:111], v2 offset:15360
    v_mov_b64 v[140:141], v[172:173]
    v_mov_b64 v[142:143], v[174:175]
    v_add_f32 v3, v3, v245
    s_branch Lat_tend
Lat_t0:
    v_mfma_f32_32x32x16_bf16 v[48:63], v[80:83], v[112:115], v[16:31]
    ds_read_b128 v[80:83], v2 offset:16384
    v_exp_f32 v8, v32
    v_exp_f32 v9, v33
    v_mfma_f32_32x32x16_bf16 v[48:63], v[84:87], v[116:119], v[48:63]
    ds_read_b128 v[84:87], v2 offset:17408
    v_exp_f32 v10, v34
    v_add_f32 v244, v8, v9
    v_cvt_pk_bf16_f32 v64, v8, v9
    v_mfma_f32_32x32x16_bf16 v[48:63], v[88:91], v[120:123], v[48:63]
    ds_read_b128 v[88:91], v2 offset:18432
    v_exp_f32 v11, v35
    v_exp_f32 v12, v36
    s_waitcnt lgkmcnt(4)
    v_mfma_f32_32x32x16_bf16 v[48:63], v[92:95], v[124:127], v[48:63]
    ds_read_b128 v[92:95], v2 offset:19456
    v_exp_f32 v13, v37
    v_add_f32 v244, v244, v10
    v_cvt_pk_bf16_f32 v65, v10, v11
    v_mfma_f32_32x32x16_bf16 v[48:63], v[96:99], v[128:131], v[48:63]
    ds_read_b128 v[96:99], v2 offset:20480
    v_exp_f32 v14, v38
    v_add_f32 v244, v244, v11
    v_add_f32 v244, v244, v12
    v_mfma_f32_32x32x16_bf16 v[48:63], v[100:103], v[132:135], v[48:63]
    ds_read_b128 v[100:103], v2 offset:21504
    v_exp_f32 v15, v39
    v_add_f32 v244, v244, v13
    v_cvt_pk_bf16_f32 v66, v12, v13
    v_mfma_f32_32x32x16_bf16 v[48:63], v[104:107], v[136:139], v[48:63]
    ds_read_b128 v[104:107], v2 offset:22528
    v_exp_f32 v8, v40
    v_add_f32 v244, v244, v14
    v_add_f32 v3, v3, v245
    s_waitcnt lgkmcnt(4)
    v_mfma_f32_32x32x16_bf16 v[48:63], v[108:111], v[140:143], v[48:63]
    ds_read_b128 v[108:111], v2 offset:23552
    v_exp_f32 v9, v41
    v_add_f32 v244, v244, v15
    v_cvt_pk_bf16_f32 v67, v14, v15
    v_mfma_f32_32x32x16_bf16 v[176:191], v[80:83], v[72:75], v[176:191]
    ds_read_b128 v[80:83], v2 offset:8192
    s_barrier
    v_exp_f32 v10, v42
    v_add_f32 v244, v244, v8
    v_min_f32 v16, v6, v5
    v_add_f32 v17, 0xf1800000, v6
    v_min_f32 v17, v17, v5
    v_add_f32 v18, 0xf2000000, v6
    v_mfma_f32_32x32x16_bf16 v[192:207], v[84:87], v[72:75], v[192:207]
    ds_read_b128 v[84:87], v2 offset:9216
    v_exp_f32 v11, v43
    v_add_f32 v244, v244, v9
    v_cvt_pk_bf16_f32 v68, v8, v9
    v_min_f32 v18, v18, v5
    v_add_f32 v19, 0xf2400000, v6
    v_min_f32 v19, v19, v5
    v_add_f32 v20, 0xf3000000, v6
    v_mfma_f32_32x32x16_bf16 v[208:223], v[88:91], v[72:75], v[208:223]
    ds_read_b128 v[88:91], v2 offset:10240
    v_exp_f32 v12, v44
    v_add_f32 v244, v244, v10
    v_min_f32 v20, v20, v5
    v_add_f32 v21, 0xf3100000, v6
    v_min_f32 v21, v21, v5
    v_add_f32 v22, 0xf3200000, v6
    s_waitcnt lgkmcnt(4)
    v_mfma_f32_32x32x16_bf16 v[224:239], v[92:95], v[72:75], v[224:239]
    ds_read_b128 v[92:95], v2 offset:11264
    v_exp_f32 v13, v45
    v_add_f32 v244, v244, v11
    v_cvt_pk_bf16_f32 v69, v10, v11
    v_min_f32 v22, v22, v5
    v_add_f32 v23, 0xf3300000, v6
    v_min_f32 v23, v23, v5
    v_add_f32 v24, 0xf3800000, v6
    v_mfma_f32_32x32x16_bf16 v[176:191], v[96:99], v[76:79], v[176:191]
    ds_read_b128 v[96:99], v2 offset:12288
    v_exp_f32 v14, v46
    v_add_f32 v244, v244, v12
    v_min_f32 v24, v24, v5
    v_add_f32 v25, 0xf3880000, v6
    v_min_f32 v25, v25, v5
    v_add_f32 v26, 0xf3900000, v6
    v_mfma_f32_32x32x16_bf16 v[192:207], v[100:103], v[76:79], v[192:207]
    ds_read_b128 v[100:103], v2 offset:13312
    v_exp_f32 v15, v47
    v_add_f32 v244, v244, v13
    v_cvt_pk_bf16_f32 v70, v12, v13
    v_min_f32 v26, v26, v5
    v_add_f32 v27, 0xf3980000, v6
    v_min_f32 v27, v27, v5
    v_add_f32 v28, 0xf3c00000, v6
    v_mfma_f32_32x32x16_bf16 v[208:223], v[104:107], v[76:79], v[208:223]
    ds_read_b128 v[104:107], v2 offset:14336
    v_add_f32 v244, v244, v14
    v_add_f32 v244, v244, v15
    v_cmp_nle_f32 vcc, v244, v241
    v_cvt_pk_bf16_f32 v71, v14, v15
    v_min_f32 v28, v28, v5
    v_add_f32 v29, 0xf3c80000, v6
    v_min_f32 v29, v29, v5
    v_add_f32 v30, 0xf3d00000, v6
    s_waitcnt lgkmcnt(4)
    v_mfma_f32_32x32x16_bf16 v[224:239], v[108:111], v[76:79], v[224:239]
    ds_read_b128 v[108:111], v2 offset:15360
    v_min_f32 v30, v30, v5
    v_add_f32 v31, 0xf3d80000, v6
    v_min_f32 v31, v31, v5
    v_add_f32 v6, 0xf4000000, v6
    s_cbranch_vccnz Lat_rs0_0
Lat_rb0_0:
    v_mfma_f32_32x32x16_bf16 v[32:47], v[80:83], v[112:115], v[16:31]
    ds_read_b128 v[80:83], v2 offset:24576
    v_exp_f32 v8, v48
    v_exp_f32 v9, v49
    v_mfma_f32_32x32x16_bf16 v[32:47], v[84:87], v[116:119], v[32:47]
    ds_read_b128 v[84:87], v2 offset:25600
    v_exp_f32 v10, v50
    v_add_f32 v245, v8, v9
    v_cvt_pk_bf16_f32 v72, v8, v9
    v_mfma_f32_32x32x16_bf16 v[32:47], v[88:91], v[120:123], v[32:47]
    ds_read_b128 v[88:91], v2 offset:26624
    v_exp_f32 v11, v51
    v_exp_f32 v12, v52
    s_waitcnt lgkmcnt(4)
    v_mfma_f32_32x32x16_bf16 v[32:47], v[92:95], v[124:127], v[32:47]
    ds_read_b128 v[92:95], v2 offset:27648
    v_exp_f32 v13, v53
    v_add_f32 v245, v245, v10
    v_cvt_pk_bf16_f32 v73, v10, v11
    v_mfma_f32_32x32x16_bf16 v[32:47], v[96:99], v[128:131], v[32:47]
    ds_read_b128 v[96:99], v2 offset:28672
    v_exp_f32 v14, v54
    v_add_f32 v245, v245, v11
    v_add_f32 v245, v245, v12
    v_mfma_f32_32x32x16_bf16 v[32:47], v[100:103], v[132:135], v[32:47]
    ds_read_b128 v[100:103], v2 offset:29696
    v_exp_f32 v15, v55
    v_add_f32 v245, v245, v13
    v_cvt_pk_bf16_f32 v74, v12, v13
    v_mfma_f32_32x32x16_bf16 v[32:47], v[104:107], v[136:139], v[32:47]
    ds_read_b128 v[104:107], v2 offset:30720
    s_add_u32 s40, s40, 32768
    s_cmp_eq_u32 s40, 163840
    s_cselect_b32 s40, 0, s40
    v_exp_f32 v8, v56
    v_add_f32 v245, v245, v14
    v_add_f32 v3, v3, v244
    s_waitcnt lgkmcnt(4)
    v_mfma_f32_32x32x16_bf16 v[32:47], v[108:111], v[140:143], v[32:47]
    ds_read_b128 v[108:111], v2 offset:31744
    v_exp_f32 v9, v57
    v_add_f32 v245, v245, v15
    v_cvt_pk_bf16_f32 v75, v14, v15
    v_mfma_f32_32x32x16_bf16 v[176:191], v[80:83], v[64:67], v[176:191]
    v_add_u32 v2, s40, v1
    ds_read_b128 v[80:83], v2 offset:0
    v_exp_f32 v10, v58
    v_add_f32 v245, v245, v8
    v_mfma_f32_32x32x16_bf16 v[192:207], v[84:87], v[64:67], v[192:207]
    ds_read_b128 v[84:87], v2 offset:1024
    v_exp_f32 v11, v59
    v_add_f32 v245, v245, v9
    v_cvt_pk_bf16_f32 v76, v8, v9
    v_mfma_f32_32x32x16_bf16 v[208:223], v[88:91], v[64:67], v[208:223]
    ds_read_b128 v[88:91], v2 offset:2048
    v_exp_f32 v12, v60
    v_add_f32 v245, v245, v10
    s_waitcnt lgkmcnt(4)
    v_mfma_f32_32x32x16_bf16 v[224:239], v[92:95], v[64:67], v[224:239]
    ds_read_b128 v[92:95], v2 offset:3072
    v_exp_f32 v13, v61
    v_add_f32 v245, v245, v11
    v_cvt_pk_bf16_f32 v77, v10, v11
    v_mfma_f32_32x32x16_bf16 v[176:191], v[96:99], v[68:71], v[176:191]
    ds_read_b128 v[96:99], v2 offset:4096
    v_exp_f32 v14, v62
    v_add_f32 v245, v245, v12
    v_mfma_f32_32x32x16_bf16 v[192:207], v[100:103], v[68:71], v[192:207]
    ds_read_b128 v[100:103], v2 offset:5120
    v_exp_f32 v15, v63
    v_add_f32 v245, v245, v13
    v_cvt_pk_bf16_f32 v78, v12, v13
    v_mfma_f32_32x32x16_bf16 v[208:223], v[104:107], v[68:71], v[208:223]
    ds_read_b128 v[104:107], v2 offset:6144
    v_add_f32 v245, v245, v14
    v_add_f32 v245, v245, v15
    v_cmp_nle_f32 vcc, v245, v241
    v_cvt_pk_bf16_f32 v79, v14, v15
    s_waitcnt lgkmcnt(4)
    v_mfma_f32_32x32x16_bf16 v[224:239], v[108:111], v[68:71], v[224:239]
    ds_read_b128 v[108:111], v2 offset:7168
    s_cbranch_vccnz Lat_rs0_1
Lat_rb0_1:
Lat_t0b:
    s_barrier
    ds_read_b128 v[80:83], v2 offset:16384
    v_exp_f32 v8, v32
    v_exp_f32 v9, v33
    ds_read_b128 v[84:87], v2 offset:17408
    v_exp_f32 v10, v34
    v_add_f32 v244, v8, v9
    v_cvt_pk_bf16_f32 v64, v8, v9
    ds_read_b128 v[88:91], v2 offset:18432
    v_exp_f32 v11, v35
    v_exp_f32 v12, v36
    s_waitcnt lgkmcnt(4)
    ds_read_b128 v[92:95], v2 offset:19456
    v_exp_f32 v13, v37
    v_add_f32 v244, v244, v10
    v_cvt_pk_bf16_f32 v65, v10, v11
    ds_read_b128 v[96:99], v2 offset:20480
    v_exp_f32 v14, v38
    v_add_f32 v244, v244, v11
    v_add_f32 v244, v244, v12
    ds_read_b128 v[100:103], v2 offset:21504
    v_exp_f32 v15, v39
    v_add_f32 v244, v244, v13
    v_cvt_pk_bf16_f32 v66, v12, v13
    ds_read_b128 v[104:107], v2 offset:22528
    v_exp_f32 v8, v40
    v_add_f32 v244, v244, v14
    v_add_f32 v3, v3, v245
    s_waitcnt lgkmcnt(4)
    ds_read_b128 v[108:111], v2 offset:23552
    v_exp_f32 v9, v41
    v_add_f32 v244, v244, v15
    v_cvt_pk_bf16_f32 v67, v14, v15
    v_mfma_f32_32x32x16_bf16 v[176:191], v[80:83], v[72:75], v[176:191]
    ds_read_b128 v[80:83], v2 offset:8192
    v_exp_f32 v10, v42
    v_add_f32 v244, v244, v8
    v_mfma_f32_32x32x16_bf16 v[192:207], v[84:87], v[72:75], v[192:207]
    ds_read_b128 v[84:87], v2 offset:9216
    v_exp_f32 v11, v43
    v_add_f32 v244, v244, v9
    v_cvt_pk_bf16_f32 v68, v8, v9
    v_mfma_f32_32x32x16_bf16 v[208:223], v[88:91], v[72:75], v[208:223]
    ds_read_b128 v[88:91], v2 offset:10240
    v_exp_f32 v12, v44
    v_add_f32 v244, v244, v10
    s_waitcnt lgkmcnt(4)
    v_mfma_f32_32x32x16_bf16 v[224:239], v[92:95], v[72:75], v[224:239]
    ds_read_b128 v[92:95], v2 offset:11264
    v_exp_f32 v13, v45
    v_add_f32 v244, v244, v11
    v_cvt_pk_bf16_f32 v69, v10, v11
    v_mfma_f32_32x32x16_bf16 v[176:191], v[96:99], v[76:79], v[176:191]
    ds_read_b128 v[96:99], v2 offset:12288
    v_exp_f32 v14, v46
    v_add_f32 v244, v244, v12
    v_mfma_f32_32x32x16_bf16 v[192:207], v[100:103], v[76:79], v[192:207]
    ds_read_b128 v[100:103], v2 offset:13312
    v_exp_f32 v15, v47
    v_add_f32 v244, v244, v13
    v_cvt_pk_bf16_f32 v70, v12, v13
    v_mfma_f32_32x32x16_bf16 v[208:223], v[104:107], v[76:79], v[208:223]
    ds_read_b128 v[104:107], v2 offset:14336
    v_add_f32 v244, v244, v14
    v_add_f32 v244, v244, v15
    v_cmp_nle_f32 vcc, v244, v241
    v_cvt_pk_bf16_f32 v71, v14, v15
    s_waitcnt lgkmcnt(4)
    v_mfma_f32_32x32x16_bf16 v[224:239], v[108:111], v[76:79], v[224:239]
    ds_read_b128 v[108:111], v2 offset:15360
    s_cbranch_vccnz Lat_rs0_2
Lat_rb0_2:
    ds_read_b128 v[80:83], v2 offset:24576
    ds_read_b128 v[84:87], v2 offset:25600
    ds_read_b128 v[88:91], v2 offset:26624
    s_waitcnt lgkmcnt(4)
    ds_read_b128 v[92:95], v2 offset:27648
    ds_read_b128 v[96:99], v2 offset:28672
    ds_read_b128 v[100:103], v2 offset:29696
    ds_read_b128 v[104:107], v2 offset:30720
    s_add_u32 s40, s40, 32768
    s_cmp_eq_u32 s40, 163840
    s_cselect_b32 s40, 0, s40
    v_add_f32 v3, v3, v244
    s_waitcnt lgkmcnt(4)
    ds_read_b128 v[108:111], v2 offset:31744
    v_mfma_f32_32x32x16_bf16 v[176:191], v[80:83], v[64:67], v[176:191]
    v_add_u32 v2, s40, v1
    ds_read_b128 v[80:83], v2 offset:0
    v_mfma_f32_32x32x16_bf16 v[192:207], v[84:87], v[64:67], v[192:207]
    ds_read_b128 v[84:87], v2 offset:1024
    v_mfma_f32_32x32x16_bf16 v[208:223], v[88:91], v[64:67], v[208:223]
    ds_read_b128 v[88:91], v2 offset:2048
    s_waitcnt lgkmcnt(4)
    v_mfma_f32_32x32x16_bf16 v[224:239], v[92:95], v[64:67], v[224:239]
    ds_read_b128 v[92:95], v2 offset:3072
    v_mfma_f32_32x32x16_bf16 v[176:191], v[96:99], v[68:71], v[176:191]
    ds_read_b128 v[96:99], v2 offset:4096
    v_mfma_f32_32x32x16_bf16 v[192:207], v[100:103], v[68:71], v[192:207]
    ds_read_b128 v[100:103], v2 offset:5120
    v_mfma_f32_32x32x16_bf16 v[208:223], v[104:107], v[68:71], v[208:223]
    ds_read_b128 v[104:107], v2 offset:6144
    s_waitcnt lgkmcnt(4)
    v_mfma_f32_32x32x16_bf16 v[224:239], v[108:111], v[68:71], v[224:239]
    ds_read_b128 v[108:111], v2 offset:7168
    s_barrier
    ds_read_b128 v[80:83], v2 offset:16384
    ds_read_b128 v[84:87], v2 offset:17408
    ds_read_b128 v[88:91], v2 offset:18432
    s_waitcnt lgkmcnt(4)
    ds_read_b128 v[92:95], v2 offset:19456
    ds_read_b128 v[96:99], v2 offset:20480
    ds_read_b128 v[100:103], v2 offset:21504
    ds_read_b128 v[104:107], v2 offset:22528
    s_waitcnt lgkmcnt(4)
    ds_read_b128 v[108:111], v2 offset:23552
    ds_read_b128 v[80:83], v2 offset:24576
    ds_read_b128 v[84:87], v2 offset:25600
    ds_read_b128 v[88:91], v2 offset:26624
    s_waitcnt lgkmcnt(4)
    ds_read_b128 v[92:95], v2 offset:27648
    ds_read_b128 v[96:99], v2 offset:28672
    ds_read_b128 v[100:103], v2 offset:29696
    ds_read_b128 v[104:107], v2 offset:30720
    s_waitcnt lgkmcnt(4)
    ds_read_b128 v[108:111], v2 offset:31744
    s_add_u32 s40, s40, 32768
    s_cmp_eq_u32 s40, 163840
    s_cselect_b32 s40, 0, s40
    v_add_u32 v2, s40, v1
    ds_read_b128 v[80:83], v2 offset:16384
    ds_read_b128 v[84:87], v2 offset:17408
    ds_read_b128 v[88:91], v2 offset:18432
    s_waitcnt lgkmcnt(4)
    ds_read_b128 v[92:95], v2 offset:19456
    ds_read_b128 v[96:99], v2 offset:20480
    ds_read_b128 v[100:103], v2 offset:21504
    ds_read_b128 v[104:107], v2 offset:22528
    s_waitcnt lgkmcnt(4)
    ds_read_b128 v[108:111], v2 offset:23552
    s_barrier
    ds_read_b128 v[80:83], v2 offset:8192
    v_mov_b64 v[112:113], v[144:145]
    v_mov_b64 v[114:115], v[146:147]
    ds_read_b128 v[84:87], v2 offset:9216
    v_mov_b64 v[116:117], v[148:149]
    v_mov_b64 v[118:119], v[150:151]
    ds_read_b128 v[88:91], v2 offset:10240
    v_mov_b64 v[120:121], v[152:153]
    v_mov_b64 v[122:123], v[154:155]
    s_waitcnt lgkmcnt(4)
    ds_read_b128 v[92:95], v2 offset:11264
    v_mov_b64 v[124:125], v[156:157]
    v_mov_b64 v[126:127], v[158:159]
    ds_read_b128 v[96:99], v2 offset:12288
    v_mov_b64 v[128:129], v[160:161]
    v_mov_b64 v[130:131], v[162:163]
    ds_read_b128 v[100:103], v2 offset:13312
    v_mov_b64 v[132:133], v[164:165]
    v_mov_b64 v[134:135], v[166:167]
    ds_read_b128 v[104:107], v2 offset:14336
    v_mov_b64 v[136:137], v[168:169]
    v_mov_b64 v[138:139], v[170:171]
    s_waitcnt lgkmcnt(4)
    ds_read_b128 v[108:111], v2 offset:15360
    v_mov_b64 v[140:141], v[172:173]
    v_mov_b64 v[142:143], v[174:175]
    s_branch Lat_tend
Lat_t1:
    v_mfma_f32_32x32x16_bf16 v[48:63], v[80:83], v[112:115], v[16:31]
    ds_read_b128 v[80:83], v2 offset:16384
    v_exp_f32 v8, v32
    v_exp_f32 v9, v33
    v_mfma_f32_32x32x16_bf16 v[48:63], v[84:87], v[116:119], v[48:63]
    ds_read_b128 v[84:87], v2 offset:17408
    v_exp_f32 v10, v34
    v_add_f32 v244, v8, v9
    v_cvt_pk_bf16_f32 v64, v8, v9
    v_mfma_f32_32x32x16_bf16 v[48:63], v[88:91], v[120:123], v[48:63]
    ds_read_b128 v[88:91], v2 offset:18432
    v_exp_f32 v11, v35
    v_exp_f32 v12, v36
    s_waitcnt lgkmcnt(4)
    v_mfma_f32_32x32x16_bf16 v[48:63], v[92:95], v[124:127], v[48:63]
    ds_read_b128 v[92:95], v2 offset:19456
    v_exp_f32 v13, v37
    v_add_f32 v244, v244, v10
    v_cvt_pk_bf16_f32 v65, v10, v11
    v_mfma_f32_32x32x16_bf16 v[48:63], v[96:99], v[128:131], v[48:63]
    ds_read_b128 v[96:99], v2 offset:20480
    v_exp_f32 v14, v38
    v_add_f32 v244, v244, v11
    v_add_f32 v244, v244, v12
    v_mfma_f32_32x32x16_bf16 v[48:63], v[100:103], v[132:135], v[48:63]
    ds_read_b128 v[100:103], v2 offset:21504
    v_exp_f32 v15, v39
    v_add_f32 v244, v244, v13
    v_cvt_pk_bf16_f32 v66, v12, v13
    v_mfma_f32_32x32x16_bf16 v[48:63], v[104:107], v[136:139], v[48:63]
    ds_read_b128 v[104:107], v2 offset:22528
    v_exp_f32 v8, v40
    v_add_f32 v244, v244, v14
    v_add_f32 v3, v3, v245
    s_waitcnt lgkmcnt(4)
    v_mfma_f32_32x32x16_bf16 v[48:63], v[108:111], v[140:143], v[48:63]
    ds_read_b128 v[108:111], v2 offset:23552
    v_exp_f32 v9, v41
    v_add_f32 v244, v244, v15
    v_cvt_pk_bf16_f32 v67, v14, v15
    v_mfma_f32_32x32x16_bf16 v[176:191], v[80:83], v[72:75], v[176:191]
    ds_read_b128 v[80:83], v2 offset:8192
    s_barrier
    v_exp_f32 v10, v42
    v_add_f32 v244, v244, v8
    v_mfma_f32_32x32x16_bf16 v[192:207], v[84:87], v[72:75], v[192:207]
    ds_read_b128 v[84:87], v2 offset:9216
    v_exp_f32 v11, v43
    v_add_f32 v244, v244, v9
    v_cvt_pk_bf16_f32 v68, v8, v9
    v_mfma_f32_32x32x16_bf16 v[208:223], v[88:91], v[72:75], v[208:223]
    ds_read_b128 v[88:91], v2 offset:10240
    v_exp_f32 v12, v44
    v_add_f32 v244, v244, v10
    s_waitcnt lgkmcnt(4)
    v_mfma_f32_32x32x16_bf16 v[224:239], v[92:95], v[72:75], v[224:239]
    ds_read_b128 v[92:95], v2 offset:11264
    v_exp_f32 v13, v45
    v_add_f32 v244, v244, v11
    v_cvt_pk_bf16_f32 v69, v10, v11
    v_mfma_f32_32x32x16_bf16 v[176:191], v[96:99], v[76:79], v[176:191]
    ds_read_b128 v[96:99], v2 offset:12288
    v_exp_f32 v14, v46
    v_add_f32 v244, v244, v12
    v_mfma_f32_32x32x16_bf16 v[192:207], v[100:103], v[76:79], v[192:207]
    ds_read_b128 v[100:103], v2 offset:13312
    v_exp_f32 v15, v47
    v_add_f32 v244, v244, v13
    v_cvt_pk_bf16_f32 v70, v12, v13
    v_mfma_f32_32x32x16_bf16 v[208:223], v[104:107], v[76:79], v[208:223]
    ds_read_b128 v[104:107], v2 offset:14336
    v_add_f32 v244, v244, v14
    v_add_f32 v244, v244, v15
    v_cmp_nle_f32 vcc, v244, v241
    v_cvt_pk_bf16_f32 v71, v14, v15
    s_waitcnt lgkmcnt(4)
    v_mfma_f32_32x32x16_bf16 v[224:239], v[108:111], v[76:79], v[224:239]
    ds_read_b128 v[108:111], v2 offset:15360
    s_cbranch_vccnz Lat_rs1_0
Lat_rb1_0:
    v_mfma_f32_32x32x16_bf16 v[32:47], v[80:83], v[112:115], v[16:31]
    ds_read_b128 v[80:83], v2 offset:24576
    v_exp_f32 v8, v48
    v_exp_f32 v9, v49
    v_mfma_f32_32x32x16_bf16 v[32:47], v[84:87], v[116:119], v[32:47]
    ds_read_b128 v[84:87], v2 offset:25600
    v_exp_f32 v10, v50
    v_add_f32 v245, v8, v9
    v_cvt_pk_bf16_f32 v72, v8, v9
    v_mfma_f32_32x32x16_bf16 v[32:47], v[88:91], v[120:123], v[32:47]
    ds_read_b128 v[88:91], v2 offset:26624
    v_exp_f32 v11, v51
    v_exp_f32 v12, v52
    s_waitcnt lgkmcnt(4)
    v_mfma_f32_32x32x16_bf16 v[32:47], v[92:95], v[124:127], v[32:47]
    ds_read_b128 v[92:95], v2 offset:27648
    v_exp_f32 v13, v53
    v_add_f32 v245, v245, v10
    v_cvt_pk_bf16_f32 v73, v10, v11
    v_mfma_f32_32x32x16_bf16 v[32:47], v[96:99], v[128:131], v[32:47]
    ds_read_b128 v[96:99], v2 offset:28672
    v_exp_f32 v14, v54
    v_add_f32 v245, v245, v11
    v_add_f32 v245, v245, v12
    v_mfma_f32_32x32x16_bf16 v[32:47], v[100:103], v[132:135], v[32:47]
    ds_read_b128 v[100:103], v2 offset:29696
    v_exp_f32 v15, v55
    v_add_f32 v245, v245, v13
    v_cvt_pk_bf16_f32 v74, v12, v13
    v_mfma_f32_32x32x16_bf16 v[32:47], v[104:107], v[136:139], v[32:47]
    ds_read_b128 v[104:107], v2 offset:30720
    s_add_u32 s40, s40, 32768
    s_cmp_eq_u32 s40, 163840
    s_cselect_b32 s40, 0, s40
    v_exp_f32 v8, v56
    v_add_f32 v245, v245, v14
    v_add_f32 v3, v3, v244
    s_waitcnt lgkmcnt(4)
    v_mfma_f32_32x32x16_bf16 v[32:47], v[108:111], v[140:143], v[32:47]
    ds_read_b128 v[108:111], v2 offset:31744
    v_exp_f32 v9, v57
    v_add_f32 v245, v245, v15
    v_cvt_pk_bf16_f32 v75, v14, v15
    v_mfma_f32_32x32x16_bf16 v[176:191], v[80:83], v[64:67], v[176:191]
    v_add_u32 v2, s40, v1
    ds_read_b128 v[80:83], v2 offset:0
    v_exp_f32 v10, v58
    v_add_f32 v245, v245, v8
    v_min_f32 v16, v6, v5
    v_add_f32 v17, 0xf1800000, v6
    v_min_f32 v17, v17, v5
    v_add_f32 v18, 0xf2000000, v6
    v_mfma_f32_32x32x16_bf16 v[192:207], v[84:87], v[64:67], v[192:207]
    ds_read_b128 v[84:87], v2 offset:1024
    v_exp_f32 v11, v59
    v_add_f32 v245, v245, v9
    v_cvt_pk_bf16_f32 v76, v8, v9
    v_min_f32 v18, v18, v5
    v_add_f32 v19, 0xf2400000, v6
    v_min_f32 v19, v19, v5
    v_add_f32 v20, 0xf3000000, v6
    v_mfma_f32_32x32x16_bf16 v[208:223], v[88:91], v[64:67], v[208:223]
    ds_read_b128 v[88:91], v2 offset:2048
    v_exp_f32 v12, v60
    v_add_f32 v245, v245, v10
    v_min_f32 v20, v20, v5
    v_add_f32 v21, 0xf3100000, v6
    v_min_f32 v21, v21, v5
    v_add_f32 v22, 0xf3200000, v6
    s_waitcnt lgkmcnt(4)
    v_mfma_f32_32x32x16_bf16 v[224:239], v[92:95], v[64:67], v[224:239]
    ds_read_b128 v[92:95], v2 offset:3072
    v_exp_f32 v13, v61
    v_add_f32 v245, v245, v11
    v_cvt_pk_bf16_f32 v77, v10, v11
    v_min_f32 v22, v22, v5
    v_add_f32 v23, 0xf3300000, v6
    v_min_f32 v23, v23, v5
    v_add_f32 v24, 0xf3800000, v6
    v_mfma_f32_32x32x16_bf16 v[176:191], v[96:99], v[68:71], v[176:191]
    ds_read_b128 v[96:99], v2 offset:4096
    v_exp_f32 v14, v62
    v_add_f32 v245, v245, v12
    v_min_f32 v24, v24, v5
    v_add_f32 v25, 0xf3880000, v6
    v_min_f32 v25, v25, v5
    v_add_f32 v26, 0xf3900000, v6
    v_mfma_f32_32x32x16_bf16 v[192:207], v[100:103], v[68:71], v[192:207]
    ds_read_b128 v[100:103], v2 offset:5120
    v_exp_f32 v15, v63
    v_add_f32 v245, v245, v13
    v_cvt_pk_bf16_f32 v78, v12, v13
    v_min_f32 v26, v26, v5
    v_add_f32 v27, 0xf3980000, v6
    v_min_f32 v27, v27, v5
    v_add_f32 v28, 0xf3c00000, v6
    v_mfma_f32_32x32x16_bf16 v[208:223], v[104:107], v[68:71], v[208:223]
    ds_read_b128 v[104:107], v2 offset:6144
    v_add_f32 v245, v245, v14
    v_add_f32 v245, v245, v15
    v_cmp_nle_f32 vcc, v245, v241
    v_cvt_pk_bf16_f32 v79, v14, v15
    v_min_f32 v28, v28, v5
    v_add_f32 v29, 0xf3c80000, v6
    v_min_f32 v29, v29, v5
    v_add_f32 v30, 0xf3d00000, v6
    s_waitcnt lgkmcnt(4)
    v_mfma_f32_32x32x16_bf16 v[224:239], v[108:111], v[68:71], v[224:239]
    ds_read_b128 v[108:111], v2 offset:7168
    v_min_f32 v30, v30, v5
    v_add_f32 v31, 0xf3d80000, v6
    v_min_f32 v31, v31, v5
    v_add_f32 v6, 0xf4000000, v6
    s_cbranch_vccnz Lat_rs1_1
Lat_rb1_1:
Lat_t1b:
    v_mfma_f32_32x32x16_bf16 v[48:63], v[80:83], v[112:115], v[16:31]
    ds_read_b128 v[80:83], v2 offset:16384
    v_exp_f32 v8, v32
    v_exp_f32 v9, v33
    v_mfma_f32_32x32x16_bf16 v[48:63], v[84:87], v[116:119], v[48:63]
    ds_read_b128 v[84:87], v2 offset:17408
    v_exp_f32 v10, v34
    v_add_f32 v244, v8, v9
    v_cvt_pk_bf16_f32 v64, v8, v9
    v_mfma_f32_32x32x16_bf16 v[48:63], v[88:91], v[120:123], v[48:63]
    ds_read_b128 v[88:91], v2 offset:18432
    v_exp_f32 v11, v35
    v_exp_f32 v12, v36
    s_waitcnt lgkmcnt(4)
    v_mfma_f32_32x32x16_bf16 v[48:63], v[92:95], v[124:127], v[48:63]
    ds_read_b128 v[92:95], v2 offset:19456
    v_exp_f32 v13, v37
    v_add_f32 v244, v244, v10
    v_cvt_pk_bf16_f32 v65, v10, v11
    v_mfma_f32_32x32x16_bf16 v[48:63], v[96:99], v[128:131], v[48:63]
    ds_read_b128 v[96:99], v2 offset:20480
    v_exp_f32 v14, v38
    v_add_f32 v244, v244, v11
    v_add_f32 v244, v244, v12
    v_mfma_f32_32x32x16_bf16 v[48:63], v[100:103], v[132:135], v[48:63]
    ds_read_b128 v[100:103], v2 offset:21504
    v_exp_f32 v15, v39
    v_add_f32 v244, v244, v13
    v_cvt_pk_bf16_f32 v66, v12, v13
    v_mfma_f32_32x32x16_bf16 v[48:63], v[104:107], v[136:139], v[48:63]
    ds_read_b128 v[104:107], v2 offset:22528
    v_exp_f32 v8, v40
    v_add_f32 v244, v244, v14
    v_add_f32 v3, v3, v245
    s_waitcnt lgkmcnt(4)
    v_mfma_f32_32x32x16_bf16 v[48:63], v[108:111], v[140:143], v[48:63]
    ds_read_b128 v[108:111], v2 offset:23552
    v_exp_f32 v9, v41
    v_add_f32 v244, v244, v15
    v_cvt_pk_bf16_f32 v67, v14, v15
    v_mfma_f32_32x32x16_bf16 v[176:191], v[80:83], v[72:75], v[176:191]
    ds_read_b128 v[80:83], v2 offset:8192
    s_barrier
    v_exp_f32 v10, v42
    v_add_f32 v244, v244, v8
    v_mfma_f32_32x32x16_bf16 v[192:207], v[84:87], v[72:75], v[192:207]
    ds_read_b128 v[84:87], v2 offset:9216
    v_exp_f32 v11, v43
    v_add_f32 v244, v244, v9
    v_cvt_pk_bf16_f32 v68, v8, v9
    v_mfma_f32_32x32x16_bf16 v[208:223], v[88:91], v[72:75], v[208:223]
    ds_read_b128 v[88:91], v2 offset:10240
    v_exp_f32 v12, v44
    v_add_f32 v244, v244, v10
    s_waitcnt lgkmcnt(4)
    v_mfma_f32_32x32x16_bf16 v[224:239], v[92:95], v[72:75], v[224:239]
    ds_read_b128 v[92:95], v2 offset:11264
    v_exp_f32 v13, v45
    v_add_f32 v244, v244, v11
    v_cvt_pk_bf16_f32 v69, v10, v11
    v_mfma_f32_32x32x16_bf16 v[176:191], v[96:99], v[76:79], v[176:191]
    ds_read_b128 v[96:99], v2 offset:12288
    v_exp_f32 v14, v46
    v_add_f32 v244, v244, v12
    v_mfma_f32_32x32x16_bf16 v[192:207], v[100:103], v[76:79], v[192:207]
    ds_read_b128 v[100:103], v2 offset:13312
    v_exp_f32 v15, v47
    v_add_f32 v244, v244, v13
    v_cvt_pk_bf16_f32 v70, v12, v13
    v_mfma_f32_32x32x16_bf16 v[208:223], v[104:107], v[76:79], v[208:223]
    ds_read_b128 v[104:107], v2 offset:14336
    v_add_f32 v244, v244, v14
    v_add_f32 v244, v244, v15
    v_cmp_nle_f32 vcc, v244, v241
    v_cvt_pk_bf16_f32 v71, v14, v15
    s_waitcnt lgkmcnt(4)
    v_mfma_f32_32x32x16_bf16 v[224:239], v[108:111], v[76:79], v[224:239]
    ds_read_b128 v[108:111], v2 offset:15360
    s_cbranch_vccnz Lat_rs1_2
Lat_rb1_2:
    ds_read_b128 v[80:83], v2 offset:24576
    v_exp_f32 v8, v48
    v_exp_f32 v9, v49
    ds_read_b128 v[84:87], v2 offset:25600
    v_exp_f32 v10, v50
    v_add_f32 v245, v8, v9
    v_cvt_pk_bf16_f32 v72, v8, v9
    ds_read_b128 v[88:91], v2 offset:26624
    v_exp_f32 v11, v51
    v_exp_f32 v12, v52
    s_waitcnt lgkmcnt(4)
    ds_read_b128 v[92:95], v2 offset:27648
    v_exp_f32 v13, v53
    v_add_f32 v245, v245, v10
    v_cvt_pk_bf16_f32 v73, v10, v11
    ds_read_b128 v[96:99], v2 offset:28672
    v_exp_f32 v14, v54
    v_add_f32 v245, v245, v11
    v_add_f32 v245, v245, v12
    ds_read_b128 v[100:103], v2 offset:29696
    v_exp_f32 v15, v55
    v_add_f32 v245, v245, v13
    v_cvt_pk_bf16_f32 v74, v12, v13
    ds_read_b128 v[104:107], v2 offset:30720
    s_add_u32 s40, s40, 32768
    s_cmp_eq_u32 s40, 163840
    s_cselect_b32 s40, 0, s40
    v_exp_f32 v8, v56
    v_add_f32 v245, v245, v14
    v_add_f32 v3, v3, v244
    s_waitcnt lgkmcnt(4)
    ds_read_b128 v[108:111], v2 offset:31744
    v_exp_f32 v9, v57
    v_add_f32 v245, v245, v15
    v_cvt_pk_bf16_f32 v75, v14, v15
    v_mfma_f32_32x32x16_bf16 v[176:191], v[80:83], v[64:67], v[176:191]
    v_add_u32 v2, s40, v1
    ds_read_b128 v[80:83], v2 offset:0
    v_exp_f32 v10, v58
    v_add_f32 v245, v245, v8
    v_mfma_f32_32x32x16_bf16 v[192:207], v[84:87], v[64:67], v[192:207]
    ds_read_b128 v[84:87], v2 offset:1024
    v_exp_f32 v11, v59
    v_add_f32 v245, v245, v9
    v_cvt_pk_bf16_f32 v76, v8, v9
    v_mfma_f32_32x32x16_bf16 v[208:223], v[88:91], v[64:67], v[208:223]
    ds_read_b128 v[88:91], v2 offset:2048
    v_exp_f32 v12, v60
    v_add_f32 v245, v245, v10
    s_waitcnt lgkmcnt(4)
    v_mfma_f32_32x32x16_bf16 v[224:239], v[92:95], v[64:67], v[224:239]
    ds_read_b128 v[92:95], v2 offset:3072
    v_exp_f32 v13, v61
    v_add_f32 v245, v245, v11
    v_cvt_pk_bf16_f32 v77, v10, v11
    v_mfma_f32_32x32x16_bf16 v[176:191], v[96:99], v[68:71], v[176:191]
    ds_read_b128 v[96:99], v2 offset:4096
    v_exp_f32 v14, v62
    v_add_f32 v245, v245, v12
    v_mfma_f32_32x32x16_bf16 v[192:207], v[100:103], v[68:71], v[192:207]
    ds_read_b128 v[100:103], v2 offset:5120
    v_exp_f32 v15, v63
    v_add_f32 v245, v245, v13
    v_cvt_pk_bf16_f32 v78, v12, v13
    v_mfma_f32_32x32x16_bf16 v[208:223], v[104:107], v[68:71], v[208:223]
    ds_read_b128 v[104:107], v2 offset:6144
    v_add_f32 v245, v245, v14
    v_add_f32 v245, v245, v15
    v_cmp_nle_f32 vcc, v245, v241
    v_cvt_pk_bf16_f32 v79, v14, v15
    s_waitcnt lgkmcnt(4)
    v_mfma_f32_32x32x16_bf16 v[224:239], v[108:111], v[68:71], v[224:239]
    ds_read_b128 v[108:111], v2 offset:7168
    s_cbranch_vccnz Lat_rs1_3
Lat_rb1_3:
    s_barrier
    ds_read_b128 v[80:83], v2 offset:16384
    ds_read_b128 v[84:87], v2 offset:17408
    ds_read_b128 v[88:91], v2 offset:18432
    s_waitcnt lgkmcnt(4)
    ds_read_b128 v[92:95], v2 offset:19456
    ds_read_b128 v[96:99], v2 offset:20480
    ds_read_b128 v[100:103], v2 offset:21504
    ds_read_b128 v[104:107], v2 offset:22528
    v_add_f32 v3, v3, v245
    s_waitcnt lgkmcnt(4)
    ds_read_b128 v[108:111], v2 offset:23552
    v_mfma_f32_32x32x16_bf16 v[176:191], v[80:83], v[72:75], v[176:191]
    ds_read_b128 v[80:83], v2 offset:24576
    v_mfma_f32_32x32x16_bf16 v[192:207], v[84:87], v[72:75], v[192:207]
    ds_read_b128 v[84:87], v2 offset:25600
    v_mfma_f32_32x32x16_bf16 v[208:223], v[88:91], v[72:75], v[208:223]
    ds_read_b128 v[88:91], v2 offset:26624
    s_waitcnt lgkmcnt(4)
    v_mfma_f32_32x32x16_bf16 v[224:239], v[92:95], v[72:75], v[224:239]
    ds_read_b128 v[92:95], v2 offset:27648
    v_mfma_f32_32x32x16_bf16 v[176:191], v[96:99], v[76:79], v[176:191]
    ds_read_b128 v[96:99], v2 offset:28672
    v_mfma_f32_32x32x16_bf16 v[192:207], v[100:103], v[76:79], v[192:207]
    ds_read_b128 v[100:103], v2 offset:29696
    v_mfma_f32_32x32x16_bf16 v[208:223], v[104:107], v[76:79], v[208:223]
    ds_read_b128 v[104:107], v2 offset:30720
    s_waitcnt lgkmcnt(4)
    v_mfma_f32_32x32x16_bf16 v[224:239], v[108:111], v[76:79], v[224:239]
    ds_read_b128 v[108:111], v2 offset:31744
    s_add_u32 s40, s40, 32768
    s_cmp_eq_u32 s40, 163840
    s_cselect_b32 s40, 0, s40
    v_add_u32 v2, s40, v1
    ds_read_b128 v[80:83], v2 offset:16384
    ds_read_b128 v[84:87], v2 offset:17408
    ds_read_b128 v[88:91], v2 offset:18432
    s_waitcnt lgkmcnt(4)
    ds_read_b128 v[92:95], v2 offset:19456
    ds_read_b128 v[96:99], v2 offset:20480
    ds_read_b128 v[100:103], v2 offset:21504
    ds_read_b128 v[104:107], v2 offset:22528
    s_waitcnt lgkmcnt(4)
    ds_read_b128 v[108:111], v2 offset:23552
    s_barrier
    ds_read_b128 v[80:83], v2 offset:8192
    v_mov_b64 v[112:113], v[144:145]
    v_mov_b64 v[114:115], v[146:147]
    ds_read_b128 v[84:87], v2 offset:9216
    v_mov_b64 v[116:117], v[148:149]
    v_mov_b64 v[118:119], v[150:151]
    ds_read_b128 v[88:91], v2 offset:10240
    v_mov_b64 v[120:121], v[152:153]
    v_mov_b64 v[122:123], v[154:155]
    s_waitcnt lgkmcnt(4)
    ds_read_b128 v[92:95], v2 offset:11264
    v_mov_b64 v[124:125], v[156:157]
    v_mov_b64 v[126:127], v[158:159]
    ds_read_b128 v[96:99], v2 offset:12288
    v_mov_b64 v[128:129], v[160:161]
    v_mov_b64 v[130:131], v[162:163]
    ds_read_b128 v[100:103], v2 offset:13312
    v_mov_b64 v[132:133], v[164:165]
    v_mov_b64 v[134:135], v[166:167]
    ds_read_b128 v[104:107], v2 offset:14336
    v_mov_b64 v[136:137], v[168:169]
    v_mov_b64 v[138:139], v[170:171]
    s_waitcnt lgkmcnt(4)
    ds_read_b128 v[108:111], v2 offset:15360
    v_mov_b64 v[140:141], v[172:173]
    v_mov_b64 v[142:143], v[174:175]
    s_branch Lat_tend
Lat_t2:
    v_mfma_f32_32x32x16_bf16 v[48:63], v[80:83], v[112:115], v[16:31]
    ds_read_b128 v[80:83], v2 offset:16384
    v_exp_f32 v8, v32
    v_exp_f32 v9, v33
    v_mfma_f32_32x32x16_bf16 v[48:63], v[84:87], v[116:119], v[48:63]
    ds_read_b128 v[84:87], v2 offset:17408
    v_exp_f32 v10, v34
    v_add_f32 v244, v8, v9
    v_cvt_pk_bf16_f32 v64, v8, v9
    v_mfma_f32_32x32x16_bf16 v[48:63], v[88:91], v[120:123], v[48:63]
    ds_read_b128 v[88:91], v2 offset:18432
    v_exp_f32 v11, v35
    v_exp_f32 v12, v36
    s_waitcnt lgkmcnt(4)
    v_mfma_f32_32x32x16_bf16 v[48:63], v[92:95], v[124:127], v[48:63]
    ds_read_b128 v[92:95], v2 offset:19456
    v_exp_f32 v13, v37
    v_add_f32 v244, v244, v10
    v_cvt_pk_bf16_f32 v65, v10, v11
    v_mfma_f32_32x32x16_bf16 v[48:63], v[96:99], v[128:131], v[48:63]
    ds_read_b128 v[96:99], v2 offset:20480
    v_exp_f32 v14, v38
    v_add_f32 v244, v244, v11
    v_add_f32 v244, v244, v12
    v_mfma_f32_32x32x16_bf16 v[48:63], v[100:103], v[132:135], v[48:63]
    ds_read_b128 v[100:103], v2 offset:21504
    v_exp_f32 v15, v39
    v_add_f32 v244, v244, v13
    v_cvt_pk_bf16_f32 v66, v12, v13
    v_mfma_f32_32x32x16_bf16 v[48:63], v[104:107], v[136:139], v[48:63]
    ds_read_b128 v[104:107], v2 offset:22528
    v_exp_f32 v8, v40
    v_add_f32 v244, v244, v14
    v_add_f32 v3, v3, v245
    s_waitcnt lgkmcnt(4)
    v_mfma_f32_32x32x16_bf16 v[48:63], v[108:111], v[140:143], v[48:63]
    ds_read_b128 v[108:111], v2 offset:23552
    v_exp_f32 v9, v41
    v_add_f32 v244, v244, v15
    v_cvt_pk_bf16_f32 v67, v14, v15
    v_mfma_f32_32x32x16_bf16 v[176:191], v[80:83], v[72:75], v[176:191]
    ds_read_b128 v[80:83], v2 offset:8192
    s_barrier
    v_exp_f32 v10, v42
    v_add_f32 v244, v244, v8
    v_mfma_f32_32x32x16_bf16 v[192:207], v[84:87], v[72:75], v[192:207]
    ds_read_b128 v[84:87], v2 offset:9216
    v_exp_f32 v11, v43
    v_add_f32 v244, v244, v9
    v_cvt_pk_bf16_f32 v68, v8, v9
    v_mfma_f32_32x32x16_bf16 v[208:223], v[88:91], v[72:75], v[208:223]
    ds_read_b128 v[88:91], v2 offset:10240
    v_exp_f32 v12, v44
    v_add_f32 v244, v244, v10
    s_waitcnt lgkmcnt(4)
    v_mfma_f32_32x32x16_bf16 v[224:239], v[92:95], v[72:75], v[224:239]
    ds_read_b128 v[92:95], v2 offset:11264
    v_exp_f32 v13, v45
    v_add_f32 v244, v244, v11
    v_cvt_pk_bf16_f32 v69, v10, v11
    v_mfma_f32_32x32x16_bf16 v[176:191], v[96:99], v[76:79], v[176:191]
    ds_read_b128 v[96:99], v2 offset:12288
    v_exp_f32 v14, v46
    v_add_f32 v244, v244, v12
    v_mfma_f32_32x32x16_bf16 v[192:207], v[100:103], v[76:79], v[192:207]
    ds_read_b128 v[100:103], v2 offset:13312
    v_exp_f32 v15, v47
    v_add_f32 v244, v244, v13
    v_cvt_pk_bf16_f32 v70, v12, v13
    v_mfma_f32_32x32x16_bf16 v[208:223], v[104:107], v[76:79], v[208:223]
    ds_read_b128 v[104:107], v2 offset:14336
    v_add_f32 v244, v244, v14
    v_add_f32 v244, v244, v15
    v_cmp_nle_f32 vcc, v244, v241
    v_cvt_pk_bf16_f32 v71, v14, v15
    s_waitcnt lgkmcnt(4)
    v_mfma_f32_32x32x16_bf16 v[224:239], v[108:111], v[76:79], v[224:239]
    ds_read_b128 v[108:111], v2 offset:15360
    s_cbranch_vccnz Lat_rs2_0
Lat_rb2_0:
    v_mfma_f32_32x32x16_bf16 v[32:47], v[80:83], v[112:115], v[16:31]
    ds_read_b128 v[80:83], v2 offset:24576
    v_exp_f32 v8, v48
    v_exp_f32 v9, v49
    v_mfma_f32_32x32x16_bf16 v[32:47], v[84:87], v[116:119], v[32:47]
    ds_read_b128 v[84:87], v2 offset:25600
    v_exp_f32 v10, v50
    v_add_f32 v245, v8, v9
    v_cvt_pk_bf16_f32 v72, v8, v9
    v_mfma_f32_32x32x16_bf16 v[32:47], v[88:91], v[120:123], v[32:47]
    ds_read_b128 v[88:91], v2 offset:26624
    v_exp_f32 v11, v51
    v_exp_f32 v12, v52
    s_waitcnt lgkmcnt(4)
    v_mfma_f32_32x32x16_bf16 v[32:47], v[92:95], v[124:127], v[32:47]
    ds_read_b128 v[92:95], v2 offset:27648
    v_exp_f32 v13, v53
    v_add_f32 v245, v245, v10
    v_cvt_pk_bf16_f32 v73, v10, v11
    v_mfma_f32_32x32x16_bf16 v[32:47], v[96:99], v[128:131], v[32:47]
    ds_read_b128 v[96:99], v2 offset:28672
    v_exp_f32 v14, v54
    v_add_f32 v245, v245, v11
    v_add_f32 v245, v245, v12
    v_mfma_f32_32x32x16_bf16 v[32:47], v[100:103], v[132:135], v[32:47]
    ds_read_b128 v[100:103], v2 offset:29696
    v_exp_f32 v15, v55
    v_add_f32 v245, v245, v13
    v_cvt_pk_bf16_f32 v74, v12, v13
    v_mfma_f32_32x32x16_bf16 v[32:47], v[104:107], v[136:139], v[32:47]
    ds_read_b128 v[104:107], v2 offset:30720
    s_add_u32 s40, s40, 32768
    s_cmp_eq_u32 s40, 163840
    s_cselect_b32 s40, 0, s40
    v_exp_f32 v8, v56
    v_add_f32 v245, v245, v14
    v_add_f32 v3, v3, v244
    s_waitcnt lgkmcnt(4)
    v_mfma_f32_32x32x16_bf16 v[32:47], v[108:111], v[140:143], v[32:47]
    ds_read_b128 v[108:111], v2 offset:31744
    v_exp_f32 v9, v57
    v_add_f32 v245, v245, v15
    v_cvt_pk_bf16_f32 v75, v14, v15
    v_mfma_f32_32x32x16_bf16 v[176:191], v[80:83], v[64:67], v[176:191]
    v_add_u32 v2, s40, v1
    ds_read_b128 v[80:83], v2 offset:0
    v_exp_f32 v10, v58
    v_add_f32 v245, v245, v8
    v_mfma_f32_32x32x16_bf16 v[192:207], v[84:87], v[64:67], v[192:207]
    ds_read_b128 v[84:87], v2 offset:1024
    v_exp_f32 v11, v59
    v_add_f32 v245, v245, v9
    v_cvt_pk_bf16_f32 v76, v8, v9
    v_mfma_f32_32x32x16_bf16 v[208:223], v[88:91], v[64:67], v[208:223]
    ds_read_b128 v[88:91], v2 offset:2048
    v_exp_f32 v12, v60
    v_add_f32 v245, v245, v10
    s_waitcnt lgkmcnt(4)
    v_mfma_f32_32x32x16_bf16 v[224:239], v[92:95], v[64:67], v[224:239]
    ds_read_b128 v[92:95], v2 offset:3072
    v_exp_f32 v13, v61
    v_add_f32 v245, v245, v11
    v_cvt_pk_bf16_f32 v77, v10, v11
    v_mfma_f32_32x32x16_bf16 v[176:191], v[96:99], v[68:71], v[176:191]
    ds_read_b128 v[96:99], v2 offset:4096
    v_exp_f32 v14, v62
    v_add_f32 v245, v245, v12
    v_mfma_f32_32x32x16_bf16 v[192:207], v[100:103], v[68:71], v[192:207]
    ds_read_b128 v[100:103], v2 offset:5120
    v_exp_f32 v15, v63
    v_add_f32 v245, v245, v13
    v_cvt_pk_bf16_f32 v78, v12, v13
    v_mfma_f32_32x32x16_bf16 v[208:223], v[104:107], v[68:71], v[208:223]
    ds_read_b128 v[104:107], v2 offset:6144
    v_add_f32 v245, v245, v14
    v_add_f32 v245, v245, v15
    v_cmp_nle_f32 vcc, v245, v241
    v_cvt_pk_bf16_f32 v79, v14, v15
    s_waitcnt lgkmcnt(4)
    v_mfma_f32_32x32x16_bf16 v[224:239], v[108:111], v[68:71], v[224:239]
    ds_read_b128 v[108:111], v2 offset:7168
    s_cbranch_vccnz Lat_rs2_1
Lat_rb2_1:
Lat_t2b:
    v_mfma_f32_32x32x16_bf16 v[48:63], v[80:83], v[112:115], v[16:31]
    ds_read_b128 v[80:83], v2 offset:16384
    v_exp_f32 v8, v32
    v_exp_f32 v9, v33
    v_mfma_f32_32x32x16_bf16 v[48:63], v[84:87], v[116:119], v[48:63]
    ds_read_b128 v[84:87], v2 offset:17408
    v_exp_f32 v10, v34
    v_add_f32 v244, v8, v9
    v_cvt_pk_bf16_f32 v64, v8, v9
    v_mfma_f32_32x32x16_bf16 v[48:63], v[88:91], v[120:123], v[48:63]
    ds_read_b128 v[88:91], v2 offset:18432
    v_exp_f32 v11, v35
    v_exp_f32 v12, v36
    s_waitcnt lgkmcnt(4)
    v_mfma_f32_32x32x16_bf16 v[48:63], v[92:95], v[124:127], v[48:63]
    ds_read_b128 v[92:95], v2 offset:19456
    v_exp_f32 v13, v37
    v_add_f32 v244, v244, v10
    v_cvt_pk_bf16_f32 v65, v10, v11
    v_mfma_f32_32x32x16_bf16 v[48:63], v[96:99], v[128:131], v[48:63]
    ds_read_b128 v[96:99], v2 offset:20480
    v_exp_f32 v14, v38
    v_add_f32 v244, v244, v11
    v_add_f32 v244, v244, v12
    v_mfma_f32_32x32x16_bf16 v[48:63], v[100:103], v[132:135], v[48:63]
    ds_read_b128 v[100:103], v2 offset:21504
    v_exp_f32 v15, v39
    v_add_f32 v244, v244, v13
    v_cvt_pk_bf16_f32 v66, v12, v13
    v_mfma_f32_32x32x16_bf16 v[48:63], v[104:107], v[136:139], v[48:63]
    ds_read_b128 v[104:107], v2 offset:22528
    v_exp_f32 v8, v40
    v_add_f32 v244, v244, v14
    v_add_f32 v3, v3, v245
    s_waitcnt lgkmcnt(4)
    v_mfma_f32_32x32x16_bf16 v[48:63], v[108:111], v[140:143], v[48:63]
    ds_read_b128 v[108:111], v2 offset:23552
    v_exp_f32 v9, v41
    v_add_f32 v244, v244, v15
    v_cvt_pk_bf16_f32 v67, v14, v15
    v_mfma_f32_32x32x16_bf16 v[176:191], v[80:83], v[72:75], v[176:191]
    ds_read_b128 v[80:83], v2 offset:8192
    s_barrier
    v_exp_f32 v10, v42
    v_add_f32 v244, v244, v8
    v_min_f32 v16, v6, v5
    v_add_f32 v17, 0xf1800000, v6
    v_min_f32 v17, v17, v5
    v_add_f32 v18, 0xf2000000, v6
    v_mfma_f32_32x32x16_bf16 v[192:207], v[84:87], v[72:75], v[192:207]
    ds_read_b128 v[84:87], v2 offset:9216
    v_exp_f32 v11, v43
    v_add_f32 v244, v244, v9
    v_cvt_pk_bf16_f32 v68, v8, v9
    v_min_f32 v18, v18, v5
    v_add_f32 v19, 0xf2400000, v6
    v_min_f32 v19, v19, v5
    v_add_f32 v20, 0xf3000000, v6
    v_mfma_f32_32x32x16_bf16 v[208:223], v[88:91], v[72:75], v[208:223]
    ds_read_b128 v[88:91], v2 offset:10240
    v_exp_f32 v12, v44
    v_add_f32 v244, v244, v10
    v_min_f32 v20, v20, v5
    v_add_f32 v21, 0xf3100000, v6
    v_min_f32 v21, v21, v5
    v_add_f32 v22, 0xf3200000, v6
    s_waitcnt lgkmcnt(4)
    v_mfma_f32_32x32x16_bf16 v[224:239], v[92:95], v[72:75], v[224:239]
    ds_read_b128 v[92:95], v2 offset:11264
    v_exp_f32 v13, v45
    v_add_f32 v244, v244, v11
    v_cvt_pk_bf16_f32 v69, v10, v11
    v_min_f32 v22, v22, v5
    v_add_f32 v23, 0xf3300000, v6
    v_min_f32 v23, v23, v5
    v_add_f32 v24, 0xf3800000, v6
    v_mfma_f32_32x32x16_bf16 v[176:191], v[96:99], v[76:79], v[176:191]
    ds_read_b128 v[96:99], v2 offset:12288
    v_exp_f32 v14, v46
    v_add_f32 v244, v244, v12
    v_min_f32 v24, v24, v5
    v_add_f32 v25, 0xf3880000, v6
    v_min_f32 v25, v25, v5
    v_add_f32 v26, 0xf3900000, v6
    v_mfma_f32_32x32x16_bf16 v[192:207], v[100:103], v[76:79], v[192:207]
    ds_read_b128 v[100:103], v2 offset:13312
    v_exp_f32 v15, v47
    v_add_f32 v244, v244, v13
    v_cvt_pk_bf16_f32 v70, v12, v13
    v_min_f32 v26, v26, v5
    v_add_f32 v27, 0xf3980000, v6
    v_min_f32 v27, v27, v5
    v_add_f32 v28, 0xf3c00000, v6
    v_mfma_f32_32x32x16_bf16 v[208:223], v[104:107], v[76:79], v[208:223]
    ds_read_b128 v[104:107], v2 offset:14336
    v_add_f32 v244, v244, v14
    v_add_f32 v244, v244, v15
    v_cmp_nle_f32 vcc, v244, v241
    v_cvt_pk_bf16_f32 v71, v14, v15
    v_min_f32 v28, v28, v5
    v_add_f32 v29, 0xf3c80000, v6
    v_min_f32 v29, v29, v5
    v_add_f32 v30, 0xf3d00000, v6
    s_waitcnt lgkmcnt(4)
    v_mfma_f32_32x32x16_bf16 v[224:239], v[108:111], v[76:79], v[224:239]
    ds_read_b128 v[108:111], v2 offset:15360
    v_min_f32 v30, v30, v5
    v_add_f32 v31, 0xf3d80000, v6
    v_min_f32 v31, v31, v5
    v_add_f32 v6, 0xf4000000, v6
    s_cbranch_vccnz Lat_rs2_2
Lat_rb2_2:
    v_mfma_f32_32x32x16_bf16 v[32:47], v[80:83], v[112:115], v[16:31]
    ds_read_b128 v[80:83], v2 offset:24576
    v_exp_f32 v8, v48
    v_exp_f32 v9, v49
    v_mfma_f32_32x32x16_bf16 v[32:47], v[84:87], v[116:119], v[32:47]
    ds_read_b128 v[84:87], v2 offset:25600
    v_exp_f32 v10, v50
    v_add_f32 v245, v8, v9
    v_cvt_pk_bf16_f32 v72, v8, v9
    v_mfma_f32_32x32x16_bf16 v[32:47], v[88:91], v[120:123], v[32:47]
    ds_read_b128 v[88:91], v2 offset:26624
    v_exp_f32 v11, v51
    v_exp_f32 v12, v52
    s_waitcnt lgkmcnt(4)
    v_mfma_f32_32x32x16_bf16 v[32:47], v[92:95], v[124:127], v[32:47]
    ds_read_b128 v[92:95], v2 offset:27648
    v_exp_f32 v13, v53
    v_add_f32 v245, v245, v10
    v_cvt_pk_bf16_f32 v73, v10, v11
    v_mfma_f32_32x32x16_bf16 v[32:47], v[96:99], v[128:131], v[32:47]
    ds_read_b128 v[96:99], v2 offset:28672
    v_exp_f32 v14, v54
    v_add_f32 v245, v245, v11
    v_add_f32 v245, v245, v12
    v_mfma_f32_32x32x16_bf16 v[32:47], v[100:103], v[132:135], v[32:47]
    ds_read_b128 v[100:103], v2 offset:29696
    v_exp_f32 v15, v55
    v_add_f32 v245, v245, v13
    v_cvt_pk_bf16_f32 v74, v12, v13
    v_mfma_f32_32x32x16_bf16 v[32:47], v[104:107], v[136:139], v[32:47]
    ds_read_b128 v[104:107], v2 offset:30720
    s_add_u32 s40, s40, 32768
    s_cmp_eq_u32 s40, 163840
    s_cselect_b32 s40, 0, s40
    v_exp_f32 v8, v56
    v_add_f32 v245, v245, v14
    v_add_f32 v3, v3, v244
    s_waitcnt lgkmcnt(4)
    v_mfma_f32_32x32x16_bf16 v[32:47], v[108:111], v[140:143], v[32:47]
    ds_read_b128 v[108:111], v2 offset:31744
    v_exp_f32 v9, v57
    v_add_f32 v245, v245, v15
    v_cvt_pk_bf16_f32 v75, v14, v15
    v_mfma_f32_32x32x16_bf16 v[176:191], v[80:83], v[64:67], v[176:191]
    v_add_u32 v2, s40, v1
    ds_read_b128 v[80:83], v2 offset:0
    v_exp_f32 v10, v58
    v_add_f32 v245, v245, v8
    v_mfma_f32_32x32x16_bf16 v[192:207], v[84:87], v[64:67], v[192:207]
    ds_read_b128 v[84:87], v2 offset:1024
    v_exp_f32 v11, v59
    v_add_f32 v245, v245, v9
    v_cvt_pk_bf16_f32 v76, v8, v9
    v_mfma_f32_32x32x16_bf16 v[208:223], v[88:91], v[64:67], v[208:223]
    ds_read_b128 v[88:91], v2 offset:2048
    v_exp_f32 v12, v60
    v_add_f32 v245, v245, v10
    s_waitcnt lgkmcnt(4)
    v_mfma_f32_32x32x16_bf16 v[224:239], v[92:95], v[64:67], v[224:239]
    ds_read_b128 v[92:95], v2 offset:3072
    v_exp_f32 v13, v61
    v_add_f32 v245, v245, v11
    v_cvt_pk_bf16_f32 v77, v10, v11
    v_mfma_f32_32x32x16_bf16 v[176:191], v[96:99], v[68:71], v[176:191]
    ds_read_b128 v[96:99], v2 offset:4096
    v_exp_f32 v14, v62
    v_add_f32 v245, v245, v12
    v_mfma_f32_32x32x16_bf16 v[192:207], v[100:103], v[68:71], v[192:207]
    ds_read_b128 v[100:103], v2 offset:5120
    v_exp_f32 v15, v63
    v_add_f32 v245, v245, v13
    v_cvt_pk_bf16_f32 v78, v12, v13
    v_mfma_f32_32x32x16_bf16 v[208:223], v[104:107], v[68:71], v[208:223]
    ds_read_b128 v[104:107], v2 offset:6144
    v_add_f32 v245, v245, v14
    v_add_f32 v245, v245, v15
    v_cmp_nle_f32 vcc, v245, v241
    v_cvt_pk_bf16_f32 v79, v14, v15
    s_waitcnt lgkmcnt(4)
    v_mfma_f32_32x32x16_bf16 v[224:239], v[108:111], v[68:71], v[224:239]
    ds_read_b128 v[108:111], v2 offset:7168
    s_cbranch_vccnz Lat_rs2_3
Lat_rb2_3:
    s_barrier
    ds_read_b128 v[80:83], v2 offset:16384
    v_exp_f32 v8, v32
    v_exp_f32 v9, v33
    ds_read_b128 v[84:87], v2 offset:17408
    v_exp_f32 v10, v34
    v_add_f32 v244, v8, v9
    v_cvt_pk_bf16_f32 v64, v8, v9
    ds_read_b128 v[88:91], v2 offset:18432
    v_exp_f32 v11, v35
    v_exp_f32 v12, v36
    s_waitcnt lgkmcnt(4)
    ds_read_b128 v[92:95], v2 offset:19456
    v_exp_f32 v13, v37
    v_add_f32 v244, v244, v10
    v_cvt_pk_bf16_f32 v65, v10, v11
    ds_read_b128 v[96:99], v2 offset:20480
    v_exp_f32 v14, v38
    v_add_f32 v244, v244, v11
    v_add_f32 v244, v244, v12
    ds_read_b128 v[100:103], v2 offset:21504
    v_exp_f32 v15, v39
    v_add_f32 v244, v244, v13
    v_cvt_pk_bf16_f32 v66, v12, v13
    ds_read_b128 v[104:107], v2 offset:22528
    v_exp_f32 v8, v40
    v_add_f32 v244, v244, v14
    v_add_f32 v3, v3, v245
    s_waitcnt lgkmcnt(4)
    ds_read_b128 v[108:111], v2 offset:23552
    v_exp_f32 v9, v41
    v_add_f32 v244, v244, v15
    v_cvt_pk_bf16_f32 v67, v14, v15
    v_mfma_f32_32x32x16_bf16 v[176:191], v[80:83], v[72:75], v[176:191]
    ds_read_b128 v[80:83], v2 offset:24576
    v_exp_f32 v10, v42
    v_add_f32 v244, v244, v8
    v_mfma_f32_32x32x16_bf16 v[192:207], v[84:87], v[72:75], v[192:207]
    ds_read_b128 v[84:87], v2 offset:25600
    v_exp_f32 v11, v43
    v_add_f32 v244, v244, v9
    v_cvt_pk_bf16_f32 v68, v8, v9
    v_mfma_f32_32x32x16_bf16 v[208:223], v[88:91], v[72:75], v[208:223]
    ds_read_b128 v[88:91], v2 offset:26624
    v_exp_f32 v12, v44
    v_add_f32 v244, v244, v10
    s_waitcnt lgkmcnt(4)
    v_mfma_f32_32x32x16_bf16 v[224:239], v[92:95], v[72:75], v[224:239]
    ds_read_b128 v[92:95], v2 offset:27648
    v_exp_f32 v13, v45
    v_add_f32 v244, v244, v11
    v_cvt_pk_bf16_f32 v69, v10, v11
    v_mfma_f32_32x32x16_bf16 v[176:191], v[96:99], v[76:79], v[176:191]
    ds_read_b128 v[96:99], v2 offset:28672
    v_exp_f32 v14, v46
    v_add_f32 v244, v244, v12
    v_mfma_f32_32x32x16_bf16 v[192:207], v[100:103], v[76:79], v[192:207]
    ds_read_b128 v[100:103], v2 offset:29696
    v_exp_f32 v15, v47
    v_add_f32 v244, v244, v13
    v_cvt_pk_bf16_f32 v70, v12, v13
    v_mfma_f32_32x32x16_bf16 v[208:223], v[104:107], v[76:79], v[208:223]
    ds_read_b128 v[104:107], v2 offset:30720
    v_add_f32 v244, v244, v14
    v_add_f32 v244, v244, v15
    v_cmp_nle_f32 vcc, v244, v241
    v_cvt_pk_bf16_f32 v71, v14, v15
    s_waitcnt lgkmcnt(4)
    v_mfma_f32_32x32x16_bf16 v[224:239], v[108:111], v[76:79], v[224:239]
    ds_read_b128 v[108:111], v2 offset:31744
    s_cbranch_vccnz Lat_rs2_4
Lat_rb2_4:
    v_mfma_f32_32x32x16_bf16 v[176:191], v[80:83], v[64:67], v[176:191]
    s_add_u32 s40, s40, 32768
    s_cmp_eq_u32 s40, 163840
    s_cselect_b32 s40, 0, s40
    v_add_u32 v2, s40, v1
    ds_read_b128 v[80:83], v2 offset:16384
    v_add_f32 v3, v3, v244
    v_mfma_f32_32x32x16_bf16 v[192:207], v[84:87], v[64:67], v[192:207]
    ds_read_b128 v[84:87], v2 offset:17408
    v_mfma_f32_32x32x16_bf16 v[208:223], v[88:91], v[64:67], v[208:223]
    ds_read_b128 v[88:91], v2 offset:18432
    s_waitcnt lgkmcnt(4)
    v_mfma_f32_32x32x16_bf16 v[224:239], v[92:95], v[64:67], v[224:239]
    ds_read_b128 v[92:95], v2 offset:19456
    v_mfma_f32_32x32x16_bf16 v[176:191], v[96:99], v[68:71], v[176:191]
    ds_read_b128 v[96:99], v2 offset:20480
    v_mfma_f32_32x32x16_bf16 v[192:207], v[100:103], v[68:71], v[192:207]
    ds_read_b128 v[100:103], v2 offset:21504
    v_mfma_f32_32x32x16_bf16 v[208:223], v[104:107], v[68:71], v[208:223]
    ds_read_b128 v[104:107], v2 offset:22528
    s_waitcnt lgkmcnt(4)
    v_mfma_f32_32x32x16_bf16 v[224:239], v[108:111], v[68:71], v[224:239]
    ds_read_b128 v[108:111], v2 offset:23552
    s_barrier
    ds_read_b128 v[80:83], v2 offset:8192
    v_mov_b64 v[112:113], v[144:145]
    v_mov_b64 v[114:115], v[146:147]
    ds_read_b128 v[84:87], v2 offset:9216
    v_mov_b64 v[116:117], v[148:149]
    v_mov_b64 v[118:119], v[150:151]
    ds_read_b128 v[88:91], v2 offset:10240
    v_mov_b64 v[120:121], v[152:153]
    v_mov_b64 v[122:123], v[154:155]
    s_waitcnt lgkmcnt(4)
    ds_read_b128 v[92:95], v2 offset:11264
    v_mov_b64 v[124:125], v[156:157]
    v_mov_b64 v[126:127], v[158:159]
    ds_read_b128 v[96:99], v2 offset:12288
    v_mov_b64 v[128:129], v[160:161]
    v_mov_b64 v[130:131], v[162:163]
    ds_read_b128 v[100:103], v2 offset:13312
    v_mov_b64 v[132:133], v[164:165]
    v_mov_b64 v[134:135], v[166:167]
    ds_read_b128 v[104:107], v2 offset:14336
    v_mov_b64 v[136:137], v[168:169]
    v_mov_b64 v[138:139], v[170:171]
    s_waitcnt lgkmcnt(4)
    ds_read_b128 v[108:111], v2 offset:15360
    v_mov_b64 v[140:141], v[172:173]
    v_mov_b64 v[142:143], v[174:175]
Lat_tend:
    v_mov_b32 v242, v3
    s_nop 1
    v_permlane32_swap_b32 v3, v242
    s_nop 1
    v_add_f32 v3, v3, v242
    v_rcp_f32 v8, v3
    s_nop 0
    v_mov_b32 v9, v8
    s_lshl_b32 s32, s42, 20
    s_lshl_b32 s33, s3, 18
    s_add_u32 s32, s32, s33
    s_lshl_b32 s33, s28, 12
    s_add_u32 s32, s32, s33
    s_nop 3
    v_pk_mul_f32 v[176:177], v[176:177], v[8:9]
    v_pk_mul_f32 v[178:179], v[178:179], v[8:9]
    v_pk_mul_f32 v[180:181], v[180:181], v[8:9]
    v_pk_mul_f32 v[182:183], v[182:183], v[8:9]
    v_cvt_pk_bf16_f32 v32, v176, v177
    v_cvt_pk_bf16_f32 v33, v178, v179
    v_cvt_pk_bf16_f32 v34, v180, v181
    v_cvt_pk_bf16_f32 v35, v182, v183
    buffer_store_dwordx4 v[32:35], v240, s[20:23], s32 offen offset:0 sc1
    v_pk_mul_f32 v[184:185], v[184:185], v[8:9]
    v_pk_mul_f32 v[186:187], v[186:187], v[8:9]
    v_pk_mul_f32 v[188:189], v[188:189], v[8:9]
    v_pk_mul_f32 v[190:191], v[190:191], v[8:9]
    v_cvt_pk_bf16_f32 v36, v184, v185
    v_cvt_pk_bf16_f32 v37, v186, v187
    v_cvt_pk_bf16_f32 v38, v188, v189
    v_cvt_pk_bf16_f32 v39, v190, v191
    buffer_store_dwordx4 v[36:39], v240, s[20:23], s32 offen offset:512 sc1
    v_pk_mul_f32 v[192:193], v[192:193], v[8:9]
    v_pk_mul_f32 v[194:195], v[194:195], v[8:9]
    v_pk_mul_f32 v[196:197], v[196:197], v[8:9]
    v_pk_mul_f32 v[198:199], v[198:199], v[8:9]
    v_cvt_pk_bf16_f32 v40, v192, v193
    v_cvt_pk_bf16_f32 v41, v194, v195
    v_cvt_pk_bf16_f32 v42, v196, v197
    v_cvt_pk_bf16_f32 v43, v198, v199
    buffer_store_dwordx4 v[40:43], v240, s[20:23], s32 offen offset:1024 sc1
    v_pk_mul_f32 v[200:201], v[200:201], v[8:9]
    v_pk_mul_f32 v[202:203], v[202:203], v[8:9]
    v_pk_mul_f32 v[204:205], v[204:205], v[8:9]
    v_pk_mul_f32 v[206:207], v[206:207], v[8:9]
    v_cvt_pk_bf16_f32 v44, v200, v201
    v_cvt_pk_bf16_f32 v45, v202, v203
    v_cvt_pk_bf16_f32 v46, v204, v205
    v_cvt_pk_bf16_f32 v47, v206, v207
    buffer_store_dwordx4 v[44:47], v240, s[20:23], s32 offen offset:1536 sc1
    v_pk_mul_f32 v[208:209], v[208:209], v[8:9]
    v_pk_mul_f32 v[210:211], v[210:211], v[8:9]
    v_pk_mul_f32 v[212:213], v[212:213], v[8:9]
    v_pk_mul_f32 v[214:215], v[214:215], v[8:9]
    v_cvt_pk_bf16_f32 v48, v208, v209
    v_cvt_pk_bf16_f32 v49, v210, v211
    v_cvt_pk_bf16_f32 v50, v212, v213
    v_cvt_pk_bf16_f32 v51, v214, v215
    buffer_store_dwordx4 v[48:51], v240, s[20:23], s32 offen offset:2048 sc1
    v_pk_mul_f32 v[216:217], v[216:217], v[8:9]
    v_pk_mul_f32 v[218:219], v[218:219], v[8:9]
    v_pk_mul_f32 v[220:221], v[220:221], v[8:9]
    v_pk_mul_f32 v[222:223], v[222:223], v[8:9]
    v_cvt_pk_bf16_f32 v52, v216, v217
    v_cvt_pk_bf16_f32 v53, v218, v219
    v_cvt_pk_bf16_f32 v54, v220, v221
    v_cvt_pk_bf16_f32 v55, v222, v223
    buffer_store_dwordx4 v[52:55], v240, s[20:23], s32 offen offset:2560 sc1
    v_pk_mul_f32 v[224:225], v[224:225], v[8:9]
    v_pk_mul_f32 v[226:227], v[226:227], v[8:9]
    v_pk_mul_f32 v[228:229], v[228:229], v[8:9]
    v_pk_mul_f32 v[230:231], v[230:231], v[8:9]
    v_cvt_pk_bf16_f32 v56, v224, v225
    v_cvt_pk_bf16_f32 v57, v226, v227
    v_cvt_pk_bf16_f32 v58, v228, v229
    v_cvt_pk_bf16_f32 v59, v230, v231
    buffer_store_dwordx4 v[56:59], v240, s[20:23], s32 offen offset:3072 sc1
    v_pk_mul_f32 v[232:233], v[232:233], v[8:9]
    v_pk_mul_f32 v[234:235], v[234:235], v[8:9]
    v_pk_mul_f32 v[236:237], v[236:237], v[8:9]
    v_pk_mul_f32 v[238:239], v[238:239], v[8:9]
    v_cvt_pk_bf16_f32 v60, v232, v233
    v_cvt_pk_bf16_f32 v61, v234, v235
    v_cvt_pk_bf16_f32 v62, v236, v237
    v_cvt_pk_bf16_f32 v63, v238, v239
    buffer_store_dwordx4 v[60:63], v240, s[20:23], s32 offen offset:3584 sc1
    s_cmp_lg_u32 s43, 0
    s_cbranch_scc1 Lat_cend
    s_mov_b32 s43, 1
    s_mov_b32 s42, s31
    s_branch Lat_qk0
Lat_rs0:
    s_call_b64 s[44:45], Lat_rare0
    s_branch Lat_rb0
Lat_rs1:
    s_call_b64 s[44:45], Lat_rare1
    s_branch Lat_rb1
Lat_rs3_0:
    s_call_b64 s[44:45], Lat_rare0
    s_branch Lat_rb3_0
Lat_rs3_1:
    s_call_b64 s[44:45], Lat_rare1
    s_branch Lat_rb3_1
Lat_rs3_2:
    s_call_b64 s[44:45], Lat_rare0
    s_branch Lat_rb3_2
Lat_rs3_3:
    s_call_b64 s[44:45], Lat_rare1
    s_branch Lat_rb3_3
Lat_rs3_4:
    s_call_b64 s[44:45], Lat_rare0
    s_branch Lat_rb3_4
Lat_rs3_5:
    s_call_b64 s[44:45], Lat_rare1
    s_branch Lat_rb3_5
Lat_rs0_0:
    s_call_b64 s[44:45], Lat_rare0
    s_branch Lat_rb0_0
Lat_rs0_1:
    s_call_b64 s[44:45], Lat_rare1
    s_branch Lat_rb0_1
Lat_rs0_2:
    s_call_b64 s[44:45], Lat_rare0
    s_branch Lat_rb0_2
Lat_rs1_0:
    s_call_b64 s[44:45], Lat_rare0
    s_branch Lat_rb1_0
Lat_rs1_1:
    s_call_b64 s[44:45], Lat_rare1
    s_branch Lat_rb1_1
Lat_rs1_2:
    s_call_b64 s[44:45], Lat_rare0
    s_branch Lat_rb1_2
Lat_rs1_3:
    s_call_b64 s[44:45], Lat_rare1
    s_branch Lat_rb1_3
Lat_rs2_0:
    s_call_b64 s[44:45], Lat_rare0
    s_branch Lat_rb2_0
Lat_rs2_1:
    s_call_b64 s[44:45], Lat_rare1
    s_branch Lat_rb2_1
Lat_rs2_2:
    s_call_b64 s[44:45], Lat_rare0
    s_branch Lat_rb2_2
Lat_rs2_3:
    s_call_b64 s[44:45], Lat_rare1
    s_branch Lat_rb2_3
Lat_rs2_4:
    s_call_b64 s[44:45], Lat_rare0
    s_branch Lat_rb2_4
Lat_rare0:
    s_nop 15
    v_max3_f32 v243, v32, v33, v34
    v_max3_f32 v243, v243, v35, v36
    v_max3_f32 v243, v243, v37, v38
    v_max3_f32 v243, v243, v39, v40
    v_max3_f32 v243, v243, v41, v42
    v_max3_f32 v243, v243, v43, v44
    v_max3_f32 v243, v243, v45, v46
    v_max_f32 v243, v243, v47
    v_mov_b32 v242, v243
    s_nop 1
    v_permlane32_swap_b32 v243, v242
    s_nop 1
    v_max3_f32 v243, v243, v242, 0
    v_exp_f32 v242, -v243
    v_sub_f32 v5, v5, v243
    v_sub_f32 v16, v16, v243
    v_sub_f32 v48, v48, v243
    v_sub_f32 v32, v32, v243
    v_sub_f32 v17, v17, v243
    v_sub_f32 v49, v49, v243
    v_sub_f32 v33, v33, v243
    v_sub_f32 v18, v18, v243
    v_sub_f32 v50, v50, v243
    v_sub_f32 v34, v34, v243
    v_sub_f32 v19, v19, v243
    v_sub_f32 v51, v51, v243
    v_sub_f32 v35, v35, v243
    v_sub_f32 v20, v20, v243
    v_sub_f32 v52, v52, v243
    v_sub_f32 v36, v36, v243
    v_sub_f32 v21, v21, v243
    v_sub_f32 v53, v53, v243
    v_sub_f32 v37, v37, v243
    v_sub_f32 v22, v22, v243
    v_sub_f32 v54, v54, v243
    v_sub_f32 v38, v38, v243
    v_sub_f32 v23, v23, v243
    v_sub_f32 v55, v55, v243
    v_sub_f32 v39, v39, v243
    v_sub_f32 v24, v24, v243
    v_sub_f32 v56, v56, v243
    v_sub_f32 v40, v40, v243
    v_sub_f32 v25, v25, v243
    v_sub_f32 v57, v57, v243
    v_sub_f32 v41, v41, v243
    v_sub_f32 v26, v26, v243
    v_sub_f32 v58, v58, v243
    v_sub_f32 v42, v42, v243
    v_sub_f32 v27, v27, v243
    v_sub_f32 v59, v59, v243
    v_sub_f32 v43, v43, v243
    v_sub_f32 v28, v28, v243
    v_sub_f32 v60, v60, v243
    v_sub_f32 v44, v44, v243
    v_sub_f32 v29, v29, v243
    v_sub_f32 v61, v61, v243
    v_sub_f32 v45, v45, v243
    v_sub_f32 v30, v30, v243
    v_sub_f32 v62, v62, v243
    v_sub_f32 v46, v46, v243
    v_sub_f32 v31, v31, v243
    v_sub_f32 v63, v63, v243
    v_sub_f32 v47, v47, v243
    v_mul_f32 v176, v176, v242
    v_mul_f32 v177, v177, v242
    v_mul_f32 v178, v178, v242
    v_mul_f32 v179, v179, v242
    v_mul_f32 v180, v180, v242
    v_mul_f32 v181, v181, v242
    v_mul_f32 v182, v182, v242
    v_mul_f32 v183, v183, v242
    v_mul_f32 v184, v184, v242
    v_mul_f32 v185, v185, v242
    v_mul_f32 v186, v186, v242
    v_mul_f32 v187, v187, v242
    v_mul_f32 v188, v188, v242
    v_mul_f32 v189, v189, v242
    v_mul_f32 v190, v190, v242
    v_mul_f32 v191, v191, v242
    v_mul_f32 v192, v192, v242
    v_mul_f32 v193, v193, v242
    v_mul_f32 v194, v194, v242
    v_mul_f32 v195, v195, v242
    v_mul_f32 v196, v196, v242
    v_mul_f32 v197, v197, v242
    v_mul_f32 v198, v198, v242
    v_mul_f32 v199, v199, v242
    v_mul_f32 v200, v200, v242
    v_mul_f32 v201, v201, v242
    v_mul_f32 v202, v202, v242
    v_mul_f32 v203, v203, v242
    v_mul_f32 v204, v204, v242
    v_mul_f32 v205, v205, v242
    v_mul_f32 v206, v206, v242
    v_mul_f32 v207, v207, v242
    v_mul_f32 v208, v208, v242
    v_mul_f32 v209, v209, v242
    v_mul_f32 v210, v210, v242
    v_mul_f32 v211, v211, v242
    v_mul_f32 v212, v212, v242
    v_mul_f32 v213, v213, v242
    v_mul_f32 v214, v214, v242
    v_mul_f32 v215, v215, v242
    v_mul_f32 v216, v216, v242
    v_mul_f32 v217, v217, v242
    v_mul_f32 v218, v218, v242
    v_mul_f32 v219, v219, v242
    v_mul_f32 v220, v220, v242
    v_mul_f32 v221, v221, v242
    v_mul_f32 v222, v222, v242
    v_mul_f32 v223, v223, v242
    v_mul_f32 v224, v224, v242
    v_mul_f32 v225, v225, v242
    v_mul_f32 v226, v226, v242
    v_mul_f32 v227, v227, v242
    v_mul_f32 v228, v228, v242
    v_mul_f32 v229, v229, v242
    v_mul_f32 v230, v230, v242
    v_mul_f32 v231, v231, v242
    v_mul_f32 v232, v232, v242
    v_mul_f32 v233, v233, v242
    v_mul_f32 v234, v234, v242
    v_mul_f32 v235, v235, v242
    v_mul_f32 v236, v236, v242
    v_mul_f32 v237, v237, v242
    v_mul_f32 v238, v238, v242
    v_mul_f32 v239, v239, v242
    v_mul_f32 v3, v3, v242
    v_exp_f32 v8, v32
    v_exp_f32 v9, v33
    s_nop 0
    v_add_f32 v244, v8, v9
    v_cvt_pk_bf16_f32 v64, v8, v9
    v_exp_f32 v10, v34
    v_exp_f32 v11, v35
    s_nop 0
    v_add_f32 v244, v244, v10
    v_add_f32 v244, v244, v11
    v_cvt_pk_bf16_f32 v65, v10, v11
    v_exp_f32 v12, v36
    v_exp_f32 v13, v37
    s_nop 0
    v_add_f32 v244, v244, v12
    v_add_f32 v244, v244, v13
    v_cvt_pk_bf16_f32 v66, v12, v13
    v_exp_f32 v14, v38
    v_exp_f32 v15, v39
    s_nop 0
    v_add_f32 v244, v244, v14
    v_add_f32 v244, v244, v15
    v_cvt_pk_bf16_f32 v67, v14, v15
    v_exp_f32 v8, v40
    v_exp_f32 v9, v41
    s_nop 0
    v_add_f32 v244, v244, v8
    v_add_f32 v244, v244, v9
    v_cvt_pk_bf16_f32 v68, v8, v9
    v_exp_f32 v10, v42
    v_exp_f32 v11, v43
    s_nop 0
    v_add_f32 v244, v244, v10
    v_add_f32 v244, v244, v11
    v_cvt_pk_bf16_f32 v69, v10, v11
    v_exp_f32 v12, v44
    v_exp_f32 v13, v45
    s_nop 0
    v_add_f32 v244, v244, v12
    v_add_f32 v244, v244, v13
    v_cvt_pk_bf16_f32 v70, v12, v13
    v_exp_f32 v14, v46
    v_exp_f32 v15, v47
    s_nop 0
    v_add_f32 v244, v244, v14
    v_add_f32 v244, v244, v15
    v_cvt_pk_bf16_f32 v71, v14, v15
    s_nop 1
    s_setpc_b64 s[44:45]
Lat_rare1:
    s_nop 15
    v_max3_f32 v243, v48, v49, v50
    v_max3_f32 v243, v243, v51, v52
    v_max3_f32 v243, v243, v53, v54
    v_max3_f32 v243, v243, v55, v56
    v_max3_f32 v243, v243, v57, v58
    v_max3_f32 v243, v243, v59, v60
    v_max3_f32 v243, v243, v61, v62
    v_max_f32 v243, v243, v63
    v_mov_b32 v242, v243
    s_nop 1
    v_permlane32_swap_b32 v243, v242
    s_nop 1
    v_max3_f32 v243, v243, v242, 0
    v_exp_f32 v242, -v243
    v_sub_f32 v5, v5, v243
    v_sub_f32 v16, v16, v243
    v_sub_f32 v32, v32, v243
    v_sub_f32 v48, v48, v243
    v_sub_f32 v17, v17, v243
    v_sub_f32 v33, v33, v243
    v_sub_f32 v49, v49, v243
    v_sub_f32 v18, v18, v243
    v_sub_f32 v34, v34, v243
    v_sub_f32 v50, v50, v243
    v_sub_f32 v19, v19, v243
    v_sub_f32 v35, v35, v243
    v_sub_f32 v51, v51, v243
    v_sub_f32 v20, v20, v243
    v_sub_f32 v36, v36, v243
    v_sub_f32 v52, v52, v243
    v_sub_f32 v21, v21, v243
    v_sub_f32 v37, v37, v243
    v_sub_f32 v53, v53, v243
    v_sub_f32 v22, v22, v243
    v_sub_f32 v38, v38, v243
    v_sub_f32 v54, v54, v243
    v_sub_f32 v23, v23, v243
    v_sub_f32 v39, v39, v243
    v_sub_f32 v55, v55, v243
    v_sub_f32 v24, v24, v243
    v_sub_f32 v40, v40, v243
    v_sub_f32 v56, v56, v243
    v_sub_f32 v25, v25, v243
    v_sub_f32 v41, v41, v243
    v_sub_f32 v57, v57, v243
    v_sub_f32 v26, v26, v243
    v_sub_f32 v42, v42, v243
    v_sub_f32 v58, v58, v243
    v_sub_f32 v27, v27, v243
    v_sub_f32 v43, v43, v243
    v_sub_f32 v59, v59, v243
    v_sub_f32 v28, v28, v243
    v_sub_f32 v44, v44, v243
    v_sub_f32 v60, v60, v243
    v_sub_f32 v29, v29, v243
    v_sub_f32 v45, v45, v243
    v_sub_f32 v61, v61, v243
    v_sub_f32 v30, v30, v243
    v_sub_f32 v46, v46, v243
    v_sub_f32 v62, v62, v243
    v_sub_f32 v31, v31, v243
    v_sub_f32 v47, v47, v243
    v_sub_f32 v63, v63, v243
    v_mul_f32 v176, v176, v242
    v_mul_f32 v177, v177, v242
    v_mul_f32 v178, v178, v242
    v_mul_f32 v179, v179, v242
    v_mul_f32 v180, v180, v242
    v_mul_f32 v181, v181, v242
    v_mul_f32 v182, v182, v242
    v_mul_f32 v183, v183, v242
    v_mul_f32 v184, v184, v242
    v_mul_f32 v185, v185, v242
    v_mul_f32 v186, v186, v242
    v_mul_f32 v187, v187, v242
    v_mul_f32 v188, v188, v242
    v_mul_f32 v189, v189, v242
    v_mul_f32 v190, v190, v242
    v_mul_f32 v191, v191, v242
    v_mul_f32 v192, v192, v242
    v_mul_f32 v193, v193, v242
    v_mul_f32 v194, v194, v242
    v_mul_f32 v195, v195, v242
    v_mul_f32 v196, v196, v242
    v_mul_f32 v197, v197, v242
    v_mul_f32 v198, v198, v242
    v_mul_f32 v199, v199, v242
    v_mul_f32 v200, v200, v242
    v_mul_f32 v201, v201, v242
    v_mul_f32 v202, v202, v242
    v_mul_f32 v203, v203, v242
    v_mul_f32 v204, v204, v242
    v_mul_f32 v205, v205, v242
    v_mul_f32 v206, v206, v242
    v_mul_f32 v207, v207, v242
    v_mul_f32 v208, v208, v242
    v_mul_f32 v209, v209, v242
    v_mul_f32 v210, v210, v242
    v_mul_f32 v211, v211, v242
    v_mul_f32 v212, v212, v242
    v_mul_f32 v213, v213, v242
    v_mul_f32 v214, v214, v242
    v_mul_f32 v215, v215, v242
    v_mul_f32 v216, v216, v242
    v_mul_f32 v217, v217, v242
    v_mul_f32 v218, v218, v242
    v_mul_f32 v219, v219, v242
    v_mul_f32 v220, v220, v242
    v_mul_f32 v221, v221, v242
    v_mul_f32 v222, v222, v242
    v_mul_f32 v223, v223, v242
    v_mul_f32 v224, v224, v242
    v_mul_f32 v225, v225, v242
    v_mul_f32 v226, v226, v242
    v_mul_f32 v227, v227, v242
    v_mul_f32 v228, v228, v242
    v_mul_f32 v229, v229, v242
    v_mul_f32 v230, v230, v242
    v_mul_f32 v231, v231, v242
    v_mul_f32 v232, v232, v242
    v_mul_f32 v233, v233, v242
    v_mul_f32 v234, v234, v242
    v_mul_f32 v235, v235, v242
    v_mul_f32 v236, v236, v242
    v_mul_f32 v237, v237, v242
    v_mul_f32 v238, v238, v242
    v_mul_f32 v239, v239, v242
    v_mul_f32 v3, v3, v242
    v_exp_f32 v8, v48
    v_exp_f32 v9, v49
    s_nop 0
    v_add_f32 v245, v8, v9
    v_cvt_pk_bf16_f32 v72, v8, v9
    v_exp_f32 v10, v50
    v_exp_f32 v11, v51
    s_nop 0
    v_add_f32 v245, v245, v10
    v_add_f32 v245, v245, v11
    v_cvt_pk_bf16_f32 v73, v10, v11
    v_exp_f32 v12, v52
    v_exp_f32 v13, v53
    s_nop 0
    v_add_f32 v245, v245, v12
    v_add_f32 v245, v245, v13
    v_cvt_pk_bf16_f32 v74, v12, v13
    v_exp_f32 v14, v54
    v_exp_f32 v15, v55
    s_nop 0
    v_add_f32 v245, v245, v14
    v_add_f32 v245, v245, v15
    v_cvt_pk_bf16_f32 v75, v14, v15
    v_exp_f32 v8, v56
    v_exp_f32 v9, v57
    s_nop 0
    v_add_f32 v245, v245, v8
    v_add_f32 v245, v245, v9
    v_cvt_pk_bf16_f32 v76, v8, v9
    v_exp_f32 v10, v58
    v_exp_f32 v11, v59
    s_nop 0
    v_add_f32 v245, v245, v10
    v_add_f32 v245, v245, v11
    v_cvt_pk_bf16_f32 v77, v10, v11
    v_exp_f32 v12, v60
    v_exp_f32 v13, v61
    s_nop 0
    v_add_f32 v245, v245, v12
    v_add_f32 v245, v245, v13
    v_cvt_pk_bf16_f32 v78, v12, v13
    v_exp_f32 v14, v62
    v_exp_f32 v15, v63
    s_nop 0
    v_add_f32 v245, v245, v14
    v_add_f32 v245, v245, v15
    v_cvt_pk_bf16_f32 v79, v14, v15
    s_nop 1
    s_setpc_b64 s[44:45]
Lat_cend:
    s_lshr_b32 s32, s28, 2
    s_add_u32 s32, s32, 48
    s_lshl_b32 s60, s31, 3
    s_add_u32 s60, s60, s32
    s_lshl_b32 s60, s60, 7
    s_waitcnt lgkmcnt(0)
    s_and_b32 s28, s2, 7
    s_lshr_b32 s29, s2, 5
    s_bfe_u32 s30, s2, 0x20003
    v_and_b32 v8, 63, v0
    v_lshlrev_b32 v1, 4, v8
    v_bfe_u32 v2, v8, 4, 1
    v_lshlrev_b32 v2, 2, v2
    v_bfe_u32 v9, v8, 2, 2
    v_add_u32 v2, v2, v9
    v_lshrrev_b32 v9, 5, v8
    v_and_b32 v10, 3, v8
    v_lshl_add_u32 v2, v9, 4, v2
    v_mul_u32_u24 v2, 288, v2
    v_lshl_add_u32 v2, v10, 3, v2
    v_add_u32 v4, 16384, v2
    s_lshl_b32 s35, s3, 12
    v_add_u32 v5, s35, v1
    v_mov_b32 v2, v4
    v_mov_b32 v3, v5
    v_mov_b64 v[16:17], 0
    v_mov_b64 v[18:19], 0
    v_mov_b64 v[20:21], 0
    v_mov_b64 v[22:23], 0
    v_mov_b64 v[24:25], 0
    v_mov_b64 v[26:27], 0
    v_mov_b64 v[28:29], 0
    v_mov_b64 v[30:31], 0
    v_mov_b64 v[32:33], 0
    v_mov_b64 v[34:35], 0
    v_mov_b64 v[36:37], 0
    v_mov_b64 v[38:39], 0
    v_mov_b64 v[40:41], 0
    v_mov_b64 v[42:43], 0
    v_mov_b64 v[44:45], 0
    v_mov_b64 v[46:47], 0
    v_mov_b64 v[48:49], 0
    v_mov_b64 v[50:51], 0
    v_mov_b64 v[52:53], 0
    v_mov_b64 v[54:55], 0
    v_mov_b64 v[56:57], 0
    v_mov_b64 v[58:59], 0
    v_mov_b64 v[60:61], 0
    v_mov_b64 v[62:63], 0
    v_mov_b64 v[64:65], 0
    v_mov_b64 v[66:67], 0
    v_mov_b64 v[68:69], 0
    v_mov_b64 v[70:71], 0
    v_mov_b64 v[72:73], 0
    v_mov_b64 v[74:75], 0
    v_mov_b64 v[76:77], 0
    v_mov_b64 v[78:79], 0
    v_mov_b64 v[80:81], 0
    v_mov_b64 v[82:83], 0
    v_mov_b64 v[84:85], 0
    v_mov_b64 v[86:87], 0
    s_add_u32 s20, s4, 52887552
    s_addc_u32 s21, s5, 0
    s_and_b32 s21, s21, 0xffff
    s_mov_b32 s22, 18874368
    s_mov_b32 s23, 0x20000
    v_bfe_u32 v6, v8, 4, 1
    v_lshlrev_b32 v6, 1, v6
    v_lshrrev_b32 v9, 5, v8
    v_add_u32 v6, v6, v9
    v_mul_u32_u24 v6, 9216, v6
    v_and_b32 v9, 15, v8
    v_lshl_add_u32 v6, v9, 4, v6
    s_load_dwordx2 s[46:47], s[0:1], 0
    s_bfe_u32 s32, s2, 0x20001
    s_lshl_b32 s32, s32, 2
    s_bfe_u32 s33, s2, 0x20003
    s_add_u32 s32, s32, s33
    s_and_b32 s43, s2, 1
    s_lshl_b32 s43, s43, 3
    s_lshr_b32 s33, s2, 5
    s_add_u32 s43, s43, s33
    s_lshl_b32 s42, s43, 4
    s_add_u32 s42, s42, s32
    s_mul_i32 s44, s42, 9216
    v_mov_b32 v232, v0
    v_add_u32 v233, 512, v0
    v_cmp_gt_u32 vcc, 64, v0
    v_mov_b32 v234, 0x0ffffff0
    s_nop 1
    v_cndmask_b32 v233, v234, v233, vcc
    v_lshlrev_b32 v236, 4, v232
    v_lshlrev_b32 v237, 4, v233
    v_mov_b32 v240, 0x3f80
    v_mov_b32 v241, 0x3f800000
    s_add_u32 s48, s4, 65536
    s_addc_u32 s49, s5, 0
    s_and_b32 s49, s49, 0xffff
    s_mov_b32 s50, 13824
    s_mov_b32 s51, 0x20000
    v_lshlrev_b32 v238, 2, v232
    v_lshlrev_b32 v239, 2, v233
    v_and_b32 v235, 63, v0
    v_lshlrev_b32 v235, 2, v235
    s_mov_b32 s32, 4608
    buffer_load_dword v208, v238, s[48:51], s32 offen sc1
    buffer_load_dword v209, v239, s[48:51], s32 offen sc1
    s_mov_b32 s32, 6912
    s_mov_b32 s33, 9216
    buffer_load_dword v210, v235, s[48:51], s32 offen offset:0 sc1
    buffer_load_dword v220, v235, s[48:51], s33 offen offset:0 sc1
    buffer_load_dword v211, v235, s[48:51], s32 offen offset:256 sc1
    buffer_load_dword v221, v235, s[48:51], s33 offen offset:256 sc1
    buffer_load_dword v212, v235, s[48:51], s32 offen offset:512 sc1
    buffer_load_dword v222, v235, s[48:51], s33 offen offset:512 sc1
    buffer_load_dword v213, v235, s[48:51], s32 offen offset:768 sc1
    buffer_load_dword v223, v235, s[48:51], s33 offen offset:768 sc1
    buffer_load_dword v214, v235, s[48:51], s32 offen offset:1024 sc1
    buffer_load_dword v224, v235, s[48:51], s33 offen offset:1024 sc1
    buffer_load_dword v215, v235, s[48:51], s32 offen offset:1280 sc1
    buffer_load_dword v225, v235, s[48:51], s33 offen offset:1280 sc1
    buffer_load_dword v216, v235, s[48:51], s32 offen offset:1536 sc1
    buffer_load_dword v226, v235, s[48:51], s33 offen offset:1536 sc1
    buffer_load_dword v217, v235, s[48:51], s32 offen offset:1792 sc1
    buffer_load_dword v227, v235, s[48:51], s33 offen offset:1792 sc1
    buffer_load_dword v218, v235, s[48:51], s32 offen offset:2048 sc1
    buffer_load_dword v228, v235, s[48:51], s33 offen offset:2048 sc1
    v_lshlrev_b32 v230, 1, v232
    v_lshlrev_b32 v231, 1, v233
    s_waitcnt lgkmcnt(0)
    s_mov_b32 s48, s46
    s_and_b32 s49, s47, 0xffff
    s_mov_b32 s50, 2359296
    s_mov_b32 s51, 0x20000
    s_mov_b32 s32, s44
    buffer_load_short_d16_hi v192, v230, s[48:51], s32 offen
    buffer_load_short_d16_hi v200, v231, s[48:51], s32 offen
    buffer_load_short_d16_hi v193, v230, s[48:51], s32 offen offset:1152
    buffer_load_short_d16_hi v201, v231, s[48:51], s32 offen offset:1152
    buffer_load_short_d16_hi v194, v230, s[48:51], s32 offen offset:2304
    buffer_load_short_d16_hi v202, v231, s[48:51], s32 offen offset:2304
    s_add_u32 s32, s32, 3456
    buffer_load_short_d16_hi v195, v230, s[48:51], s32 offen
    buffer_load_short_d16_hi v203, v231, s[48:51], s32 offen
    buffer_load_short_d16_hi v196, v230, s[48:51], s32 offen offset:1152
    buffer_load_short_d16_hi v204, v231, s[48:51], s32 offen offset:1152
    buffer_load_short_d16_hi v197, v230, s[48:51], s32 offen offset:2304
    buffer_load_short_d16_hi v205, v231, s[48:51], s32 offen offset:2304
    s_add_u32 s32, s32, 3456
    buffer_load_short_d16_hi v198, v230, s[48:51], s32 offen
    buffer_load_short_d16_hi v206, v231, s[48:51], s32 offen
    buffer_load_short_d16_hi v199, v230, s[48:51], s32 offen offset:1152
    buffer_load_short_d16_hi v207, v231, s[48:51], s32 offen offset:1152
    v_add_u32 v238, 118784, v238
    s_mul_i32 s32, s3, 2304
    s_add_u32 s32, s32, 118784
    v_add_u32 v239, s32, v235
    s_waitcnt vmcnt(36)
    v_mov_b32 v9, 1
    s_mov_b64 exec, 1
    buffer_atomic_add v9, off, s[96:99], s60 sc1
    s_mov_b64 exec, -1
    s_mov_b32 s40, 0
    s_mov_b32 s41, 8
    s_mov_b32 s45, 0
    s_lshl_b32 s34, s28, 8
    s_lshl_b32 s33, s29, 4
    s_add_u32 s34, s34, s33
    s_lshl_b32 s33, s3, 2
    s_add_u32 s34, s34, s33
    s_mul_i32 s34, s34, 9216
    s_mul_i32 s33, s30, 2304
    s_add_u32 s34, s34, s33
    s_barrier
    ds_read_b128 v[96:99], v3 offset:0
    ds_read_b128 v[100:103], v3 offset:2048
    ds_read_b64_tr_b16 v[104:105], v2 offset:0
    ds_read_b64_tr_b16 v[106:107], v2 offset:2304
    ds_read_b64_tr_b16 v[108:109], v2 offset:32
    ds_read_b64_tr_b16 v[110:111], v2 offset:2336
    ds_read_b64_tr_b16 v[112:113], v2 offset:64
    ds_read_b64_tr_b16 v[114:115], v2 offset:2368
    ds_read_b64_tr_b16 v[116:117], v2 offset:96
    ds_read_b64_tr_b16 v[118:119], v2 offset:2400
    ds_read_b64_tr_b16 v[120:121], v2 offset:128
    ds_read_b64_tr_b16 v[122:123], v2 offset:2432
    ds_read_b64_tr_b16 v[124:125], v2 offset:160
    ds_read_b64_tr_b16 v[126:127], v2 offset:2464
    ds_read_b64_tr_b16 v[128:129], v2 offset:192
    ds_read_b64_tr_b16 v[130:131], v2 offset:2496
    ds_read_b64_tr_b16 v[132:133], v2 offset:224
    ds_read_b64_tr_b16 v[134:135], v2 offset:2528
    ds_read_b64_tr_b16 v[136:137], v2 offset:256
    ds_read_b64_tr_b16 v[138:139], v2 offset:2560
    s_branch Lgo_cin
Lgo_cloop:
    s_barrier
Lgo_cin:
    s_waitcnt lgkmcnt(6)
    v_mfma_f32_16x16x32_bf16 v[16:19], v[96:99], v[104:107], v[16:19]
    ds_read_b128 v[144:147], v3 offset:1024
    v_mfma_f32_16x16x32_bf16 v[52:55], v[100:103], v[104:107], v[52:55]
    ds_read_b128 v[148:151], v3 offset:3072
    v_mfma_f32_16x16x32_bf16 v[20:23], v[96:99], v[108:111], v[20:23]
    ds_read_b64_tr_b16 v[152:153], v2 offset:9216
    v_mfma_f32_16x16x32_bf16 v[56:59], v[100:103], v[108:111], v[56:59]
    ds_read_b64_tr_b16 v[154:155], v2 offset:11520
    ds_read_b64_tr_b16 v[156:157], v2 offset:9248
    v_mfma_f32_16x16x32_bf16 v[24:27], v[96:99], v[112:115], v[24:27]
    ds_read_b64_tr_b16 v[158:159], v2 offset:11552
    v_mfma_f32_16x16x32_bf16 v[60:63], v[100:103], v[112:115], v[60:63]
    ds_read_b64_tr_b16 v[160:161], v2 offset:9280
    v_mfma_f32_16x16x32_bf16 v[28:31], v[96:99], v[116:119], v[28:31]
    ds_read_b64_tr_b16 v[162:163], v2 offset:11584
    v_mfma_f32_16x16x32_bf16 v[64:67], v[100:103], v[116:119], v[64:67]
    ds_read_b64_tr_b16 v[164:165], v2 offset:9312
    ds_read_b64_tr_b16 v[166:167], v2 offset:11616
    v_mfma_f32_16x16x32_bf16 v[32:35], v[96:99], v[120:123], v[32:35]
    ds_read_b64_tr_b16 v[168:169], v2 offset:9344
    v_mfma_f32_16x16x32_bf16 v[68:71], v[100:103], v[120:123], v[68:71]
    ds_read_b64_tr_b16 v[170:171], v2 offset:11648
    v_mfma_f32_16x16x32_bf16 v[36:39], v[96:99], v[124:127], v[36:39]
    ds_read_b64_tr_b16 v[172:173], v2 offset:9376
    v_mfma_f32_16x16x32_bf16 v[72:75], v[100:103], v[124:127], v[72:75]
    ds_read_b64_tr_b16 v[174:175], v2 offset:11680
    ds_read_b64_tr_b16 v[176:177], v2 offset:9408
    s_waitcnt lgkmcnt(15)
    v_mfma_f32_16x16x32_bf16 v[40:43], v[96:99], v[128:131], v[40:43]
    ds_read_b64_tr_b16 v[178:179], v2 offset:11712
    v_mfma_f32_16x16x32_bf16 v[76:79], v[100:103], v[128:131], v[76:79]
    ds_read_b64_tr_b16 v[180:181], v2 offset:9440
    v_mfma_f32_16x16x32_bf16 v[44:47], v[96:99], v[132:135], v[44:47]
    ds_read_b64_tr_b16 v[182:183], v2 offset:11744
    s_add_u32 s40, s40, 36864
    s_cmp_eq_u32 s40, 147456
    s_cselect_b32 s40, 0, s40
    v_mfma_f32_16x16x32_bf16 v[80:83], v[100:103], v[132:135], v[80:83]
    ds_read_b64_tr_b16 v[184:185], v2 offset:9472
    ds_read_b64_tr_b16 v[186:187], v2 offset:11776
    v_mfma_f32_16x16x32_bf16 v[48:51], v[96:99], v[136:139], v[48:51]
    v_add_u32 v2, s40, v4
    v_mfma_f32_16x16x32_bf16 v[84:87], v[100:103], v[136:139], v[84:87]
    v_add_u32 v3, s40, v5
    s_waitcnt lgkmcnt(6)
    v_mfma_f32_16x16x32_bf16 v[16:19], v[144:147], v[152:155], v[16:19]
    ds_read_b128 v[96:99], v3 offset:0
    v_mfma_f32_16x16x32_bf16 v[52:55], v[148:151], v[152:155], v[52:55]
    ds_read_b128 v[100:103], v3 offset:2048
    v_mfma_f32_16x16x32_bf16 v[20:23], v[144:147], v[156:159], v[20:23]
    ds_read_b64_tr_b16 v[104:105], v2 offset:0
    v_mfma_f32_16x16x32_bf16 v[56:59], v[148:151], v[156:159], v[56:59]
    ds_read_b64_tr_b16 v[106:107], v2 offset:2304
    ds_read_b64_tr_b16 v[108:109], v2 offset:32
    v_mfma_f32_16x16x32_bf16 v[24:27], v[144:147], v[160:163], v[24:27]
    ds_read_b64_tr_b16 v[110:111], v2 offset:2336
    v_mfma_f32_16x16x32_bf16 v[60:63], v[148:151], v[160:163], v[60:63]
    ds_read_b64_tr_b16 v[112:113], v2 offset:64
    v_mfma_f32_16x16x32_bf16 v[28:31], v[144:147], v[164:167], v[28:31]
    ds_read_b64_tr_b16 v[114:115], v2 offset:2368
    v_mfma_f32_16x16x32_bf16 v[64:67], v[148:151], v[164:167], v[64:67]
    ds_read_b64_tr_b16 v[116:117], v2 offset:96
    ds_read_b64_tr_b16 v[118:119], v2 offset:2400
    v_mfma_f32_16x16x32_bf16 v[32:35], v[144:147], v[168:171], v[32:35]
    ds_read_b64_tr_b16 v[120:121], v2 offset:128
    v_mfma_f32_16x16x32_bf16 v[68:71], v[148:151], v[168:171], v[68:71]
    ds_read_b64_tr_b16 v[122:123], v2 offset:2432
    v_mfma_f32_16x16x32_bf16 v[36:39], v[144:147], v[172:175], v[36:39]
    ds_read_b64_tr_b16 v[124:125], v2 offset:160
    v_mfma_f32_16x16x32_bf16 v[72:75], v[148:151], v[172:175], v[72:75]
    ds_read_b64_tr_b16 v[126:127], v2 offset:2464
    ds_read_b64_tr_b16 v[128:129], v2 offset:192
    s_waitcnt lgkmcnt(15)
    v_mfma_f32_16x16x32_bf16 v[40:43], v[144:147], v[176:179], v[40:43]
    ds_read_b64_tr_b16 v[130:131], v2 offset:2496
    v_mfma_f32_16x16x32_bf16 v[76:79], v[148:151], v[176:179], v[76:79]
    ds_read_b64_tr_b16 v[132:133], v2 offset:224
    s_cmp_lg_u32 s41, 5
    s_cbranch_scc1 Lgo_nd
    s_waitcnt vmcnt(0)
Lgo_nd:
    v_mfma_f32_16x16x32_bf16 v[44:47], v[144:147], v[180:183], v[44:47]
    ds_read_b64_tr_b16 v[134:135], v2 offset:2528
    v_mfma_f32_16x16x32_bf16 v[80:83], v[148:151], v[180:183], v[80:83]
    ds_read_b64_tr_b16 v[136:137], v2 offset:256
    ds_read_b64_tr_b16 v[138:139], v2 offset:2560
    v_mfma_f32_16x16x32_bf16 v[48:51], v[144:147], v[184:187], v[48:51]
    s_sub_u32 s41, s41, 1
    v_mfma_f32_16x16x32_bf16 v[84:87], v[148:151], v[184:187], v[84:87]
    s_cmp_lg_u32 s41, 0
    s_cbranch_scc1 Lgo_cloop
Lgo_cend:
    s_nop 4
    v_cvt_pk_bf16_f32 v16, v16, v17
    v_cvt_pk_bf16_f32 v17, v18, v19
    v_cvt_pk_bf16_f32 v18, v52, v53
    v_cvt_pk_bf16_f32 v19, v54, v55
    v_cvt_pk_bf16_f32 v20, v20, v21
    v_cvt_pk_bf16_f32 v21, v22, v23
    v_cvt_pk_bf16_f32 v22, v56, v57
    v_cvt_pk_bf16_f32 v23, v58, v59
    v_cvt_pk_bf16_f32 v24, v24, v25
    v_cvt_pk_bf16_f32 v25, v26, v27
    v_cvt_pk_bf16_f32 v26, v60, v61
    v_cvt_pk_bf16_f32 v27, v62, v63
    v_cvt_pk_bf16_f32 v28, v28, v29
    v_cvt_pk_bf16_f32 v29, v30, v31
    v_cvt_pk_bf16_f32 v30, v64, v65
    v_cvt_pk_bf16_f32 v31, v66, v67
    v_cvt_pk_bf16_f32 v32, v32, v33
    v_cvt_pk_bf16_f32 v33, v34, v35
    v_cvt_pk_bf16_f32 v34, v68, v69
    v_cvt_pk_bf16_f32 v35, v70, v71
    v_cvt_pk_bf16_f32 v36, v36, v37
    v_cvt_pk_bf16_f32 v37, v38, v39
    v_cvt_pk_bf16_f32 v38, v72, v73
    v_cvt_pk_bf16_f32 v39, v74, v75
    v_cvt_pk_bf16_f32 v40, v40, v41
    v_cvt_pk_bf16_f32 v41, v42, v43
    v_cvt_pk_bf16_f32 v42, v76, v77
    v_cvt_pk_bf16_f32 v43, v78, v79
    v_cvt_pk_bf16_f32 v44, v44, v45
    v_cvt_pk_bf16_f32 v45, v46, v47
    v_cvt_pk_bf16_f32 v46, v80, v81
    v_cvt_pk_bf16_f32 v47, v82, v83
    v_cvt_pk_bf16_f32 v48, v48, v49
    v_cvt_pk_bf16_f32 v49, v50, v51
    v_cvt_pk_bf16_f32 v50, v84, v85
    v_cvt_pk_bf16_f32 v51, v86, v87
    v_permlane16_swap_b32 v16, v18
    v_permlane16_swap_b32 v17, v19
    buffer_store_dwordx4 v[16:19], v6, s[20:23], s34 offen offset:0 sc1
    v_permlane16_swap_b32 v20, v22
    v_permlane16_swap_b32 v21, v23
    buffer_store_dwordx4 v[20:23], v6, s[20:23], s34 offen offset:256 sc1
    v_permlane16_swap_b32 v24, v26
    v_permlane16_swap_b32 v25, v27
    buffer_store_dwordx4 v[24:27], v6, s[20:23], s34 offen offset:512 sc1
    v_permlane16_swap_b32 v28, v30
    v_permlane16_swap_b32 v29, v31
    buffer_store_dwordx4 v[28:31], v6, s[20:23], s34 offen offset:768 sc1
    v_permlane16_swap_b32 v32, v34
    v_permlane16_swap_b32 v33, v35
    buffer_store_dwordx4 v[32:35], v6, s[20:23], s34 offen offset:1024 sc1
    v_permlane16_swap_b32 v36, v38
    v_permlane16_swap_b32 v37, v39
    buffer_store_dwordx4 v[36:39], v6, s[20:23], s34 offen offset:1280 sc1
    v_permlane16_swap_b32 v40, v42
    v_permlane16_swap_b32 v41, v43
    buffer_store_dwordx4 v[40:43], v6, s[20:23], s34 offen offset:1536 sc1
    v_permlane16_swap_b32 v44, v46
    v_permlane16_swap_b32 v45, v47
    buffer_store_dwordx4 v[44:47], v6, s[20:23], s34 offen offset:1792 sc1
    v_permlane16_swap_b32 v48, v50
    v_permlane16_swap_b32 v49, v51
    buffer_store_dwordx4 v[48:51], v6, s[20:23], s34 offen offset:2048 sc1
    s_cmp_lg_u32 s45, 0
    s_cbranch_scc1 Lgo_cfin
    s_mov_b32 s45, 1
    s_mov_b32 s41, 8
    s_add_u32 s34, s34, 1179648
    v_mov_b64 v[52:53], 0
    v_mov_b64 v[54:55], 0
    v_mov_b64 v[56:57], 0
    v_mov_b64 v[58:59], 0
    v_mov_b64 v[60:61], 0
    v_mov_b64 v[62:63], 0
    v_mov_b64 v[64:65], 0
    v_mov_b64 v[66:67], 0
    v_mov_b64 v[68:69], 0
    v_mov_b64 v[70:71], 0
    v_mov_b64 v[72:73], 0
    v_mov_b64 v[74:75], 0
    v_mov_b64 v[76:77], 0
    v_mov_b64 v[78:79], 0
    v_mov_b64 v[80:81], 0
    v_mov_b64 v[82:83], 0
    v_mov_b64 v[84:85], 0
    v_mov_b64 v[86:87], 0
    v_mov_b64 v[16:17], 0
    v_mov_b64 v[18:19], 0
    v_mov_b64 v[20:21], 0
    v_mov_b64 v[22:23], 0
    v_mov_b64 v[24:25], 0
    v_mov_b64 v[26:27], 0
    v_mov_b64 v[28:29], 0
    v_mov_b64 v[30:31], 0
    v_mov_b64 v[32:33], 0
    v_mov_b64 v[34:35], 0
    v_mov_b64 v[36:37], 0
    v_mov_b64 v[38:39], 0
    v_mov_b64 v[40:41], 0
    v_mov_b64 v[42:43], 0
    v_mov_b64 v[44:45], 0
    v_mov_b64 v[46:47], 0
    v_mov_b64 v[48:49], 0
    v_mov_b64 v[50:51], 0
    s_branch Lgo_cloop
Lgo_cfin:
    s_waitcnt lgkmcnt(0)
    s_waitcnt vmcnt(18)
    v_and_b32 v192, 0xffff0000, v192
    v_and_b32 v193, 0xffff0000, v193
    v_and_b32 v194, 0xffff0000, v194
    v_and_b32 v195, 0xffff0000, v195
    v_and_b32 v196, 0xffff0000, v196
    v_and_b32 v197, 0xffff0000, v197
    v_and_b32 v198, 0xffff0000, v198
    v_and_b32 v199, 0xffff0000, v199
    v_and_b32 v200, 0xffff0000, v200
    v_and_b32 v201, 0xffff0000, v201
    v_and_b32 v202, 0xffff0000, v202
    v_and_b32 v203, 0xffff0000, v203
    v_and_b32 v204, 0xffff0000, v204
    v_and_b32 v205, 0xffff0000, v205
    v_and_b32 v206, 0xffff0000, v206
    v_and_b32 v207, 0xffff0000, v207
    v_add_f32 v220, 1.0, v220
    v_cvt_pk_bf16_f32 v220, v220, v220
    v_and_b32 v220, 0xffff0000, v220
    v_add_f32 v221, 1.0, v221
    v_cvt_pk_bf16_f32 v221, v221, v221
    v_and_b32 v221, 0xffff0000, v221
    v_add_f32 v222, 1.0, v222
    v_cvt_pk_bf16_f32 v222, v222, v222
    v_and_b32 v222, 0xffff0000, v222
    v_add_f32 v223, 1.0, v223
    v_cvt_pk_bf16_f32 v223, v223, v223
    v_and_b32 v223, 0xffff0000, v223
    v_add_f32 v224, 1.0, v224
    v_cvt_pk_bf16_f32 v224, v224, v224
    v_and_b32 v224, 0xffff0000, v224
    v_add_f32 v225, 1.0, v225
    v_cvt_pk_bf16_f32 v225, v225, v225
    v_and_b32 v225, 0xffff0000, v225
    v_add_f32 v226, 1.0, v226
    v_cvt_pk_bf16_f32 v226, v226, v226
    v_and_b32 v226, 0xffff0000, v226
    v_add_f32 v227, 1.0, v227
    v_cvt_pk_bf16_f32 v227, v227, v227
    v_and_b32 v227, 0xffff0000, v227
    v_add_f32 v228, 1.0, v228
    v_cvt_pk_bf16_f32 v228, v228, v228
    v_and_b32 v228, 0xffff0000, v228
    v_lshrrev_b32 v230, 5, v232
    v_lshlrev_b32 v230, 17, v230
    v_and_b32 v234, 31, v232
    v_lshl_add_u32 v230, v234, 4, v230
    v_lshrrev_b32 v231, 5, v233
    v_lshlrev_b32 v231, 17, v231
    v_and_b32 v234, 31, v233
    v_lshl_add_u32 v231, v234, 4, v231
    s_waitcnt vmcnt(0)
    s_barrier
    s_barrier
Lln_shared:
    s_add_u32 s48, s4, 52887552
    s_addc_u32 s49, s5, 0
    s_and_b32 s49, s49, 0xffff
    s_mov_b32 s50, 18874368
    s_mov_b32 s51, 0x20000
    s_mov_b32 s32, s44
    buffer_load_dwordx4 v[96:99], v236, s[48:51], s32 offen sc1
    s_add_u32 s32, s32, 2359296
    buffer_load_dwordx4 v[100:103], v236, s[48:51], s32 offen sc1
    s_add_u32 s32, s32, 2359296
    buffer_load_dwordx4 v[104:107], v236, s[48:51], s32 offen sc1
    s_add_u32 s32, s32, 2359296
    buffer_load_dwordx4 v[108:111], v236, s[48:51], s32 offen sc1
    s_add_u32 s32, s32, 2359296
    buffer_load_dwordx4 v[112:115], v236, s[48:51], s32 offen sc1
    s_add_u32 s32, s32, 2359296
    buffer_load_dwordx4 v[116:119], v236, s[48:51], s32 offen sc1
    s_add_u32 s32, s32, 2359296
    buffer_load_dwordx4 v[120:123], v236, s[48:51], s32 offen sc1
    s_add_u32 s32, s32, 2359296
    buffer_load_dwordx4 v[124:127], v236, s[48:51], s32 offen sc1
    s_cmp_lg_u32 s3, 0
    s_cbranch_scc1 Lln_spa
    s_mov_b32 s32, s44
    buffer_load_dwordx4 v[128:131], v237, s[48:51], s32 offen sc1
    s_add_u32 s32, s32, 2359296
    buffer_load_dwordx4 v[132:135], v237, s[48:51], s32 offen sc1
    s_add_u32 s32, s32, 2359296
    buffer_load_dwordx4 v[136:139], v237, s[48:51], s32 offen sc1
    s_add_u32 s32, s32, 2359296
    buffer_load_dwordx4 v[140:143], v237, s[48:51], s32 offen sc1
    s_add_u32 s32, s32, 2359296
    buffer_load_dwordx4 v[144:147], v237, s[48:51], s32 offen sc1
    s_add_u32 s32, s32, 2359296
    buffer_load_dwordx4 v[148:151], v237, s[48:51], s32 offen sc1
    s_add_u32 s32, s32, 2359296
    buffer_load_dwordx4 v[152:155], v237, s[48:51], s32 offen sc1
    s_add_u32 s32, s32, 2359296
    buffer_load_dwordx4 v[156:159], v237, s[48:51], s32 offen sc1
Lln_spa:
    s_cmp_lt_u32 s3, 4
    s_cbranch_scc1 Lln_w0
    s_cmp_ge_u32 s2, 216
    s_cbranch_scc1 Lln_w0
    s_mov_b32 s40, 0
    s_add_u32 s32, s40, s37
    s_add_u32 m0, s32, 0
    s_add_u32 s33, s34, 0
    buffer_load_dwordx4 v2, s[8:11], s33 offen lds
    s_add_u32 m0, s32, 1088
    s_add_u32 s33, s34, 9216
    buffer_load_dwordx4 v2, s[8:11], s33 offen lds
    s_add_u32 m0, s32, 2176
    s_add_u32 s33, s34, 18432
    buffer_load_dwordx4 v2, s[8:11], s33 offen lds
    s_add_u32 m0, s32, 3264
    s_add_u32 s33, s34, 27648
    buffer_load_dwordx4 v2, s[8:11], s33 offen lds
    s_add_u32 s34, s34, 589824
    s_mov_b32 s40, 29696
    s_add_u32 s32, s40, s37
    s_add_u32 m0, s32, 0
    s_add_u32 s33, s34, 0
    buffer_load_dwordx4 v2, s[8:11], s33 offen lds
    s_add_u32 m0, s32, 1088
    s_add_u32 s33, s34, 9216
    buffer_load_dwordx4 v2, s[8:11], s33 offen lds
    s_add_u32 m0, s32, 2176
    s_add_u32 s33, s34, 18432
    buffer_load_dwordx4 v2, s[8:11], s33 offen lds
    s_add_u32 m0, s32, 3264
    s_add_u32 s33, s34, 27648
    buffer_load_dwordx4 v2, s[8:11], s33 offen lds
    s_add_u32 s34, s34, 589824
    s_mov_b32 s40, 59392
    s_add_u32 s32, s40, s37
    s_add_u32 m0, s32, 0
    s_add_u32 s33, s34, 0
    buffer_load_dwordx4 v2, s[8:11], s33 offen lds
    s_add_u32 m0, s32, 1088
    s_add_u32 s33, s34, 9216
    buffer_load_dwordx4 v2, s[8:11], s33 offen lds
    s_add_u32 m0, s32, 2176
    s_add_u32 s33, s34, 18432
    buffer_load_dwordx4 v2, s[8:11], s33 offen lds
    s_add_u32 m0, s32, 3264
    s_add_u32 s33, s34, 27648
    buffer_load_dwordx4 v2, s[8:11], s33 offen lds
    s_add_u32 s34, s34, 589824
    s_mov_b32 s40, 89088
    s_add_u32 s32, s40, s37
    s_add_u32 m0, s32, 0
    s_add_u32 s33, s34, 0
    buffer_load_dwordx4 v2, s[8:11], s33 offen lds
    s_add_u32 m0, s32, 1088
    s_add_u32 s33, s34, 9216
    buffer_load_dwordx4 v2, s[8:11], s33 offen lds
    s_add_u32 m0, s32, 2176
    s_add_u32 s33, s34, 18432
    buffer_load_dwordx4 v2, s[8:11], s33 offen lds
    s_add_u32 m0, s32, 3264
    s_add_u32 s33, s34, 27648
    buffer_load_dwordx4 v2, s[8:11], s33 offen lds
    s_add_u32 s34, s34, 589824
    s_waitcnt vmcnt(16)
    s_branch Lln_w1
Lln_w0:
    s_waitcnt vmcnt(0)
Lln_w1:
    s_add_u32 s48, s4, 71761920
    s_addc_u32 s49, s5, 0
    s_and_b32 s49, s49, 0xffff
    s_mov_b32 s50, 2359296
    s_mov_b32 s51, 0x20000
    s_add_u32 s52, s4, 74121216
    s_addc_u32 s53, s5, 0
    s_and_b32 s53, s53, 0xffff
    s_mov_b32 s54, 2359296
    s_mov_b32 s55, 0x20000
    v_lshlrev_b32 v160, 16, v96
    v_and_b32 v161, 0xffff0000, v96
    v_lshlrev_b32 v162, 16, v97
    v_and_b32 v163, 0xffff0000, v97
    v_lshlrev_b32 v164, 16, v98
    v_and_b32 v165, 0xffff0000, v98
    v_lshlrev_b32 v166, 16, v99
    v_and_b32 v167, 0xffff0000, v99
    v_dot2c_f32_bf16 v160, v100, v240
    v_dot2c_f32_bf16 v161, v100, v241
    v_dot2c_f32_bf16 v162, v101, v240
    v_dot2c_f32_bf16 v163, v101, v241
    v_dot2c_f32_bf16 v164, v102, v240
    v_dot2c_f32_bf16 v165, v102, v241
    v_dot2c_f32_bf16 v166, v103, v240
    v_dot2c_f32_bf16 v167, v103, v241
    v_dot2c_f32_bf16 v160, v104, v240
    v_dot2c_f32_bf16 v161, v104, v241
    v_dot2c_f32_bf16 v162, v105, v240
    v_dot2c_f32_bf16 v163, v105, v241
    v_dot2c_f32_bf16 v164, v106, v240
    v_dot2c_f32_bf16 v165, v106, v241
    v_dot2c_f32_bf16 v166, v107, v240
    v_dot2c_f32_bf16 v167, v107, v241
    v_dot2c_f32_bf16 v160, v108, v240
    v_dot2c_f32_bf16 v161, v108, v241
    v_dot2c_f32_bf16 v162, v109, v240
    v_dot2c_f32_bf16 v163, v109, v241
    v_dot2c_f32_bf16 v164, v110, v240
    v_dot2c_f32_bf16 v165, v110, v241
    v_dot2c_f32_bf16 v166, v111, v240
    v_dot2c_f32_bf16 v167, v111, v241
    v_dot2c_f32_bf16 v160, v112, v240
    v_dot2c_f32_bf16 v161, v112, v241
    v_dot2c_f32_bf16 v162, v113, v240
    v_dot2c_f32_bf16 v163, v113, v241
    v_dot2c_f32_bf16 v164, v114, v240
    v_dot2c_f32_bf16 v165, v114, v241
    v_dot2c_f32_bf16 v166, v115, v240
    v_dot2c_f32_bf16 v167, v115, v241
    v_dot2c_f32_bf16 v160, v116, v240
    v_dot2c_f32_bf16 v161, v116, v241
    v_dot2c_f32_bf16 v162, v117, v240
    v_dot2c_f32_bf16 v163, v117, v241
    v_dot2c_f32_bf16 v164, v118, v240
    v_dot2c_f32_bf16 v165, v118, v241
    v_dot2c_f32_bf16 v166, v119, v240
    v_dot2c_f32_bf16 v167, v119, v241
    v_dot2c_f32_bf16 v160, v120, v240
    v_dot2c_f32_bf16 v161, v120, v241
    v_dot2c_f32_bf16 v162, v121, v240
    v_dot2c_f32_bf16 v163, v121, v241
    v_dot2c_f32_bf16 v164, v122, v240
    v_dot2c_f32_bf16 v165, v122, v241
    v_dot2c_f32_bf16 v166, v123, v240
    v_dot2c_f32_bf16 v167, v123, v241
    v_dot2c_f32_bf16 v160, v124, v240
    v_dot2c_f32_bf16 v161, v124, v241
    v_dot2c_f32_bf16 v162, v125, v240
    v_dot2c_f32_bf16 v163, v125, v241
    v_dot2c_f32_bf16 v164, v126, v240
    v_dot2c_f32_bf16 v165, v126, v241
    v_dot2c_f32_bf16 v166, v127, v240
    v_dot2c_f32_bf16 v167, v127, v241
    s_nop 2
    v_fmac_f32 v192, v208, v160
    v_fmac_f32 v193, v208, v161
    v_fmac_f32 v194, v208, v162
    v_fmac_f32 v195, v208, v163
    v_fmac_f32 v196, v208, v164
    v_fmac_f32 v197, v208, v165
    v_fmac_f32 v198, v208, v166
    v_fmac_f32 v199, v208, v167
    v_cvt_pk_bf16_f32 v168, v192, v193
    v_cvt_pk_bf16_f32 v169, v194, v195
    v_cvt_pk_bf16_f32 v170, v196, v197
    v_cvt_pk_bf16_f32 v171, v198, v199
    v_lshlrev_b32 v160, 16, v168
    v_and_b32 v161, 0xffff0000, v168
    v_lshlrev_b32 v162, 16, v169
    v_and_b32 v163, 0xffff0000, v169
    v_lshlrev_b32 v164, 16, v170
    v_and_b32 v165, 0xffff0000, v170
    v_lshlrev_b32 v166, 16, v171
    v_and_b32 v167, 0xffff0000, v171
    ds_write_b32 v238, v160 offset:0
    ds_write_b32 v238, v161 offset:2304
    ds_write_b32 v238, v162 offset:4608
    ds_write_b32 v238, v163 offset:6912
    ds_write_b32 v238, v164 offset:9216
    ds_write_b32 v238, v165 offset:11520
    ds_write_b32 v238, v166 offset:13824
    ds_write_b32 v238, v167 offset:16128
    buffer_store_dwordx4 v[168:171], v236, s[48:51], s44 offen sc1
    s_cmp_lg_u32 s3, 0
    s_cbranch_scc1 Lln_u1
    v_lshlrev_b32 v160, 16, v128
    v_and_b32 v161, 0xffff0000, v128
    v_lshlrev_b32 v162, 16, v129
    v_and_b32 v163, 0xffff0000, v129
    v_lshlrev_b32 v164, 16, v130
    v_and_b32 v165, 0xffff0000, v130
    v_lshlrev_b32 v166, 16, v131
    v_and_b32 v167, 0xffff0000, v131
    v_dot2c_f32_bf16 v160, v132, v240
    v_dot2c_f32_bf16 v161, v132, v241
    v_dot2c_f32_bf16 v162, v133, v240
    v_dot2c_f32_bf16 v163, v133, v241
    v_dot2c_f32_bf16 v164, v134, v240
    v_dot2c_f32_bf16 v165, v134, v241
    v_dot2c_f32_bf16 v166, v135, v240
    v_dot2c_f32_bf16 v167, v135, v241
    v_dot2c_f32_bf16 v160, v136, v240
    v_dot2c_f32_bf16 v161, v136, v241
    v_dot2c_f32_bf16 v162, v137, v240
    v_dot2c_f32_bf16 v163, v137, v241
    v_dot2c_f32_bf16 v164, v138, v240
    v_dot2c_f32_bf16 v165, v138, v241
    v_dot2c_f32_bf16 v166, v139, v240
    v_dot2c_f32_bf16 v167, v139, v241
    v_dot2c_f32_bf16 v160, v140, v240
    v_dot2c_f32_bf16 v161, v140, v241
    v_dot2c_f32_bf16 v162, v141, v240
    v_dot2c_f32_bf16 v163, v141, v241
    v_dot2c_f32_bf16 v164, v142, v240
    v_dot2c_f32_bf16 v165, v142, v241
    v_dot2c_f32_bf16 v166, v143, v240
    v_dot2c_f32_bf16 v167, v143, v241
    v_dot2c_f32_bf16 v160, v144, v240
    v_dot2c_f32_bf16 v161, v144, v241
    v_dot2c_f32_bf16 v162, v145, v240
    v_dot2c_f32_bf16 v163, v145, v241
    v_dot2c_f32_bf16 v164, v146, v240
    v_dot2c_f32_bf16 v165, v146, v241
    v_dot2c_f32_bf16 v166, v147, v240
    v_dot2c_f32_bf16 v167, v147, v241
    v_dot2c_f32_bf16 v160, v148, v240
    v_dot2c_f32_bf16 v161, v148, v241
    v_dot2c_f32_bf16 v162, v149, v240
    v_dot2c_f32_bf16 v163, v149, v241
    v_dot2c_f32_bf16 v164, v150, v240
    v_dot2c_f32_bf16 v165, v150, v241
    v_dot2c_f32_bf16 v166, v151, v240
    v_dot2c_f32_bf16 v167, v151, v241
    v_dot2c_f32_bf16 v160, v152, v240
    v_dot2c_f32_bf16 v161, v152, v241
    v_dot2c_f32_bf16 v162, v153, v240
    v_dot2c_f32_bf16 v163, v153, v241
    v_dot2c_f32_bf16 v164, v154, v240
    v_dot2c_f32_bf16 v165, v154, v241
    v_dot2c_f32_bf16 v166, v155, v240
    v_dot2c_f32_bf16 v167, v155, v241
    v_dot2c_f32_bf16 v160, v156, v240
    v_dot2c_f32_bf16 v161, v156, v241
    v_dot2c_f32_bf16 v162, v157, v240
    v_dot2c_f32_bf16 v163, v157, v241
    v_dot2c_f32_bf16 v164, v158, v240
    v_dot2c_f32_bf16 v165, v158, v241
    v_dot2c_f32_bf16 v166, v159, v240
    v_dot2c_f32_bf16 v167, v159, v241
    s_nop 2
    v_fmac_f32 v200, v209, v160
    v_fmac_f32 v201, v209, v161
    v_fmac_f32 v202, v209, v162
    v_fmac_f32 v203, v209, v163
    v_fmac_f32 v204, v209, v164
    v_fmac_f32 v205, v209, v165
    v_fmac_f32 v206, v209, v166
    v_fmac_f32 v207, v209, v167
    v_cvt_pk_bf16_f32 v172, v200, v201
    v_cvt_pk_bf16_f32 v173, v202, v203
    v_cvt_pk_bf16_f32 v174, v204, v205
    v_cvt_pk_bf16_f32 v175, v206, v207
    v_lshlrev_b32 v160, 16, v172
    v_and_b32 v161, 0xffff0000, v172
    v_lshlrev_b32 v162, 16, v173
    v_and_b32 v163, 0xffff0000, v173
    v_lshlrev_b32 v164, 16, v174
    v_and_b32 v165, 0xffff0000, v174
    v_lshlrev_b32 v166, 16, v175
    v_and_b32 v167, 0xffff0000, v175
    ds_write_b32 v238, v160 offset:2048
    ds_write_b32 v238, v161 offset:4352
    ds_write_b32 v238, v162 offset:6656
    ds_write_b32 v238, v163 offset:8960
    ds_write_b32 v238, v164 offset:11264
    ds_write_b32 v238, v165 offset:13568
    ds_write_b32 v238, v166 offset:15872
    ds_write_b32 v238, v167 offset:18176
    buffer_store_dwordx4 v[172:175], v237, s[48:51], s44 offen sc1
Lln_u1:
    s_waitcnt lgkmcnt(0)
    s_barrier
    s_cmp_eq_u32 s3, 4
    s_cselect_b32 s36, 1, 0
    s_cmp_ge_u32 s43, 8
    s_cselect_b32 s36, s36, 0
    s_cmp_lt_u32 s2, 216
    s_cselect_b32 s36, s36, 0
    s_cmp_eq_u32 s36, 0
    s_cbranch_scc1 Lln_n1
    buffer_load_dword v247, v7, s[96:99], 0 offen sc1
Lln_n1:
    ds_read_b32 v96, v239 offset:0
    ds_read_b32 v97, v239 offset:256
    ds_read_b32 v98, v239 offset:512
    ds_read_b32 v99, v239 offset:768
    ds_read_b32 v100, v239 offset:1024
    ds_read_b32 v101, v239 offset:1280
    ds_read_b32 v102, v239 offset:1536
    ds_read_b32 v103, v239 offset:1792
    ds_read_b32 v104, v239 offset:2048
    s_waitcnt lgkmcnt(0)
    v_add_f32 v108, v96, v97
    v_add_f32 v108, v108, v98
    v_add_f32 v108, v108, v99
    v_add_f32 v108, v108, v100
    v_add_f32 v108, v108, v101
    v_add_f32 v108, v108, v102
    v_add_f32 v108, v108, v103
    v_add_f32 v108, v108, v104
    s_nop 1
    v_add_f32_dpp v108, v108, v108 row_ror:8 row_mask:0xf bank_mask:0xf
    s_nop 1
    v_add_f32_dpp v108, v108, v108 row_ror:4 row_mask:0xf bank_mask:0xf
    s_nop 1
    v_add_f32_dpp v108, v108, v108 row_ror:2 row_mask:0xf bank_mask:0xf
    s_nop 1
    v_add_f32_dpp v108, v108, v108 row_ror:1 row_mask:0xf bank_mask:0xf
    v_mov_b32 v110, v108
    s_nop 1
    v_permlane16_swap_b32 v108, v110
    s_nop 1
    v_add_f32 v108, v108, v110
    v_mov_b32 v110, v108
    s_nop 1
    v_permlane32_swap_b32 v108, v110
    s_nop 1
    v_add_f32 v108, v108, v110
    v_mul_f32 v108, 0x3ae38e39, v108
    v_mov_b32 v109, 0
    v_sub_f32 v110, v96, v108
    v_fmac_f32 v109, v110, v110
    v_sub_f32 v110, v97, v108
    v_fmac_f32 v109, v110, v110
    v_sub_f32 v110, v98, v108
    v_fmac_f32 v109, v110, v110
    v_sub_f32 v110, v99, v108
    v_fmac_f32 v109, v110, v110
    v_sub_f32 v110, v100, v108
    v_fmac_f32 v109, v110, v110
    v_sub_f32 v110, v101, v108
    v_fmac_f32 v109, v110, v110
    v_sub_f32 v110, v102, v108
    v_fmac_f32 v109, v110, v110
    v_sub_f32 v110, v103, v108
    v_fmac_f32 v109, v110, v110
    v_sub_f32 v110, v104, v108
    v_fmac_f32 v109, v110, v110
    s_nop 1
    v_add_f32_dpp v109, v109, v109 row_ror:8 row_mask:0xf bank_mask:0xf
    s_nop 1
    v_add_f32_dpp v109, v109, v109 row_ror:4 row_mask:0xf bank_mask:0xf
    s_nop 1
    v_add_f32_dpp v109, v109, v109 row_ror:2 row_mask:0xf bank_mask:0xf
    s_nop 1
    v_add_f32_dpp v109, v109, v109 row_ror:1 row_mask:0xf bank_mask:0xf
    v_mov_b32 v110, v109
    s_nop 1
    v_permlane16_swap_b32 v109, v110
    s_nop 1
    v_add_f32 v109, v109, v110
    v_mov_b32 v110, v109
    s_nop 1
    v_permlane32_swap_b32 v109, v110
    s_nop 1
    v_add_f32 v109, v109, v110
    v_mul_f32 v109, 0x3ae38e39, v109
    v_cvt_pk_bf16_f32 v108, v108, v108
    v_and_b32 v108, 0xffff0000, v108
    v_cvt_pk_bf16_f32 v109, v109, v109
    v_and_b32 v109, 0xffff0000, v109
    v_add_f32 v109, 0x3727c5ac, v109
    v_cvt_pk_bf16_f32 v109, v109, v109
    v_and_b32 v109, 0xffff0000, v109
    v_sqrt_f32 v109, v109
    s_nop 0
    v_cvt_pk_bf16_f32 v109, v109, v109
    v_and_b32 v109, 0xffff0000, v109
    v_rcp_f32 v109, v109
    v_sub_f32 v96, v96, v108
    v_sub_f32 v97, v97, v108
    v_sub_f32 v98, v98, v108
    v_sub_f32 v99, v99, v108
    v_sub_f32 v100, v100, v108
    v_sub_f32 v101, v101, v108
    v_sub_f32 v102, v102, v108
    v_sub_f32 v103, v103, v108
    v_sub_f32 v104, v104, v108
    v_mul_f32 v96, v96, v109
    v_mul_f32 v97, v97, v109
    v_mul_f32 v98, v98, v109
    v_mul_f32 v99, v99, v109
    v_mul_f32 v100, v100, v109
    v_mul_f32 v101, v101, v109
    v_mul_f32 v102, v102, v109
    v_mul_f32 v103, v103, v109
    v_mul_f32 v104, v104, v109
    v_fma_f32 v96, v96, v220, v210
    v_fma_f32 v97, v97, v221, v211
    v_fma_f32 v98, v98, v222, v212
    v_fma_f32 v99, v99, v223, v213
    v_fma_f32 v100, v100, v224, v214
    v_fma_f32 v101, v101, v225, v215
    v_fma_f32 v102, v102, v226, v216
    v_fma_f32 v103, v103, v227, v217
    v_fma_f32 v104, v104, v228, v218
    v_add_f32 v108, v96, v97
    v_add_f32 v108, v108, v98
    v_add_f32 v108, v108, v99
    v_add_f32 v108, v108, v100
    v_add_f32 v108, v108, v101
    v_add_f32 v108, v108, v102
    v_add_f32 v108, v108, v103
    v_add_f32 v108, v108, v104
    s_nop 1
    v_add_f32_dpp v108, v108, v108 row_ror:8 row_mask:0xf bank_mask:0xf
    s_nop 1
    v_add_f32_dpp v108, v108, v108 row_ror:4 row_mask:0xf bank_mask:0xf
    s_nop 1
    v_add_f32_dpp v108, v108, v108 row_ror:2 row_mask:0xf bank_mask:0xf
    s_nop 1
    v_add_f32_dpp v108, v108, v108 row_ror:1 row_mask:0xf bank_mask:0xf
    v_mov_b32 v110, v108
    s_nop 1
    v_permlane16_swap_b32 v108, v110
    s_nop 1
    v_add_f32 v108, v108, v110
    v_mov_b32 v110, v108
    s_nop 1
    v_permlane32_swap_b32 v108, v110
    s_nop 1
    v_add_f32 v108, v108, v110
    v_mul_f32 v108, 0x3ae38e39, v108
    v_mov_b32 v109, 0
    v_sub_f32 v110, v96, v108
    v_fmac_f32 v109, v110, v110
    v_sub_f32 v110, v97, v108
    v_fmac_f32 v109, v110, v110
    v_sub_f32 v110, v98, v108
    v_fmac_f32 v109, v110, v110
    v_sub_f32 v110, v99, v108
    v_fmac_f32 v109, v110, v110
    v_sub_f32 v110, v100, v108
    v_fmac_f32 v109, v110, v110
    v_sub_f32 v110, v101, v108
    v_fmac_f32 v109, v110, v110
    v_sub_f32 v110, v102, v108
    v_fmac_f32 v109, v110, v110
    v_sub_f32 v110, v103, v108
    v_fmac_f32 v109, v110, v110
    v_sub_f32 v110, v104, v108
    v_fmac_f32 v109, v110, v110
    s_nop 1
    v_add_f32_dpp v109, v109, v109 row_ror:8 row_mask:0xf bank_mask:0xf
    s_nop 1
    v_add_f32_dpp v109, v109, v109 row_ror:4 row_mask:0xf bank_mask:0xf
    s_nop 1
    v_add_f32_dpp v109, v109, v109 row_ror:2 row_mask:0xf bank_mask:0xf
    s_nop 1
    v_add_f32_dpp v109, v109, v109 row_ror:1 row_mask:0xf bank_mask:0xf
    v_mov_b32 v110, v109
    s_nop 1
    v_permlane16_swap_b32 v109, v110
    s_nop 1
    v_add_f32 v109, v109, v110
    v_mov_b32 v110, v109
    s_nop 1
    v_permlane32_swap_b32 v109, v110
    s_nop 1
    v_add_f32 v109, v109, v110
    v_mul_f32 v109, 0x3ae38e39, v109
    v_cvt_pk_bf16_f32 v108, v108, v108
    v_and_b32 v108, 0xffff0000, v108
    v_cvt_pk_bf16_f32 v109, v109, v109
    v_and_b32 v109, 0xffff0000, v109
    v_add_f32 v109, 0x3727c5ac, v109
    v_cvt_pk_bf16_f32 v109, v109, v109
    v_and_b32 v109, 0xffff0000, v109
    v_sqrt_f32 v109, v109
    s_nop 0
    v_cvt_pk_bf16_f32 v109, v109, v109
    v_and_b32 v109, 0xffff0000, v109
    v_rcp_f32 v109, v109
    v_sub_f32 v96, v96, v108
    v_sub_f32 v97, v97, v108
    v_sub_f32 v98, v98, v108
    v_sub_f32 v99, v99, v108
    v_sub_f32 v100, v100, v108
    v_sub_f32 v101, v101, v108
    v_sub_f32 v102, v102, v108
    v_sub_f32 v103, v103, v108
    v_sub_f32 v104, v104, v108
    v_mul_f32 v96, v96, v109
    v_mul_f32 v97, v97, v109
    v_mul_f32 v98, v98, v109
    v_mul_f32 v99, v99, v109
    v_mul_f32 v100, v100, v109
    v_mul_f32 v101, v101, v109
    v_mul_f32 v102, v102, v109
    v_mul_f32 v103, v103, v109
    v_mul_f32 v104, v104, v109
    ds_write_b32 v239, v96 offset:0
    ds_write_b32 v239, v97 offset:256
    ds_write_b32 v239, v98 offset:512
    ds_write_b32 v239, v99 offset:768
    ds_write_b32 v239, v100 offset:1024
    ds_write_b32 v239, v101 offset:1280
    ds_write_b32 v239, v102 offset:1536
    ds_write_b32 v239, v103 offset:1792
    ds_write_b32 v239, v104 offset:2048
    s_cmp_eq_u32 s36, 0
    s_cbranch_scc1 Lln_n2
    s_waitcnt vmcnt(0)
    v_cmp_gt_u32 vcc, 16, v247
    s_nop 1
    s_cbranch_vccz Lln_n2
    s_mov_b32 s100, 0x8000
Lpoll1:
    buffer_load_dword v244, v7, s[96:99], 0 offen sc1
    s_waitcnt vmcnt(0)
    v_cmp_gt_u32 vcc, 16, v244
    s_sub_u32 s100, s100, 1
    s_cbranch_vccz Lpolld1
    s_cmp_eq_u32 s100, 0
    s_cbranch_scc1 Lpolld1
    s_sleep 1
    s_branch Lpoll1
Lpolld1:
Lln_n2:
    s_waitcnt lgkmcnt(0)
    s_barrier
    s_cmp_lt_u32 s3, 4
    s_cbranch_scc1 Lln_nf
    s_cmp_ge_u32 s2, 216
    s_cbranch_scc1 Lln_nf
    s_cmp_lt_u32 s43, 8
    s_cbranch_scc1 Lln_nf
    s_mov_b32 s40, 0
    s_add_u32 s32, s40, s38
    s_add_u32 m0, s32, 0
    s_add_u32 s33, s35, 0
    buffer_load_dwordx4 v1, s[12:15], s33 offen sc1 lds
    s_add_u32 m0, s32, 4096
    s_add_u32 s33, s35, 131072
    buffer_load_dwordx4 v1, s[12:15], s33 offen sc1 lds
    s_add_u32 m0, s32, 8192
    s_add_u32 s33, s35, 262144
    buffer_load_dwordx4 v1, s[12:15], s33 offen sc1 lds
    s_add_u32 s35, s35, 4096
    s_mov_b32 s40, 29696
    s_add_u32 s32, s40, s38
    s_add_u32 m0, s32, 0
    s_add_u32 s33, s35, 0
    buffer_load_dwordx4 v1, s[12:15], s33 offen sc1 lds
    s_add_u32 m0, s32, 4096
    s_add_u32 s33, s35, 131072
    buffer_load_dwordx4 v1, s[12:15], s33 offen sc1 lds
    s_add_u32 m0, s32, 8192
    s_add_u32 s33, s35, 262144
    buffer_load_dwordx4 v1, s[12:15], s33 offen sc1 lds
    s_add_u32 s35, s35, 4096
    s_mov_b32 s40, 59392
    s_add_u32 s32, s40, s38
    s_add_u32 m0, s32, 0
    s_add_u32 s33, s35, 0
    buffer_load_dwordx4 v1, s[12:15], s33 offen sc1 lds
    s_add_u32 m0, s32, 4096
    s_add_u32 s33, s35, 131072
    buffer_load_dwordx4 v1, s[12:15], s33 offen sc1 lds
    s_add_u32 m0, s32, 8192
    s_add_u32 s33, s35, 262144
    buffer_load_dwordx4 v1, s[12:15], s33 offen sc1 lds
    s_add_u32 s35, s35, 4096
    s_mov_b32 s40, 89088
    s_add_u32 s32, s40, s38
    s_add_u32 m0, s32, 0
    s_add_u32 s33, s35, 0
    buffer_load_dwordx4 v1, s[12:15], s33 offen sc1 lds
    s_add_u32 m0, s32, 4096
    s_add_u32 s33, s35, 131072
    buffer_load_dwordx4 v1, s[12:15], s33 offen sc1 lds
    s_add_u32 m0, s32, 8192
    s_add_u32 s33, s35, 262144
    buffer_load_dwordx4 v1, s[12:15], s33 offen sc1 lds
    s_add_u32 s35, s35, 4096
Lln_nf:
    s_lshl_b32 s32, s42, 9
    ds_read_b32 v96, v238 offset:0
    ds_read_b32 v97, v238 offset:2304
    ds_read_b32 v98, v238 offset:4608
    ds_read_b32 v99, v238 offset:6912
    ds_read_b32 v100, v238 offset:9216
    ds_read_b32 v101, v238 offset:11520
    ds_read_b32 v102, v238 offset:13824
    ds_read_b32 v103, v238 offset:16128
    s_waitcnt lgkmcnt(0)
    v_cvt_pk_bf16_f32 v112, v96, v97
    v_cvt_pk_bf16_f32 v113, v98, v99
    v_cvt_pk_bf16_f32 v114, v100, v101
    v_cvt_pk_bf16_f32 v115, v102, v103
    buffer_store_dwordx4 v[112:115], v230, s[52:55], s32 offen sc1
    s_cmp_lg_u32 s3, 0
    s_cbranch_scc1 Lln_u2
    ds_read_b32 v104, v238 offset:2048
    ds_read_b32 v105, v238 offset:4352
    ds_read_b32 v106, v238 offset:6656
    ds_read_b32 v107, v238 offset:8960
    ds_read_b32 v108, v238 offset:11264
    ds_read_b32 v109, v238 offset:13568
    ds_read_b32 v110, v238 offset:15872
    ds_read_b32 v111, v238 offset:18176
    s_waitcnt lgkmcnt(0)
    v_cvt_pk_bf16_f32 v116, v104, v105
    v_cvt_pk_bf16_f32 v117, v106, v107
    v_cvt_pk_bf16_f32 v118, v108, v109
    v_cvt_pk_bf16_f32 v119, v110, v111
    buffer_store_dwordx4 v[116:119], v231, s[52:55], s32 offen sc1
Lln_u2:
    s_cmp_ge_u32 s3, 4
    s_cbranch_scc1 Ll_after_ln
    s_cmp_lt_u32 s2, 216
    s_cbranch_scc1 Lc_g1
    s_waitcnt vmcnt(0)
    s_barrier
    s_branch Lc_g2
Lc_g1:
    s_cmp_ge_u32 s43, 8
    s_cbranch_scc1 Lc_g1b
    s_waitcnt vmcnt(0)
    s_barrier
    s_barrier
Lc_g1b:
    s_load_dwordx2 s[24:25], s[0:1], 64
    s_and_b32 s32, s2, 7
    s_mul_i32 s32, s32, 27
    s_lshr_b32 s33, s2, 3
    s_add_u32 s32, s32, s33
    s_mul_hi_u32 s28, s32, 0x2aaaaaab
    s_mul_i32 s33, s28, 6
    s_sub_u32 s29, s32, s33
    v_and_b32 v8, 63, v0
    v_lshlrev_b32 v1, 4, v8
    v_bfe_u32 v2, v8, 2, 2
    v_mul_u32_u24 v2, 1088, v2
    v_lshrrev_b32 v9, 5, v8
    v_lshl_add_u32 v2, v9, 9, v2
    v_bfe_u32 v9, v8, 4, 1
    v_lshl_add_u32 v2, v9, 5, v2
    v_and_b32 v9, 3, v8
    v_lshl_add_u32 v2, v9, 3, v2
    s_lshl_b32 s32, s3, 6
    v_add_u32 v4, s32, v2
    v_add_u32 v5, 17408, v1
    v_mov_b32 v2, v4
    v_mov_b32 v3, v5
    v_mov_b64 v[16:17], 0
    v_mov_b64 v[18:19], 0
    v_mov_b64 v[20:21], 0
    v_mov_b64 v[22:23], 0
    v_mov_b64 v[24:25], 0
    v_mov_b64 v[26:27], 0
    v_mov_b64 v[28:29], 0
    v_mov_b64 v[30:31], 0
    v_mov_b64 v[32:33], 0
    v_mov_b64 v[34:35], 0
    v_mov_b64 v[36:37], 0
    v_mov_b64 v[38:39], 0
    v_mov_b64 v[40:41], 0
    v_mov_b64 v[42:43], 0
    v_mov_b64 v[44:45], 0
    v_mov_b64 v[46:47], 0
    v_mov_b64 v[48:49], 0
    v_mov_b64 v[50:51], 0
    v_mov_b64 v[52:53], 0
    v_mov_b64 v[54:55], 0
    v_mov_b64 v[56:57], 0
    v_mov_b64 v[58:59], 0
    v_mov_b64 v[60:61], 0
    v_mov_b64 v[62:63], 0
    s_waitcnt lgkmcnt(0)
    s_mov_b32 s16, s24
    s_and_b32 s17, s25, 0xffff
    s_mov_b32 s18, 9216
    s_mov_b32 s19, 0x20000
    s_lshl_b32 s32, s28, 2
    s_add_u32 s45, s32, s3
    s_lshl_b32 s32, s45, 6
    v_lshrrev_b32 v9, 5, v8
    v_lshlrev_b32 v9, 3, v9
    buffer_load_dwordx2 v[152:153], v9, s[16:19], s32 offen offset:0
    buffer_load_dwordx2 v[154:155], v9, s[16:19], s32 offen offset:16
    buffer_load_dwordx2 v[156:157], v9, s[16:19], s32 offen offset:32
    buffer_load_dwordx2 v[158:159], v9, s[16:19], s32 offen offset:48
    s_add_u32 s20, s4, 76480512
    s_addc_u32 s21, s5, 0
    s_and_b32 s21, s21, 0xffff
    s_mov_b32 s22, 5308416
    s_mov_b32 s23, 0x20000
    v_bfe_u32 v9, v8, 4, 1
    v_mul_u32_u24 v9, 147456, v9
    v_lshrrev_b32 v10, 5, v8
    v_lshl_add_u32 v9, v10, 8, v9
    v_and_b32 v10, 15, v8
    v_lshl_add_u32 v6, v10, 4, v9
    s_mul_i32 s39, s29, 884736
    s_lshl_b32 s33, s45, 10
    s_add_u32 s39, s39, s33
    s_mov_b32 s40, 0
    s_mov_b32 s41, 32
    s_barrier
    ds_read_b64_tr_b16 v[64:65], v2 offset:0
    ds_read_b64_tr_b16 v[66:67], v2 offset:256
    ds_read_b128 v[68:71], v3 offset:0
    ds_read_b128 v[72:75], v3 offset:4096
    ds_read_b128 v[76:79], v3 offset:8192
    ds_read_b64_tr_b16 v[80:81], v2 offset:4352
    ds_read_b64_tr_b16 v[82:83], v2 offset:4608
    ds_read_b128 v[84:87], v3 offset:1024
    ds_read_b128 v[88:91], v3 offset:5120
    ds_read_b128 v[92:95], v3 offset:9216
Lm1_cloop:
    s_waitcnt lgkmcnt(5)
    v_mfma_f32_32x32x16_bf16 v[16:31], v[64:67], v[68:71], v[16:31]
    ds_read_b64_tr_b16 v[96:97], v2 offset:8704
    ds_read_b64_tr_b16 v[98:99], v2 offset:8960
    v_mfma_f32_32x32x16_bf16 v[32:47], v[64:67], v[72:75], v[32:47]
    ds_read_b128 v[100:103], v3 offset:2048
    ds_read_b128 v[104:107], v3 offset:6144
    v_mfma_f32_32x32x16_bf16 v[48:63], v[64:67], v[76:79], v[48:63]
    ds_read_b128 v[108:111], v3 offset:10240
    ds_read_b64_tr_b16 v[112:113], v2 offset:13056
    s_waitcnt lgkmcnt(6)
    v_mfma_f32_32x32x16_bf16 v[16:31], v[80:83], v[84:87], v[16:31]
    ds_read_b64_tr_b16 v[114:115], v2 offset:13312
    ds_read_b128 v[116:119], v3 offset:3072
    s_add_u32 s40, s40, 29696
    s_cmp_eq_u32 s40, 148480
    s_cselect_b32 s40, 0, s40
    v_mfma_f32_32x32x16_bf16 v[32:47], v[80:83], v[88:91], v[32:47]
    ds_read_b128 v[120:123], v3 offset:7168
    ds_read_b128 v[124:127], v3 offset:11264
    v_mfma_f32_32x32x16_bf16 v[48:63], v[80:83], v[92:95], v[48:63]
    v_add_u32 v2, s40, v4
    v_add_u32 v3, s40, v5
    s_waitcnt lgkmcnt(5)
    v_mfma_f32_32x32x16_bf16 v[16:31], v[96:99], v[100:103], v[16:31]
    ds_read_b64_tr_b16 v[64:65], v2 offset:0
    ds_read_b64_tr_b16 v[66:67], v2 offset:256
    v_mfma_f32_32x32x16_bf16 v[32:47], v[96:99], v[104:107], v[32:47]
    ds_read_b128 v[68:71], v3 offset:0
    ds_read_b128 v[72:75], v3 offset:4096
    v_mfma_f32_32x32x16_bf16 v[48:63], v[96:99], v[108:111], v[48:63]
    ds_read_b128 v[76:79], v3 offset:8192
    ds_read_b64_tr_b16 v[80:81], v2 offset:4352
    s_waitcnt lgkmcnt(6)
    v_mfma_f32_32x32x16_bf16 v[16:31], v[112:115], v[116:119], v[16:31]
    ds_read_b64_tr_b16 v[82:83], v2 offset:4608
    ds_read_b128 v[84:87], v3 offset:1024
    v_mfma_f32_32x32x16_bf16 v[32:47], v[112:115], v[120:123], v[32:47]
    ds_read_b128 v[88:91], v3 offset:5120
    ds_read_b128 v[92:95], v3 offset:9216
    v_mfma_f32_32x32x16_bf16 v[48:63], v[112:115], v[124:127], v[48:63]
    s_sub_u32 s41, s41, 1
    s_cmp_lg_u32 s41, 0
    s_waitcnt vmcnt(0)
    s_barrier
    s_cbranch_scc1 Lm1_cloop
    s_mul_i32 s32, s3, 6144
    s_add_u32 s32, s32, 114688
    v_add_u32 v4, s32, v1
    s_waitcnt lgkmcnt(0)
    s_nop 3
    ds_write_b128 v4, v[40:43] offset:0
    ds_write_b128 v4, v[44:47] offset:1024
    ds_write_b128 v4, v[48:51] offset:2048
    ds_write_b128 v4, v[52:55] offset:3072
    ds_write_b128 v4, v[56:59] offset:4096
    ds_write_b128 v4, v[60:63] offset:5120
    s_waitcnt lgkmcnt(0)
    s_barrier
    s_waitcnt vmcnt(0)
    v_lshlrev_b32 v160, 16, v152
    v_and_b32 v161, 0xffff0000, v152
    v_lshlrev_b32 v162, 16, v153
    v_and_b32 v163, 0xffff0000, v153
    v_lshlrev_b32 v164, 16, v154
    v_and_b32 v165, 0xffff0000, v154
    v_lshlrev_b32 v166, 16, v155
    v_and_b32 v167, 0xffff0000, v155
    v_lshlrev_b32 v168, 16, v156
    v_and_b32 v169, 0xffff0000, v156
    v_lshlrev_b32 v170, 16, v157
    v_and_b32 v171, 0xffff0000, v157
    v_lshlrev_b32 v172, 16, v158
    v_and_b32 v173, 0xffff0000, v158
    v_lshlrev_b32 v174, 16, v159
    v_and_b32 v175, 0xffff0000, v159
    v_mov_b32 v10, 0xc0135761
    v_mov_b32 v11, 0xbdd2d3e8
    v_add_f32 v16, v16, v160
    v_add_f32 v17, v17, v161
    v_add_f32 v18, v18, v162
    v_add_f32 v19, v19, v163
    v_add_f32 v20, v20, v164
    v_add_f32 v21, v21, v165
    v_add_f32 v22, v22, v166
    v_add_f32 v23, v23, v167
    v_mul_f32 v64, v16, v16
    v_mul_f32 v65, v17, v17
    v_mul_f32 v66, v18, v18
    v_mul_f32 v67, v19, v19
    v_mul_f32 v68, v20, v20
    v_mul_f32 v69, v21, v21
    v_mul_f32 v70, v22, v22
    v_mul_f32 v71, v23, v23
    v_fma_f32 v64, v64, v11, v10
    v_fma_f32 v65, v65, v11, v10
    v_fma_f32 v66, v66, v11, v10
    v_fma_f32 v67, v67, v11, v10
    v_fma_f32 v68, v68, v11, v10
    v_fma_f32 v69, v69, v11, v10
    v_fma_f32 v70, v70, v11, v10
    v_fma_f32 v71, v71, v11, v10
    v_mul_f32 v64, v64, v16
    v_mul_f32 v65, v65, v17
    v_mul_f32 v66, v66, v18
    v_mul_f32 v67, v67, v19
    v_mul_f32 v68, v68, v20
    v_mul_f32 v69, v69, v21
    v_mul_f32 v70, v70, v22
    v_mul_f32 v71, v71, v23
    v_exp_f32 v64, v64
    v_exp_f32 v65, v65
    v_exp_f32 v66, v66
    v_exp_f32 v67, v67
    v_exp_f32 v68, v68
    v_exp_f32 v69, v69
    v_exp_f32 v70, v70
    v_exp_f32 v71, v71
    v_add_f32 v64, 1.0, v64
    v_add_f32 v65, 1.0, v65
    v_add_f32 v66, 1.0, v66
    v_add_f32 v67, 1.0, v67
    v_add_f32 v68, 1.0, v68
    v_add_f32 v69, 1.0, v69
    v_add_f32 v70, 1.0, v70
    v_add_f32 v71, 1.0, v71
    v_rcp_f32 v64, v64
    v_rcp_f32 v65, v65
    v_rcp_f32 v66, v66
    v_rcp_f32 v67, v67
    v_rcp_f32 v68, v68
    v_rcp_f32 v69, v69
    v_rcp_f32 v70, v70
    v_rcp_f32 v71, v71
    v_mul_f32 v16, v16, v64
    v_mul_f32 v17, v17, v65
    v_mul_f32 v18, v18, v66
    v_mul_f32 v19, v19, v67
    v_mul_f32 v20, v20, v68
    v_mul_f32 v21, v21, v69
    v_mul_f32 v22, v22, v70
    v_mul_f32 v23, v23, v71
    v_cvt_pk_bf16_f32 v64, v16, v17
    v_cvt_pk_bf16_f32 v65, v18, v19
    v_cvt_pk_bf16_f32 v66, v20, v21
    v_cvt_pk_bf16_f32 v67, v22, v23
    s_add_u32 s32, s39, 0
    buffer_store_dwordx4 v[64:67], v6, s[20:23], s32 offen offset:0 sc1
    v_add_f32 v24, v24, v168
    v_add_f32 v25, v25, v169
    v_add_f32 v26, v26, v170
    v_add_f32 v27, v27, v171
    v_add_f32 v28, v28, v172
    v_add_f32 v29, v29, v173
    v_add_f32 v30, v30, v174
    v_add_f32 v31, v31, v175
    v_mul_f32 v72, v24, v24
    v_mul_f32 v73, v25, v25
    v_mul_f32 v74, v26, v26
    v_mul_f32 v75, v27, v27
    v_mul_f32 v76, v28, v28
    v_mul_f32 v77, v29, v29
    v_mul_f32 v78, v30, v30
    v_mul_f32 v79, v31, v31
    v_fma_f32 v72, v72, v11, v10
    v_fma_f32 v73, v73, v11, v10
    v_fma_f32 v74, v74, v11, v10
    v_fma_f32 v75, v75, v11, v10
    v_fma_f32 v76, v76, v11, v10
    v_fma_f32 v77, v77, v11, v10
    v_fma_f32 v78, v78, v11, v10
    v_fma_f32 v79, v79, v11, v10
    v_mul_f32 v72, v72, v24
    v_mul_f32 v73, v73, v25
    v_mul_f32 v74, v74, v26
    v_mul_f32 v75, v75, v27
    v_mul_f32 v76, v76, v28
    v_mul_f32 v77, v77, v29
    v_mul_f32 v78, v78, v30
    v_mul_f32 v79, v79, v31
    v_exp_f32 v72, v72
    v_exp_f32 v73, v73
    v_exp_f32 v74, v74
    v_exp_f32 v75, v75
    v_exp_f32 v76, v76
    v_exp_f32 v77, v77
    v_exp_f32 v78, v78
    v_exp_f32 v79, v79
    v_add_f32 v72, 1.0, v72
    v_add_f32 v73, 1.0, v73
    v_add_f32 v74, 1.0, v74
    v_add_f32 v75, 1.0, v75
    v_add_f32 v76, 1.0, v76
    v_add_f32 v77, 1.0, v77
    v_add_f32 v78, 1.0, v78
    v_add_f32 v79, 1.0, v79
    v_rcp_f32 v72, v72
    v_rcp_f32 v73, v73
    v_rcp_f32 v74, v74
    v_rcp_f32 v75, v75
    v_rcp_f32 v76, v76
    v_rcp_f32 v77, v77
    v_rcp_f32 v78, v78
    v_rcp_f32 v79, v79
    v_mul_f32 v24, v24, v72
    v_mul_f32 v25, v25, v73
    v_mul_f32 v26, v26, v74
    v_mul_f32 v27, v27, v75
    v_mul_f32 v28, v28, v76
    v_mul_f32 v29, v29, v77
    v_mul_f32 v30, v30, v78
    v_mul_f32 v31, v31, v79
    v_cvt_pk_bf16_f32 v72, v24, v25
    v_cvt_pk_bf16_f32 v73, v26, v27
    v_cvt_pk_bf16_f32 v74, v28, v29
    v_cvt_pk_bf16_f32 v75, v30, v31
    s_add_u32 s32, s39, 0
    buffer_store_dwordx4 v[72:75], v6, s[20:23], s32 offen offset:512 sc1
    v_add_f32 v32, v32, v160
    v_add_f32 v33, v33, v161
    v_add_f32 v34, v34, v162
    v_add_f32 v35, v35, v163
    v_add_f32 v36, v36, v164
    v_add_f32 v37, v37, v165
    v_add_f32 v38, v38, v166
    v_add_f32 v39, v39, v167
    v_mul_f32 v80, v32, v32
    v_mul_f32 v81, v33, v33
    v_mul_f32 v82, v34, v34
    v_mul_f32 v83, v35, v35
    v_mul_f32 v84, v36, v36
    v_mul_f32 v85, v37, v37
    v_mul_f32 v86, v38, v38
    v_mul_f32 v87, v39, v39
    v_fma_f32 v80, v80, v11, v10
    v_fma_f32 v81, v81, v11, v10
    v_fma_f32 v82, v82, v11, v10
    v_fma_f32 v83, v83, v11, v10
    v_fma_f32 v84, v84, v11, v10
    v_fma_f32 v85, v85, v11, v10
    v_fma_f32 v86, v86, v11, v10
    v_fma_f32 v87, v87, v11, v10
    v_mul_f32 v80, v80, v32
    v_mul_f32 v81, v81, v33
    v_mul_f32 v82, v82, v34
    v_mul_f32 v83, v83, v35
    v_mul_f32 v84, v84, v36
    v_mul_f32 v85, v85, v37
    v_mul_f32 v86, v86, v38
    v_mul_f32 v87, v87, v39
    v_exp_f32 v80, v80
    v_exp_f32 v81, v81
    v_exp_f32 v82, v82
    v_exp_f32 v83, v83
    v_exp_f32 v84, v84
    v_exp_f32 v85, v85
    v_exp_f32 v86, v86
    v_exp_f32 v87, v87
    v_add_f32 v80, 1.0, v80
    v_add_f32 v81, 1.0, v81
    v_add_f32 v82, 1.0, v82
    v_add_f32 v83, 1.0, v83
    v_add_f32 v84, 1.0, v84
    v_add_f32 v85, 1.0, v85
    v_add_f32 v86, 1.0, v86
    v_add_f32 v87, 1.0, v87
    v_rcp_f32 v80, v80
    v_rcp_f32 v81, v81
    v_rcp_f32 v82, v82
    v_rcp_f32 v83, v83
    v_rcp_f32 v84, v84
    v_rcp_f32 v85, v85
    v_rcp_f32 v86, v86
    v_rcp_f32 v87, v87
    v_mul_f32 v32, v32, v80
    v_mul_f32 v33, v33, v81
    v_mul_f32 v34, v34, v82
    v_mul_f32 v35, v35, v83
    v_mul_f32 v36, v36, v84
    v_mul_f32 v37, v37, v85
    v_mul_f32 v38, v38, v86
    v_mul_f32 v39, v39, v87
    v_cvt_pk_bf16_f32 v80, v32, v33
    v_cvt_pk_bf16_f32 v81, v34, v35
    v_cvt_pk_bf16_f32 v82, v36, v37
    v_cvt_pk_bf16_f32 v83, v38, v39
    s_add_u32 s32, s39, 294912
    buffer_store_dwordx4 v[80:83], v6, s[20:23], s32 offen offset:0 sc1
    s_waitcnt vmcnt(0)
    s_barrier
Lc_g2:
    s_bfe_u32 s28, s2, 0x20001
    s_and_b32 s29, s2, 1
    s_lshl_b32 s29, s29, 3
    s_lshr_b32 s30, s2, 5
    s_add_u32 s29, s29, s30
    s_bfe_u32 s30, s2, 0x20003
    v_and_b32 v8, 63, v0
    v_lshlrev_b32 v1, 4, v8
    v_bfe_u32 v2, v8, 4, 1
    v_lshlrev_b32 v2, 2, v2
    v_bfe_u32 v9, v8, 2, 2
    v_add_u32 v2, v2, v9
    v_lshrrev_b32 v9, 5, v8
    v_and_b32 v10, 3, v8
    v_mul_u32_u24 v2, 1056, v2
    v_lshl_add_u32 v2, v9, 9, v2
    v_lshl_add_u32 v2, v10, 3, v2
    s_lshl_b32 s35, s3, 6
    s_add_u32 s35, s35, 20480
    v_add_u32 v4, s35, v2
    v_mov_b32 v5, v1
    v_mov_b32 v2, v4
    v_mov_b32 v3, v5
    v_mov_b64 v[16:17], 0
    v_mov_b64 v[18:19], 0
    v_mov_b64 v[20:21], 0
    v_mov_b64 v[22:23], 0
    v_mov_b64 v[24:25], 0
    v_mov_b64 v[26:27], 0
    v_mov_b64 v[28:29], 0
    v_mov_b64 v[30:31], 0
    v_mov_b64 v[32:33], 0
    v_mov_b64 v[34:35], 0
    v_mov_b64 v[36:37], 0
    v_mov_b64 v[38:39], 0
    v_mov_b64 v[40:41], 0
    v_mov_b64 v[42:43], 0
    v_mov_b64 v[44:45], 0
    v_mov_b64 v[46:47], 0
    v_mov_b64 v[48:49], 0
    v_mov_b64 v[50:51], 0
    v_mov_b64 v[52:53], 0
    v_mov_b64 v[54:55], 0
    v_mov_b64 v[56:57], 0
    v_mov_b64 v[58:59], 0
    v_mov_b64 v[60:61], 0
    v_mov_b64 v[62:63], 0
    v_mov_b64 v[64:65], 0
    v_mov_b64 v[66:67], 0
    v_mov_b64 v[68:69], 0
    v_mov_b64 v[70:71], 0
    v_mov_b64 v[72:73], 0
    v_mov_b64 v[74:75], 0
    v_mov_b64 v[76:77], 0
    v_mov_b64 v[78:79], 0
    v_mov_b64 v[80:81], 0
    v_mov_b64 v[82:83], 0
    v_mov_b64 v[84:85], 0
    v_mov_b64 v[86:87], 0
    s_add_u32 s20, s4, 81788928
    s_addc_u32 s21, s5, 0
    s_and_b32 s21, s21, 0xffff
    s_mov_b32 s22, 9437184
    s_mov_b32 s23, 0x20000
    v_bfe_u32 v6, v8, 4, 1
    v_lshlrev_b32 v6, 1, v6
    v_lshrrev_b32 v9, 5, v8
    v_add_u32 v6, v6, v9
    v_mul_u32_u24 v6, 9216, v6
    v_and_b32 v9, 15, v8
    v_lshl_add_u32 v6, v9, 4, v6
    s_load_dwordx2 s[46:47], s[0:1], 80
    s_load_dwordx2 s[52:53], s[0:1], 104
    s_bfe_u32 s32, s2, 0x20001
    s_lshl_b32 s32, s32, 2
    s_bfe_u32 s33, s2, 0x20003
    s_add_u32 s32, s32, s33
    s_and_b32 s43, s2, 1
    s_lshl_b32 s43, s43, 3
    s_lshr_b32 s33, s2, 5
    s_add_u32 s43, s43, s33
    s_lshl_b32 s42, s43, 4
    s_add_u32 s42, s42, s32
    s_mul_i32 s44, s42, 9216
    v_mov_b32 v232, v0
    v_add_u32 v233, 512, v0
    v_cmp_gt_u32 vcc, 64, v0
    v_mov_b32 v234, 0x0ffffff0
    s_nop 1
    v_cndmask_b32 v233, v234, v233, vcc
    v_lshlrev_b32 v236, 4, v232
    v_lshlrev_b32 v237, 4, v233
    v_mov_b32 v240, 0x3f80
    v_mov_b32 v241, 0x3f800000
    s_add_u32 s48, s4, 65536
    s_addc_u32 s49, s5, 0
    s_and_b32 s49, s49, 0xffff
    s_mov_b32 s50, 13824
    s_mov_b32 s51, 0x20000
    v_lshlrev_b32 v238, 2, v232
    v_lshlrev_b32 v239, 2, v233
    s_mov_b32 s32, 11520
    buffer_load_dword v208, v238, s[48:51], s32 offen sc1
    buffer_load_dword v209, v239, s[48:51], s32 offen sc1
    s_add_u32 s48, s4, 71761920
    s_addc_u32 s49, s5, 0
    s_and_b32 s49, s49, 0xffff
    s_mov_b32 s50, 2359296
    s_mov_b32 s51, 0x20000
    buffer_load_dwordx4 v[192:195], v236, s[48:51], s44 offen sc1
    buffer_load_dwordx4 v[196:199], v237, s[48:51], s44 offen sc1
    v_lshlrev_b32 v230, 1, v232
    v_lshlrev_b32 v231, 1, v233
    s_waitcnt lgkmcnt(0)
    s_lshl_b32 s32, s42, 4
    s_add_u32 s46, s46, s32
    s_addc_u32 s47, s47, 0
    s_load_dwordx4 s[36:39], s[46:47], 0
    s_mov_b32 s24, s52
    s_and_b32 s25, s53, 0xffff
    s_mov_b32 s26, 2359296
    s_mov_b32 s27, 0x20000
    s_waitcnt lgkmcnt(0)
    s_mov_b32 s40, 0
    s_mov_b32 s41, 18
    s_mov_b32 s45, 1
    s_lshl_b32 s34, s28, 8
    s_lshl_b32 s33, s29, 4
    s_add_u32 s34, s34, s33
    s_lshl_b32 s33, s3, 2
    s_add_u32 s34, s34, s33
    s_mul_i32 s34, s34, 9216
    s_mul_i32 s33, s30, 2304
    s_add_u32 s34, s34, s33
    s_barrier
    s_barrier
    ds_read_b64_tr_b16 v[96:97], v2 offset:0
    ds_read_b64_tr_b16 v[98:99], v2 offset:256
    ds_read_b64_tr_b16 v[100:101], v2 offset:32
    ds_read_b64_tr_b16 v[102:103], v2 offset:288
    ds_read_b128 v[104:107], v3 offset:0
    ds_read_b128 v[108:111], v3 offset:2048
    ds_read_b128 v[112:115], v3 offset:4096
    ds_read_b128 v[116:119], v3 offset:6144
    ds_read_b128 v[120:123], v3 offset:8192
    ds_read_b128 v[124:127], v3 offset:10240
    ds_read_b128 v[128:131], v3 offset:12288
    ds_read_b128 v[132:135], v3 offset:14336
    ds_read_b128 v[136:139], v3 offset:16384
    s_branch Lgy_cin
Lgy_cloop:
    s_barrier
Lgy_cin:
    s_waitcnt lgkmcnt(3)
    v_mfma_f32_16x16x32_bf16 v[16:19], v[96:99], v[104:107], v[16:19]
    v_mfma_f32_16x16x32_bf16 v[52:55], v[100:103], v[104:107], v[52:55]
    ds_read_b64_tr_b16 v[144:145], v2 offset:8448
    v_mfma_f32_16x16x32_bf16 v[20:23], v[96:99], v[108:111], v[20:23]
    ds_read_b64_tr_b16 v[146:147], v2 offset:8704
    v_mfma_f32_16x16x32_bf16 v[56:59], v[100:103], v[108:111], v[56:59]
    ds_read_b64_tr_b16 v[148:149], v2 offset:8480
    v_mfma_f32_16x16x32_bf16 v[24:27], v[96:99], v[112:115], v[24:27]
    ds_read_b64_tr_b16 v[150:151], v2 offset:8736
    v_mfma_f32_16x16x32_bf16 v[60:63], v[100:103], v[112:115], v[60:63]
    v_mfma_f32_16x16x32_bf16 v[28:31], v[96:99], v[116:119], v[28:31]
    ds_read_b128 v[152:155], v3 offset:1024
    v_mfma_f32_16x16x32_bf16 v[64:67], v[100:103], v[116:119], v[64:67]
    ds_read_b128 v[156:159], v3 offset:3072
    v_mfma_f32_16x16x32_bf16 v[32:35], v[96:99], v[120:123], v[32:35]
    ds_read_b128 v[160:163], v3 offset:5120
    v_mfma_f32_16x16x32_bf16 v[68:71], v[100:103], v[120:123], v[68:71]
    ds_read_b128 v[164:167], v3 offset:7168
    v_mfma_f32_16x16x32_bf16 v[36:39], v[96:99], v[124:127], v[36:39]
    v_mfma_f32_16x16x32_bf16 v[72:75], v[100:103], v[124:127], v[72:75]
    ds_read_b128 v[168:171], v3 offset:9216
    s_waitcnt lgkmcnt(9)
    v_mfma_f32_16x16x32_bf16 v[40:43], v[96:99], v[128:131], v[40:43]
    ds_read_b128 v[172:175], v3 offset:11264
    v_mfma_f32_16x16x32_bf16 v[76:79], v[100:103], v[128:131], v[76:79]
    ds_read_b128 v[176:179], v3 offset:13312
    v_mfma_f32_16x16x32_bf16 v[44:47], v[96:99], v[132:135], v[44:47]
    ds_read_b128 v[180:183], v3 offset:15360
    s_add_u32 s40, s40, 37376
    s_cmp_eq_u32 s40, 149504
    s_cselect_b32 s40, 0, s40
    v_mfma_f32_16x16x32_bf16 v[80:83], v[100:103], v[132:135], v[80:83]
    ds_read_b128 v[184:187], v3 offset:17408
    v_mfma_f32_16x16x32_bf16 v[48:51], v[96:99], v[136:139], v[48:51]
    v_add_u32 v2, s40, v4
    v_mfma_f32_16x16x32_bf16 v[84:87], v[100:103], v[136:139], v[84:87]
    v_add_u32 v3, s40, v5
    s_waitcnt lgkmcnt(3)
    v_mfma_f32_16x16x32_bf16 v[16:19], v[144:147], v[152:155], v[16:19]
    v_mfma_f32_16x16x32_bf16 v[52:55], v[148:151], v[152:155], v[52:55]
    ds_read_b64_tr_b16 v[96:97], v2 offset:0
    v_mfma_f32_16x16x32_bf16 v[20:23], v[144:147], v[156:159], v[20:23]
    ds_read_b64_tr_b16 v[98:99], v2 offset:256
    v_mfma_f32_16x16x32_bf16 v[56:59], v[148:151], v[156:159], v[56:59]
    ds_read_b64_tr_b16 v[100:101], v2 offset:32
    v_mfma_f32_16x16x32_bf16 v[24:27], v[144:147], v[160:163], v[24:27]
    ds_read_b64_tr_b16 v[102:103], v2 offset:288
    v_mfma_f32_16x16x32_bf16 v[60:63], v[148:151], v[160:163], v[60:63]
    v_mfma_f32_16x16x32_bf16 v[28:31], v[144:147], v[164:167], v[28:31]
    ds_read_b128 v[104:107], v3 offset:0
    v_mfma_f32_16x16x32_bf16 v[64:67], v[148:151], v[164:167], v[64:67]
    ds_read_b128 v[108:111], v3 offset:2048
    v_mfma_f32_16x16x32_bf16 v[32:35], v[144:147], v[168:171], v[32:35]
    ds_read_b128 v[112:115], v3 offset:4096
    v_mfma_f32_16x16x32_bf16 v[68:71], v[148:151], v[168:171], v[68:71]
    ds_read_b128 v[116:119], v3 offset:6144
    v_mfma_f32_16x16x32_bf16 v[36:39], v[144:147], v[172:175], v[36:39]
    v_mfma_f32_16x16x32_bf16 v[72:75], v[148:151], v[172:175], v[72:75]
    ds_read_b128 v[120:123], v3 offset:8192
    s_waitcnt lgkmcnt(9)
    v_mfma_f32_16x16x32_bf16 v[40:43], v[144:147], v[176:179], v[40:43]
    ds_read_b128 v[124:127], v3 offset:10240
    v_mfma_f32_16x16x32_bf16 v[76:79], v[148:151], v[176:179], v[76:79]
    ds_read_b128 v[128:131], v3 offset:12288
    v_mfma_f32_16x16x32_bf16 v[44:47], v[144:147], v[180:183], v[44:47]
    ds_read_b128 v[132:135], v3 offset:14336
    v_mfma_f32_16x16x32_bf16 v[80:83], v[148:151], v[180:183], v[80:83]
    ds_read_b128 v[136:139], v3 offset:16384
    v_mfma_f32_16x16x32_bf16 v[48:51], v[144:147], v[184:187], v[48:51]
    s_sub_u32 s41, s41, 1
    v_mfma_f32_16x16x32_bf16 v[84:87], v[148:151], v[184:187], v[84:87]
    s_cmp_lg_u32 s41, 0
    s_cbranch_scc1 Lgy_cloop
Lgy_cend:
    s_nop 4
    v_cvt_pk_bf16_f32 v16, v16, v17
    v_cvt_pk_bf16_f32 v17, v18, v19
    v_cvt_pk_bf16_f32 v18, v52, v53
    v_cvt_pk_bf16_f32 v19, v54, v55
    v_cvt_pk_bf16_f32 v20, v20, v21
    v_cvt_pk_bf16_f32 v21, v22, v23
    v_cvt_pk_bf16_f32 v22, v56, v57
    v_cvt_pk_bf16_f32 v23, v58, v59
    v_cvt_pk_bf16_f32 v24, v24, v25
    v_cvt_pk_bf16_f32 v25, v26, v27
    v_cvt_pk_bf16_f32 v26, v60, v61
    v_cvt_pk_bf16_f32 v27, v62, v63
    v_cvt_pk_bf16_f32 v28, v28, v29
    v_cvt_pk_bf16_f32 v29, v30, v31
    v_cvt_pk_bf16_f32 v30, v64, v65
    v_cvt_pk_bf16_f32 v31, v66, v67
    v_cvt_pk_bf16_f32 v32, v32, v33
    v_cvt_pk_bf16_f32 v33, v34, v35
    v_cvt_pk_bf16_f32 v34, v68, v69
    v_cvt_pk_bf16_f32 v35, v70, v71
    v_cvt_pk_bf16_f32 v36, v36, v37
    v_cvt_pk_bf16_f32 v37, v38, v39
    v_cvt_pk_bf16_f32 v38, v72, v73
    v_cvt_pk_bf16_f32 v39, v74, v75
    v_cvt_pk_bf16_f32 v40, v40, v41
    v_cvt_pk_bf16_f32 v41, v42, v43
    v_cvt_pk_bf16_f32 v42, v76, v77
    v_cvt_pk_bf16_f32 v43, v78, v79
    v_cvt_pk_bf16_f32 v44, v44, v45
    v_cvt_pk_bf16_f32 v45, v46, v47
    v_cvt_pk_bf16_f32 v46, v80, v81
    v_cvt_pk_bf16_f32 v47, v82, v83
    v_cvt_pk_bf16_f32 v48, v48, v49
    v_cvt_pk_bf16_f32 v49, v50, v51
    v_cvt_pk_bf16_f32 v50, v84, v85
    v_cvt_pk_bf16_f32 v51, v86, v87
    v_permlane16_swap_b32 v16, v18
    v_permlane16_swap_b32 v17, v19
    buffer_store_dwordx4 v[16:19], v6, s[20:23], s34 offen offset:0 sc1
    v_permlane16_swap_b32 v20, v22
    v_permlane16_swap_b32 v21, v23
    buffer_store_dwordx4 v[20:23], v6, s[20:23], s34 offen offset:256 sc1
    v_permlane16_swap_b32 v24, v26
    v_permlane16_swap_b32 v25, v27
    buffer_store_dwordx4 v[24:27], v6, s[20:23], s34 offen offset:512 sc1
    v_permlane16_swap_b32 v28, v30
    v_permlane16_swap_b32 v29, v31
    buffer_store_dwordx4 v[28:31], v6, s[20:23], s34 offen offset:768 sc1
    v_permlane16_swap_b32 v32, v34
    v_permlane16_swap_b32 v33, v35
    buffer_store_dwordx4 v[32:35], v6, s[20:23], s34 offen offset:1024 sc1
    v_permlane16_swap_b32 v36, v38
    v_permlane16_swap_b32 v37, v39
    buffer_store_dwordx4 v[36:39], v6, s[20:23], s34 offen offset:1280 sc1
    v_permlane16_swap_b32 v40, v42
    v_permlane16_swap_b32 v41, v43
    buffer_store_dwordx4 v[40:43], v6, s[20:23], s34 offen offset:1536 sc1
    v_permlane16_swap_b32 v44, v46
    v_permlane16_swap_b32 v45, v47
    buffer_store_dwordx4 v[44:47], v6, s[20:23], s34 offen offset:1792 sc1
    v_permlane16_swap_b32 v48, v50
    v_permlane16_swap_b32 v49, v51
    buffer_store_dwordx4 v[48:51], v6, s[20:23], s34 offen offset:2048 sc1
    s_waitcnt lgkmcnt(0)
    s_waitcnt vmcnt(9)
    s_lshl_b32 s48, s36, 16
    s_and_b32 s49, s36, 0xffff0000
    s_lshl_b32 s50, s37, 16
    s_and_b32 s51, s37, 0xffff0000
    s_lshl_b32 s52, s38, 16
    s_and_b32 s53, s38, 0xffff0000
    s_lshl_b32 s54, s39, 16
    s_and_b32 s55, s39, 0xffff0000
    v_lshlrev_b32 v210, 16, v192
    v_and_b32 v211, 0xffff0000, v192
    v_lshlrev_b32 v212, 16, v193
    v_and_b32 v213, 0xffff0000, v193
    v_lshlrev_b32 v214, 16, v194
    v_and_b32 v215, 0xffff0000, v194
    v_lshlrev_b32 v216, 16, v195
    v_and_b32 v217, 0xffff0000, v195
    v_fmac_f32 v210, s48, v208
    v_fmac_f32 v211, s49, v208
    v_fmac_f32 v212, s50, v208
    v_fmac_f32 v213, s51, v208
    v_fmac_f32 v214, s52, v208
    v_fmac_f32 v215, s53, v208
    v_fmac_f32 v216, s54, v208
    v_fmac_f32 v217, s55, v208
    v_lshlrev_b32 v218, 16, v196
    v_and_b32 v219, 0xffff0000, v196
    v_lshlrev_b32 v220, 16, v197
    v_and_b32 v221, 0xffff0000, v197
    v_lshlrev_b32 v222, 16, v198
    v_and_b32 v223, 0xffff0000, v198
    v_lshlrev_b32 v224, 16, v199
    v_and_b32 v225, 0xffff0000, v199
    v_fmac_f32 v218, s48, v209
    v_fmac_f32 v219, s49, v209
    v_fmac_f32 v220, s50, v209
    v_fmac_f32 v221, s51, v209
    v_fmac_f32 v222, s52, v209
    v_fmac_f32 v223, s53, v209
    v_fmac_f32 v224, s54, v209
    v_fmac_f32 v225, s55, v209
    s_waitcnt vmcnt(0)
    s_barrier
    s_barrier
    s_branch Lfinal
Lat_load:
    s_cmp_lg_u32 s51, 0
    s_cbranch_scc1 Lat_early
    s_add_u32 s32, s40, s38
    s_add_u32 m0, s32, 0
    s_add_u32 s33, s35, 0
    buffer_load_dwordx4 v1, s[12:15], s33 offen sc1 lds
    buffer_load_dwordx4 v1, s[12:15], s33 offen offset:1024 sc1 lds
    s_add_u32 m0, s32, 2048
    s_add_u32 s33, s35, 36864
    buffer_load_dwordx4 v1, s[12:15], s33 offen sc1 lds
    buffer_load_dwordx4 v1, s[12:15], s33 offen offset:1024 sc1 lds
    s_add_u32 m0, s32, 8192
    s_add_u32 s33, s36, 0
    buffer_load_dwordx4 v1, s[12:15], s33 offen sc1 lds
    buffer_load_dwordx4 v1, s[12:15], s33 offen offset:1024 sc1 lds
    s_add_u32 m0, s32, 10240
    s_add_u32 s33, s36, 36864
    buffer_load_dwordx4 v1, s[12:15], s33 offen sc1 lds
    buffer_load_dwordx4 v1, s[12:15], s33 offen offset:1024 sc1 lds
    s_add_u32 s35, s35, 2048
    s_add_u32 s36, s36, 2048
    s_add_u32 s40, s40, 32768
    s_cmp_eq_u32 s40, 163840
    s_cselect_b32 s40, 0, s40
    s_add_u32 s32, s40, s38
    s_add_u32 m0, s32, 0
    s_add_u32 s33, s35, 0
    buffer_load_dwordx4 v1, s[12:15], s33 offen sc1 lds
    buffer_load_dwordx4 v1, s[12:15], s33 offen offset:1024 sc1 lds
    s_add_u32 m0, s32, 2048
    s_add_u32 s33, s35, 36864
    buffer_load_dwordx4 v1, s[12:15], s33 offen sc1 lds
    buffer_load_dwordx4 v1, s[12:15], s33 offen offset:1024 sc1 lds
    s_add_u32 m0, s32, 8192
    s_add_u32 s33, s36, 0
    buffer_load_dwordx4 v1, s[12:15], s33 offen sc1 lds
    buffer_load_dwordx4 v1, s[12:15], s33 offen offset:1024 sc1 lds
    s_add_u32 m0, s32, 10240
    s_add_u32 s33, s36, 36864
    buffer_load_dwordx4 v1, s[12:15], s33 offen sc1 lds
    buffer_load_dwordx4 v1, s[12:15], s33 offen offset:1024 sc1 lds
    s_add_u32 s35, s35, 2048
    s_add_u32 s36, s36, 2048
    s_add_u32 s40, s40, 32768
    s_cmp_eq_u32 s40, 163840
    s_cselect_b32 s40, 0, s40
Lat_early:
    s_add_u32 s32, s40, s38
    s_add_u32 m0, s32, 0
    s_add_u32 s33, s35, 0
    buffer_load_dwordx4 v1, s[12:15], s33 offen sc1 lds
    buffer_load_dwordx4 v1, s[12:15], s33 offen offset:1024 sc1 lds
    s_add_u32 m0, s32, 2048
    s_add_u32 s33, s35, 36864
    buffer_load_dwordx4 v1, s[12:15], s33 offen sc1 lds
    buffer_load_dwordx4 v1, s[12:15], s33 offen offset:1024 sc1 lds
    s_add_u32 m0, s32, 8192
    s_add_u32 s33, s36, 0
    buffer_load_dwordx4 v1, s[12:15], s33 offen sc1 lds
    buffer_load_dwordx4 v1, s[12:15], s33 offen offset:1024 sc1 lds
    s_add_u32 m0, s32, 10240
    s_add_u32 s33, s36, 36864
    buffer_load_dwordx4 v1, s[12:15], s33 offen sc1 lds
    buffer_load_dwordx4 v1, s[12:15], s33 offen offset:1024 sc1 lds
    s_add_u32 s35, s35, 2048
    s_add_u32 s36, s36, 2048
    s_add_u32 s40, s40, 32768
    s_cmp_eq_u32 s40, 163840
    s_cselect_b32 s40, 0, s40
    s_add_u32 s32, s40, s38
    s_add_u32 m0, s32, 0
    s_add_u32 s33, s35, 0
    buffer_load_dwordx4 v1, s[12:15], s33 offen sc1 lds
    buffer_load_dwordx4 v1, s[12:15], s33 offen offset:1024 sc1 lds
    s_add_u32 m0, s32, 2048
    s_add_u32 s33, s35, 36864
    buffer_load_dwordx4 v1, s[12:15], s33 offen sc1 lds
    buffer_load_dwordx4 v1, s[12:15], s33 offen offset:1024 sc1 lds
    s_add_u32 m0, s32, 8192
    s_add_u32 s33, s36, 0
    buffer_load_dwordx4 v1, s[12:15], s33 offen sc1 lds
    buffer_load_dwordx4 v1, s[12:15], s33 offen offset:1024 sc1 lds
    s_add_u32 m0, s32, 10240
    s_add_u32 s33, s36, 36864
    buffer_load_dwordx4 v1, s[12:15], s33 offen sc1 lds
    buffer_load_dwordx4 v1, s[12:15], s33 offen offset:1024 sc1 lds
    s_add_u32 s35, s35, 2048
    s_add_u32 s36, s36, 2048
    s_add_u32 s40, s40, 32768
    s_cmp_eq_u32 s40, 163840
    s_cselect_b32 s40, 0, s40
    s_mov_b32 s41, 14
Lat_lq:
    s_waitcnt vmcnt(16)
    s_barrier
    s_add_u32 s32, s40, s38
    s_add_u32 m0, s32, 0
    s_add_u32 s33, s35, 0
    buffer_load_dwordx4 v1, s[12:15], s33 offen sc1 lds
    buffer_load_dwordx4 v1, s[12:15], s33 offen offset:1024 sc1 lds
    s_add_u32 m0, s32, 2048
    s_add_u32 s33, s35, 36864
    buffer_load_dwordx4 v1, s[12:15], s33 offen sc1 lds
    buffer_load_dwordx4 v1, s[12:15], s33 offen offset:1024 sc1 lds
    s_add_u32 m0, s32, 8192
    s_add_u32 s33, s36, 0
    buffer_load_dwordx4 v1, s[12:15], s33 offen sc1 lds
    buffer_load_dwordx4 v1, s[12:15], s33 offen offset:1024 sc1 lds
    s_add_u32 m0, s32, 10240
    s_add_u32 s33, s36, 36864
    buffer_load_dwordx4 v1, s[12:15], s33 offen sc1 lds
    buffer_load_dwordx4 v1, s[12:15], s33 offen offset:1024 sc1 lds
    s_add_u32 s35, s35, 2048
    s_add_u32 s36, s36, 2048
    s_add_u32 s40, s40, 32768
    s_cmp_eq_u32 s40, 163840
    s_cselect_b32 s40, 0, s40
    s_sub_u32 s41, s41, 1
    s_cmp_lg_u32 s41, 0
    s_cbranch_scc1 Lat_lq
    s_waitcnt vmcnt(16)
    s_barrier
    s_add_u32 s32, s40, s39
    s_add_u32 m0, s32, 0
    s_add_u32 s33, s46, 4096
    buffer_load_dwordx4 v1, s[16:19], s46 offen offset:0 sc1 lds
    buffer_load_dwordx4 v1, s[16:19], s46 offen offset:1024 sc1 lds
    buffer_load_dwordx4 v1, s[16:19], s46 offen offset:2048 sc1 lds
    buffer_load_dwordx4 v1, s[16:19], s46 offen offset:3072 sc1 lds
    s_add_u32 m0, s32, 4096
    s_nop 0
    buffer_load_dwordx4 v1, s[16:19], s33 offen offset:0 sc1 lds
    buffer_load_dwordx4 v1, s[16:19], s33 offen offset:1024 sc1 lds
    buffer_load_dwordx4 v1, s[16:19], s33 offen offset:2048 sc1 lds
    buffer_load_dwordx4 v1, s[16:19], s33 offen offset:3072 sc1 lds
    s_add_u32 s32, s40, s39
    s_add_u32 m0, s32, 16384
    s_add_u32 s33, s47, 4096
    buffer_load_dwordx4 v1, s[20:23], s47 offen offset:0 sc1 lds
    buffer_load_dwordx4 v1, s[20:23], s47 offen offset:1024 sc1 lds
    buffer_load_dwordx4 v1, s[20:23], s47 offen offset:2048 sc1 lds
    buffer_load_dwordx4 v1, s[20:23], s47 offen offset:3072 sc1 lds
    s_add_u32 m0, s32, 20480
    s_nop 0
    buffer_load_dwordx4 v1, s[20:23], s33 offen offset:0 sc1 lds
    buffer_load_dwordx4 v1, s[20:23], s33 offen offset:1024 sc1 lds
    buffer_load_dwordx4 v1, s[20:23], s33 offen offset:2048 sc1 lds
    buffer_load_dwordx4 v1, s[20:23], s33 offen offset:3072 sc1 lds
    s_add_u32 s46, s46, 16384
    s_add_u32 s47, s47, 16384
    s_add_u32 s48, s48, 1
    s_cmp_eq_u32 s48, s49
    s_cselect_b32 s46, s44, s46
    s_add_u32 s32, s49, 1
    s_add_u32 s33, s45, 16384
    s_cmp_eq_u32 s48, s32
    s_cselect_b32 s47, s33, s47
    s_add_u32 s40, s40, 32768
    s_cmp_eq_u32 s40, 163840
    s_cselect_b32 s40, 0, s40
    s_waitcnt vmcnt(24)
    s_barrier
    s_add_u32 s32, s40, s39
    s_add_u32 m0, s32, 0
    s_add_u32 s33, s46, 4096
    buffer_load_dwordx4 v1, s[16:19], s46 offen offset:0 sc1 lds
    buffer_load_dwordx4 v1, s[16:19], s46 offen offset:1024 sc1 lds
    buffer_load_dwordx4 v1, s[16:19], s46 offen offset:2048 sc1 lds
    buffer_load_dwordx4 v1, s[16:19], s46 offen offset:3072 sc1 lds
    s_add_u32 m0, s32, 4096
    s_nop 0
    buffer_load_dwordx4 v1, s[16:19], s33 offen offset:0 sc1 lds
    buffer_load_dwordx4 v1, s[16:19], s33 offen offset:1024 sc1 lds
    buffer_load_dwordx4 v1, s[16:19], s33 offen offset:2048 sc1 lds
    buffer_load_dwordx4 v1, s[16:19], s33 offen offset:3072 sc1 lds
    s_add_u32 s32, s40, s39
    s_add_u32 m0, s32, 16384
    s_add_u32 s33, s47, 4096
    buffer_load_dwordx4 v1, s[20:23], s47 offen offset:0 sc1 lds
    buffer_load_dwordx4 v1, s[20:23], s47 offen offset:1024 sc1 lds
    buffer_load_dwordx4 v1, s[20:23], s47 offen offset:2048 sc1 lds
    buffer_load_dwordx4 v1, s[20:23], s47 offen offset:3072 sc1 lds
    s_add_u32 m0, s32, 20480
    s_nop 0
    buffer_load_dwordx4 v1, s[20:23], s33 offen offset:0 sc1 lds
    buffer_load_dwordx4 v1, s[20:23], s33 offen offset:1024 sc1 lds
    buffer_load_dwordx4 v1, s[20:23], s33 offen offset:2048 sc1 lds
    buffer_load_dwordx4 v1, s[20:23], s33 offen offset:3072 sc1 lds
    s_add_u32 s46, s46, 16384
    s_add_u32 s47, s47, 16384
    s_add_u32 s48, s48, 1
    s_cmp_eq_u32 s48, s49
    s_cselect_b32 s46, s44, s46
    s_add_u32 s32, s49, 1
    s_add_u32 s33, s45, 16384
    s_cmp_eq_u32 s48, s32
    s_cselect_b32 s47, s33, s47
    s_add_u32 s40, s40, 32768
    s_cmp_eq_u32 s40, 163840
    s_cselect_b32 s40, 0, s40
    s_waitcnt lgkmcnt(0)
    s_cmp_eq_u32 s6, 0
    s_cselect_b32 s24, s16, s20
    s_cselect_b32 s25, s17, s21
    s_mov_b32 s26, s18
    s_mov_b32 s27, 0x20000
    s_waitcnt vmcnt(32)
    s_barrier
    s_add_u32 s32, s40, s39
    s_add_u32 m0, s32, 0
    s_add_u32 s33, s46, 4096
    buffer_load_dwordx4 v1, s[16:19], s46 offen offset:0 sc1 lds
    buffer_load_dwordx4 v1, s[16:19], s46 offen offset:1024 sc1 lds
    buffer_load_dwordx4 v1, s[16:19], s46 offen offset:2048 sc1 lds
    buffer_load_dwordx4 v1, s[16:19], s46 offen offset:3072 sc1 lds
    s_add_u32 m0, s32, 4096
    s_nop 0
    buffer_load_dwordx4 v1, s[16:19], s33 offen offset:0 sc1 lds
    buffer_load_dwordx4 v1, s[16:19], s33 offen offset:1024 sc1 lds
    buffer_load_dwordx4 v1, s[16:19], s33 offen offset:2048 sc1 lds
    buffer_load_dwordx4 v1, s[16:19], s33 offen offset:3072 sc1 lds
    s_add_u32 s32, s40, s39
    s_add_u32 m0, s32, 16384
    s_add_u32 s33, s47, 4096
    buffer_load_dwordx4 v1, s[20:23], s47 offen offset:0 sc1 lds
    buffer_load_dwordx4 v1, s[20:23], s47 offen offset:1024 sc1 lds
    buffer_load_dwordx4 v1, s[20:23], s47 offen offset:2048 sc1 lds
    buffer_load_dwordx4 v1, s[20:23], s47 offen offset:3072 sc1 lds
    s_add_u32 m0, s32, 20480
    s_nop 0
    buffer_load_dwordx4 v1, s[20:23], s33 offen offset:0 sc1 lds
    buffer_load_dwordx4 v1, s[20:23], s33 offen offset:1024 sc1 lds
    buffer_load_dwordx4 v1, s[20:23], s33 offen offset:2048 sc1 lds
    buffer_load_dwordx4 v1, s[20:23], s33 offen offset:3072 sc1 lds
    s_add_u32 s46, s46, 16384
    s_add_u32 s47, s47, 16384
    s_add_u32 s48, s48, 1
    s_cmp_eq_u32 s48, s49
    s_cselect_b32 s46, s44, s46
    s_add_u32 s32, s49, 1
    s_add_u32 s33, s45, 16384
    s_cmp_eq_u32 s48, s32
    s_cselect_b32 s47, s33, s47
    s_add_u32 s40, s40, 32768
    s_cmp_eq_u32 s40, 163840
    s_cselect_b32 s40, 0, s40
    buffer_store_dwordx4 v[192:195], v1, s[24:27], s62 offen sc1
    s_add_u32 s33, s62, s63
    buffer_store_dwordx4 v[196:199], v1, s[24:27], s33 offen sc1
    s_waitcnt vmcnt(34)
    s_barrier
    s_add_u32 s32, s40, s39
    s_add_u32 m0, s32, 0
    s_add_u32 s33, s46, 4096
    buffer_load_dwordx4 v1, s[16:19], s46 offen offset:0 sc1 lds
    buffer_load_dwordx4 v1, s[16:19], s46 offen offset:1024 sc1 lds
    buffer_load_dwordx4 v1, s[16:19], s46 offen offset:2048 sc1 lds
    buffer_load_dwordx4 v1, s[16:19], s46 offen offset:3072 sc1 lds
    s_add_u32 m0, s32, 4096
    s_nop 0
    buffer_load_dwordx4 v1, s[16:19], s33 offen offset:0 sc1 lds
    buffer_load_dwordx4 v1, s[16:19], s33 offen offset:1024 sc1 lds
    buffer_load_dwordx4 v1, s[16:19], s33 offen offset:2048 sc1 lds
    buffer_load_dwordx4 v1, s[16:19], s33 offen offset:3072 sc1 lds
    s_add_u32 s32, s40, s39
    s_add_u32 m0, s32, 16384
    s_add_u32 s33, s47, 4096
    buffer_load_dwordx4 v1, s[20:23], s47 offen offset:0 sc1 lds
    buffer_load_dwordx4 v1, s[20:23], s47 offen offset:1024 sc1 lds
    buffer_load_dwordx4 v1, s[20:23], s47 offen offset:2048 sc1 lds
    buffer_load_dwordx4 v1, s[20:23], s47 offen offset:3072 sc1 lds
    s_add_u32 m0, s32, 20480
    s_nop 0
    buffer_load_dwordx4 v1, s[20:23], s33 offen offset:0 sc1 lds
    buffer_load_dwordx4 v1, s[20:23], s33 offen offset:1024 sc1 lds
    buffer_load_dwordx4 v1, s[20:23], s33 offen offset:2048 sc1 lds
    buffer_load_dwordx4 v1, s[20:23], s33 offen offset:3072 sc1 lds
    s_add_u32 s46, s46, 16384
    s_add_u32 s47, s47, 16384
    s_add_u32 s48, s48, 1
    s_cmp_eq_u32 s48, s49
    s_cselect_b32 s46, s44, s46
    s_add_u32 s32, s49, 1
    s_add_u32 s33, s45, 16384
    s_cmp_eq_u32 s48, s32
    s_cselect_b32 s47, s33, s47
    s_add_u32 s40, s40, 32768
    s_cmp_eq_u32 s40, 163840
    s_cselect_b32 s40, 0, s40
    s_add_u32 s33, s62, s7
    buffer_store_dwordx4 v[200:203], v1, s[24:27], s33 offen sc1
    s_add_u32 s33, s62, s101
    buffer_store_dwordx4 v[204:207], v1, s[24:27], s33 offen sc1
    s_add_u32 s62, s62, 65536
    s_waitcnt vmcnt(36)
    s_barrier
    s_add_u32 s32, s40, s39
    s_add_u32 m0, s32, 0
    s_add_u32 s33, s46, 4096
    buffer_load_dwordx4 v1, s[16:19], s46 offen offset:0 sc1 lds
    buffer_load_dwordx4 v1, s[16:19], s46 offen offset:1024 sc1 lds
    buffer_load_dwordx4 v1, s[16:19], s46 offen offset:2048 sc1 lds
    buffer_load_dwordx4 v1, s[16:19], s46 offen offset:3072 sc1 lds
    s_add_u32 m0, s32, 4096
    s_nop 0
    buffer_load_dwordx4 v1, s[16:19], s33 offen offset:0 sc1 lds
    buffer_load_dwordx4 v1, s[16:19], s33 offen offset:1024 sc1 lds
    buffer_load_dwordx4 v1, s[16:19], s33 offen offset:2048 sc1 lds
    buffer_load_dwordx4 v1, s[16:19], s33 offen offset:3072 sc1 lds
    s_add_u32 s32, s40, s39
    s_add_u32 m0, s32, 16384
    s_add_u32 s33, s47, 4096
    buffer_load_dwordx4 v1, s[20:23], s47 offen offset:0 sc1 lds
    buffer_load_dwordx4 v1, s[20:23], s47 offen offset:1024 sc1 lds
    buffer_load_dwordx4 v1, s[20:23], s47 offen offset:2048 sc1 lds
    buffer_load_dwordx4 v1, s[20:23], s47 offen offset:3072 sc1 lds
    s_add_u32 m0, s32, 20480
    s_nop 0
    buffer_load_dwordx4 v1, s[20:23], s33 offen offset:0 sc1 lds
    buffer_load_dwordx4 v1, s[20:23], s33 offen offset:1024 sc1 lds
    buffer_load_dwordx4 v1, s[20:23], s33 offen offset:2048 sc1 lds
    buffer_load_dwordx4 v1, s[20:23], s33 offen offset:3072 sc1 lds
    s_add_u32 s46, s46, 16384
    s_add_u32 s47, s47, 16384
    s_add_u32 s48, s48, 1
    s_cmp_eq_u32 s48, s49
    s_cselect_b32 s46, s44, s46
    s_add_u32 s32, s49, 1
    s_add_u32 s33, s45, 16384
    s_cmp_eq_u32 s48, s32
    s_cselect_b32 s47, s33, s47
    s_add_u32 s40, s40, 32768
    s_cmp_eq_u32 s40, 163840
    s_cselect_b32 s40, 0, s40
    buffer_store_dwordx4 v[208:211], v1, s[24:27], s62 offen sc1
    s_add_u32 s33, s62, s63
    buffer_store_dwordx4 v[212:215], v1, s[24:27], s33 offen sc1
    s_waitcnt vmcnt(36)
    s_barrier
    s_add_u32 s32, s40, s39
    s_add_u32 m0, s32, 0
    s_add_u32 s33, s46, 4096
    buffer_load_dwordx4 v1, s[16:19], s46 offen offset:0 sc1 lds
    buffer_load_dwordx4 v1, s[16:19], s46 offen offset:1024 sc1 lds
    buffer_load_dwordx4 v1, s[16:19], s46 offen offset:2048 sc1 lds
    buffer_load_dwordx4 v1, s[16:19], s46 offen offset:3072 sc1 lds
    s_add_u32 m0, s32, 4096
    s_nop 0
    buffer_load_dwordx4 v1, s[16:19], s33 offen offset:0 sc1 lds
    buffer_load_dwordx4 v1, s[16:19], s33 offen offset:1024 sc1 lds
    buffer_load_dwordx4 v1, s[16:19], s33 offen offset:2048 sc1 lds
    buffer_load_dwordx4 v1, s[16:19], s33 offen offset:3072 sc1 lds
    s_add_u32 s32, s40, s39
    s_add_u32 m0, s32, 16384
    s_add_u32 s33, s47, 4096
    buffer_load_dwordx4 v1, s[20:23], s47 offen offset:0 sc1 lds
    buffer_load_dwordx4 v1, s[20:23], s47 offen offset:1024 sc1 lds
    buffer_load_dwordx4 v1, s[20:23], s47 offen offset:2048 sc1 lds
    buffer_load_dwordx4 v1, s[20:23], s47 offen offset:3072 sc1 lds
    s_add_u32 m0, s32, 20480
    s_nop 0
    buffer_load_dwordx4 v1, s[20:23], s33 offen offset:0 sc1 lds
    buffer_load_dwordx4 v1, s[20:23], s33 offen offset:1024 sc1 lds
    buffer_load_dwordx4 v1, s[20:23], s33 offen offset:2048 sc1 lds
    buffer_load_dwordx4 v1, s[20:23], s33 offen offset:3072 sc1 lds
    s_add_u32 s46, s46, 16384
    s_add_u32 s47, s47, 16384
    s_add_u32 s48, s48, 1
    s_cmp_eq_u32 s48, s49
    s_cselect_b32 s46, s44, s46
    s_add_u32 s32, s49, 1
    s_add_u32 s33, s45, 16384
    s_cmp_eq_u32 s48, s32
    s_cselect_b32 s47, s33, s47
    s_add_u32 s40, s40, 32768
    s_cmp_eq_u32 s40, 163840
    s_cselect_b32 s40, 0, s40
    s_add_u32 s33, s62, s7
    buffer_store_dwordx4 v[216:219], v1, s[24:27], s33 offen sc1
    s_add_u32 s33, s62, s101
    buffer_store_dwordx4 v[220:223], v1, s[24:27], s33 offen sc1
    s_add_u32 s62, s62, 65536
    s_waitcnt vmcnt(36)
    s_barrier
    s_add_u32 s32, s40, s39
    s_add_u32 m0, s32, 0
    s_add_u32 s33, s46, 4096
    buffer_load_dwordx4 v1, s[16:19], s46 offen offset:0 sc1 lds
    buffer_load_dwordx4 v1, s[16:19], s46 offen offset:1024 sc1 lds
    buffer_load_dwordx4 v1, s[16:19], s46 offen offset:2048 sc1 lds
    buffer_load_dwordx4 v1, s[16:19], s46 offen offset:3072 sc1 lds
    s_add_u32 m0, s32, 4096
    s_nop 0
    buffer_load_dwordx4 v1, s[16:19], s33 offen offset:0 sc1 lds
    buffer_load_dwordx4 v1, s[16:19], s33 offen offset:1024 sc1 lds
    buffer_load_dwordx4 v1, s[16:19], s33 offen offset:2048 sc1 lds
    buffer_load_dwordx4 v1, s[16:19], s33 offen offset:3072 sc1 lds
    s_add_u32 s32, s40, s39
    s_add_u32 m0, s32, 16384
    s_add_u32 s33, s47, 4096
    buffer_load_dwordx4 v1, s[20:23], s47 offen offset:0 sc1 lds
    buffer_load_dwordx4 v1, s[20:23], s47 offen offset:1024 sc1 lds
    buffer_load_dwordx4 v1, s[20:23], s47 offen offset:2048 sc1 lds
    buffer_load_dwordx4 v1, s[20:23], s47 offen offset:3072 sc1 lds
    s_add_u32 m0, s32, 20480
    s_nop 0
    buffer_load_dwordx4 v1, s[20:23], s33 offen offset:0 sc1 lds
    buffer_load_dwordx4 v1, s[20:23], s33 offen offset:1024 sc1 lds
    buffer_load_dwordx4 v1, s[20:23], s33 offen offset:2048 sc1 lds
    buffer_load_dwordx4 v1, s[20:23], s33 offen offset:3072 sc1 lds
    s_add_u32 s46, s46, 16384
    s_add_u32 s47, s47, 16384
    s_add_u32 s48, s48, 1
    s_cmp_eq_u32 s48, s49
    s_cselect_b32 s46, s44, s46
    s_add_u32 s32, s49, 1
    s_add_u32 s33, s45, 16384
    s_cmp_eq_u32 s48, s32
    s_cselect_b32 s47, s33, s47
    s_add_u32 s40, s40, 32768
    s_cmp_eq_u32 s40, 163840
    s_cselect_b32 s40, 0, s40
    buffer_store_dwordx4 v[224:227], v1, s[24:27], s62 offen sc1
    s_add_u32 s33, s62, s63
    buffer_store_dwordx4 v[228:231], v1, s[24:27], s33 offen sc1
    s_waitcnt vmcnt(36)
    s_barrier
    s_add_u32 s32, s40, s39
    s_add_u32 m0, s32, 0
    s_add_u32 s33, s46, 4096
    buffer_load_dwordx4 v1, s[16:19], s46 offen offset:0 sc1 lds
    buffer_load_dwordx4 v1, s[16:19], s46 offen offset:1024 sc1 lds
    buffer_load_dwordx4 v1, s[16:19], s46 offen offset:2048 sc1 lds
    buffer_load_dwordx4 v1, s[16:19], s46 offen offset:3072 sc1 lds
    s_add_u32 m0, s32, 4096
    s_nop 0
    buffer_load_dwordx4 v1, s[16:19], s33 offen offset:0 sc1 lds
    buffer_load_dwordx4 v1, s[16:19], s33 offen offset:1024 sc1 lds
    buffer_load_dwordx4 v1, s[16:19], s33 offen offset:2048 sc1 lds
    buffer_load_dwordx4 v1, s[16:19], s33 offen offset:3072 sc1 lds
    s_add_u32 s32, s40, s39
    s_add_u32 m0, s32, 16384
    s_add_u32 s33, s47, 4096
    buffer_load_dwordx4 v1, s[20:23], s47 offen offset:0 sc1 lds
    buffer_load_dwordx4 v1, s[20:23], s47 offen offset:1024 sc1 lds
    buffer_load_dwordx4 v1, s[20:23], s47 offen offset:2048 sc1 lds
    buffer_load_dwordx4 v1, s[20:23], s47 offen offset:3072 sc1 lds
    s_add_u32 m0, s32, 20480
    s_nop 0
    buffer_load_dwordx4 v1, s[20:23], s33 offen offset:0 sc1 lds
    buffer_load_dwordx4 v1, s[20:23], s33 offen offset:1024 sc1 lds
    buffer_load_dwordx4 v1, s[20:23], s33 offen offset:2048 sc1 lds
    buffer_load_dwordx4 v1, s[20:23], s33 offen offset:3072 sc1 lds
    s_add_u32 s46, s46, 16384
    s_add_u32 s47, s47, 16384
    s_add_u32 s48, s48, 1
    s_cmp_eq_u32 s48, s49
    s_cselect_b32 s46, s44, s46
    s_add_u32 s32, s49, 1
    s_add_u32 s33, s45, 16384
    s_cmp_eq_u32 s48, s32
    s_cselect_b32 s47, s33, s47
    s_add_u32 s40, s40, 32768
    s_cmp_eq_u32 s40, 163840
    s_cselect_b32 s40, 0, s40
    s_add_u32 s33, s62, s7
    buffer_store_dwordx4 v[232:235], v1, s[24:27], s33 offen sc1
    s_add_u32 s33, s62, s101
    buffer_store_dwordx4 v[236:239], v1, s[24:27], s33 offen sc1
    s_add_u32 s62, s62, 65536
    s_waitcnt vmcnt(36)
    s_barrier
    s_add_u32 s32, s40, s39
    s_add_u32 m0, s32, 0
    s_add_u32 s33, s46, 4096
    buffer_load_dwordx4 v1, s[16:19], s46 offen offset:0 sc1 lds
    buffer_load_dwordx4 v1, s[16:19], s46 offen offset:1024 sc1 lds
    buffer_load_dwordx4 v1, s[16:19], s46 offen offset:2048 sc1 lds
    buffer_load_dwordx4 v1, s[16:19], s46 offen offset:3072 sc1 lds
    s_add_u32 m0, s32, 4096
    s_nop 0
    buffer_load_dwordx4 v1, s[16:19], s33 offen offset:0 sc1 lds
    buffer_load_dwordx4 v1, s[16:19], s33 offen offset:1024 sc1 lds
    buffer_load_dwordx4 v1, s[16:19], s33 offen offset:2048 sc1 lds
    buffer_load_dwordx4 v1, s[16:19], s33 offen offset:3072 sc1 lds
    s_add_u32 s32, s40, s39
    s_add_u32 m0, s32, 16384
    s_add_u32 s33, s47, 4096
    buffer_load_dwordx4 v1, s[20:23], s47 offen offset:0 sc1 lds
    buffer_load_dwordx4 v1, s[20:23], s47 offen offset:1024 sc1 lds
    buffer_load_dwordx4 v1, s[20:23], s47 offen offset:2048 sc1 lds
    buffer_load_dwordx4 v1, s[20:23], s47 offen offset:3072 sc1 lds
    s_add_u32 m0, s32, 20480
    s_nop 0
    buffer_load_dwordx4 v1, s[20:23], s33 offen offset:0 sc1 lds
    buffer_load_dwordx4 v1, s[20:23], s33 offen offset:1024 sc1 lds
    buffer_load_dwordx4 v1, s[20:23], s33 offen offset:2048 sc1 lds
    buffer_load_dwordx4 v1, s[20:23], s33 offen offset:3072 sc1 lds
    s_add_u32 s46, s46, 16384
    s_add_u32 s47, s47, 16384
    s_add_u32 s48, s48, 1
    s_cmp_eq_u32 s48, s49
    s_cselect_b32 s46, s44, s46
    s_add_u32 s32, s49, 1
    s_add_u32 s33, s45, 16384
    s_cmp_eq_u32 s48, s32
    s_cselect_b32 s47, s33, s47
    s_add_u32 s40, s40, 32768
    s_cmp_eq_u32 s40, 163840
    s_cselect_b32 s40, 0, s40
    buffer_store_dwordx4 v[240:243], v1, s[24:27], s62 offen sc1
    s_add_u32 s33, s62, s63
    buffer_store_dwordx4 v[244:247], v1, s[24:27], s33 offen sc1
    s_waitcnt vmcnt(36)
    s_barrier
    s_add_u32 s32, s40, s39
    s_add_u32 m0, s32, 0
    s_add_u32 s33, s46, 4096
    buffer_load_dwordx4 v1, s[16:19], s46 offen offset:0 sc1 lds
    buffer_load_dwordx4 v1, s[16:19], s46 offen offset:1024 sc1 lds
    buffer_load_dwordx4 v1, s[16:19], s46 offen offset:2048 sc1 lds
    buffer_load_dwordx4 v1, s[16:19], s46 offen offset:3072 sc1 lds
    s_add_u32 m0, s32, 4096
    s_nop 0
    buffer_load_dwordx4 v1, s[16:19], s33 offen offset:0 sc1 lds
    buffer_load_dwordx4 v1, s[16:19], s33 offen offset:1024 sc1 lds
    buffer_load_dwordx4 v1, s[16:19], s33 offen offset:2048 sc1 lds
    buffer_load_dwordx4 v1, s[16:19], s33 offen offset:3072 sc1 lds
    s_add_u32 s32, s40, s39
    s_add_u32 m0, s32, 16384
    s_add_u32 s33, s47, 4096
    buffer_load_dwordx4 v1, s[20:23], s47 offen offset:0 sc1 lds
    buffer_load_dwordx4 v1, s[20:23], s47 offen offset:1024 sc1 lds
    buffer_load_dwordx4 v1, s[20:23], s47 offen offset:2048 sc1 lds
    buffer_load_dwordx4 v1, s[20:23], s47 offen offset:3072 sc1 lds
    s_add_u32 m0, s32, 20480
    s_nop 0
    buffer_load_dwordx4 v1, s[20:23], s33 offen offset:0 sc1 lds
    buffer_load_dwordx4 v1, s[20:23], s33 offen offset:1024 sc1 lds
    buffer_load_dwordx4 v1, s[20:23], s33 offen offset:2048 sc1 lds
    buffer_load_dwordx4 v1, s[20:23], s33 offen offset:3072 sc1 lds
    s_add_u32 s46, s46, 16384
    s_add_u32 s47, s47, 16384
    s_add_u32 s48, s48, 1
    s_cmp_eq_u32 s48, s49
    s_cselect_b32 s46, s44, s46
    s_add_u32 s32, s49, 1
    s_add_u32 s33, s45, 16384
    s_cmp_eq_u32 s48, s32
    s_cselect_b32 s47, s33, s47
    s_add_u32 s40, s40, 32768
    s_cmp_eq_u32 s40, 163840
    s_cselect_b32 s40, 0, s40
    s_add_u32 s33, s62, s7
    buffer_store_dwordx4 v[248:251], v1, s[24:27], s33 offen sc1
    s_add_u32 s33, s62, s101
    buffer_store_dwordx4 v[252:255], v1, s[24:27], s33 offen sc1
    s_add_u32 s62, s62, 65536
    s_waitcnt lgkmcnt(0)
    s_lshl_b32 s52, s2, 1
    s_add_u32 s52, s52, s6
    s_mul_i32 s50, s52, 9216
    s_mul_i32 s52, s52, 36864
    s_mov_b32 s41, 0
    s_mov_b32 s24, s56
    s_and_b32 s25, s57, 0xffff
    s_mov_b32 s26, 4718592
    s_mov_b32 s27, 0x20000
    s_lshr_b32 s53, s2, 3
    s_mul_hi_u32 s54, s53, 1431655766
    s_mul_i32 s54, s54, 3
    s_sub_u32 s53, s53, s54
    s_mov_b32 s54, s53
    s_cmp_eq_u32 s54, 0
    s_cbranch_scc1 Lat_lpf
Lat_lpre:
    s_waitcnt vmcnt(32)
    s_barrier
    s_add_u32 s32, s40, s39
    s_add_u32 m0, s32, 0
    s_add_u32 s33, s46, 4096
    buffer_load_dwordx4 v1, s[16:19], s46 offen offset:0 sc1 lds
    buffer_load_dwordx4 v1, s[16:19], s46 offen offset:1024 sc1 lds
    buffer_load_dwordx4 v1, s[16:19], s46 offen offset:2048 sc1 lds
    buffer_load_dwordx4 v1, s[16:19], s46 offen offset:3072 sc1 lds
    s_add_u32 m0, s32, 4096
    s_nop 0
    buffer_load_dwordx4 v1, s[16:19], s33 offen offset:0 sc1 lds
    buffer_load_dwordx4 v1, s[16:19], s33 offen offset:1024 sc1 lds
    buffer_load_dwordx4 v1, s[16:19], s33 offen offset:2048 sc1 lds
    buffer_load_dwordx4 v1, s[16:19], s33 offen offset:3072 sc1 lds
    s_add_u32 s32, s40, s39
    s_add_u32 m0, s32, 16384
    s_add_u32 s33, s47, 4096
    buffer_load_dwordx4 v1, s[20:23], s47 offen offset:0 sc1 lds
    buffer_load_dwordx4 v1, s[20:23], s47 offen offset:1024 sc1 lds
    buffer_load_dwordx4 v1, s[20:23], s47 offen offset:2048 sc1 lds
    buffer_load_dwordx4 v1, s[20:23], s47 offen offset:3072 sc1 lds
    s_add_u32 m0, s32, 20480
    s_nop 0
    buffer_load_dwordx4 v1, s[20:23], s33 offen offset:0 sc1 lds
    buffer_load_dwordx4 v1, s[20:23], s33 offen offset:1024 sc1 lds
    buffer_load_dwordx4 v1, s[20:23], s33 offen offset:2048 sc1 lds
    buffer_load_dwordx4 v1, s[20:23], s33 offen offset:3072 sc1 lds
    s_add_u32 s46, s46, 16384
    s_add_u32 s47, s47, 16384
    s_add_u32 s48, s48, 1
    s_cmp_eq_u32 s48, s49
    s_cselect_b32 s46, s44, s46
    s_add_u32 s32, s49, 1
    s_add_u32 s33, s45, 16384
    s_cmp_eq_u32 s48, s32
    s_cselect_b32 s47, s33, s47
    s_add_u32 s40, s40, 32768
    s_cmp_eq_u32 s40, 163840
    s_cselect_b32 s40, 0, s40
    s_sub_u32 s54, s54, 1
    s_cmp_lg_u32 s54, 0
    s_cbranch_scc1 Lat_lpre
Lat_lpf:
    s_waitcnt vmcnt(32)
    s_barrier
    s_add_u32 s32, s40, s39
    s_add_u32 m0, s32, 0
    s_add_u32 s33, s46, 4096
    buffer_load_dwordx4 v1, s[16:19], s46 offen offset:0 sc1 lds
    buffer_load_dwordx4 v1, s[16:19], s46 offen offset:1024 sc1 lds
    buffer_load_dwordx4 v1, s[16:19], s46 offen offset:2048 sc1 lds
    buffer_load_dwordx4 v1, s[16:19], s46 offen offset:3072 sc1 lds
    s_add_u32 m0, s32, 4096
    s_nop 0
    buffer_load_dwordx4 v1, s[16:19], s33 offen offset:0 sc1 lds
    buffer_load_dwordx4 v1, s[16:19], s33 offen offset:1024 sc1 lds
    buffer_load_dwordx4 v1, s[16:19], s33 offen offset:2048 sc1 lds
    buffer_load_dwordx4 v1, s[16:19], s33 offen offset:3072 sc1 lds
    s_add_u32 s32, s40, s39
    s_add_u32 m0, s32, 16384
    s_add_u32 s33, s47, 4096
    buffer_load_dwordx4 v1, s[20:23], s47 offen offset:0 sc1 lds
    buffer_load_dwordx4 v1, s[20:23], s47 offen offset:1024 sc1 lds
    buffer_load_dwordx4 v1, s[20:23], s47 offen offset:2048 sc1 lds
    buffer_load_dwordx4 v1, s[20:23], s47 offen offset:3072 sc1 lds
    s_add_u32 m0, s32, 20480
    s_nop 0
    buffer_load_dwordx4 v1, s[20:23], s33 offen offset:0 sc1 lds
    buffer_load_dwordx4 v1, s[20:23], s33 offen offset:1024 sc1 lds
    buffer_load_dwordx4 v1, s[20:23], s33 offen offset:2048 sc1 lds
    buffer_load_dwordx4 v1, s[20:23], s33 offen offset:3072 sc1 lds
    s_add_u32 s46, s46, 16384
    s_add_u32 s47, s47, 16384
    s_add_u32 s48, s48, 1
    s_cmp_eq_u32 s48, s49
    s_cselect_b32 s46, s44, s46
    s_add_u32 s32, s49, 1
    s_add_u32 s33, s45, 16384
    s_cmp_eq_u32 s48, s32
    s_cselect_b32 s47, s33, s47
    s_add_u32 s40, s40, 32768
    s_cmp_eq_u32 s40, 163840
    s_cselect_b32 s40, 0, s40
    buffer_load_dwordx4 v[8:11], v1, s[24:27], s50 offen offset:0
    buffer_load_dwordx4 v[8:11], v1, s[24:27], s50 offen offset:1024
    buffer_load_dwordx4 v[8:11], v1, s[24:27], s50 offen offset:2048
    s_add_u32 s50, s50, 3072
    buffer_load_dwordx4 v[8:11], v1, s[24:27], s50 offen offset:0
    buffer_load_dwordx4 v[8:11], v1, s[24:27], s50 offen offset:1024
    buffer_load_dwordx4 v[8:11], v1, s[24:27], s50 offen offset:2048
    s_add_u32 s50, s50, 3072
    buffer_load_dwordx4 v[8:11], v1, s[24:27], s50 offen offset:0
    buffer_load_dwordx4 v[8:11], v1, s[24:27], s50 offen offset:1024
    buffer_load_dwordx4 v[8:11], v1, s[24:27], s50 offen offset:2048
    s_add_u32 s50, s50, 3072
    buffer_load_dwordx4 v[8:11], v1, s[24:27], s50 offen offset:0
    buffer_load_dwordx4 v[8:11], v1, s[24:27], s50 offen offset:1024
    buffer_load_dwordx4 v[8:11], v1, s[24:27], s50 offen offset:2048
    s_add_u32 s50, s50, 3072
    s_waitcnt vmcnt(44)
    s_barrier
    s_add_u32 s32, s40, s39
    s_add_u32 m0, s32, 0
    s_add_u32 s33, s46, 4096
    buffer_load_dwordx4 v1, s[16:19], s46 offen offset:0 sc1 lds
    buffer_load_dwordx4 v1, s[16:19], s46 offen offset:1024 sc1 lds
    buffer_load_dwordx4 v1, s[16:19], s46 offen offset:2048 sc1 lds
    buffer_load_dwordx4 v1, s[16:19], s46 offen offset:3072 sc1 lds
    s_add_u32 m0, s32, 4096
    s_nop 0
    buffer_load_dwordx4 v1, s[16:19], s33 offen offset:0 sc1 lds
    buffer_load_dwordx4 v1, s[16:19], s33 offen offset:1024 sc1 lds
    buffer_load_dwordx4 v1, s[16:19], s33 offen offset:2048 sc1 lds
    buffer_load_dwordx4 v1, s[16:19], s33 offen offset:3072 sc1 lds
    s_add_u32 s32, s40, s39
    s_add_u32 m0, s32, 16384
    s_add_u32 s33, s47, 4096
    buffer_load_dwordx4 v1, s[20:23], s47 offen offset:0 sc1 lds
    buffer_load_dwordx4 v1, s[20:23], s47 offen offset:1024 sc1 lds
    buffer_load_dwordx4 v1, s[20:23], s47 offen offset:2048 sc1 lds
    buffer_load_dwordx4 v1, s[20:23], s47 offen offset:3072 sc1 lds
    s_add_u32 m0, s32, 20480
    s_nop 0
    buffer_load_dwordx4 v1, s[20:23], s33 offen offset:0 sc1 lds
    buffer_load_dwordx4 v1, s[20:23], s33 offen offset:1024 sc1 lds
    buffer_load_dwordx4 v1, s[20:23], s33 offen offset:2048 sc1 lds
    buffer_load_dwordx4 v1, s[20:23], s33 offen offset:3072 sc1 lds
    s_add_u32 s46, s46, 16384
    s_add_u32 s47, s47, 16384
    s_add_u32 s48, s48, 1
    s_cmp_eq_u32 s48, s49
    s_cselect_b32 s46, s44, s46
    s_add_u32 s32, s49, 1
    s_add_u32 s33, s45, 16384
    s_cmp_eq_u32 s48, s32
    s_cselect_b32 s47, s33, s47
    s_add_u32 s40, s40, 32768
    s_cmp_eq_u32 s40, 163840
    s_cselect_b32 s40, 0, s40
    s_waitcnt vmcnt(44)
    s_barrier
    s_add_u32 s32, s40, s39
    s_add_u32 m0, s32, 0
    s_add_u32 s33, s46, 4096
    buffer_load_dwordx4 v1, s[16:19], s46 offen offset:0 sc1 lds
    buffer_load_dwordx4 v1, s[16:19], s46 offen offset:1024 sc1 lds
    buffer_load_dwordx4 v1, s[16:19], s46 offen offset:2048 sc1 lds
    buffer_load_dwordx4 v1, s[16:19], s46 offen offset:3072 sc1 lds
    s_add_u32 m0, s32, 4096
    s_nop 0
    buffer_load_dwordx4 v1, s[16:19], s33 offen offset:0 sc1 lds
    buffer_load_dwordx4 v1, s[16:19], s33 offen offset:1024 sc1 lds
    buffer_load_dwordx4 v1, s[16:19], s33 offen offset:2048 sc1 lds
    buffer_load_dwordx4 v1, s[16:19], s33 offen offset:3072 sc1 lds
    s_add_u32 s32, s40, s39
    s_add_u32 m0, s32, 16384
    s_add_u32 s33, s47, 4096
    buffer_load_dwordx4 v1, s[20:23], s47 offen offset:0 sc1 lds
    buffer_load_dwordx4 v1, s[20:23], s47 offen offset:1024 sc1 lds
    buffer_load_dwordx4 v1, s[20:23], s47 offen offset:2048 sc1 lds
    buffer_load_dwordx4 v1, s[20:23], s47 offen offset:3072 sc1 lds
    s_add_u32 m0, s32, 20480
    s_nop 0
    buffer_load_dwordx4 v1, s[20:23], s33 offen offset:0 sc1 lds
    buffer_load_dwordx4 v1, s[20:23], s33 offen offset:1024 sc1 lds
    buffer_load_dwordx4 v1, s[20:23], s33 offen offset:2048 sc1 lds
    buffer_load_dwordx4 v1, s[20:23], s33 offen offset:3072 sc1 lds
    s_add_u32 s46, s46, 16384
    s_add_u32 s47, s47, 16384
    s_add_u32 s48, s48, 1
    s_cmp_eq_u32 s48, s49
    s_cselect_b32 s46, s44, s46
    s_add_u32 s32, s49, 1
    s_add_u32 s33, s45, 16384
    s_cmp_eq_u32 s48, s32
    s_cselect_b32 s47, s33, s47
    s_add_u32 s40, s40, 32768
    s_cmp_eq_u32 s40, 163840
    s_cselect_b32 s40, 0, s40
    s_add_u32 s41, s41, 1
    s_and_b32 s33, s59, 0xffff
    s_cmp_eq_u32 s41, 1
    s_cselect_b32 s24, s58, s24
    s_cselect_b32 s25, s33, s25
    s_cselect_b32 s50, s52, s50
    s_and_b32 s33, s61, 0xffff
    s_cmp_eq_u32 s41, 4
    s_cselect_b32 s24, s60, s24
    s_cselect_b32 s25, s33, s25
    s_cselect_b32 s50, s52, s50
    s_mov_b32 s26, 18874368
    s_cmp_lt_u32 s41, 7
    s_cbranch_scc1 Lat_lpf
    s_sub_u32 s41, 6, s53
Lat_lkv:
    s_waitcnt vmcnt(32)
    s_barrier
    s_add_u32 s32, s40, s39
    s_add_u32 m0, s32, 0
    s_add_u32 s33, s46, 4096
    buffer_load_dwordx4 v1, s[16:19], s46 offen offset:0 sc1 lds
    buffer_load_dwordx4 v1, s[16:19], s46 offen offset:1024 sc1 lds
    buffer_load_dwordx4 v1, s[16:19], s46 offen offset:2048 sc1 lds
    buffer_load_dwordx4 v1, s[16:19], s46 offen offset:3072 sc1 lds
    s_add_u32 m0, s32, 4096
    s_nop 0
    buffer_load_dwordx4 v1, s[16:19], s33 offen offset:0 sc1 lds
    buffer_load_dwordx4 v1, s[16:19], s33 offen offset:1024 sc1 lds
    buffer_load_dwordx4 v1, s[16:19], s33 offen offset:2048 sc1 lds
    buffer_load_dwordx4 v1, s[16:19], s33 offen offset:3072 sc1 lds
    s_add_u32 s32, s40, s39
    s_add_u32 m0, s32, 16384
    s_add_u32 s33, s47, 4096
    buffer_load_dwordx4 v1, s[20:23], s47 offen offset:0 sc1 lds
    buffer_load_dwordx4 v1, s[20:23], s47 offen offset:1024 sc1 lds
    buffer_load_dwordx4 v1, s[20:23], s47 offen offset:2048 sc1 lds
    buffer_load_dwordx4 v1, s[20:23], s47 offen offset:3072 sc1 lds
    s_add_u32 m0, s32, 20480
    s_nop 0
    buffer_load_dwordx4 v1, s[20:23], s33 offen offset:0 sc1 lds
    buffer_load_dwordx4 v1, s[20:23], s33 offen offset:1024 sc1 lds
    buffer_load_dwordx4 v1, s[20:23], s33 offen offset:2048 sc1 lds
    buffer_load_dwordx4 v1, s[20:23], s33 offen offset:3072 sc1 lds
    s_add_u32 s46, s46, 16384
    s_add_u32 s47, s47, 16384
    s_add_u32 s48, s48, 1
    s_cmp_eq_u32 s48, s49
    s_cselect_b32 s46, s44, s46
    s_add_u32 s32, s49, 1
    s_add_u32 s33, s45, 16384
    s_cmp_eq_u32 s48, s32
    s_cselect_b32 s47, s33, s47
    s_add_u32 s40, s40, 32768
    s_cmp_eq_u32 s40, 163840
    s_cselect_b32 s40, 0, s40
    s_sub_u32 s41, s41, 1
    s_cmp_lg_u32 s41, 0
    s_cbranch_scc1 Lat_lkv
    s_branch Lat_ldone
Lat_sw:
    s_mov_b32 s62, s57
    s_load_dwordx2 s[56:57], s[0:1], 40
    s_load_dwordx2 s[58:59], s[0:1], 56
    s_load_dwordx2 s[60:61], s[0:1], 72
    s_add_u32 s32, s48, 16
    s_lshl_b32 s32, s32, 7
    v_mov_b32 v3, s32
    s_add_u32 s33, s32, 44032
    v_mov_b32 v5, s33
    s_cmp_eq_u32 s3, 7
    s_cbranch_scc1 Lat_w7
    s_waitcnt lgkmcnt(0)
    s_barrier
    v_add_u32 v6, 4096, v5
    v_and_b32 v9, 15, v1
    v_lshlrev_b32 v9, 7, v9
    s_lshr_b32 s34, s2, 5
    s_lshl_b32 s34, s34, 3
    s_and_b32 s35, s2, 7
    s_add_u32 s34, s34, s35
    s_add_u32 s34, s34, 48
    s_lshl_b32 s34, s34, 7
    v_mov_b32 v10, s34
    s_add_u32 s55, s62, 2048
    buffer_store_dwordx4 v[64:67], v7, s[20:23], s55 offen offset:0 sc1
    s_add_u32 s55, s62, 6144
    buffer_store_dwordx4 v[68:71], v7, s[20:23], s55 offen offset:0 sc1
    s_barrier
    s_add_u32 s55, s62, 2048
    buffer_store_dwordx4 v[72:75], v7, s[20:23], s55 offen offset:1024 sc1
    s_add_u32 s55, s62, 6144
    buffer_store_dwordx4 v[76:79], v7, s[20:23], s55 offen offset:1024 sc1
    s_barrier
    s_add_u32 s55, s62, 0
    buffer_store_dwordx4 v[128:131], v7, s[20:23], s55 offen offset:0 sc1
    s_add_u32 s55, s62, 4096
    buffer_store_dwordx4 v[132:135], v7, s[20:23], s55 offen offset:0 sc1
    s_barrier
    s_add_u32 s55, s62, 0
    buffer_store_dwordx4 v[136:139], v7, s[20:23], s55 offen offset:1024 sc1
    s_add_u32 s55, s62, 4096
    buffer_store_dwordx4 v[140:143], v7, s[20:23], s55 offen offset:1024 sc1
    s_barrier
    s_add_u32 s55, s62, 67584
    buffer_store_dwordx4 v[80:83], v7, s[20:23], s55 offen offset:0 sc1
    s_add_u32 s55, s62, 71680
    buffer_store_dwordx4 v[84:87], v7, s[20:23], s55 offen offset:0 sc1
    s_barrier
    s_add_u32 s55, s62, 67584
    buffer_store_dwordx4 v[88:91], v7, s[20:23], s55 offen offset:1024 sc1
    s_add_u32 s55, s62, 71680
    buffer_store_dwordx4 v[92:95], v7, s[20:23], s55 offen offset:1024 sc1
    s_barrier
    s_add_u32 s55, s62, 65536
    buffer_store_dwordx4 v[144:147], v7, s[20:23], s55 offen offset:0 sc1
    s_add_u32 s55, s62, 69632
    buffer_store_dwordx4 v[148:151], v7, s[20:23], s55 offen offset:0 sc1
    s_barrier
    s_add_u32 s55, s62, 65536
    buffer_store_dwordx4 v[152:155], v7, s[20:23], s55 offen offset:1024 sc1
    s_add_u32 s55, s62, 69632
    buffer_store_dwordx4 v[156:159], v7, s[20:23], s55 offen offset:1024 sc1
    s_barrier
    s_add_u32 s55, s62, 133120
    buffer_store_dwordx4 v[96:99], v7, s[20:23], s55 offen offset:0 sc1
    s_add_u32 s55, s62, 137216
    buffer_store_dwordx4 v[100:103], v7, s[20:23], s55 offen offset:0 sc1
    s_barrier
    s_add_u32 s55, s62, 133120
    buffer_store_dwordx4 v[104:107], v7, s[20:23], s55 offen offset:1024 sc1
    s_add_u32 s55, s62, 137216
    buffer_store_dwordx4 v[108:111], v7, s[20:23], s55 offen offset:1024 sc1
    s_waitcnt vmcnt(4)
    s_barrier
    s_add_u32 s55, s62, 131072
    buffer_store_dwordx4 v[160:163], v7, s[20:23], s55 offen offset:0 sc1
    s_add_u32 s55, s62, 135168
    buffer_store_dwordx4 v[164:167], v7, s[20:23], s55 offen offset:0 sc1
    v_mov_b32 v4, 1
    s_mov_b64 exec, 1
    buffer_atomic_add v4, off, s[96:99], s32 sc1
    s_mov_b64 exec, -1
    s_barrier
    s_add_u32 s55, s62, 131072
    buffer_store_dwordx4 v[168:171], v7, s[20:23], s55 offen offset:1024 sc1
    s_add_u32 s55, s62, 135168
    buffer_store_dwordx4 v[172:175], v7, s[20:23], s55 offen offset:1024 sc1
    s_barrier
    buffer_load_dword v247, v3, s[96:99], 0 offen sc1
    s_add_u32 s55, s62, 198656
    buffer_store_dwordx4 v[112:115], v7, s[20:23], s55 offen offset:0 sc1
    s_add_u32 s55, s62, 202752
    buffer_store_dwordx4 v[116:119], v7, s[20:23], s55 offen offset:0 sc1
    s_barrier
    s_waitcnt vmcnt(2)
    v_cmp_gt_u32 vcc, 8, v247
    s_nop 1
    s_cbranch_vccz Lat_lk13
    s_mov_b32 s100, 0x8000
Lpoll2:
    buffer_load_dword v244, v3, s[96:99], 0 offen sc1
    s_waitcnt vmcnt(0)
    v_cmp_gt_u32 vcc, 8, v244
    s_sub_u32 s100, s100, 1
    s_cbranch_vccz Lpolld2
    s_cmp_eq_u32 s100, 0
    s_cbranch_scc1 Lpolld2
    s_sleep 1
    s_branch Lpoll2
Lpolld2:
Lat_lk13:
    s_add_u32 s55, s62, 198656
    buffer_store_dwordx4 v[120:123], v7, s[20:23], s55 offen offset:1024 sc1
    s_add_u32 s55, s62, 202752
    buffer_store_dwordx4 v[124:127], v7, s[20:23], s55 offen offset:1024 sc1
    s_barrier
    s_add_u32 s55, s62, 196608
    buffer_store_dwordx4 v[176:179], v7, s[20:23], s55 offen offset:0 sc1
    s_add_u32 s55, s62, 200704
    buffer_store_dwordx4 v[180:183], v7, s[20:23], s55 offen offset:0 sc1
    s_barrier
    s_add_u32 s55, s62, 196608
    buffer_store_dwordx4 v[184:187], v7, s[20:23], s55 offen offset:1024 sc1
    s_add_u32 s55, s62, 200704
    buffer_store_dwordx4 v[188:191], v7, s[20:23], s55 offen offset:1024 sc1
    s_barrier
    s_barrier
    s_waitcnt vmcnt(0)
    s_barrier
    v_mov_b32 v4, 1
    s_mov_b64 exec, 1
    buffer_atomic_add v4, off, s[96:99], s33 sc1
    s_mov_b64 exec, -1
    s_barrier
    s_barrier
    buffer_load_dword v247, v5, s[96:99], 0 offen sc1
    s_barrier
    s_waitcnt vmcnt(0)
    v_cmp_gt_u32 vcc, 8, v247
    s_nop 1
    s_cbranch_vccz Lat_lk21
    s_mov_b32 s100, 0x8000
Lpoll3:
    buffer_load_dword v244, v5, s[96:99], 0 offen sc1
    s_waitcnt vmcnt(0)
    v_cmp_gt_u32 vcc, 8, v244
    s_sub_u32 s100, s100, 1
    s_cbranch_vccz Lpolld3
    s_cmp_eq_u32 s100, 0
    s_cbranch_scc1 Lpolld3
    s_sleep 1
    s_branch Lpoll3
Lpolld3:
Lat_lk21:
    s_barrier
    s_barrier
    s_barrier
    s_barrier
    buffer_load_dword v247, v9, s[96:99], 0 offen sc1
    s_barrier
    s_waitcnt vmcnt(0)
    v_cmp_gt_u32 vcc, 16, v247
    s_nop 1
    s_cbranch_vccz Lat_lk26
    s_mov_b32 s100, 0x8000
Lpoll4:
    buffer_load_dword v244, v9, s[96:99], 0 offen sc1
    s_waitcnt vmcnt(0)
    v_cmp_gt_u32 vcc, 16, v244
    s_sub_u32 s100, s100, 1
    s_cbranch_vccz Lpolld4
    s_cmp_eq_u32 s100, 0
    s_cbranch_scc1 Lpolld4
    s_sleep 1
    s_branch Lpoll4
Lpolld4:
Lat_lk26:
    s_barrier
    s_barrier
    s_barrier
    s_barrier
    s_barrier
    buffer_load_dword v247, v6, s[96:99], 0 offen sc1
    s_barrier
    s_waitcnt vmcnt(0)
    v_cmp_gt_u32 vcc, 8, v247
    s_nop 1
    s_cbranch_vccz Lat_lk32
    s_mov_b32 s100, 0x8000
Lpoll5:
    buffer_load_dword v244, v6, s[96:99], 0 offen sc1
    s_waitcnt vmcnt(0)
    v_cmp_gt_u32 vcc, 8, v244
    s_sub_u32 s100, s100, 1
    s_cbranch_vccz Lpolld5
    s_cmp_eq_u32 s100, 0
    s_cbranch_scc1 Lpolld5
    s_sleep 1
    s_branch Lpoll5
Lpolld5:
Lat_lk32:
    s_barrier
    s_barrier
    s_barrier
    s_barrier
    s_barrier
    s_barrier
    s_barrier
    s_barrier
    s_barrier
    s_barrier
    s_barrier
    s_barrier
    buffer_load_dword v247, v10, s[96:99], 0 offen sc1
    s_barrier
    s_waitcnt vmcnt(0)
    v_cmp_gt_u32 vcc, 16, v247
    s_nop 1
    s_cbranch_vccz Lat_lk45
    s_mov_b32 s100, 0x8000
Lpoll6:
    buffer_load_dword v244, v10, s[96:99], 0 offen sc1
    s_waitcnt vmcnt(0)
    v_cmp_gt_u32 vcc, 16, v244
    s_sub_u32 s100, s100, 1
    s_cbranch_vccz Lpolld6
    s_cmp_eq_u32 s100, 0
    s_cbranch_scc1 Lpolld6
    s_sleep 1
    s_branch Lpoll6
Lpolld6:
Lat_lk45:
    s_barrier
    s_barrier
    s_barrier
    s_barrier
    s_barrier
    s_branch Lat_ldone
Lat_w7:
    s_add_u32 m0, s40, 0
    s_add_u32 s36, s34, 0
    buffer_load_dwordx4 v13, s[8:11], s36 offen lds
    s_add_u32 m0, s40, 1088
    s_add_u32 s36, s34, 8192
    buffer_load_dwordx4 v13, s[8:11], s36 offen lds
    s_add_u32 m0, s40, 2176
    s_add_u32 s36, s34, 16384
    buffer_load_dwordx4 v13, s[8:11], s36 offen lds
    s_add_u32 m0, s40, 3264
    s_add_u32 s36, s34, 24576
    buffer_load_dwordx4 v13, s[8:11], s36 offen lds
    s_add_u32 m0, s40, 4352
    s_add_u32 s36, s34, 131072
    buffer_load_dwordx4 v13, s[8:11], s36 offen lds
    s_add_u32 m0, s40, 5440
    s_add_u32 s36, s34, 139264
    buffer_load_dwordx4 v13, s[8:11], s36 offen lds
    s_add_u32 m0, s40, 6528
    s_add_u32 s36, s34, 147456
    buffer_load_dwordx4 v13, s[8:11], s36 offen lds
    s_add_u32 m0, s40, 7616
    s_add_u32 s36, s34, 155648
    buffer_load_dwordx4 v13, s[8:11], s36 offen lds
    s_add_u32 s34, s34, 262144
    s_add_u32 s40, s40, 32768
    s_cmp_eq_u32 s40, 163840
    s_cselect_b32 s40, 0, s40
    s_add_u32 m0, s40, 0
    s_add_u32 s36, s34, 0
    buffer_load_dwordx4 v13, s[8:11], s36 offen lds
    s_add_u32 m0, s40, 1088
    s_add_u32 s36, s34, 8192
    buffer_load_dwordx4 v13, s[8:11], s36 offen lds
    s_add_u32 m0, s40, 2176
    s_add_u32 s36, s34, 16384
    buffer_load_dwordx4 v13, s[8:11], s36 offen lds
    s_add_u32 m0, s40, 3264
    s_add_u32 s36, s34, 24576
    buffer_load_dwordx4 v13, s[8:11], s36 offen lds
    s_add_u32 m0, s40, 4352
    s_add_u32 s36, s34, 131072
    buffer_load_dwordx4 v13, s[8:11], s36 offen lds
    s_add_u32 m0, s40, 5440
    s_add_u32 s36, s34, 139264
    buffer_load_dwordx4 v13, s[8:11], s36 offen lds
    s_add_u32 m0, s40, 6528
    s_add_u32 s36, s34, 147456
    buffer_load_dwordx4 v13, s[8:11], s36 offen lds
    s_add_u32 m0, s40, 7616
    s_add_u32 s36, s34, 155648
    buffer_load_dwordx4 v13, s[8:11], s36 offen lds
    s_add_u32 s34, s34, 262144
    s_add_u32 s40, s40, 32768
    s_cmp_eq_u32 s40, 163840
    s_cselect_b32 s40, 0, s40
    s_waitcnt vmcnt(16) lgkmcnt(0)
    s_barrier
    s_mov_b32 s41, 14
Lat_w7q:
    s_add_u32 m0, s40, 0
    s_add_u32 s36, s34, 0
    buffer_load_dwordx4 v13, s[8:11], s36 offen lds
    s_add_u32 m0, s40, 1088
    s_add_u32 s36, s34, 8192
    buffer_load_dwordx4 v13, s[8:11], s36 offen lds
    s_add_u32 m0, s40, 2176
    s_add_u32 s36, s34, 16384
    buffer_load_dwordx4 v13, s[8:11], s36 offen lds
    s_add_u32 m0, s40, 3264
    s_add_u32 s36, s34, 24576
    buffer_load_dwordx4 v13, s[8:11], s36 offen lds
    s_add_u32 m0, s40, 4352
    s_add_u32 s36, s34, 131072
    buffer_load_dwordx4 v13, s[8:11], s36 offen lds
    s_add_u32 m0, s40, 5440
    s_add_u32 s36, s34, 139264
    buffer_load_dwordx4 v13, s[8:11], s36 offen lds
    s_add_u32 m0, s40, 6528
    s_add_u32 s36, s34, 147456
    buffer_load_dwordx4 v13, s[8:11], s36 offen lds
    s_add_u32 m0, s40, 7616
    s_add_u32 s36, s34, 155648
    buffer_load_dwordx4 v13, s[8:11], s36 offen lds
    s_add_u32 s34, s34, 262144
    s_add_u32 s40, s40, 32768
    s_cmp_eq_u32 s40, 163840
    s_cselect_b32 s40, 0, s40
    s_sub_u32 s41, s41, 1
    s_cmp_lg_u32 s41, 0
    s_waitcnt vmcnt(16)
    s_barrier
    s_cbranch_scc1 Lat_w7q
    s_waitcnt vmcnt(8)
    s_barrier
    s_waitcnt vmcnt(0)
    s_barrier
    s_barrier
    s_add_u32 s55, s62, 2048
    buffer_store_dwordx4 v[64:67], v7, s[20:23], s55 offen offset:0 sc1
    s_add_u32 s55, s62, 6144
    buffer_store_dwordx4 v[68:71], v7, s[20:23], s55 offen offset:0 sc1
    s_add_u32 s55, s62, 2048
    buffer_store_dwordx4 v[72:75], v7, s[20:23], s55 offen offset:1024 sc1
    s_barrier
    s_add_u32 s55, s62, 6144
    buffer_store_dwordx4 v[76:79], v7, s[20:23], s55 offen offset:1024 sc1
    s_add_u32 s55, s62, 0
    buffer_store_dwordx4 v[128:131], v7, s[16:19], s55 offen offset:0 sc1
    s_add_u32 s55, s62, 0
    buffer_store_dwordx4 v[132:135], v7, s[16:19], s55 offen offset:1024 sc1
    s_barrier
    s_add_u32 s55, s62, 0
    buffer_store_dwordx4 v[136:139], v7, s[16:19], s55 offen offset:2048 sc1
    s_add_u32 s55, s62, 0
    buffer_store_dwordx4 v[140:143], v7, s[16:19], s55 offen offset:3072 sc1
    s_add_u32 s55, s62, 67584
    buffer_store_dwordx4 v[80:83], v7, s[20:23], s55 offen offset:0 sc1
    s_barrier
    s_add_u32 s55, s62, 71680
    buffer_store_dwordx4 v[84:87], v7, s[20:23], s55 offen offset:0 sc1
    s_add_u32 s55, s62, 67584
    buffer_store_dwordx4 v[88:91], v7, s[20:23], s55 offen offset:1024 sc1
    s_add_u32 s55, s62, 71680
    buffer_store_dwordx4 v[92:95], v7, s[20:23], s55 offen offset:1024 sc1
    s_barrier
    s_add_u32 s55, s62, 65536
    buffer_store_dwordx4 v[144:147], v7, s[16:19], s55 offen offset:0 sc1
    s_add_u32 s55, s62, 65536
    buffer_store_dwordx4 v[148:151], v7, s[16:19], s55 offen offset:1024 sc1
    s_add_u32 s55, s62, 65536
    buffer_store_dwordx4 v[152:155], v7, s[16:19], s55 offen offset:2048 sc1
    s_barrier
    s_add_u32 s55, s62, 65536
    buffer_store_dwordx4 v[156:159], v7, s[16:19], s55 offen offset:3072 sc1
    s_add_u32 s55, s62, 133120
    buffer_store_dwordx4 v[96:99], v7, s[20:23], s55 offen offset:0 sc1
    s_add_u32 s55, s62, 137216
    buffer_store_dwordx4 v[100:103], v7, s[20:23], s55 offen offset:0 sc1
    s_barrier
    s_add_u32 s55, s62, 133120
    buffer_store_dwordx4 v[104:107], v7, s[20:23], s55 offen offset:1024 sc1
    s_add_u32 s55, s62, 137216
    buffer_store_dwordx4 v[108:111], v7, s[20:23], s55 offen offset:1024 sc1
    s_add_u32 s55, s62, 131072
    buffer_store_dwordx4 v[160:163], v7, s[16:19], s55 offen offset:0 sc1
    s_barrier
    s_add_u32 s55, s62, 131072
    buffer_store_dwordx4 v[164:167], v7, s[16:19], s55 offen offset:1024 sc1
    s_add_u32 s55, s62, 131072
    buffer_store_dwordx4 v[168:171], v7, s[16:19], s55 offen offset:2048 sc1
    s_add_u32 s55, s62, 131072
    buffer_store_dwordx4 v[172:175], v7, s[16:19], s55 offen offset:3072 sc1
    s_barrier
    s_add_u32 s55, s62, 198656
    buffer_store_dwordx4 v[112:115], v7, s[20:23], s55 offen offset:0 sc1
    s_add_u32 s55, s62, 202752
    buffer_store_dwordx4 v[116:119], v7, s[20:23], s55 offen offset:0 sc1
    s_add_u32 s55, s62, 198656
    buffer_store_dwordx4 v[120:123], v7, s[20:23], s55 offen offset:1024 sc1
    s_barrier
    s_add_u32 s55, s62, 202752
    buffer_store_dwordx4 v[124:127], v7, s[20:23], s55 offen offset:1024 sc1
    s_add_u32 s55, s62, 196608
    buffer_store_dwordx4 v[176:179], v7, s[16:19], s55 offen offset:0 sc1
    s_add_u32 s55, s62, 196608
    buffer_store_dwordx4 v[180:183], v7, s[16:19], s55 offen offset:1024 sc1
    s_barrier
    s_add_u32 s55, s62, 196608
    buffer_store_dwordx4 v[184:187], v7, s[16:19], s55 offen offset:2048 sc1
    s_add_u32 s55, s62, 196608
    buffer_store_dwordx4 v[188:191], v7, s[16:19], s55 offen offset:3072 sc1
    s_barrier
    s_barrier
    s_waitcnt vmcnt(0)
    s_add_u32 s33, s32, 48128
    v_mov_b32 v4, 1
    s_mov_b64 exec, 1
    buffer_atomic_add v4, off, s[96:99], s33 sc1
    s_mov_b64 exec, -1
    s_barrier
    s_barrier
    s_barrier
    s_barrier
    s_barrier
    s_barrier
    s_barrier
    s_barrier
    s_barrier
    s_barrier
    s_barrier
    s_barrier
    s_barrier
    s_barrier
    s_barrier
    s_barrier
    s_barrier
    s_barrier
    s_barrier
    s_barrier
    s_barrier
Lat_ldone:
    s_and_b32 s28, s2, 7
    s_lshr_b32 s29, s2, 5
    s_bfe_u32 s30, s2, 0x20003
    v_and_b32 v8, 63, v0
    v_lshlrev_b32 v1, 4, v8
    s_mul_i32 s32, s6, 320
    s_mov_b32 s33, 0xe38e38f
    v_add_u32 v9, s32, v8
    v_add_u32 v9, 0, v9
    v_mul_hi_u32 v10, v9, s33
    v_mul_u32_u24 v11, 18, v10
    v_sub_u32 v11, v9, v11
    v_mul_u32_u24 v10, 1152, v10
    v_lshl_add_u32 v2, v11, 4, v10
    v_cmp_gt_u32 vcc, 1152, v9
    v_mov_b32 v10, 0xffffff00
    s_nop 1
    v_cndmask_b32 v2, v10, v2, vcc
    v_add_u32 v9, s32, v8
    v_add_u32 v9, 64, v9
    v_mul_hi_u32 v10, v9, s33
    v_mul_u32_u24 v11, 18, v10
    v_sub_u32 v11, v9, v11
    v_mul_u32_u24 v10, 1152, v10
    v_lshl_add_u32 v3, v11, 4, v10
    v_cmp_gt_u32 vcc, 1152, v9
    v_mov_b32 v10, 0xffffff00
    s_nop 1
    v_cndmask_b32 v3, v10, v3, vcc
    v_add_u32 v9, s32, v8
    v_add_u32 v9, 128, v9
    v_mul_hi_u32 v10, v9, s33
    v_mul_u32_u24 v11, 18, v10
    v_sub_u32 v11, v9, v11
    v_mul_u32_u24 v10, 1152, v10
    v_lshl_add_u32 v4, v11, 4, v10
    v_cmp_gt_u32 vcc, 1152, v9
    v_mov_b32 v10, 0xffffff00
    s_nop 1
    v_cndmask_b32 v4, v10, v4, vcc
    v_add_u32 v9, s32, v8
    v_add_u32 v9, 192, v9
    v_mul_hi_u32 v10, v9, s33
    v_mul_u32_u24 v11, 18, v10
    v_sub_u32 v11, v9, v11
    v_mul_u32_u24 v10, 1152, v10
    v_lshl_add_u32 v5, v11, 4, v10
    v_cmp_gt_u32 vcc, 1152, v9
    v_mov_b32 v10, 0xffffff00
    s_nop 1
    v_cndmask_b32 v5, v10, v5, vcc
    v_add_u32 v9, s32, v8
    v_add_u32 v9, 256, v9
    v_mul_hi_u32 v10, v9, s33
    v_mul_u32_u24 v11, 18, v10
    v_sub_u32 v11, v9, v11
    v_mul_u32_u24 v10, 1152, v10
    v_lshl_add_u32 v6, v11, 4, v10
    v_cmp_gt_u32 vcc, 1152, v9
    v_mov_b32 v10, 0xffffff00
    s_nop 1
    v_cndmask_b32 v6, v10, v6, vcc
    s_mov_b32 s8, s56
    s_and_b32 s9, s57, 0xffff
    s_mov_b32 s10, 4718592
    s_mov_b32 s11, 0x20000
    s_add_u32 s12, s4, 36110336
    s_addc_u32 s13, s5, 0
    s_and_b32 s13, s13, 0xffff
    s_mov_b32 s14, 16777216
    s_mov_b32 s15, 0x20000
    s_mul_i32 s34, s28, 589824
    s_mul_i32 s32, s30, 288
    s_add_u32 s34, s34, s32
    s_lshl_b32 s35, s29, 3
    s_lshl_b32 s32, s6, 1
    s_add_u32 s35, s35, s32
    s_lshl_b32 s35, s35, 17
    s_lshl_b32 s32, s28, 14
    s_add_u32 s35, s35, s32
    s_mul_i32 s37, s6, 5120
    s_add_u32 s37, s37, 16384
    s_lshl_b32 s38, s6, 12
    s_lshl_b32 s32, s29, 3
    s_add_u32 s32, s32, s28
    s_add_u32 s32, s32, 112
    s_lshl_b32 s32, s32, 7
    v_mov_b32 v7, s32
    s_waitcnt vmcnt(32) lgkmcnt(0)
    s_barrier
    s_waitcnt vmcnt(16)
    s_barrier
    s_mov_b32 s40, 0
    s_add_u32 s32, s40, s37
    s_add_u32 m0, s32, 0
    s_nop 0
    buffer_load_dwordx4 v2, s[8:11], s34 offen lds
    s_add_u32 m0, s32, 1024
    s_nop 0
    buffer_load_dwordx4 v3, s[8:11], s34 offen lds
    s_add_u32 m0, s32, 2048
    s_nop 0
    buffer_load_dwordx4 v4, s[8:11], s34 offen lds
    s_add_u32 m0, s32, 3072
    s_nop 0
    buffer_load_dwordx4 v5, s[8:11], s34 offen lds
    s_add_u32 m0, s32, 4096
    s_nop 0
    buffer_load_dwordx4 v6, s[8:11], s34 offen lds
    s_add_u32 s34, s34, 73728
    s_add_u32 m0, s40, s38
    s_add_u32 s33, s35, 0x20000
    buffer_load_dwordx4 v1, s[12:15], s35 offen sc1 lds
    buffer_load_dwordx4 v1, s[12:15], s35 offen offset:1024 sc1 lds
    s_add_u32 s32, s40, s38
    s_add_u32 m0, s32, 2048
    s_nop 0
    buffer_load_dwordx4 v1, s[12:15], s33 offen sc1 lds
    buffer_load_dwordx4 v1, s[12:15], s33 offen offset:1024 sc1 lds
    s_add_u32 s35, s35, 2048
    s_waitcnt vmcnt(9)
    s_barrier
    s_mov_b32 s40, 36864
    s_add_u32 s32, s40, s37
    s_add_u32 m0, s32, 0
    s_nop 0
    buffer_load_dwordx4 v2, s[8:11], s34 offen lds
    s_add_u32 m0, s32, 1024
    s_nop 0
    buffer_load_dwordx4 v3, s[8:11], s34 offen lds
    s_add_u32 m0, s32, 2048
    s_nop 0
    buffer_load_dwordx4 v4, s[8:11], s34 offen lds
    s_add_u32 m0, s32, 3072
    s_nop 0
    buffer_load_dwordx4 v5, s[8:11], s34 offen lds
    s_add_u32 m0, s32, 4096
    s_nop 0
    buffer_load_dwordx4 v6, s[8:11], s34 offen lds
    s_add_u32 s34, s34, 73728
    s_add_u32 m0, s40, s38
    s_add_u32 s33, s35, 0x20000
    buffer_load_dwordx4 v1, s[12:15], s35 offen sc1 lds
    buffer_load_dwordx4 v1, s[12:15], s35 offen offset:1024 sc1 lds
    s_add_u32 s32, s40, s38
    s_add_u32 m0, s32, 2048
    s_nop 0
    buffer_load_dwordx4 v1, s[12:15], s33 offen sc1 lds
    buffer_load_dwordx4 v1, s[12:15], s33 offen offset:1024 sc1 lds
    s_add_u32 s35, s35, 2048
    s_barrier
    s_mov_b32 s40, 73728
    s_add_u32 s32, s40, s37
    s_add_u32 m0, s32, 0
    s_nop 0
    buffer_load_dwordx4 v2, s[8:11], s34 offen lds
    s_add_u32 m0, s32, 1024
    s_nop 0
    buffer_load_dwordx4 v3, s[8:11], s34 offen lds
    s_add_u32 m0, s32, 2048
    s_nop 0
    buffer_load_dwordx4 v4, s[8:11], s34 offen lds
    s_add_u32 m0, s32, 3072
    s_nop 0
    buffer_load_dwordx4 v5, s[8:11], s34 offen lds
    s_add_u32 m0, s32, 4096
    s_nop 0
    buffer_load_dwordx4 v6, s[8:11], s34 offen lds
    s_add_u32 s34, s34, 73728
    s_add_u32 m0, s40, s38
    s_add_u32 s33, s35, 0x20000
    buffer_load_dwordx4 v1, s[12:15], s35 offen sc1 lds
    buffer_load_dwordx4 v1, s[12:15], s35 offen offset:1024 sc1 lds
    s_add_u32 s32, s40, s38
    s_add_u32 m0, s32, 2048
    s_nop 0
    buffer_load_dwordx4 v1, s[12:15], s33 offen sc1 lds
    buffer_load_dwordx4 v1, s[12:15], s33 offen offset:1024 sc1 lds
    s_add_u32 s35, s35, 2048
    s_load_dwordx2 s[46:47], s[0:1], 0
    s_bfe_u32 s32, s2, 0x20001
    s_lshl_b32 s32, s32, 2
    s_bfe_u32 s33, s2, 0x20003
    s_add_u32 s32, s32, s33
    s_and_b32 s43, s2, 1
    s_lshl_b32 s43, s43, 3
    s_lshr_b32 s33, s2, 5
    s_add_u32 s43, s43, s33
    s_lshl_b32 s42, s43, 4
    s_add_u32 s42, s42, s32
    s_mul_i32 s44, s42, 9216
    v_mov_b32 v232, v0
    v_add_u32 v233, 512, v0
    v_cmp_gt_u32 vcc, 64, v0
    v_mov_b32 v234, 0x0ffffff0
    s_nop 1
    v_cndmask_b32 v233, v234, v233, vcc
    v_lshlrev_b32 v236, 4, v232
    v_lshlrev_b32 v237, 4, v233
    v_mov_b32 v240, 0x3f80
    v_mov_b32 v241, 0x3f800000
    s_add_u32 s48, s4, 65536
    s_addc_u32 s49, s5, 0
    s_and_b32 s49, s49, 0xffff
    s_mov_b32 s50, 13824
    s_mov_b32 s51, 0x20000
    v_lshlrev_b32 v238, 2, v232
    v_lshlrev_b32 v239, 2, v233
    v_and_b32 v235, 63, v0
    v_lshlrev_b32 v235, 2, v235
    s_mov_b32 s32, 4608
    buffer_load_dword v208, v238, s[48:51], s32 offen sc1
    buffer_load_dword v209, v239, s[48:51], s32 offen sc1
    s_mov_b32 s32, 6912
    s_mov_b32 s33, 9216
    buffer_load_dword v210, v235, s[48:51], s32 offen offset:0 sc1
    buffer_load_dword v220, v235, s[48:51], s33 offen offset:0 sc1
    buffer_load_dword v211, v235, s[48:51], s32 offen offset:256 sc1
    buffer_load_dword v221, v235, s[48:51], s33 offen offset:256 sc1
    buffer_load_dword v212, v235, s[48:51], s32 offen offset:512 sc1
    buffer_load_dword v222, v235, s[48:51], s33 offen offset:512 sc1
    buffer_load_dword v213, v235, s[48:51], s32 offen offset:768 sc1
    buffer_load_dword v223, v235, s[48:51], s33 offen offset:768 sc1
    buffer_load_dword v214, v235, s[48:51], s32 offen offset:1024 sc1
    buffer_load_dword v224, v235, s[48:51], s33 offen offset:1024 sc1
    buffer_load_dword v215, v235, s[48:51], s32 offen offset:1280 sc1
    buffer_load_dword v225, v235, s[48:51], s33 offen offset:1280 sc1
    buffer_load_dword v216, v235, s[48:51], s32 offen offset:1536 sc1
    buffer_load_dword v226, v235, s[48:51], s33 offen offset:1536 sc1
    buffer_load_dword v217, v235, s[48:51], s32 offen offset:1792 sc1
    buffer_load_dword v227, v235, s[48:51], s33 offen offset:1792 sc1
    buffer_load_dword v218, v235, s[48:51], s32 offen offset:2048 sc1
    buffer_load_dword v228, v235, s[48:51], s33 offen offset:2048 sc1
    v_lshlrev_b32 v230, 1, v232
    v_lshlrev_b32 v231, 1, v233
    s_waitcnt lgkmcnt(0)
    s_mov_b32 s48, s46
    s_and_b32 s49, s47, 0xffff
    s_mov_b32 s50, 2359296
    s_mov_b32 s51, 0x20000
    s_mov_b32 s32, s44
    buffer_load_short_d16_hi v192, v230, s[48:51], s32 offen
    buffer_load_short_d16_hi v200, v231, s[48:51], s32 offen
    buffer_load_short_d16_hi v193, v230, s[48:51], s32 offen offset:1152
    buffer_load_short_d16_hi v201, v231, s[48:51], s32 offen offset:1152
    buffer_load_short_d16_hi v194, v230, s[48:51], s32 offen offset:2304
    buffer_load_short_d16_hi v202, v231, s[48:51], s32 offen offset:2304
    s_add_u32 s32, s32, 3456
    buffer_load_short_d16_hi v195, v230, s[48:51], s32 offen
    buffer_load_short_d16_hi v203, v231, s[48:51], s32 offen
    buffer_load_short_d16_hi v196, v230, s[48:51], s32 offen offset:1152
    buffer_load_short_d16_hi v204, v231, s[48:51], s32 offen offset:1152
    buffer_load_short_d16_hi v197, v230, s[48:51], s32 offen offset:2304
    buffer_load_short_d16_hi v205, v231, s[48:51], s32 offen offset:2304
    s_add_u32 s32, s32, 3456
    buffer_load_short_d16_hi v198, v230, s[48:51], s32 offen
    buffer_load_short_d16_hi v206, v231, s[48:51], s32 offen
    buffer_load_short_d16_hi v199, v230, s[48:51], s32 offen offset:1152
    buffer_load_short_d16_hi v207, v231, s[48:51], s32 offen offset:1152
    v_add_u32 v238, 118784, v238
    s_mul_i32 s32, s3, 2304
    s_add_u32 s32, s32, 118784
    v_add_u32 v239, s32, v235
    s_waitcnt vmcnt(45)
    s_barrier
    s_mov_b32 s40, 110592
    s_add_u32 s32, s40, s37
    s_add_u32 m0, s32, 0
    s_nop 0
    buffer_load_dwordx4 v2, s[8:11], s34 offen lds
    s_add_u32 m0, s32, 1024
    s_nop 0
    buffer_load_dwordx4 v3, s[8:11], s34 offen lds
    s_add_u32 m0, s32, 2048
    s_nop 0
    buffer_load_dwordx4 v4, s[8:11], s34 offen lds
    s_add_u32 m0, s32, 3072
    s_nop 0
    buffer_load_dwordx4 v5, s[8:11], s34 offen lds
    s_add_u32 m0, s32, 4096
    s_nop 0
    buffer_load_dwordx4 v6, s[8:11], s34 offen lds
    s_add_u32 s34, s34, 73728
    s_add_u32 m0, s40, s38
    s_add_u32 s33, s35, 0x20000
    buffer_load_dwordx4 v1, s[12:15], s35 offen sc1 lds
    buffer_load_dwordx4 v1, s[12:15], s35 offen offset:1024 sc1 lds
    s_add_u32 s32, s40, s38
    s_add_u32 m0, s32, 2048
    s_nop 0
    buffer_load_dwordx4 v1, s[12:15], s33 offen sc1 lds
    buffer_load_dwordx4 v1, s[12:15], s33 offen offset:1024 sc1 lds
    s_add_u32 s35, s35, 2048
    s_waitcnt vmcnt(45)
    s_barrier
    s_mov_b32 s40, 0
    s_add_u32 s32, s40, s37
    s_add_u32 m0, s32, 0
    s_nop 0
    buffer_load_dwordx4 v2, s[8:11], s34 offen lds
    s_add_u32 m0, s32, 1024
    s_nop 0
    buffer_load_dwordx4 v3, s[8:11], s34 offen lds
    s_add_u32 m0, s32, 2048
    s_nop 0
    buffer_load_dwordx4 v4, s[8:11], s34 offen lds
    s_add_u32 m0, s32, 3072
    s_nop 0
    buffer_load_dwordx4 v5, s[8:11], s34 offen lds
    s_add_u32 m0, s32, 4096
    s_nop 0
    buffer_load_dwordx4 v6, s[8:11], s34 offen lds
    s_add_u32 s34, s34, 73728
    s_add_u32 m0, s40, s38
    s_add_u32 s33, s35, 0x20000
    buffer_load_dwordx4 v1, s[12:15], s35 offen sc1 lds
    buffer_load_dwordx4 v1, s[12:15], s35 offen offset:1024 sc1 lds
    s_add_u32 s32, s40, s38
    s_add_u32 m0, s32, 2048
    s_nop 0
    buffer_load_dwordx4 v1, s[12:15], s33 offen sc1 lds
    buffer_load_dwordx4 v1, s[12:15], s33 offen offset:1024 sc1 lds
    s_add_u32 s35, s35, 2048
    s_waitcnt vmcnt(9)
    s_barrier
    s_mov_b32 s40, 36864
    s_add_u32 s32, s40, s37
    s_add_u32 m0, s32, 0
    s_nop 0
    buffer_load_dwordx4 v2, s[8:11], s34 offen lds
    s_add_u32 m0, s32, 1024
    s_nop 0
    buffer_load_dwordx4 v3, s[8:11], s34 offen lds
    s_add_u32 m0, s32, 2048
    s_nop 0
    buffer_load_dwordx4 v4, s[8:11], s34 offen lds
    s_add_u32 m0, s32, 3072
    s_nop 0
    buffer_load_dwordx4 v5, s[8:11], s34 offen lds
    s_add_u32 m0, s32, 4096
    s_nop 0
    buffer_load_dwordx4 v6, s[8:11], s34 offen lds
    s_add_u32 s34, s34, 73728
    s_add_u32 m0, s40, s38
    s_add_u32 s33, s35, 0x20000
    buffer_load_dwordx4 v1, s[12:15], s35 offen sc1 lds
    buffer_load_dwordx4 v1, s[12:15], s35 offen offset:1024 sc1 lds
    s_add_u32 s32, s40, s38
    s_add_u32 m0, s32, 2048
    s_nop 0
    buffer_load_dwordx4 v1, s[12:15], s33 offen sc1 lds
    buffer_load_dwordx4 v1, s[12:15], s33 offen offset:1024 sc1 lds
    s_add_u32 s35, s35, 2048
    s_waitcnt vmcnt(9)
    s_barrier
    s_mov_b32 s40, 73728
    s_add_u32 s32, s40, s37
    s_add_u32 m0, s32, 0
    s_nop 0
    buffer_load_dwordx4 v2, s[8:11], s34 offen lds
    s_add_u32 m0, s32, 1024
    s_nop 0
    buffer_load_dwordx4 v3, s[8:11], s34 offen lds
    s_add_u32 m0, s32, 2048
    s_nop 0
    buffer_load_dwordx4 v4, s[8:11], s34 offen lds
    s_add_u32 m0, s32, 3072
    s_nop 0
    buffer_load_dwordx4 v5, s[8:11], s34 offen lds
    s_add_u32 m0, s32, 4096
    s_nop 0
    buffer_load_dwordx4 v6, s[8:11], s34 offen lds
    s_add_u32 s34, s34, 73728
    s_add_u32 m0, s40, s38
    s_add_u32 s33, s35, 0x20000
    buffer_load_dwordx4 v1, s[12:15], s35 offen sc1 lds
    buffer_load_dwordx4 v1, s[12:15], s35 offen offset:1024 sc1 lds
    s_add_u32 s32, s40, s38
    s_add_u32 m0, s32, 2048
    s_nop 0
    buffer_load_dwordx4 v1, s[12:15], s33 offen sc1 lds
    buffer_load_dwordx4 v1, s[12:15], s33 offen offset:1024 sc1 lds
    s_add_u32 s35, s35, 2048
    s_cmp_lg_u32 s6, 0
    s_cbranch_scc1 Lgo_nl
    buffer_load_dword v244, v7, s[96:99], 0 offen sc1
Lgo_nl:
    v_and_b32 v192, 0xffff0000, v192
    v_and_b32 v193, 0xffff0000, v193
    v_and_b32 v194, 0xffff0000, v194
    v_and_b32 v195, 0xffff0000, v195
    v_and_b32 v196, 0xffff0000, v196
    v_and_b32 v197, 0xffff0000, v197
    v_and_b32 v198, 0xffff0000, v198
    v_and_b32 v199, 0xffff0000, v199
    v_and_b32 v200, 0xffff0000, v200
    v_and_b32 v201, 0xffff0000, v201
    v_and_b32 v202, 0xffff0000, v202
    v_and_b32 v203, 0xffff0000, v203
    v_and_b32 v204, 0xffff0000, v204
    v_and_b32 v205, 0xffff0000, v205
    v_and_b32 v206, 0xffff0000, v206
    v_and_b32 v207, 0xffff0000, v207
    v_add_f32 v220, 1.0, v220
    v_cvt_pk_bf16_f32 v220, v220, v220
    v_and_b32 v220, 0xffff0000, v220
    v_add_f32 v221, 1.0, v221
    v_cvt_pk_bf16_f32 v221, v221, v221
    v_and_b32 v221, 0xffff0000, v221
    v_add_f32 v222, 1.0, v222
    v_cvt_pk_bf16_f32 v222, v222, v222
    v_and_b32 v222, 0xffff0000, v222
    v_add_f32 v223, 1.0, v223
    v_cvt_pk_bf16_f32 v223, v223, v223
    v_and_b32 v223, 0xffff0000, v223
    v_add_f32 v224, 1.0, v224
    v_cvt_pk_bf16_f32 v224, v224, v224
    v_and_b32 v224, 0xffff0000, v224
    v_add_f32 v225, 1.0, v225
    v_cvt_pk_bf16_f32 v225, v225, v225
    v_and_b32 v225, 0xffff0000, v225
    v_add_f32 v226, 1.0, v226
    v_cvt_pk_bf16_f32 v226, v226, v226
    v_and_b32 v226, 0xffff0000, v226
    v_add_f32 v227, 1.0, v227
    v_cvt_pk_bf16_f32 v227, v227, v227
    v_and_b32 v227, 0xffff0000, v227
    v_add_f32 v228, 1.0, v228
    v_cvt_pk_bf16_f32 v228, v228, v228
    v_and_b32 v228, 0xffff0000, v228
    v_lshrrev_b32 v230, 5, v232
    v_lshlrev_b32 v230, 17, v230
    v_and_b32 v234, 31, v232
    v_lshl_add_u32 v230, v234, 4, v230
    v_lshrrev_b32 v231, 5, v233
    v_lshlrev_b32 v231, 17, v231
    v_and_b32 v234, 31, v233
    v_lshl_add_u32 v231, v234, 4, v231
    s_waitcnt vmcnt(9)
    s_barrier
    s_mov_b32 s40, 110592
    s_add_u32 s32, s40, s37
    s_add_u32 m0, s32, 0
    s_nop 0
    buffer_load_dwordx4 v2, s[8:11], s34 offen lds
    s_add_u32 m0, s32, 1024
    s_nop 0
    buffer_load_dwordx4 v3, s[8:11], s34 offen lds
    s_add_u32 m0, s32, 2048
    s_nop 0
    buffer_load_dwordx4 v4, s[8:11], s34 offen lds
    s_add_u32 m0, s32, 3072
    s_nop 0
    buffer_load_dwordx4 v5, s[8:11], s34 offen lds
    s_add_u32 m0, s32, 4096
    s_nop 0
    buffer_load_dwordx4 v6, s[8:11], s34 offen lds
    s_add_u32 s34, s34, 73728
    s_add_u32 m0, s40, s38
    s_add_u32 s33, s35, 0x20000
    buffer_load_dwordx4 v1, s[12:15], s35 offen sc1 lds
    buffer_load_dwordx4 v1, s[12:15], s35 offen offset:1024 sc1 lds
    s_add_u32 s32, s40, s38
    s_add_u32 m0, s32, 2048
    s_nop 0
    buffer_load_dwordx4 v1, s[12:15], s33 offen sc1 lds
    buffer_load_dwordx4 v1, s[12:15], s33 offen offset:1024 sc1 lds
    s_add_u32 s35, s35, 2048
    s_waitcnt vmcnt(9)
    s_cmp_lg_u32 s6, 0
    s_cbranch_scc1 Lgo_np
    v_cmp_gt_u32 vcc, 16, v244
    s_nop 1
    s_cbranch_vccz Lgo_np
    s_mov_b32 s100, 0x8000
Lpoll7:
    buffer_load_dword v244, v7, s[96:99], 0 offen sc1
    s_waitcnt vmcnt(0)
    v_cmp_gt_u32 vcc, 16, v244
    s_sub_u32 s100, s100, 1
    s_cbranch_vccz Lpolld7
    s_cmp_eq_u32 s100, 0
    s_cbranch_scc1 Lpolld7
    s_sleep 1
    s_branch Lpoll7
Lpolld7:
Lgo_np:
    s_barrier
    s_add_u32 s35, s35, 8372224
    s_sub_u32 s34, s34, 589824
    s_mov_b32 s40, 0
    s_add_u32 s32, s40, s37
    s_add_u32 m0, s32, 0
    s_nop 0
    buffer_load_dwordx4 v2, s[8:11], s34 offen lds
    s_add_u32 m0, s32, 1024
    s_nop 0
    buffer_load_dwordx4 v3, s[8:11], s34 offen lds
    s_add_u32 m0, s32, 2048
    s_nop 0
    buffer_load_dwordx4 v4, s[8:11], s34 offen lds
    s_add_u32 m0, s32, 3072
    s_nop 0
    buffer_load_dwordx4 v5, s[8:11], s34 offen lds
    s_add_u32 m0, s32, 4096
    s_nop 0
    buffer_load_dwordx4 v6, s[8:11], s34 offen lds
    s_add_u32 s34, s34, 73728
    s_add_u32 m0, s40, s38
    s_add_u32 s33, s35, 0x20000
    buffer_load_dwordx4 v1, s[12:15], s35 offen sc1 lds
    buffer_load_dwordx4 v1, s[12:15], s35 offen offset:1024 sc1 lds
    s_add_u32 s32, s40, s38
    s_add_u32 m0, s32, 2048
    s_nop 0
    buffer_load_dwordx4 v1, s[12:15], s33 offen sc1 lds
    buffer_load_dwordx4 v1, s[12:15], s33 offen offset:1024 sc1 lds
    s_add_u32 s35, s35, 2048
    s_waitcnt vmcnt(9)
    s_barrier
    s_mov_b32 s40, 36864
    s_add_u32 s32, s40, s37
    s_add_u32 m0, s32, 0
    s_nop 0
    buffer_load_dwordx4 v2, s[8:11], s34 offen lds
    s_add_u32 m0, s32, 1024
    s_nop 0
    buffer_load_dwordx4 v3, s[8:11], s34 offen lds
    s_add_u32 m0, s32, 2048
    s_nop 0
    buffer_load_dwordx4 v4, s[8:11], s34 offen lds
    s_add_u32 m0, s32, 3072
    s_nop 0
    buffer_load_dwordx4 v5, s[8:11], s34 offen lds
    s_add_u32 m0, s32, 4096
    s_nop 0
    buffer_load_dwordx4 v6, s[8:11], s34 offen lds
    s_add_u32 s34, s34, 73728
    s_add_u32 m0, s40, s38
    s_add_u32 s33, s35, 0x20000
    buffer_load_dwordx4 v1, s[12:15], s35 offen sc1 lds
    buffer_load_dwordx4 v1, s[12:15], s35 offen offset:1024 sc1 lds
    s_add_u32 s32, s40, s38
    s_add_u32 m0, s32, 2048
    s_nop 0
    buffer_load_dwordx4 v1, s[12:15], s33 offen sc1 lds
    buffer_load_dwordx4 v1, s[12:15], s33 offen offset:1024 sc1 lds
    s_add_u32 s35, s35, 2048
    s_waitcnt vmcnt(9)
    s_barrier
    s_mov_b32 s40, 73728
    s_add_u32 s32, s40, s37
    s_add_u32 m0, s32, 0
    s_nop 0
    buffer_load_dwordx4 v2, s[8:11], s34 offen lds
    s_add_u32 m0, s32, 1024
    s_nop 0
    buffer_load_dwordx4 v3, s[8:11], s34 offen lds
    s_add_u32 m0, s32, 2048
    s_nop 0
    buffer_load_dwordx4 v4, s[8:11], s34 offen lds
    s_add_u32 m0, s32, 3072
    s_nop 0
    buffer_load_dwordx4 v5, s[8:11], s34 offen lds
    s_add_u32 m0, s32, 4096
    s_nop 0
    buffer_load_dwordx4 v6, s[8:11], s34 offen lds
    s_add_u32 s34, s34, 73728
    s_add_u32 m0, s40, s38
    s_add_u32 s33, s35, 0x20000
    buffer_load_dwordx4 v1, s[12:15], s35 offen sc1 lds
    buffer_load_dwordx4 v1, s[12:15], s35 offen offset:1024 sc1 lds
    s_add_u32 s32, s40, s38
    s_add_u32 m0, s32, 2048
    s_nop 0
    buffer_load_dwordx4 v1, s[12:15], s33 offen sc1 lds
    buffer_load_dwordx4 v1, s[12:15], s33 offen offset:1024 sc1 lds
    s_add_u32 s35, s35, 2048
    s_waitcnt vmcnt(9)
    s_barrier
    s_mov_b32 s40, 110592
    s_add_u32 s32, s40, s37
    s_add_u32 m0, s32, 0
    s_nop 0
    buffer_load_dwordx4 v2, s[8:11], s34 offen lds
    s_add_u32 m0, s32, 1024
    s_nop 0
    buffer_load_dwordx4 v3, s[8:11], s34 offen lds
    s_add_u32 m0, s32, 2048
    s_nop 0
    buffer_load_dwordx4 v4, s[8:11], s34 offen lds
    s_add_u32 m0, s32, 3072
    s_nop 0
    buffer_load_dwordx4 v5, s[8:11], s34 offen lds
    s_add_u32 m0, s32, 4096
    s_nop 0
    buffer_load_dwordx4 v6, s[8:11], s34 offen lds
    s_add_u32 s34, s34, 73728
    s_add_u32 m0, s40, s38
    s_add_u32 s33, s35, 0x20000
    buffer_load_dwordx4 v1, s[12:15], s35 offen sc1 lds
    buffer_load_dwordx4 v1, s[12:15], s35 offen offset:1024 sc1 lds
    s_add_u32 s32, s40, s38
    s_add_u32 m0, s32, 2048
    s_nop 0
    buffer_load_dwordx4 v1, s[12:15], s33 offen sc1 lds
    buffer_load_dwordx4 v1, s[12:15], s33 offen offset:1024 sc1 lds
    s_add_u32 s35, s35, 2048
    s_waitcnt vmcnt(9)
    s_barrier
    s_mov_b32 s40, 0
    s_add_u32 s32, s40, s37
    s_add_u32 m0, s32, 0
    s_nop 0
    buffer_load_dwordx4 v2, s[8:11], s34 offen lds
    s_add_u32 m0, s32, 1024
    s_nop 0
    buffer_load_dwordx4 v3, s[8:11], s34 offen lds
    s_add_u32 m0, s32, 2048
    s_nop 0
    buffer_load_dwordx4 v4, s[8:11], s34 offen lds
    s_add_u32 m0, s32, 3072
    s_nop 0
    buffer_load_dwordx4 v5, s[8:11], s34 offen lds
    s_add_u32 m0, s32, 4096
    s_nop 0
    buffer_load_dwordx4 v6, s[8:11], s34 offen lds
    s_add_u32 s34, s34, 73728
    s_add_u32 m0, s40, s38
    s_add_u32 s33, s35, 0x20000
    buffer_load_dwordx4 v1, s[12:15], s35 offen sc1 lds
    buffer_load_dwordx4 v1, s[12:15], s35 offen offset:1024 sc1 lds
    s_add_u32 s32, s40, s38
    s_add_u32 m0, s32, 2048
    s_nop 0
    buffer_load_dwordx4 v1, s[12:15], s33 offen sc1 lds
    buffer_load_dwordx4 v1, s[12:15], s33 offen offset:1024 sc1 lds
    s_add_u32 s35, s35, 2048
    s_waitcnt vmcnt(9)
    s_barrier
    s_mov_b32 s40, 36864
    s_add_u32 s32, s40, s37
    s_add_u32 m0, s32, 0
    s_nop 0
    buffer_load_dwordx4 v2, s[8:11], s34 offen lds
    s_add_u32 m0, s32, 1024
    s_nop 0
    buffer_load_dwordx4 v3, s[8:11], s34 offen lds
    s_add_u32 m0, s32, 2048
    s_nop 0
    buffer_load_dwordx4 v4, s[8:11], s34 offen lds
    s_add_u32 m0, s32, 3072
    s_nop 0
    buffer_load_dwordx4 v5, s[8:11], s34 offen lds
    s_add_u32 m0, s32, 4096
    s_nop 0
    buffer_load_dwordx4 v6, s[8:11], s34 offen lds
    s_add_u32 s34, s34, 73728
    s_add_u32 m0, s40, s38
    s_add_u32 s33, s35, 0x20000
    buffer_load_dwordx4 v1, s[12:15], s35 offen sc1 lds
    buffer_load_dwordx4 v1, s[12:15], s35 offen offset:1024 sc1 lds
    s_add_u32 s32, s40, s38
    s_add_u32 m0, s32, 2048
    s_nop 0
    buffer_load_dwordx4 v1, s[12:15], s33 offen sc1 lds
    buffer_load_dwordx4 v1, s[12:15], s33 offen offset:1024 sc1 lds
    s_add_u32 s35, s35, 2048
    s_waitcnt vmcnt(9)
    s_barrier
    s_mov_b32 s40, 73728
    s_add_u32 s32, s40, s37
    s_add_u32 m0, s32, 0
    s_nop 0
    buffer_load_dwordx4 v2, s[8:11], s34 offen lds
    s_add_u32 m0, s32, 1024
    s_nop 0
    buffer_load_dwordx4 v3, s[8:11], s34 offen lds
    s_add_u32 m0, s32, 2048
    s_nop 0
    buffer_load_dwordx4 v4, s[8:11], s34 offen lds
    s_add_u32 m0, s32, 3072
    s_nop 0
    buffer_load_dwordx4 v5, s[8:11], s34 offen lds
    s_add_u32 m0, s32, 4096
    s_nop 0
    buffer_load_dwordx4 v6, s[8:11], s34 offen lds
    s_add_u32 s34, s34, 73728
    s_add_u32 m0, s40, s38
    s_add_u32 s33, s35, 0x20000
    buffer_load_dwordx4 v1, s[12:15], s35 offen sc1 lds
    buffer_load_dwordx4 v1, s[12:15], s35 offen offset:1024 sc1 lds
    s_add_u32 s32, s40, s38
    s_add_u32 m0, s32, 2048
    s_nop 0
    buffer_load_dwordx4 v1, s[12:15], s33 offen sc1 lds
    buffer_load_dwordx4 v1, s[12:15], s33 offen offset:1024 sc1 lds
    s_add_u32 s35, s35, 2048
    s_waitcnt vmcnt(9)
    s_barrier
    s_mov_b32 s40, 110592
    s_add_u32 s32, s40, s37
    s_add_u32 m0, s32, 0
    s_nop 0
    buffer_load_dwordx4 v2, s[8:11], s34 offen lds
    s_add_u32 m0, s32, 1024
    s_nop 0
    buffer_load_dwordx4 v3, s[8:11], s34 offen lds
    s_add_u32 m0, s32, 2048
    s_nop 0
    buffer_load_dwordx4 v4, s[8:11], s34 offen lds
    s_add_u32 m0, s32, 3072
    s_nop 0
    buffer_load_dwordx4 v5, s[8:11], s34 offen lds
    s_add_u32 m0, s32, 4096
    s_nop 0
    buffer_load_dwordx4 v6, s[8:11], s34 offen lds
    s_add_u32 s34, s34, 73728
    s_add_u32 m0, s40, s38
    s_add_u32 s33, s35, 0x20000
    buffer_load_dwordx4 v1, s[12:15], s35 offen sc1 lds
    buffer_load_dwordx4 v1, s[12:15], s35 offen offset:1024 sc1 lds
    s_add_u32 s32, s40, s38
    s_add_u32 m0, s32, 2048
    s_nop 0
    buffer_load_dwordx4 v1, s[12:15], s33 offen sc1 lds
    buffer_load_dwordx4 v1, s[12:15], s33 offen offset:1024 sc1 lds
    s_add_u32 s35, s35, 2048
    s_cmp_lg_u32 s6, 0
    s_cbranch_scc1 Lgo_ns
    s_add_u32 s32, s29, 176
    s_lshl_b32 s32, s32, 7
    v_mov_b32 v9, 1
    s_mov_b64 exec, 1
    buffer_atomic_add v9, off, s[96:99], s32 sc1
    s_mov_b64 exec, -1
Lgo_ns:
    s_waitcnt vmcnt(9)
    s_barrier
    s_waitcnt vmcnt(0)
    s_barrier
    s_barrier
    s_and_b32 s32, s2, 7
    s_mul_i32 s32, s32, 27
    s_lshr_b32 s33, s2, 3
    s_add_u32 s32, s32, s33
    s_mul_hi_u32 s28, s32, 0x2aaaaaab
    s_mul_i32 s33, s28, 6
    s_sub_u32 s29, s32, s33
    v_and_b32 v8, 63, v0
    v_lshlrev_b32 v1, 4, v8
    v_lshrrev_b32 v2, 4, v8
    v_mul_u32_u24 v2, 36864, v2
    v_and_b32 v9, 15, v8
    v_lshl_add_u32 v2, v9, 4, v2
    s_mul_i32 s32, s6, 147456
    v_add_u32 v2, s32, v2
    s_mov_b32 s8, s58
    s_and_b32 s9, s59, 0xffff
    s_mov_b32 s10, 18874368
    s_mov_b32 s11, 0x20000
    s_add_u32 s12, s4, 74121216
    s_addc_u32 s13, s5, 0
    s_and_b32 s13, s13, 0xffff
    s_mov_b32 s14, 2359296
    s_mov_b32 s15, 0x20000
    s_lshl_b32 s34, s28, 8
    s_mul_i32 s35, s29, 393216
    s_lshl_b32 s32, s6, 10
    s_add_u32 s35, s35, s32
    s_mul_i32 s37, s6, 4352
    s_lshl_b32 s38, s6, 10
    s_add_u32 s38, s38, 17408
    s_and_b32 s32, s2, 7
    s_lshl_b32 s32, s32, 4
    s_add_u32 s32, s32, 232
    v_and_b32 v7, 7, v8
    v_add_u32 v7, s32, v7
    v_lshlrev_b32 v7, 7, v7
    s_load_dwordx2 s[24:25], s[0:1], 64
    s_waitcnt lgkmcnt(0)
    s_mov_b32 s16, s24
    s_and_b32 s17, s25, 0xffff
    s_mov_b32 s18, 9216
    s_mov_b32 s19, 0x20000
    s_lshl_b32 s32, s28, 2
    s_add_u32 s45, s32, s6
    s_lshl_b32 s32, s45, 6
    v_lshrrev_b32 v9, 5, v8
    v_lshlrev_b32 v9, 3, v9
    buffer_load_dwordx2 v[152:153], v9, s[16:19], s32 offen offset:0
    buffer_load_dwordx2 v[154:155], v9, s[16:19], s32 offen offset:16
    buffer_load_dwordx2 v[156:157], v9, s[16:19], s32 offen offset:32
    buffer_load_dwordx2 v[158:159], v9, s[16:19], s32 offen offset:48
    s_add_u32 s20, s4, 76480512
    s_addc_u32 s21, s5, 0
    s_and_b32 s21, s21, 0xffff
    s_mov_b32 s22, 5308416
    s_mov_b32 s23, 0x20000
    v_bfe_u32 v9, v8, 4, 1
    v_mul_u32_u24 v9, 147456, v9
    v_lshrrev_b32 v10, 5, v8
    v_lshl_add_u32 v9, v10, 8, v9
    v_and_b32 v10, 15, v8
    v_lshl_add_u32 v6, v10, 4, v9
    s_mul_i32 s39, s29, 884736
    s_lshl_b32 s33, s45, 10
    s_add_u32 s39, s39, s33
    s_barrier
    s_cmp_lg_u32 s6, 0
    s_cbranch_scc1 Ll_s1
    s_lshr_b32 s32, s2, 5
    s_add_u32 s32, s32, 184
    s_lshl_b32 s32, s32, 7
    v_mov_b32 v9, 1
    s_mov_b64 exec, 1
    buffer_atomic_add v9, off, s[96:99], s32 sc1
    s_mov_b64 exec, -1
Ll_s1:
    s_cmp_lg_u32 s6, 0
    s_cbranch_scc1 Ll_np1
    s_add_u32 s32, s43, 176
    s_lshl_b32 s32, s32, 7
    v_mov_b32 v10, s32
    s_mov_b32 s100, 0x8000
Lpoll8:
    buffer_load_dword v244, v10, s[96:99], 0 offen sc1
    s_waitcnt vmcnt(0)
    v_cmp_gt_u32 vcc, 32, v244
    s_sub_u32 s100, s100, 1
    s_cbranch_vccz Lpolld8
    s_cmp_eq_u32 s100, 0
    s_cbranch_scc1 Lpolld8
    s_sleep 1
    s_branch Lpoll8
Lpolld8:
Ll_np1:
    s_barrier
    s_branch Lln_shared
Ll_after_ln:
    s_cmp_ge_u32 s2, 216
    s_cbranch_scc1 Ll_nom1
    s_cmp_ge_u32 s43, 8
    s_cbranch_scc1 Ll_late
    s_waitcnt vmcnt(0)
    s_barrier
    s_cmp_lg_u32 s6, 0
    s_cbranch_scc1 Ll_s2
    s_add_u32 s32, s43, 232
    s_lshl_b32 s32, s32, 7
    v_lshlrev_b32 v10, 11, v8
    v_mov_b32 v9, 1
    s_mov_b64 exec, 0xff
    buffer_atomic_add v9, v10, s[96:99], s32 offen sc1
    s_mov_b64 exec, -1
    s_mov_b32 s100, 0x8000
Lpoll9:
    buffer_load_dword v244, v7, s[96:99], 0 offen sc1
    s_waitcnt vmcnt(0)
    v_cmp_gt_u32 vcc, 16, v244
    s_sub_u32 s100, s100, 1
    s_cbranch_vccz Lpolld9
    s_cmp_eq_u32 s100, 0
    s_cbranch_scc1 Lpolld9
    s_sleep 1
    s_branch Lpoll9
Lpolld9:
Ll_s2:
    s_barrier
    s_mov_b32 s40, 0
    s_add_u32 s32, s40, s38
    s_add_u32 m0, s32, 0
    s_add_u32 s33, s35, 0
    buffer_load_dwordx4 v1, s[12:15], s33 offen sc1 lds
    s_add_u32 m0, s32, 4096
    s_add_u32 s33, s35, 131072
    buffer_load_dwordx4 v1, s[12:15], s33 offen sc1 lds
    s_add_u32 m0, s32, 8192
    s_add_u32 s33, s35, 262144
    buffer_load_dwordx4 v1, s[12:15], s33 offen sc1 lds
    s_add_u32 s35, s35, 4096
    s_mov_b32 s40, 29696
    s_add_u32 s32, s40, s38
    s_add_u32 m0, s32, 0
    s_add_u32 s33, s35, 0
    buffer_load_dwordx4 v1, s[12:15], s33 offen sc1 lds
    s_add_u32 m0, s32, 4096
    s_add_u32 s33, s35, 131072
    buffer_load_dwordx4 v1, s[12:15], s33 offen sc1 lds
    s_add_u32 m0, s32, 8192
    s_add_u32 s33, s35, 262144
    buffer_load_dwordx4 v1, s[12:15], s33 offen sc1 lds
    s_add_u32 s35, s35, 4096
    s_mov_b32 s40, 59392
    s_add_u32 s32, s40, s38
    s_add_u32 m0, s32, 0
    s_add_u32 s33, s35, 0
    buffer_load_dwordx4 v1, s[12:15], s33 offen sc1 lds
    s_add_u32 m0, s32, 4096
    s_add_u32 s33, s35, 131072
    buffer_load_dwordx4 v1, s[12:15], s33 offen sc1 lds
    s_add_u32 m0, s32, 8192
    s_add_u32 s33, s35, 262144
    buffer_load_dwordx4 v1, s[12:15], s33 offen sc1 lds
    s_add_u32 s35, s35, 4096
    s_mov_b32 s40, 89088
    s_add_u32 s32, s40, s38
    s_add_u32 m0, s32, 0
    s_add_u32 s33, s35, 0
    buffer_load_dwordx4 v1, s[12:15], s33 offen sc1 lds
    s_add_u32 m0, s32, 4096
    s_add_u32 s33, s35, 131072
    buffer_load_dwordx4 v1, s[12:15], s33 offen sc1 lds
    s_add_u32 m0, s32, 8192
    s_add_u32 s33, s35, 262144
    buffer_load_dwordx4 v1, s[12:15], s33 offen sc1 lds
    s_add_u32 s35, s35, 4096
Ll_late:
    s_mov_b32 s40, 118784
    s_waitcnt vmcnt(6)
    s_barrier
    s_add_u32 s32, s40, s38
    s_add_u32 m0, s32, 0
    s_add_u32 s33, s35, 0
    buffer_load_dwordx4 v1, s[12:15], s33 offen sc1 lds
    s_add_u32 m0, s32, 4096
    s_add_u32 s33, s35, 131072
    buffer_load_dwordx4 v1, s[12:15], s33 offen sc1 lds
    s_add_u32 m0, s32, 8192
    s_add_u32 s33, s35, 262144
    buffer_load_dwordx4 v1, s[12:15], s33 offen sc1 lds
    s_add_u32 s35, s35, 4096
    s_add_u32 s32, s40, s37
    s_add_u32 m0, s32, 0
    s_add_u32 s33, s34, 0
    buffer_load_dwordx4 v2, s[8:11], s33 offen lds
    s_add_u32 m0, s32, 1088
    s_add_u32 s33, s34, 9216
    buffer_load_dwordx4 v2, s[8:11], s33 offen lds
    s_add_u32 m0, s32, 2176
    s_add_u32 s33, s34, 18432
    buffer_load_dwordx4 v2, s[8:11], s33 offen lds
    s_add_u32 m0, s32, 3264
    s_add_u32 s33, s34, 27648
    buffer_load_dwordx4 v2, s[8:11], s33 offen lds
    s_add_u32 s34, s34, 589824
    s_add_u32 s40, s40, 29696
    s_cmp_eq_u32 s40, 148480
    s_cselect_b32 s40, 0, s40
    s_waitcnt vmcnt(7)
    s_barrier
    s_cmp_lg_u32 s6, 0
    s_cbranch_scc1 Lm1_ns
    s_cmp_lt_u32 s43, 8
    s_cbranch_scc1 Lm1_ns
    s_add_u32 s32, s43, 232
    s_lshl_b32 s32, s32, 7
    v_lshlrev_b32 v10, 11, v8
    v_mov_b32 v9, 1
    s_mov_b64 exec, 0xff
    buffer_atomic_add v9, v10, s[96:99], s32 offen sc1
    s_mov_b64 exec, -1
Lm1_ns:
    s_add_u32 s32, s40, s38
    s_add_u32 m0, s32, 0
    s_add_u32 s33, s35, 0
    buffer_load_dwordx4 v1, s[12:15], s33 offen sc1 lds
    s_add_u32 m0, s32, 4096
    s_add_u32 s33, s35, 131072
    buffer_load_dwordx4 v1, s[12:15], s33 offen sc1 lds
    s_add_u32 m0, s32, 8192
    s_add_u32 s33, s35, 262144
    buffer_load_dwordx4 v1, s[12:15], s33 offen sc1 lds
    s_add_u32 s35, s35, 4096
    s_add_u32 s32, s40, s37
    s_add_u32 m0, s32, 0
    s_add_u32 s33, s34, 0
    buffer_load_dwordx4 v2, s[8:11], s33 offen lds
    s_add_u32 m0, s32, 1088
    s_add_u32 s33, s34, 9216
    buffer_load_dwordx4 v2, s[8:11], s33 offen lds
    s_add_u32 m0, s32, 2176
    s_add_u32 s33, s34, 18432
    buffer_load_dwordx4 v2, s[8:11], s33 offen lds
    s_add_u32 m0, s32, 3264
    s_add_u32 s33, s34, 27648
    buffer_load_dwordx4 v2, s[8:11], s33 offen lds
    s_add_u32 s34, s34, 589824
    s_add_u32 s40, s40, 29696
    s_cmp_eq_u32 s40, 148480
    s_cselect_b32 s40, 0, s40
    s_mov_b32 s41, 8
    v_add_u32 v7, 1024, v7
Lm1_lloop0:
    s_waitcnt vmcnt(14)
    s_barrier
    s_add_u32 s32, s40, s38
    s_add_u32 m0, s32, 0
    s_add_u32 s33, s35, 0
    buffer_load_dwordx4 v1, s[12:15], s33 offen sc1 lds
    s_add_u32 m0, s32, 4096
    s_add_u32 s33, s35, 131072
    buffer_load_dwordx4 v1, s[12:15], s33 offen sc1 lds
    s_add_u32 m0, s32, 8192
    s_add_u32 s33, s35, 262144
    buffer_load_dwordx4 v1, s[12:15], s33 offen sc1 lds
    s_add_u32 s35, s35, 4096
    s_add_u32 s32, s40, s37
    s_add_u32 m0, s32, 0
    s_add_u32 s33, s34, 0
    buffer_load_dwordx4 v2, s[8:11], s33 offen lds
    s_add_u32 m0, s32, 1088
    s_add_u32 s33, s34, 9216
    buffer_load_dwordx4 v2, s[8:11], s33 offen lds
    s_add_u32 m0, s32, 2176
    s_add_u32 s33, s34, 18432
    buffer_load_dwordx4 v2, s[8:11], s33 offen lds
    s_add_u32 m0, s32, 3264
    s_add_u32 s33, s34, 27648
    buffer_load_dwordx4 v2, s[8:11], s33 offen lds
    s_add_u32 s34, s34, 589824
    s_add_u32 s40, s40, 29696
    s_cmp_eq_u32 s40, 148480
    s_cselect_b32 s40, 0, s40
    s_sub_u32 s41, s41, 1
    s_cmp_lg_u32 s41, 0
    s_cbranch_scc1 Lm1_lloop0
    s_cmp_lg_u32 s6, 0
    s_cbranch_scc1 Lm1_nl
    buffer_load_dword v244, v7, s[96:99], 0 offen sc1
Lm1_nl:
    s_waitcnt vmcnt(14)
    s_barrier
    s_add_u32 s32, s40, s38
    s_add_u32 m0, s32, 0
    s_add_u32 s33, s35, 0
    buffer_load_dwordx4 v1, s[12:15], s33 offen sc1 lds
    s_add_u32 m0, s32, 4096
    s_add_u32 s33, s35, 131072
    buffer_load_dwordx4 v1, s[12:15], s33 offen sc1 lds
    s_add_u32 m0, s32, 8192
    s_add_u32 s33, s35, 262144
    buffer_load_dwordx4 v1, s[12:15], s33 offen sc1 lds
    s_add_u32 s35, s35, 4096
    s_add_u32 s32, s40, s37
    s_add_u32 m0, s32, 0
    s_add_u32 s33, s34, 0
    buffer_load_dwordx4 v2, s[8:11], s33 offen lds
    s_add_u32 m0, s32, 1088
    s_add_u32 s33, s34, 9216
    buffer_load_dwordx4 v2, s[8:11], s33 offen lds
    s_add_u32 m0, s32, 2176
    s_add_u32 s33, s34, 18432
    buffer_load_dwordx4 v2, s[8:11], s33 offen lds
    s_add_u32 m0, s32, 3264
    s_add_u32 s33, s34, 27648
    buffer_load_dwordx4 v2, s[8:11], s33 offen lds
    s_add_u32 s34, s34, 589824
    s_add_u32 s40, s40, 29696
    s_cmp_eq_u32 s40, 148480
    s_cselect_b32 s40, 0, s40
    s_waitcnt vmcnt(14)
    s_barrier
    s_add_u32 s32, s40, s38
    s_add_u32 m0, s32, 0
    s_add_u32 s33, s35, 0
    buffer_load_dwordx4 v1, s[12:15], s33 offen sc1 lds
    s_add_u32 m0, s32, 4096
    s_add_u32 s33, s35, 131072
    buffer_load_dwordx4 v1, s[12:15], s33 offen sc1 lds
    s_add_u32 m0, s32, 8192
    s_add_u32 s33, s35, 262144
    buffer_load_dwordx4 v1, s[12:15], s33 offen sc1 lds
    s_add_u32 s35, s35, 4096
    s_add_u32 s32, s40, s37
    s_add_u32 m0, s32, 0
    s_add_u32 s33, s34, 0
    buffer_load_dwordx4 v2, s[8:11], s33 offen lds
    s_add_u32 m0, s32, 1088
    s_add_u32 s33, s34, 9216
    buffer_load_dwordx4 v2, s[8:11], s33 offen lds
    s_add_u32 m0, s32, 2176
    s_add_u32 s33, s34, 18432
    buffer_load_dwordx4 v2, s[8:11], s33 offen lds
    s_add_u32 m0, s32, 3264
    s_add_u32 s33, s34, 27648
    buffer_load_dwordx4 v2, s[8:11], s33 offen lds
    s_add_u32 s34, s34, 589824
    s_add_u32 s40, s40, 29696
    s_cmp_eq_u32 s40, 148480
    s_cselect_b32 s40, 0, s40
    s_cmp_lg_u32 s6, 0
    s_cbranch_scc1 Lm1_np
    s_waitcnt vmcnt(14)
    v_cmp_gt_u32 vcc, 16, v244
    s_nop 1
    s_cbranch_vccz Lm1_np
    s_mov_b32 s100, 0x8000
Lpoll10:
    buffer_load_dword v244, v7, s[96:99], 0 offen sc1
    s_waitcnt vmcnt(0)
    v_cmp_gt_u32 vcc, 16, v244
    s_sub_u32 s100, s100, 1
    s_cbranch_vccz Lpolld10
    s_cmp_eq_u32 s100, 0
    s_cbranch_scc1 Lpolld10
    s_sleep 1
    s_branch Lpoll10
Lpolld10:
Lm1_np:
    s_mov_b32 s41, 16
Lm1_lloop:
    s_waitcnt vmcnt(14)
    s_barrier
    s_add_u32 s32, s40, s38
    s_add_u32 m0, s32, 0
    s_add_u32 s33, s35, 0
    buffer_load_dwordx4 v1, s[12:15], s33 offen sc1 lds
    s_add_u32 m0, s32, 4096
    s_add_u32 s33, s35, 131072
    buffer_load_dwordx4 v1, s[12:15], s33 offen sc1 lds
    s_add_u32 m0, s32, 8192
    s_add_u32 s33, s35, 262144
    buffer_load_dwordx4 v1, s[12:15], s33 offen sc1 lds
    s_add_u32 s35, s35, 4096
    s_add_u32 s32, s40, s37
    s_add_u32 m0, s32, 0
    s_add_u32 s33, s34, 0
    buffer_load_dwordx4 v2, s[8:11], s33 offen lds
    s_add_u32 m0, s32, 1088
    s_add_u32 s33, s34, 9216
    buffer_load_dwordx4 v2, s[8:11], s33 offen lds
    s_add_u32 m0, s32, 2176
    s_add_u32 s33, s34, 18432
    buffer_load_dwordx4 v2, s[8:11], s33 offen lds
    s_add_u32 m0, s32, 3264
    s_add_u32 s33, s34, 27648
    buffer_load_dwordx4 v2, s[8:11], s33 offen lds
    s_add_u32 s34, s34, 589824
    s_add_u32 s40, s40, 29696
    s_cmp_eq_u32 s40, 148480
    s_cselect_b32 s40, 0, s40
    s_sub_u32 s41, s41, 1
    s_cmp_lg_u32 s41, 0
    s_cbranch_scc1 Lm1_lloop
    s_waitcnt vmcnt(14)
    s_barrier
    s_waitcnt vmcnt(7)
    s_barrier
    s_waitcnt vmcnt(0)
    s_barrier
    s_waitcnt vmcnt(0)
    s_barrier
    s_barrier
    s_mul_hi_u32 s32, s28, 0x1c71c71d
    s_mul_i32 s32, s32, 6
    s_add_u32 s32, s32, s29
    s_add_u32 s32, s32, 192
    s_lshl_b32 s63, s32, 7
    s_bfe_u32 s28, s2, 0x20001
    s_and_b32 s29, s2, 1
    s_lshl_b32 s29, s29, 3
    s_lshr_b32 s30, s2, 5
    s_add_u32 s29, s29, s30
    s_bfe_u32 s30, s2, 0x20003
    v_and_b32 v8, 63, v0
    v_lshlrev_b32 v1, 4, v8
    v_lshrrev_b32 v2, 4, v8
    v_lshlrev_b32 v2, 15, v2
    v_and_b32 v9, 15, v8
    v_lshl_add_u32 v2, v9, 4, v2
    s_and_b32 s32, s6, 1
    s_lshl_b32 s32, s32, 14
    s_lshr_b32 s33, s6, 1
    s_lshl_b32 s33, s33, 17
    s_add_u32 s32, s32, s33
    v_add_u32 v2, s32, v2
    s_mov_b32 s8, s60
    s_and_b32 s9, s61, 0xffff
    s_mov_b32 s10, 18874368
    s_mov_b32 s11, 0x20000
    s_add_u32 s12, s4, 76480512
    s_addc_u32 s13, s5, 0
    s_and_b32 s13, s13, 0xffff
    s_mov_b32 s14, 5308416
    s_mov_b32 s15, 0x20000
    s_mul_i32 s34, s28, 4718592
    s_lshl_b32 s32, s29, 8
    s_add_u32 s34, s34, s32
    s_mul_i32 s35, s30, 1327104
    s_mul_i32 s32, s28, 36864
    s_add_u32 s35, s35, s32
    s_mul_i32 s32, s6, 5
    s_add_u32 s32, s32, 0
    s_lshr_b32 s33, s32, 1
    s_mul_i32 s33, s33, 147456
    s_and_b32 s36, s32, 1
    s_lshl_b32 s36, s36, 10
    s_add_u32 s33, s33, s36
    s_add_u32 s33, s33, s35
    s_cmp_lt_u32 s32, 18
    s_cselect_b32 s46, s33, 0x7f000000
    s_mul_i32 s32, s6, 5
    s_add_u32 s32, s32, 1
    s_lshr_b32 s33, s32, 1
    s_mul_i32 s33, s33, 147456
    s_and_b32 s36, s32, 1
    s_lshl_b32 s36, s36, 10
    s_add_u32 s33, s33, s36
    s_add_u32 s33, s33, s35
    s_cmp_lt_u32 s32, 18
    s_cselect_b32 s47, s33, 0x7f000000
    s_mul_i32 s32, s6, 5
    s_add_u32 s32, s32, 2
    s_lshr_b32 s33, s32, 1
    s_mul_i32 s33, s33, 147456
    s_and_b32 s36, s32, 1
    s_lshl_b32 s36, s36, 10
    s_add_u32 s33, s33, s36
    s_add_u32 s33, s33, s35
    s_cmp_lt_u32 s32, 18
    s_cselect_b32 s48, s33, 0x7f000000
    s_mul_i32 s32, s6, 5
    s_add_u32 s32, s32, 3
    s_lshr_b32 s33, s32, 1
    s_mul_i32 s33, s33, 147456
    s_and_b32 s36, s32, 1
    s_lshl_b32 s36, s36, 10
    s_add_u32 s33, s33, s36
    s_add_u32 s33, s33, s35
    s_cmp_lt_u32 s32, 18
    s_cselect_b32 s49, s33, 0x7f000000
    s_mul_i32 s32, s6, 5
    s_add_u32 s32, s32, 4
    s_lshr_b32 s33, s32, 1
    s_mul_i32 s33, s33, 147456
    s_and_b32 s36, s32, 1
    s_lshl_b32 s36, s36, 10
    s_add_u32 s33, s33, s36
    s_add_u32 s33, s33, s35
    s_cmp_lt_u32 s32, 18
    s_cselect_b32 s50, s33, 0x7f000000
    s_mul_i32 s37, s6, 4224
    s_add_u32 s37, s37, 20480
    s_mul_i32 s38, s6, 5120
    s_mul_i32 s32, s28, 6
    s_mul_i32 s33, s30, 3
    s_lshr_b32 s33, s33, 1
    s_add_u32 s32, s32, s33
    s_add_u32 s32, s32, 192
    v_and_b32 v7, 1, v8
    v_add_u32 v7, s32, v7
    v_lshlrev_b32 v7, 7, v7
    s_mov_b32 s40, 0
    s_add_u32 s32, s40, s37
    s_add_u32 m0, s32, 0
    s_add_u32 s33, s34, 0
    buffer_load_dwordx4 v2, s[8:11], s33 offen lds
    s_add_u32 m0, s32, 1056
    s_add_u32 s33, s34, 4096
    buffer_load_dwordx4 v2, s[8:11], s33 offen lds
    s_add_u32 m0, s32, 2112
    s_add_u32 s33, s34, 8192
    buffer_load_dwordx4 v2, s[8:11], s33 offen lds
    s_add_u32 m0, s32, 3168
    s_add_u32 s33, s34, 12288
    buffer_load_dwordx4 v2, s[8:11], s33 offen lds
    s_add_u32 s34, s34, 262144
    s_mov_b32 s40, 37376
    s_add_u32 s32, s40, s37
    s_add_u32 m0, s32, 0
    s_add_u32 s33, s34, 0
    buffer_load_dwordx4 v2, s[8:11], s33 offen lds
    s_add_u32 m0, s32, 1056
    s_add_u32 s33, s34, 4096
    buffer_load_dwordx4 v2, s[8:11], s33 offen lds
    s_add_u32 m0, s32, 2112
    s_add_u32 s33, s34, 8192
    buffer_load_dwordx4 v2, s[8:11], s33 offen lds
    s_add_u32 m0, s32, 3168
    s_add_u32 s33, s34, 12288
    buffer_load_dwordx4 v2, s[8:11], s33 offen lds
    s_add_u32 s34, s34, 262144
    s_mov_b32 s40, 74752
    s_add_u32 s32, s40, s37
    s_add_u32 m0, s32, 0
    s_add_u32 s33, s34, 0
    buffer_load_dwordx4 v2, s[8:11], s33 offen lds
    s_add_u32 m0, s32, 1056
    s_add_u32 s33, s34, 4096
    buffer_load_dwordx4 v2, s[8:11], s33 offen lds
    s_add_u32 m0, s32, 2112
    s_add_u32 s33, s34, 8192
    buffer_load_dwordx4 v2, s[8:11], s33 offen lds
    s_add_u32 m0, s32, 3168
    s_add_u32 s33, s34, 12288
    buffer_load_dwordx4 v2, s[8:11], s33 offen lds
    s_add_u32 s34, s34, 262144
    s_mul_i32 s32, s6, 6144
    s_add_u32 s32, s32, 114688
    v_add_u32 v4, s32, v1
    s_barrier
    ds_read_b128 v[16:19], v4 offset:0
    ds_read_b128 v[20:23], v4 offset:1024
    ds_read_b128 v[24:27], v4 offset:2048
    ds_read_b128 v[28:31], v4 offset:3072
    ds_read_b128 v[32:35], v4 offset:4096
    ds_read_b128 v[36:39], v4 offset:5120
    v_lshlrev_b32 v160, 16, v152
    v_and_b32 v161, 0xffff0000, v152
    v_lshlrev_b32 v162, 16, v153
    v_and_b32 v163, 0xffff0000, v153
    v_lshlrev_b32 v164, 16, v154
    v_and_b32 v165, 0xffff0000, v154
    v_lshlrev_b32 v166, 16, v155
    v_and_b32 v167, 0xffff0000, v155
    v_lshlrev_b32 v168, 16, v156
    v_and_b32 v169, 0xffff0000, v156
    v_lshlrev_b32 v170, 16, v157
    v_and_b32 v171, 0xffff0000, v157
    v_lshlrev_b32 v172, 16, v158
    v_and_b32 v173, 0xffff0000, v158
    v_lshlrev_b32 v174, 16, v159
    v_and_b32 v175, 0xffff0000, v159
    v_mov_b32 v10, 0xc0135761
    v_mov_b32 v11, 0xbdd2d3e8
    s_waitcnt lgkmcnt(4)
    v_add_f32 v16, v16, v168
    v_add_f32 v17, v17, v169
    v_add_f32 v18, v18, v170
    v_add_f32 v19, v19, v171
    v_add_f32 v20, v20, v172
    v_add_f32 v21, v21, v173
    v_add_f32 v22, v22, v174
    v_add_f32 v23, v23, v175
    v_mul_f32 v40, v16, v16
    v_mul_f32 v41, v17, v17
    v_mul_f32 v42, v18, v18
    v_mul_f32 v43, v19, v19
    v_mul_f32 v44, v20, v20
    v_mul_f32 v45, v21, v21
    v_mul_f32 v46, v22, v22
    v_mul_f32 v47, v23, v23
    v_fma_f32 v40, v40, v11, v10
    v_fma_f32 v41, v41, v11, v10
    v_fma_f32 v42, v42, v11, v10
    v_fma_f32 v43, v43, v11, v10
    v_fma_f32 v44, v44, v11, v10
    v_fma_f32 v45, v45, v11, v10
    v_fma_f32 v46, v46, v11, v10
    v_fma_f32 v47, v47, v11, v10
    v_mul_f32 v40, v40, v16
    v_mul_f32 v41, v41, v17
    v_mul_f32 v42, v42, v18
    v_mul_f32 v43, v43, v19
    v_mul_f32 v44, v44, v20
    v_mul_f32 v45, v45, v21
    v_mul_f32 v46, v46, v22
    v_mul_f32 v47, v47, v23
    v_exp_f32 v40, v40
    v_exp_f32 v41, v41
    v_exp_f32 v42, v42
    v_exp_f32 v43, v43
    v_exp_f32 v44, v44
    v_exp_f32 v45, v45
    v_exp_f32 v46, v46
    v_exp_f32 v47, v47
    v_add_f32 v40, 1.0, v40
    v_add_f32 v41, 1.0, v41
    v_add_f32 v42, 1.0, v42
    v_add_f32 v43, 1.0, v43
    v_add_f32 v44, 1.0, v44
    v_add_f32 v45, 1.0, v45
    v_add_f32 v46, 1.0, v46
    v_add_f32 v47, 1.0, v47
    v_rcp_f32 v40, v40
    v_rcp_f32 v41, v41
    v_rcp_f32 v42, v42
    v_rcp_f32 v43, v43
    v_rcp_f32 v44, v44
    v_rcp_f32 v45, v45
    v_rcp_f32 v46, v46
    v_rcp_f32 v47, v47
    v_mul_f32 v16, v16, v40
    v_mul_f32 v17, v17, v41
    v_mul_f32 v18, v18, v42
    v_mul_f32 v19, v19, v43
    v_mul_f32 v20, v20, v44
    v_mul_f32 v21, v21, v45
    v_mul_f32 v22, v22, v46
    v_mul_f32 v23, v23, v47
    v_cvt_pk_bf16_f32 v40, v16, v17
    v_cvt_pk_bf16_f32 v41, v18, v19
    v_cvt_pk_bf16_f32 v42, v20, v21
    v_cvt_pk_bf16_f32 v43, v22, v23
    s_add_u32 s32, s39, 294912
    buffer_store_dwordx4 v[40:43], v6, s[20:23], s32 offen offset:512 sc1
    s_waitcnt lgkmcnt(2)
    v_add_f32 v24, v24, v160
    v_add_f32 v25, v25, v161
    v_add_f32 v26, v26, v162
    v_add_f32 v27, v27, v163
    v_add_f32 v28, v28, v164
    v_add_f32 v29, v29, v165
    v_add_f32 v30, v30, v166
    v_add_f32 v31, v31, v167
    v_mul_f32 v48, v24, v24
    v_mul_f32 v49, v25, v25
    v_mul_f32 v50, v26, v26
    v_mul_f32 v51, v27, v27
    v_mul_f32 v52, v28, v28
    v_mul_f32 v53, v29, v29
    v_mul_f32 v54, v30, v30
    v_mul_f32 v55, v31, v31
    v_fma_f32 v48, v48, v11, v10
    v_fma_f32 v49, v49, v11, v10
    v_fma_f32 v50, v50, v11, v10
    v_fma_f32 v51, v51, v11, v10
    v_fma_f32 v52, v52, v11, v10
    v_fma_f32 v53, v53, v11, v10
    v_fma_f32 v54, v54, v11, v10
    v_fma_f32 v55, v55, v11, v10
    v_mul_f32 v48, v48, v24
    v_mul_f32 v49, v49, v25
    v_mul_f32 v50, v50, v26
    v_mul_f32 v51, v51, v27
    v_mul_f32 v52, v52, v28
    v_mul_f32 v53, v53, v29
    v_mul_f32 v54, v54, v30
    v_mul_f32 v55, v55, v31
    v_exp_f32 v48, v48
    v_exp_f32 v49, v49
    v_exp_f32 v50, v50
    v_exp_f32 v51, v51
    v_exp_f32 v52, v52
    v_exp_f32 v53, v53
    v_exp_f32 v54, v54
    v_exp_f32 v55, v55
    v_add_f32 v48, 1.0, v48
    v_add_f32 v49, 1.0, v49
    v_add_f32 v50, 1.0, v50
    v_add_f32 v51, 1.0, v51
    v_add_f32 v52, 1.0, v52
    v_add_f32 v53, 1.0, v53
    v_add_f32 v54, 1.0, v54
    v_add_f32 v55, 1.0, v55
    v_rcp_f32 v48, v48
    v_rcp_f32 v49, v49
    v_rcp_f32 v50, v50
    v_rcp_f32 v51, v51
    v_rcp_f32 v52, v52
    v_rcp_f32 v53, v53
    v_rcp_f32 v54, v54
    v_rcp_f32 v55, v55
    v_mul_f32 v24, v24, v48
    v_mul_f32 v25, v25, v49
    v_mul_f32 v26, v26, v50
    v_mul_f32 v27, v27, v51
    v_mul_f32 v28, v28, v52
    v_mul_f32 v29, v29, v53
    v_mul_f32 v30, v30, v54
    v_mul_f32 v31, v31, v55
    v_cvt_pk_bf16_f32 v48, v24, v25
    v_cvt_pk_bf16_f32 v49, v26, v27
    v_cvt_pk_bf16_f32 v50, v28, v29
    v_cvt_pk_bf16_f32 v51, v30, v31
    s_add_u32 s32, s39, 589824
    buffer_store_dwordx4 v[48:51], v6, s[20:23], s32 offen offset:0 sc1
    s_waitcnt lgkmcnt(0)
    v_add_f32 v32, v32, v168
    v_add_f32 v33, v33, v169
    v_add_f32 v34, v34, v170
    v_add_f32 v35, v35, v171
    v_add_f32 v36, v36, v172
    v_add_f32 v37, v37, v173
    v_add_f32 v38, v38, v174
    v_add_f32 v39, v39, v175
    v_mul_f32 v56, v32, v32
    v_mul_f32 v57, v33, v33
    v_mul_f32 v58, v34, v34
    v_mul_f32 v59, v35, v35
    v_mul_f32 v60, v36, v36
    v_mul_f32 v61, v37, v37
    v_mul_f32 v62, v38, v38
    v_mul_f32 v63, v39, v39
    v_fma_f32 v56, v56, v11, v10
    v_fma_f32 v57, v57, v11, v10
    v_fma_f32 v58, v58, v11, v10
    v_fma_f32 v59, v59, v11, v10
    v_fma_f32 v60, v60, v11, v10
    v_fma_f32 v61, v61, v11, v10
    v_fma_f32 v62, v62, v11, v10
    v_fma_f32 v63, v63, v11, v10
    v_mul_f32 v56, v56, v32
    v_mul_f32 v57, v57, v33
    v_mul_f32 v58, v58, v34
    v_mul_f32 v59, v59, v35
    v_mul_f32 v60, v60, v36
    v_mul_f32 v61, v61, v37
    v_mul_f32 v62, v62, v38
    v_mul_f32 v63, v63, v39
    v_exp_f32 v56, v56
    v_exp_f32 v57, v57
    v_exp_f32 v58, v58
    v_exp_f32 v59, v59
    v_exp_f32 v60, v60
    v_exp_f32 v61, v61
    v_exp_f32 v62, v62
    v_exp_f32 v63, v63
    v_add_f32 v56, 1.0, v56
    v_add_f32 v57, 1.0, v57
    v_add_f32 v58, 1.0, v58
    v_add_f32 v59, 1.0, v59
    v_add_f32 v60, 1.0, v60
    v_add_f32 v61, 1.0, v61
    v_add_f32 v62, 1.0, v62
    v_add_f32 v63, 1.0, v63
    v_rcp_f32 v56, v56
    v_rcp_f32 v57, v57
    v_rcp_f32 v58, v58
    v_rcp_f32 v59, v59
    v_rcp_f32 v60, v60
    v_rcp_f32 v61, v61
    v_rcp_f32 v62, v62
    v_rcp_f32 v63, v63
    v_mul_f32 v32, v32, v56
    v_mul_f32 v33, v33, v57
    v_mul_f32 v34, v34, v58
    v_mul_f32 v35, v35, v59
    v_mul_f32 v36, v36, v60
    v_mul_f32 v37, v37, v61
    v_mul_f32 v38, v38, v62
    v_mul_f32 v39, v39, v63
    v_cvt_pk_bf16_f32 v56, v32, v33
    v_cvt_pk_bf16_f32 v57, v34, v35
    v_cvt_pk_bf16_f32 v58, v36, v37
    v_cvt_pk_bf16_f32 v59, v38, v39
    s_add_u32 s32, s39, 589824
    buffer_store_dwordx4 v[56:59], v6, s[20:23], s32 offen offset:512 sc1
    s_waitcnt vmcnt(0)
    s_barrier
    s_cmp_lg_u32 s6, 0
    s_cbranch_scc1 Ll_s3
    v_mov_b32 v9, 1
    s_mov_b64 exec, 1
    buffer_atomic_add v9, off, s[96:99], s63 sc1
    s_mov_b64 exec, -1
Ll_s3:
    s_branch Ll_g2
Ll_nom1:
    s_waitcnt vmcnt(0)
    s_barrier
    s_cmp_lg_u32 s6, 0
    s_cbranch_scc1 Ll_nh
    s_add_u32 s32, s43, 232
    s_lshl_b32 s32, s32, 7
    v_lshlrev_b32 v10, 11, v8
    v_mov_b32 v9, 1
    s_mov_b64 exec, 0xff
    buffer_atomic_add v9, v10, s[96:99], s32 offen sc1
    s_mov_b64 exec, -1
Ll_nh:
    s_bfe_u32 s28, s2, 0x20001
    s_and_b32 s29, s2, 1
    s_lshl_b32 s29, s29, 3
    s_lshr_b32 s30, s2, 5
    s_add_u32 s29, s29, s30
    s_bfe_u32 s30, s2, 0x20003
    v_and_b32 v8, 63, v0
    v_lshlrev_b32 v1, 4, v8
    v_lshrrev_b32 v2, 4, v8
    v_lshlrev_b32 v2, 15, v2
    v_and_b32 v9, 15, v8
    v_lshl_add_u32 v2, v9, 4, v2
    s_and_b32 s32, s6, 1
    s_lshl_b32 s32, s32, 14
    s_lshr_b32 s33, s6, 1
    s_lshl_b32 s33, s33, 17
    s_add_u32 s32, s32, s33
    v_add_u32 v2, s32, v2
    s_mov_b32 s8, s60
    s_and_b32 s9, s61, 0xffff
    s_mov_b32 s10, 18874368
    s_mov_b32 s11, 0x20000
    s_add_u32 s12, s4, 76480512
    s_addc_u32 s13, s5, 0
    s_and_b32 s13, s13, 0xffff
    s_mov_b32 s14, 5308416
    s_mov_b32 s15, 0x20000
    s_mul_i32 s34, s28, 4718592
    s_lshl_b32 s32, s29, 8
    s_add_u32 s34, s34, s32
    s_mul_i32 s35, s30, 1327104
    s_mul_i32 s32, s28, 36864
    s_add_u32 s35, s35, s32
    s_mul_i32 s32, s6, 5
    s_add_u32 s32, s32, 0
    s_lshr_b32 s33, s32, 1
    s_mul_i32 s33, s33, 147456
    s_and_b32 s36, s32, 1
    s_lshl_b32 s36, s36, 10
    s_add_u32 s33, s33, s36
    s_add_u32 s33, s33, s35
    s_cmp_lt_u32 s32, 18
    s_cselect_b32 s46, s33, 0x7f000000
    s_mul_i32 s32, s6, 5
    s_add_u32 s32, s32, 1
    s_lshr_b32 s33, s32, 1
    s_mul_i32 s33, s33, 147456
    s_and_b32 s36, s32, 1
    s_lshl_b32 s36, s36, 10
    s_add_u32 s33, s33, s36
    s_add_u32 s33, s33, s35
    s_cmp_lt_u32 s32, 18
    s_cselect_b32 s47, s33, 0x7f000000
    s_mul_i32 s32, s6, 5
    s_add_u32 s32, s32, 2
    s_lshr_b32 s33, s32, 1
    s_mul_i32 s33, s33, 147456
    s_and_b32 s36, s32, 1
    s_lshl_b32 s36, s36, 10
    s_add_u32 s33, s33, s36
    s_add_u32 s33, s33, s35
    s_cmp_lt_u32 s32, 18
    s_cselect_b32 s48, s33, 0x7f000000
    s_mul_i32 s32, s6, 5
    s_add_u32 s32, s32, 3
    s_lshr_b32 s33, s32, 1
    s_mul_i32 s33, s33, 147456
    s_and_b32 s36, s32, 1
    s_lshl_b32 s36, s36, 10
    s_add_u32 s33, s33, s36
    s_add_u32 s33, s33, s35
    s_cmp_lt_u32 s32, 18
    s_cselect_b32 s49, s33, 0x7f000000
    s_mul_i32 s32, s6, 5
    s_add_u32 s32, s32, 4
    s_lshr_b32 s33, s32, 1
    s_mul_i32 s33, s33, 147456
    s_and_b32 s36, s32, 1
    s_lshl_b32 s36, s36, 10
    s_add_u32 s33, s33, s36
    s_add_u32 s33, s33, s35
    s_cmp_lt_u32 s32, 18
    s_cselect_b32 s50, s33, 0x7f000000
    s_mul_i32 s37, s6, 4224
    s_add_u32 s37, s37, 20480
    s_mul_i32 s38, s6, 5120
    s_mul_i32 s32, s28, 6
    s_mul_i32 s33, s30, 3
    s_lshr_b32 s33, s33, 1
    s_add_u32 s32, s32, s33
    s_add_u32 s32, s32, 192
    v_and_b32 v7, 1, v8
    v_add_u32 v7, s32, v7
    v_lshlrev_b32 v7, 7, v7
    s_mov_b32 s40, 0
    s_add_u32 s32, s40, s37
    s_add_u32 m0, s32, 0
    s_add_u32 s33, s34, 0
    buffer_load_dwordx4 v2, s[8:11], s33 offen lds
    s_add_u32 m0, s32, 1056
    s_add_u32 s33, s34, 4096
    buffer_load_dwordx4 v2, s[8:11], s33 offen lds
    s_add_u32 m0, s32, 2112
    s_add_u32 s33, s34, 8192
    buffer_load_dwordx4 v2, s[8:11], s33 offen lds
    s_add_u32 m0, s32, 3168
    s_add_u32 s33, s34, 12288
    buffer_load_dwordx4 v2, s[8:11], s33 offen lds
    s_add_u32 s34, s34, 262144
    s_mov_b32 s40, 37376
    s_add_u32 s32, s40, s37
    s_add_u32 m0, s32, 0
    s_add_u32 s33, s34, 0
    buffer_load_dwordx4 v2, s[8:11], s33 offen lds
    s_add_u32 m0, s32, 1056
    s_add_u32 s33, s34, 4096
    buffer_load_dwordx4 v2, s[8:11], s33 offen lds
    s_add_u32 m0, s32, 2112
    s_add_u32 s33, s34, 8192
    buffer_load_dwordx4 v2, s[8:11], s33 offen lds
    s_add_u32 m0, s32, 3168
    s_add_u32 s33, s34, 12288
    buffer_load_dwordx4 v2, s[8:11], s33 offen lds
    s_add_u32 s34, s34, 262144
    s_mov_b32 s40, 74752
    s_add_u32 s32, s40, s37
    s_add_u32 m0, s32, 0
    s_add_u32 s33, s34, 0
    buffer_load_dwordx4 v2, s[8:11], s33 offen lds
    s_add_u32 m0, s32, 1056
    s_add_u32 s33, s34, 4096
    buffer_load_dwordx4 v2, s[8:11], s33 offen lds
    s_add_u32 m0, s32, 2112
    s_add_u32 s33, s34, 8192
    buffer_load_dwordx4 v2, s[8:11], s33 offen lds
    s_add_u32 m0, s32, 3168
    s_add_u32 s33, s34, 12288
    buffer_load_dwordx4 v2, s[8:11], s33 offen lds
    s_add_u32 s34, s34, 262144
    s_cmp_lg_u32 s6, 0
    s_cbranch_scc1 Ll_g2
    s_mov_b32 s100, 0x2000
Ll_idle:
    s_sleep 32
    buffer_load_dword v244, v7, s[96:99], 0 offen sc1
    s_waitcnt vmcnt(0)
    v_cmp_gt_u32 vcc, 1, v244
    s_sub_u32 s100, s100, 1
    s_cbranch_vccz Ll_g2
    s_cmp_lg_u32 s100, 0
    s_cbranch_scc1 Ll_idle
Ll_g2:
    s_cmp_lg_u32 s6, 0
    s_cbranch_scc1 Lgy_np
    s_mov_b32 s100, 0x8000
Lpoll11:
    buffer_load_dword v244, v7, s[96:99], 0 offen sc1
    s_waitcnt vmcnt(0)
    v_cmp_gt_u32 vcc, 9, v244
    s_sub_u32 s100, s100, 1
    s_cbranch_vccz Lpolld11
    s_cmp_eq_u32 s100, 0
    s_cbranch_scc1 Lpolld11
    s_sleep 1
    s_branch Lpoll11
Lpolld11:
Lgy_np:
    s_barrier
    s_mov_b32 s40, 0
    s_add_u32 s32, s40, s38
    s_add_u32 m0, s32, 0
    s_nop 0
    buffer_load_dwordx4 v1, s[12:15], s46 offen sc1 lds
    s_add_u32 s46, s46, 2048
    s_add_u32 m0, s32, 1024
    s_nop 0
    buffer_load_dwordx4 v1, s[12:15], s47 offen sc1 lds
    s_add_u32 s47, s47, 2048
    s_add_u32 m0, s32, 2048
    s_nop 0
    buffer_load_dwordx4 v1, s[12:15], s48 offen sc1 lds
    s_add_u32 s48, s48, 2048
    s_add_u32 m0, s32, 3072
    s_nop 0
    buffer_load_dwordx4 v1, s[12:15], s49 offen sc1 lds
    s_add_u32 s49, s49, 2048
    s_add_u32 m0, s32, 4096
    s_nop 0
    buffer_load_dwordx4 v1, s[12:15], s50 offen sc1 lds
    s_add_u32 s50, s50, 2048
    s_mov_b32 s40, 37376
    s_add_u32 s32, s40, s38
    s_add_u32 m0, s32, 0
    s_nop 0
    buffer_load_dwordx4 v1, s[12:15], s46 offen sc1 lds
    s_add_u32 s46, s46, 2048
    s_add_u32 m0, s32, 1024
    s_nop 0
    buffer_load_dwordx4 v1, s[12:15], s47 offen sc1 lds
    s_add_u32 s47, s47, 2048
    s_add_u32 m0, s32, 2048
    s_nop 0
    buffer_load_dwordx4 v1, s[12:15], s48 offen sc1 lds
    s_add_u32 s48, s48, 2048
    s_add_u32 m0, s32, 3072
    s_nop 0
    buffer_load_dwordx4 v1, s[12:15], s49 offen sc1 lds
    s_add_u32 s49, s49, 2048
    s_add_u32 m0, s32, 4096
    s_nop 0
    buffer_load_dwordx4 v1, s[12:15], s50 offen sc1 lds
    s_add_u32 s50, s50, 2048
    s_mov_b32 s40, 74752
    s_add_u32 s32, s40, s38
    s_add_u32 m0, s32, 0
    s_nop 0
    buffer_load_dwordx4 v1, s[12:15], s46 offen sc1 lds
    s_add_u32 s46, s46, 2048
    s_add_u32 m0, s32, 1024
    s_nop 0
    buffer_load_dwordx4 v1, s[12:15], s47 offen sc1 lds
    s_add_u32 s47, s47, 2048
    s_add_u32 m0, s32, 2048
    s_nop 0
    buffer_load_dwordx4 v1, s[12:15], s48 offen sc1 lds
    s_add_u32 s48, s48, 2048
    s_add_u32 m0, s32, 3072
    s_nop 0
    buffer_load_dwordx4 v1, s[12:15], s49 offen sc1 lds
    s_add_u32 s49, s49, 2048
    s_add_u32 m0, s32, 4096
    s_nop 0
    buffer_load_dwordx4 v1, s[12:15], s50 offen sc1 lds
    s_add_u32 s50, s50, 2048
    s_mov_b32 s40, 112128
    s_mov_b32 s41, 15
    s_waitcnt vmcnt(5)
    s_branch Lgy_lb
Lgy_lloop:
    s_waitcnt vmcnt(9)
Lgy_lb:
    s_barrier
    s_add_u32 s32, s40, s38
    s_add_u32 m0, s32, 0
    s_nop 0
    buffer_load_dwordx4 v1, s[12:15], s46 offen sc1 lds
    s_add_u32 s46, s46, 2048
    s_add_u32 m0, s32, 1024
    s_nop 0
    buffer_load_dwordx4 v1, s[12:15], s47 offen sc1 lds
    s_add_u32 s47, s47, 2048
    s_add_u32 m0, s32, 2048
    s_nop 0
    buffer_load_dwordx4 v1, s[12:15], s48 offen sc1 lds
    s_add_u32 s48, s48, 2048
    s_add_u32 m0, s32, 3072
    s_nop 0
    buffer_load_dwordx4 v1, s[12:15], s49 offen sc1 lds
    s_add_u32 s49, s49, 2048
    s_add_u32 m0, s32, 4096
    s_nop 0
    buffer_load_dwordx4 v1, s[12:15], s50 offen sc1 lds
    s_add_u32 s50, s50, 2048
    s_add_u32 s32, s40, s37
    s_add_u32 m0, s32, 0
    s_add_u32 s33, s34, 0
    buffer_load_dwordx4 v2, s[8:11], s33 offen lds
    s_add_u32 m0, s32, 1056
    s_add_u32 s33, s34, 4096
    buffer_load_dwordx4 v2, s[8:11], s33 offen lds
    s_add_u32 m0, s32, 2112
    s_add_u32 s33, s34, 8192
    buffer_load_dwordx4 v2, s[8:11], s33 offen lds
    s_add_u32 m0, s32, 3168
    s_add_u32 s33, s34, 12288
    buffer_load_dwordx4 v2, s[8:11], s33 offen lds
    s_add_u32 s34, s34, 262144
    s_add_u32 s40, s40, 37376
    s_cmp_eq_u32 s40, 149504
    s_cselect_b32 s40, 0, s40
    s_sub_u32 s41, s41, 1
    s_cmp_lg_u32 s41, 0
    s_cbranch_scc1 Lgy_lloop
    s_waitcnt vmcnt(9)
    s_barrier
    s_waitcnt vmcnt(0)
    s_barrier
    s_barrier
    s_load_dwordx2 s[46:47], s[0:1], 80
    s_load_dwordx2 s[52:53], s[0:1], 104
    s_bfe_u32 s32, s2, 0x20001
    s_lshl_b32 s32, s32, 2
    s_bfe_u32 s33, s2, 0x20003
    s_add_u32 s32, s32, s33
    s_and_b32 s43, s2, 1
    s_lshl_b32 s43, s43, 3
    s_lshr_b32 s33, s2, 5
    s_add_u32 s43, s43, s33
    s_lshl_b32 s42, s43, 4
    s_add_u32 s42, s42, s32
    s_mul_i32 s44, s42, 9216
    v_mov_b32 v232, v0
    v_add_u32 v233, 512, v0
    v_cmp_gt_u32 vcc, 64, v0
    v_mov_b32 v234, 0x0ffffff0
    s_nop 1
    v_cndmask_b32 v233, v234, v233, vcc
    v_lshlrev_b32 v236, 4, v232
    v_lshlrev_b32 v237, 4, v233
    v_mov_b32 v240, 0x3f80
    v_mov_b32 v241, 0x3f800000
    s_add_u32 s48, s4, 65536
    s_addc_u32 s49, s5, 0
    s_and_b32 s49, s49, 0xffff
    s_mov_b32 s50, 13824
    s_mov_b32 s51, 0x20000
    v_lshlrev_b32 v238, 2, v232
    v_lshlrev_b32 v239, 2, v233
    s_mov_b32 s32, 11520
    buffer_load_dword v208, v238, s[48:51], s32 offen sc1
    buffer_load_dword v209, v239, s[48:51], s32 offen sc1
    s_add_u32 s48, s4, 71761920
    s_addc_u32 s49, s5, 0
    s_and_b32 s49, s49, 0xffff
    s_mov_b32 s50, 2359296
    s_mov_b32 s51, 0x20000
    buffer_load_dwordx4 v[192:195], v236, s[48:51], s44 offen sc1
    buffer_load_dwordx4 v[196:199], v237, s[48:51], s44 offen sc1
    v_lshlrev_b32 v230, 1, v232
    v_lshlrev_b32 v231, 1, v233
    s_waitcnt lgkmcnt(0)
    s_lshl_b32 s32, s42, 4
    s_add_u32 s46, s46, s32
    s_addc_u32 s47, s47, 0
    s_load_dwordx4 s[36:39], s[46:47], 0
    s_mov_b32 s24, s52
    s_and_b32 s25, s53, 0xffff
    s_mov_b32 s26, 2359296
    s_mov_b32 s27, 0x20000
    s_waitcnt lgkmcnt(0)
    s_waitcnt vmcnt(0)
    s_lshl_b32 s48, s36, 16
    s_and_b32 s49, s36, 0xffff0000
    s_lshl_b32 s50, s37, 16
    s_and_b32 s51, s37, 0xffff0000
    s_lshl_b32 s52, s38, 16
    s_and_b32 s53, s38, 0xffff0000
    s_lshl_b32 s54, s39, 16
    s_and_b32 s55, s39, 0xffff0000
    v_lshlrev_b32 v210, 16, v192
    v_and_b32 v211, 0xffff0000, v192
    v_lshlrev_b32 v212, 16, v193
    v_and_b32 v213, 0xffff0000, v193
    v_lshlrev_b32 v214, 16, v194
    v_and_b32 v215, 0xffff0000, v194
    v_lshlrev_b32 v216, 16, v195
    v_and_b32 v217, 0xffff0000, v195
    v_fmac_f32 v210, s48, v208
    v_fmac_f32 v211, s49, v208
    v_fmac_f32 v212, s50, v208
    v_fmac_f32 v213, s51, v208
    v_fmac_f32 v214, s52, v208
    v_fmac_f32 v215, s53, v208
    v_fmac_f32 v216, s54, v208
    v_fmac_f32 v217, s55, v208
    v_lshlrev_b32 v218, 16, v196
    v_and_b32 v219, 0xffff0000, v196
    v_lshlrev_b32 v220, 16, v197
    v_and_b32 v221, 0xffff0000, v197
    v_lshlrev_b32 v222, 16, v198
    v_and_b32 v223, 0xffff0000, v198
    v_lshlrev_b32 v224, 16, v199
    v_and_b32 v225, 0xffff0000, v199
    v_fmac_f32 v218, s48, v209
    v_fmac_f32 v219, s49, v209
    v_fmac_f32 v220, s50, v209
    v_fmac_f32 v221, s51, v209
    v_fmac_f32 v222, s52, v209
    v_fmac_f32 v223, s53, v209
    v_fmac_f32 v224, s54, v209
    v_fmac_f32 v225, s55, v209
    s_barrier
    s_cmp_lg_u32 s6, 0
    s_cbranch_scc1 Ll_np2
    s_add_u32 s32, s43, 216
    s_lshl_b32 s32, s32, 7
    v_mov_b32 v10, s32
    v_mov_b32 v9, 1
    s_mov_b64 exec, 1
    buffer_atomic_add v9, off, s[96:99], s32 sc1
    s_mov_b64 exec, -1
    s_mov_b32 s100, 0x8000
Lpoll12:
    buffer_load_dword v244, v10, s[96:99], 0 offen sc1
    s_waitcnt vmcnt(0)
    v_cmp_gt_u32 vcc, 16, v244
    s_sub_u32 s100, s100, 1
    s_cbranch_vccz Lpolld12
    s_cmp_eq_u32 s100, 0
    s_cbranch_scc1 Lpolld12
    s_sleep 1
    s_branch Lpoll12
Lpolld12:
Ll_np2:
    s_barrier
Lfinal:
    s_add_u32 s48, s4, 81788928
    s_addc_u32 s49, s5, 0
    s_and_b32 s49, s49, 0xffff
    s_mov_b32 s50, 9437184
    s_mov_b32 s51, 0x20000
    s_mov_b32 s32, s44
    buffer_load_dwordx4 v[96:99], v236, s[48:51], s32 offen sc1
    s_add_u32 s32, s32, 2359296
    buffer_load_dwordx4 v[100:103], v236, s[48:51], s32 offen sc1
    s_add_u32 s32, s32, 2359296
    buffer_load_dwordx4 v[104:107], v236, s[48:51], s32 offen sc1
    s_add_u32 s32, s32, 2359296
    buffer_load_dwordx4 v[108:111], v236, s[48:51], s32 offen sc1
    s_cmp_lg_u32 s3, 0
    s_cbranch_scc1 Lfi_spa
    s_mov_b32 s32, s44
    buffer_load_dwordx4 v[128:131], v237, s[48:51], s32 offen sc1
    s_add_u32 s32, s32, 2359296
    buffer_load_dwordx4 v[132:135], v237, s[48:51], s32 offen sc1
    s_add_u32 s32, s32, 2359296
    buffer_load_dwordx4 v[136:139], v237, s[48:51], s32 offen sc1
    s_add_u32 s32, s32, 2359296
    buffer_load_dwordx4 v[140:143], v237, s[48:51], s32 offen sc1
Lfi_spa:
    s_waitcnt vmcnt(0)
    v_lshlrev_b32 v160, 16, v96
    v_and_b32 v161, 0xffff0000, v96
    v_lshlrev_b32 v162, 16, v97
    v_and_b32 v163, 0xffff0000, v97
    v_lshlrev_b32 v164, 16, v98
    v_and_b32 v165, 0xffff0000, v98
    v_lshlrev_b32 v166, 16, v99
    v_and_b32 v167, 0xffff0000, v99
    v_dot2c_f32_bf16 v160, v100, v240
    v_dot2c_f32_bf16 v161, v100, v241
    v_dot2c_f32_bf16 v162, v101, v240
    v_dot2c_f32_bf16 v163, v101, v241
    v_dot2c_f32_bf16 v164, v102, v240
    v_dot2c_f32_bf16 v165, v102, v241
    v_dot2c_f32_bf16 v166, v103, v240
    v_dot2c_f32_bf16 v167, v103, v241
    v_dot2c_f32_bf16 v160, v104, v240
    v_dot2c_f32_bf16 v161, v104, v241
    v_dot2c_f32_bf16 v162, v105, v240
    v_dot2c_f32_bf16 v163, v105, v241
    v_dot2c_f32_bf16 v164, v106, v240
    v_dot2c_f32_bf16 v165, v106, v241
    v_dot2c_f32_bf16 v166, v107, v240
    v_dot2c_f32_bf16 v167, v107, v241
    v_dot2c_f32_bf16 v160, v108, v240
    v_dot2c_f32_bf16 v161, v108, v241
    v_dot2c_f32_bf16 v162, v109, v240
    v_dot2c_f32_bf16 v163, v109, v241
    v_dot2c_f32_bf16 v164, v110, v240
    v_dot2c_f32_bf16 v165, v110, v241
    v_dot2c_f32_bf16 v166, v111, v240
    v_dot2c_f32_bf16 v167, v111, v241
    s_nop 2
    v_fmac_f32 v210, v208, v160
    v_fmac_f32 v211, v208, v161
    v_fmac_f32 v212, v208, v162
    v_fmac_f32 v213, v208, v163
    v_fmac_f32 v214, v208, v164
    v_fmac_f32 v215, v208, v165
    v_fmac_f32 v216, v208, v166
    v_fmac_f32 v217, v208, v167
    v_cvt_pk_bf16_f32 v168, v210, v211
    v_cvt_pk_bf16_f32 v169, v212, v213
    v_cvt_pk_bf16_f32 v170, v214, v215
    v_cvt_pk_bf16_f32 v171, v216, v217
    ds_write_b16 v230, v168 offset:0
    ds_write_b16_d16_hi v230, v168 offset:1152
    ds_write_b16 v230, v169 offset:2304
    ds_write_b16_d16_hi v230, v169 offset:3456
    ds_write_b16 v230, v170 offset:4608
    ds_write_b16_d16_hi v230, v170 offset:5760
    ds_write_b16 v230, v171 offset:6912
    ds_write_b16_d16_hi v230, v171 offset:8064
    s_cmp_lg_u32 s3, 0
    s_cbranch_scc1 Lfi_u1
    v_lshlrev_b32 v160, 16, v128
    v_and_b32 v161, 0xffff0000, v128
    v_lshlrev_b32 v162, 16, v129
    v_and_b32 v163, 0xffff0000, v129
    v_lshlrev_b32 v164, 16, v130
    v_and_b32 v165, 0xffff0000, v130
    v_lshlrev_b32 v166, 16, v131
    v_and_b32 v167, 0xffff0000, v131
    v_dot2c_f32_bf16 v160, v132, v240
    v_dot2c_f32_bf16 v161, v132, v241
    v_dot2c_f32_bf16 v162, v133, v240
    v_dot2c_f32_bf16 v163, v133, v241
    v_dot2c_f32_bf16 v164, v134, v240
    v_dot2c_f32_bf16 v165, v134, v241
    v_dot2c_f32_bf16 v166, v135, v240
    v_dot2c_f32_bf16 v167, v135, v241
    v_dot2c_f32_bf16 v160, v136, v240
    v_dot2c_f32_bf16 v161, v136, v241
    v_dot2c_f32_bf16 v162, v137, v240
    v_dot2c_f32_bf16 v163, v137, v241
    v_dot2c_f32_bf16 v164, v138, v240
    v_dot2c_f32_bf16 v165, v138, v241
    v_dot2c_f32_bf16 v166, v139, v240
    v_dot2c_f32_bf16 v167, v139, v241
    v_dot2c_f32_bf16 v160, v140, v240
    v_dot2c_f32_bf16 v161, v140, v241
    v_dot2c_f32_bf16 v162, v141, v240
    v_dot2c_f32_bf16 v163, v141, v241
    v_dot2c_f32_bf16 v164, v142, v240
    v_dot2c_f32_bf16 v165, v142, v241
    v_dot2c_f32_bf16 v166, v143, v240
    v_dot2c_f32_bf16 v167, v143, v241
    s_nop 2
    v_fmac_f32 v218, v209, v160
    v_fmac_f32 v219, v209, v161
    v_fmac_f32 v220, v209, v162
    v_fmac_f32 v221, v209, v163
    v_fmac_f32 v222, v209, v164
    v_fmac_f32 v223, v209, v165
    v_fmac_f32 v224, v209, v166
    v_fmac_f32 v225, v209, v167
    v_cvt_pk_bf16_f32 v172, v218, v219
    v_cvt_pk_bf16_f32 v173, v220, v221
    v_cvt_pk_bf16_f32 v174, v222, v223
    v_cvt_pk_bf16_f32 v175, v224, v225
    ds_write_b16 v230, v172 offset:1024
    ds_write_b16_d16_hi v230, v172 offset:2176
    ds_write_b16 v230, v173 offset:3328
    ds_write_b16_d16_hi v230, v173 offset:4480
    ds_write_b16 v230, v174 offset:5632
    ds_write_b16_d16_hi v230, v174 offset:6784
    ds_write_b16 v230, v175 offset:7936
    ds_write_b16_d16_hi v230, v175 offset:9088
Lfi_u1:
    s_waitcnt lgkmcnt(0)
    s_barrier
    ds_read_b128 v[96:99], v236
    ds_read_b128 v[100:103], v236 offset:8192
    s_waitcnt lgkmcnt(0)
    buffer_store_dwordx4 v[96:99], v236, s[24:27], s44 offen sc1
    buffer_store_dwordx4 v[100:103], v237, s[24:27], s44 offen sc1
Lend:
    s_endpgm
.section .rodata,"a"
.p2align 6
.amdhsa_kernel adaLN_cond__compressed_kv_cla__mixer_token_mlp__prompt_kernel
  .amdhsa_next_free_vgpr 256
  .amdhsa_next_free_sgpr 102
  .amdhsa_accum_offset 256
  .amdhsa_group_segment_fixed_size 0
  .amdhsa_kernarg_size 128
  .amdhsa_user_sgpr_count 2
  .amdhsa_user_sgpr_kernarg_segment_ptr 1
  .amdhsa_system_sgpr_workgroup_id_x 1
.end_amdhsa_kernel
```
